```python
import torch

def _softmax(x, axis=-1):
    return torch.softmax(x, dim=axis)
def _gelu(x):
    return torch.nn.functional.gelu(x, approximate="tanh")
def _silu(x):
    return torch.nn.functional.silu(x)
def _sigmoid(x):
    return torch.sigmoid(x)
def _layernorm(x, axis=-1, eps=1e-5):
    m = x.mean(dim=axis, keepdim=True)
    v = x.var(dim=axis, keepdim=True, unbiased=False)
    return (x - m) / torch.sqrt(v + eps)
def _scatter_add(tgt, idx, src, axis=0):
    return tgt.clone().index_add_(axis, idx, src)
def _segment_sum(src, seg, n):
    out = torch.zeros((n,) + src.shape[1:], dtype=src.dtype)
    return out.index_add_(0, seg, src)
def _pad(x, pw):
    flat = tuple(v for pair in reversed(pw) for v in pair)
    return torch.nn.functional.pad(x, flat)

kernel_name = 'concat_heads__compressed_kv_cla__ssm_conv_s5__prompt'

def setup_inputs():

    _w = (lambda a: (lambda t: t.to(torch.bfloat16) if t.is_floating_point() else t)(torch.as_tensor(a)))
    def _A_setup():
        B, H, Sq, Sk, D, M = 1, 32, 2048, 2048, 128, 512
        Dc = 4 * D
        return {
            "x": _w((lambda *s: torch.randn(*s, dtype=torch.bfloat16) * 3.2)(B, Sq, M)),
            "c_kv": _w((lambda *s: torch.randn(*s, dtype=torch.bfloat16) * 0.1)(B, Sk, Dc)),
            "w_q": _w((lambda *s: torch.randn(*s, dtype=torch.bfloat16) * 6.4)(M, H, D) * (M ** -0.5)),
            "w_uk": _w((lambda *s: torch.randn(*s, dtype=torch.bfloat16) * 6.4)(Dc, H, D) * (Dc ** -0.5)),
            "w_uv": _w((lambda *s: torch.randn(*s, dtype=torch.bfloat16) * 0.1)(Dc, H, D) * (Dc ** -0.5)),
            "w_o": _w((lambda *s: torch.randn(*s, dtype=torch.bfloat16) * 0.1)(H, D, M) * ((H * D) ** -0.5)),
        }
    _A_in = _A_setup()

    def _B_setup():
        B, S, D = 1, 2048, 512
        P = D
        Lambda_re = -0.5 * (lambda _x: torch.exp(torch.as_tensor(_x)))((lambda *s: torch.randn(*s, dtype=torch.bfloat16) * 0.2)(P))
        Lambda_im = (lambda *s: torch.randn(*s, dtype=torch.bfloat16) * 0.4)(P) * 1.0
        B_re = (lambda *s: torch.randn(*s, dtype=torch.bfloat16) * 0.2)(P, D) * (D ** -0.5)
        B_im = (lambda *s: torch.randn(*s, dtype=torch.bfloat16) * 0.2)(P, D) * (D ** -0.5)
        C_re = (lambda *s: torch.randn(*s, dtype=torch.bfloat16) * 0.2)(D, P) * (P ** -0.5)
        C_im = (lambda *s: torch.randn(*s, dtype=torch.bfloat16) * 0.2)(D, P) * (P ** -0.5)
        log_dt = (lambda *s: torch.randn(*s, dtype=torch.bfloat16) * 0.2)(P) * 0.3 - 2.0
        Dskip = (lambda *s: torch.randn(*s, dtype=torch.bfloat16) * 0.05)(D)
        return {
            "x": _w((lambda *s: torch.randn(*s, dtype=torch.bfloat16) * 0.05)(B, S, D)),
            "Lambda_re": _w(Lambda_re),
            "Lambda_im": _w(Lambda_im),
            "B_re": _w(B_re),
            "B_im": _w(B_im),
            "C_re": _w(C_re),
            "C_im": _w(C_im),
            "log_dt": _w(log_dt),
            "Dskip": _w(Dskip),
        }
    _B_in = _B_setup()

    return {
        "A_x": _A_in["x"],
        "A_c_kv": _A_in["c_kv"],
        "A_w_q": _A_in["w_q"],
        "A_w_uk": _A_in["w_uk"],
        "A_w_uv": _A_in["w_uv"],
        "A_w_o": _A_in["w_o"],
        "B_x": _B_in["x"],
        "B_Lambda_re": _B_in["Lambda_re"],
        "B_Lambda_im": _B_in["Lambda_im"],
        "B_B_re": _B_in["B_re"],
        "B_B_im": _B_in["B_im"],
        "B_C_re": _B_in["C_re"],
        "B_C_im": _B_in["C_im"],
        "B_log_dt": _B_in["log_dt"],
        "B_Dskip": _B_in["Dskip"],
    }

def reference(A_x, A_c_kv, A_w_q, A_w_uk, A_w_uv, A_w_o, B_x, B_Lambda_re, B_Lambda_im, B_B_re, B_B_im, B_C_re, B_C_im, B_log_dt, B_Dskip):
    def _A_ref(x, c_kv, w_q, w_uk, w_uv, w_o):
        B, Sq, M = x.shape[0], x.shape[1], x.shape[2]
        Sk = c_kv.shape[1]
        H, D = w_q.shape[1], w_q.shape[2]
        q = torch.einsum("bqm,mhd->bhqd", x, w_q)
        k = torch.einsum("bkc,chd->bhkd", c_kv, w_uk)
        v = torch.einsum("bkc,chd->bhkd", c_kv, w_uv)
        scores = torch.einsum("bhqd,bhkd->bhqk", q, k) * (D ** -0.5)
        off = Sk - Sq
        qi = torch.arange(Sq)[:, None]
        kj = torch.arange(Sk)[None, :]
        cmask = kj <= (qi + off)
        scores = torch.where(cmask[None, None], scores, -1e9)
        p = _softmax(scores, axis=-1)
        ctx = torch.einsum("bhqk,bhkd->bhqd", p, v)
        return torch.einsum("bhqd,hdm->bqm", ctx, w_o)

    def _B_ref(x, Lambda_re, Lambda_im, B_re, B_im, C_re, C_im, log_dt, Dskip):
        Bsz, L, H = x.shape
        Lam = Lambda_re + 1j * Lambda_im
        Bmat = B_re + 1j * B_im
        Cmat = C_re + 1j * C_im
        dt = torch.exp(log_dt)
        Lam_bar = torch.exp(dt * Lam)
        B_bar = ((Lam_bar - 1.0) / Lam)[:, None] * Bmat
        Bu = torch.einsum("bld,pd->blp", x + 0j, B_bar)
        h = torch.zeros_like(Bu[:, 0, :])
        hs = []
        for t in range(L):
            h = Lam_bar[None, :] * h + Bu[:, t, :]
            hs.append(h)
        hseq = torch.stack(hs, 1)
        y = 2.0 * torch.einsum("blp,dp->bld", hseq, Cmat).real + x * Dskip[None, None, :]
        return y

    a = _A_ref(A_x, A_c_kv, A_w_q, A_w_uk, A_w_uv, A_w_o)
    b = _B_ref(B_x, B_Lambda_re, B_Lambda_im, B_B_re, B_B_im, B_C_re, B_C_im, B_log_dt, B_Dskip)
    return torch.concatenate([a, b], axis=-1)
```

```asm
; @launch kernel=k1_kernel grid=(256,1,1) block=(256,1,1) lds=163840
; @launch kernel=k2_kernel grid=(256,1,1) block=(512,1,1) lds=163840
; @launch kernel=k3_kernel grid=(256,1,1) block=(512,1,1) lds=163840
.amdgcn_target "amdgcn-amd-amdhsa--gfx950"

.text
.globl k1_kernel
.p2align 8
.type k1_kernel,@function
k1_kernel:
  s_cmp_ge_u32 s2, 256
  s_cbranch_scc1 K1_exit
  s_load_dwordx16 s[16:31], s[0:1], 0
  s_load_dwordx16 s[32:47], s[0:1], 64
  s_load_dwordx4 s[48:51], s[0:1], 128
  v_lshrrev_b32 v1, 6, v0
  s_nop 0
  v_readfirstlane_b32 s3, v1
  s_lshr_b32 s4, s2, 5
  s_and_b32 s5, s2, 31
  s_add_u32 s14, s2, s4
  s_and_b32 s14, s14, 7
  s_waitcnt lgkmcnt(0)
  s_cmp_lt_u32 s5, 13
  s_cbranch_scc1 K1_K10
  s_cmp_lt_u32 s5, 26
  s_cbranch_scc1 K1_V10
  s_branch K1_S6
K1_exit:
  s_endpgm
K1_K10:
  v_and_b32 v239, 63, v0
  v_lshlrev_b32 v140, 4, v239
  s_getpc_b64 s[76:77]
K1c_K10:
  s_lshl_b32 s78, s3, 10
  v_add_u32 v142, s78, v140
  v_min_u32 v143, K1e_K10-K1c_K10-16, v142
  global_load_dwordx4 v[144:147], v143, s[76:77]
  v_add_u32 v142, 4096, v142
  v_min_u32 v143, K1e_K10-K1c_K10-16, v142
  global_load_dwordx4 v[144:147], v143, s[76:77]
  v_add_u32 v142, 4096, v142
  v_min_u32 v143, K1e_K10-K1c_K10-16, v142
  global_load_dwordx4 v[144:147], v143, s[76:77]
  v_add_u32 v142, 4096, v142
  v_min_u32 v143, K1e_K10-K1c_K10-16, v142
  global_load_dwordx4 v[144:147], v143, s[76:77]
  v_add_u32 v142, 4096, v142
  v_min_u32 v143, K1e_K10-K1c_K10-16, v142
  global_load_dwordx4 v[144:147], v143, s[76:77]
  v_add_u32 v142, 4096, v142
  v_min_u32 v143, K1e_K10-K1c_K10-16, v142
  global_load_dwordx4 v[144:147], v143, s[76:77]
  v_lshrrev_b32 v224, 3, v239
  v_and_b32 v225, 7, v239
  v_add_u32 v226, 0, v224
  v_bfe_u32 v227, v226, 1, 3
  v_xor_b32 v227, v227, v225
  v_lshlrev_b32 v227, 4, v227
  v_lshl_add_u32 v227, v226, 10, v227
  v_subrev_u32 v250, 0, v227
  v_add_u32 v226, 8, v224
  v_bfe_u32 v227, v226, 1, 3
  v_xor_b32 v227, v227, v225
  v_lshlrev_b32 v227, 4, v227
  v_lshl_add_u32 v227, v226, 10, v227
  v_subrev_u32 v251, 1024, v227
  s_lshl_b32 s6, s4, 18
  s_lshl_b32 s7, s3, 16
  s_add_u32 s100, s6, s7
  s_mul_i32 s101, s3, 16384
  s_add_u32 s101, s101, 81920
  v_and_b32 v234, 15, v239
  v_lshlrev_b32 v224, 7, v234
  v_bfe_u32 v225, v239, 1, 3
  v_lshrrev_b32 v226, 4, v239
  v_xor_b32 v225, v225, v226
  v_lshl_add_u32 v228, v225, 4, v224
  v_add_u32 v252, s101, v228
  v_xor_b32 v253, 64, v252
  s_mov_b32 s56, s22
  s_and_b32 s57, s23, 0xffff
  s_mov_b32 s58, 4194304
  s_mov_b32 s59, 0x00020000
  s_lshl_b32 s9, s3, 12
  s_mov_b32 s52, s18
  s_and_b32 s53, s19, 0xffff
  s_mov_b32 s54, 2097152
  s_mov_b32 s55, 0x00020000
  s_mul_i32 s94, s5, 10
  s_min_u32 s94, s94, 118
  s_and_b32 s7, s3, 1
  s_add_u32 s7, s7, s94
  s_lshl_b32 s10, s7, 6
  s_and_b32 s7, s3, 1
  s_add_u32 s7, s7, s94
  s_add_u32 s7, s7, 2
  s_lshl_b32 s11, s7, 6
  s_and_b32 s7, s3, 1
  s_add_u32 s7, s7, s94
  s_add_u32 s7, s7, 4
  s_lshl_b32 s12, s7, 6
  s_and_b32 s7, s3, 1
  s_add_u32 s7, s7, s94
  s_add_u32 s7, s7, 6
  s_lshl_b32 s13, s7, 6
  s_and_b32 s7, s3, 1
  s_add_u32 s7, s7, s94
  s_add_u32 s7, s7, 8
  s_lshl_b32 s97, s7, 6
  v_mbcnt_lo_u32_b32 v239, -1, 0
  v_mbcnt_hi_u32_b32 v239, -1, v239
  v_lshrrev_b32 v234, 4, v239
  v_lshlrev_b32 v240, 9, v234
  v_bfe_u32 v235, v239, 2, 2
  v_lshl_add_u32 v240, v235, 6, v240
  v_and_b32 v235, 3, v239
  v_lshl_add_u32 v240, v235, 3, v240
  v_and_b32 v234, 1, v234
  v_lshl_add_u32 v240, v234, 5, v240
  v_xor_b32 v241, 32, v240
  v_add_u32 v242, 0x10000, v240
  v_add_u32 v243, 0x10000, v241
  v_lshrrev_b32 v234, 5, v239
  v_lshlrev_b32 v234, 1, v234
  v_xor_b32 v235, v234, v235
  v_lshlrev_b32 v244, 4, v235
  v_lshrrev_b32 v234, 2, v239
  v_lshl_add_u32 v244, v234, 13, v244
  v_add_u32 v245, 130048, v244
  v_add_u32 v246, 260096, v244
  v_add_u32 v247, 390144, v244
  v_lshlrev_b32 v234, 4, v239
  s_lshl_b32 s6, s4, 16
  s_lshl_b32 s7, s3, 14
  s_add_u32 s6, s6, s7
  v_add_u32 v128, s6, v234
  v_add_u32 v129, 4096, v128
  v_add_u32 v130, 8192, v128
  v_add_u32 v131, 12288, v128
  s_lshr_b32 s6, s3, 1
  s_add_u32 s6, s6, s14
  s_add_u32 s6, s6, 0
  s_and_b32 s6, s6, 7
  s_lshl_b32 s6, s6, 19
  s_add_u32 m0, s9, 0
  s_add_u32 s6, s6, s10
  buffer_load_dwordx4 v244, s[56:59], s6 offen offset:0 lds
  buffer_load_dwordx4 v245, s[56:59], s6 offen offset:1024 lds
  buffer_load_dwordx4 v246, s[56:59], s6 offen offset:2048 lds
  buffer_load_dwordx4 v247, s[56:59], s6 offen offset:3072 lds
  s_add_u32 s15, s14, 0
  s_and_b32 s15, s15, 7
  s_lshl_b32 s15, s15, 7
  s_add_u32 s15, s15, s100
  s_add_u32 m0, s101, 0
  s_nop 0
  buffer_load_dwordx4 v250, s[52:55], s15 offen offset:0 lds
  buffer_load_dwordx4 v251, s[52:55], s15 offen offset:1024 lds
  s_add_u32 m0, s101, 2048
  s_add_u32 s15, s15, 16384
  buffer_load_dwordx4 v250, s[52:55], s15 offen offset:0 lds
  buffer_load_dwordx4 v251, s[52:55], s15 offen offset:1024 lds
  s_add_u32 m0, s101, 4096
  s_add_u32 s15, s15, 16384
  buffer_load_dwordx4 v250, s[52:55], s15 offen offset:0 lds
  buffer_load_dwordx4 v251, s[52:55], s15 offen offset:1024 lds
  s_add_u32 m0, s101, 6144
  s_add_u32 s15, s15, 16384
  buffer_load_dwordx4 v250, s[52:55], s15 offen offset:0 lds
  buffer_load_dwordx4 v251, s[52:55], s15 offen offset:1024 lds
  s_add_u32 s15, s14, 1
  s_and_b32 s15, s15, 7
  s_lshl_b32 s15, s15, 7
  s_add_u32 s15, s15, s100
  s_add_u32 m0, s101, 8192
  s_nop 0
  buffer_load_dwordx4 v250, s[52:55], s15 offen offset:0 lds
  buffer_load_dwordx4 v251, s[52:55], s15 offen offset:1024 lds
  s_add_u32 m0, s101, 10240
  s_add_u32 s15, s15, 16384
  buffer_load_dwordx4 v250, s[52:55], s15 offen offset:0 lds
  buffer_load_dwordx4 v251, s[52:55], s15 offen offset:1024 lds
  s_add_u32 m0, s101, 12288
  s_add_u32 s15, s15, 16384
  buffer_load_dwordx4 v250, s[52:55], s15 offen offset:0 lds
  buffer_load_dwordx4 v251, s[52:55], s15 offen offset:1024 lds
  s_add_u32 m0, s101, 14336
  s_add_u32 s15, s15, 16384
  buffer_load_dwordx4 v250, s[52:55], s15 offen offset:0 lds
  buffer_load_dwordx4 v251, s[52:55], s15 offen offset:1024 lds
  s_lshr_b32 s6, s3, 1
  s_add_u32 s6, s6, s14
  s_add_u32 s6, s6, 2
  s_and_b32 s6, s6, 7
  s_lshl_b32 s6, s6, 19
  s_add_u32 m0, s9, 16384
  s_add_u32 s6, s6, s10
  buffer_load_dwordx4 v244, s[56:59], s6 offen offset:0 lds
  buffer_load_dwordx4 v245, s[56:59], s6 offen offset:1024 lds
  buffer_load_dwordx4 v246, s[56:59], s6 offen offset:2048 lds
  buffer_load_dwordx4 v247, s[56:59], s6 offen offset:3072 lds
  s_mov_b32 s64, s50
  s_and_b32 s65, s51, 0xffff
  s_mov_b32 s66, 67108864
  s_mov_b32 s67, 0x00020000
  s_add_u32 s6, s94, 0
  s_lshr_b32 s7, s6, 2
  s_lshl_b32 s7, s7, 19
  s_and_b32 s6, s6, 3
  s_lshl_b32 s6, s6, 10
  s_add_u32 s6, s6, s7
  s_add_u32 s84, s6, 0
  s_add_u32 s6, s94, 1
  s_lshr_b32 s7, s6, 2
  s_lshl_b32 s7, s7, 19
  s_and_b32 s6, s6, 3
  s_lshl_b32 s6, s6, 10
  s_add_u32 s6, s6, s7
  s_add_u32 s85, s6, 0
  s_add_u32 s6, s94, 2
  s_lshr_b32 s7, s6, 2
  s_lshl_b32 s7, s7, 19
  s_and_b32 s6, s6, 3
  s_lshl_b32 s6, s6, 10
  s_add_u32 s6, s6, s7
  s_add_u32 s86, s6, 0
  s_add_u32 s6, s94, 3
  s_lshr_b32 s7, s6, 2
  s_lshl_b32 s7, s7, 19
  s_and_b32 s6, s6, 3
  s_lshl_b32 s6, s6, 10
  s_add_u32 s6, s6, s7
  s_add_u32 s87, s6, 0
  s_add_u32 s6, s94, 4
  s_lshr_b32 s7, s6, 2
  s_lshl_b32 s7, s7, 19
  s_and_b32 s6, s6, 3
  s_lshl_b32 s6, s6, 10
  s_add_u32 s6, s6, s7
  s_add_u32 s88, s6, 0
  s_add_u32 s6, s94, 5
  s_lshr_b32 s7, s6, 2
  s_lshl_b32 s7, s7, 19
  s_and_b32 s6, s6, 3
  s_lshl_b32 s6, s6, 10
  s_add_u32 s6, s6, s7
  s_add_u32 s89, s6, 0
  s_add_u32 s6, s94, 6
  s_lshr_b32 s7, s6, 2
  s_lshl_b32 s7, s7, 19
  s_and_b32 s6, s6, 3
  s_lshl_b32 s6, s6, 10
  s_add_u32 s6, s6, s7
  s_add_u32 s90, s6, 0
  s_add_u32 s6, s94, 7
  s_lshr_b32 s7, s6, 2
  s_lshl_b32 s7, s7, 19
  s_and_b32 s6, s6, 3
  s_lshl_b32 s6, s6, 10
  s_add_u32 s6, s6, s7
  s_add_u32 s91, s6, 0
  s_add_u32 s6, s94, 8
  s_lshr_b32 s7, s6, 2
  s_lshl_b32 s7, s7, 19
  s_and_b32 s6, s6, 3
  s_lshl_b32 s6, s6, 10
  s_add_u32 s6, s6, s7
  s_add_u32 s92, s6, 0
  s_add_u32 s6, s94, 9
  s_lshr_b32 s7, s6, 2
  s_lshl_b32 s7, s7, 19
  s_and_b32 s6, s6, 3
  s_lshl_b32 s6, s6, 10
  s_add_u32 s6, s6, s7
  s_add_u32 s93, s6, 0
  v_mbcnt_lo_u32_b32 v140, -1, 0
  v_mbcnt_hi_u32_b32 v140, -1, v140
  v_lshlrev_b32 v140, 4, v140
  s_waitcnt vmcnt(12)
  ds_read_b128 a[0:3], v252 offset:0
  ds_read_b128 a[4:7], v252 offset:2048
  ds_read_b128 a[8:11], v252 offset:4096
  ds_read_b128 a[12:15], v252 offset:6144
  ds_read_b128 a[16:19], v253 offset:0
  ds_read_b128 a[20:23], v253 offset:2048
  ds_read_b128 a[24:27], v253 offset:4096
  ds_read_b128 a[28:31], v253 offset:6144
  s_barrier
  s_waitcnt lgkmcnt(0)
  s_add_u32 s15, s14, 2
  s_and_b32 s15, s15, 7
  s_lshl_b32 s15, s15, 7
  s_add_u32 s15, s15, s100
  s_add_u32 m0, s101, 0
  s_nop 0
  buffer_load_dwordx4 v250, s[52:55], s15 offen offset:0 lds
  buffer_load_dwordx4 v251, s[52:55], s15 offen offset:1024 lds
  s_add_u32 m0, s101, 2048
  s_add_u32 s15, s15, 16384
  buffer_load_dwordx4 v250, s[52:55], s15 offen offset:0 lds
  buffer_load_dwordx4 v251, s[52:55], s15 offen offset:1024 lds
  s_add_u32 m0, s101, 4096
  s_add_u32 s15, s15, 16384
  buffer_load_dwordx4 v250, s[52:55], s15 offen offset:0 lds
  buffer_load_dwordx4 v251, s[52:55], s15 offen offset:1024 lds
  s_add_u32 m0, s101, 6144
  s_add_u32 s15, s15, 16384
  buffer_load_dwordx4 v250, s[52:55], s15 offen offset:0 lds
  buffer_load_dwordx4 v251, s[52:55], s15 offen offset:1024 lds
  s_waitcnt vmcnt(8)
  s_barrier
  ds_read_b64_tr_b16 v[192:193], v240 offset:0
  ds_read_b64_tr_b16 v[194:195], v240 offset:256
  ds_read_b64_tr_b16 v[196:197], v241 offset:0
  ds_read_b64_tr_b16 v[198:199], v241 offset:256
  ds_read_b64_tr_b16 v[200:201], v240 offset:4096
  ds_read_b64_tr_b16 v[202:203], v240 offset:4352
  ds_read_b64_tr_b16 v[204:205], v241 offset:4096
  ds_read_b64_tr_b16 v[206:207], v241 offset:4352
  ds_read_b64_tr_b16 v[208:209], v240 offset:2048
  ds_read_b64_tr_b16 v[210:211], v240 offset:2304
  ds_read_b64_tr_b16 v[212:213], v241 offset:2048
  ds_read_b64_tr_b16 v[214:215], v241 offset:2304
  ds_read_b64_tr_b16 v[216:217], v240 offset:6144
  ds_read_b64_tr_b16 v[218:219], v240 offset:6400
  ds_read_b64_tr_b16 v[220:221], v241 offset:6144
  ds_read_b64_tr_b16 v[222:223], v241 offset:6400
  s_waitcnt lgkmcnt(14)
  v_mfma_f32_16x16x32_bf16 v[0:3], v[192:195], a[0:3], 0
  v_mfma_f32_16x16x32_bf16 v[4:7], v[192:195], a[4:7], 0
  v_mfma_f32_16x16x32_bf16 v[8:11], v[192:195], a[8:11], 0
  s_lshr_b32 s6, s3, 1
  s_add_u32 s6, s6, s14
  v_mfma_f32_16x16x32_bf16 v[12:15], v[192:195], a[12:15], 0
  ds_read_b64_tr_b16 v[192:193], v240 offset:8192
  ds_read_b64_tr_b16 v[194:195], v240 offset:8448
  s_waitcnt lgkmcnt(14)
  v_mfma_f32_16x16x32_bf16 v[16:19], v[196:199], a[0:3], 0
  s_add_u32 s6, s6, 4
  s_and_b32 s6, s6, 7
  v_mfma_f32_16x16x32_bf16 v[20:23], v[196:199], a[4:7], 0
  s_lshl_b32 s6, s6, 19
  s_add_u32 m0, s9, 32768
  v_mfma_f32_16x16x32_bf16 v[24:27], v[196:199], a[8:11], 0
  s_add_u32 s6, s6, s10
  buffer_load_dwordx4 v244, s[56:59], s6 offen offset:0 lds
  v_mfma_f32_16x16x32_bf16 v[28:31], v[196:199], a[12:15], 0
  ds_read_b64_tr_b16 v[196:197], v241 offset:8192
  ds_read_b64_tr_b16 v[198:199], v241 offset:8448
  s_waitcnt lgkmcnt(14)
  v_mfma_f32_16x16x32_bf16 v[32:35], v[200:203], a[0:3], 0
  buffer_load_dwordx4 v245, s[56:59], s6 offen offset:1024 lds
  buffer_load_dwordx4 v246, s[56:59], s6 offen offset:2048 lds
  v_mfma_f32_16x16x32_bf16 v[36:39], v[200:203], a[4:7], 0
  buffer_load_dwordx4 v247, s[56:59], s6 offen offset:3072 lds
  ds_read_b128 a[32:35], v252 offset:8192
  v_mfma_f32_16x16x32_bf16 v[40:43], v[200:203], a[8:11], 0
  ds_read_b128 a[36:39], v252 offset:10240
  ds_read_b128 a[40:43], v252 offset:12288
  v_mfma_f32_16x16x32_bf16 v[44:47], v[200:203], a[12:15], 0
  ds_read_b64_tr_b16 v[200:201], v240 offset:12288
  ds_read_b64_tr_b16 v[202:203], v240 offset:12544
  s_waitcnt lgkmcnt(15)
  v_mfma_f32_16x16x32_bf16 v[48:51], v[204:207], a[0:3], 0
  ds_read_b128 a[44:47], v252 offset:14336
  ds_read_b128 a[48:51], v253 offset:8192
  v_mfma_f32_16x16x32_bf16 v[52:55], v[204:207], a[4:7], 0
  ds_read_b128 a[52:55], v253 offset:10240
  ds_read_b128 a[56:59], v253 offset:12288
  v_mfma_f32_16x16x32_bf16 v[56:59], v[204:207], a[8:11], 0
  ds_read_b128 a[60:63], v253 offset:14336
  v_mfma_f32_16x16x32_bf16 v[60:63], v[204:207], a[12:15], 0
  ds_read_b64_tr_b16 v[204:205], v241 offset:12288
  ds_read_b64_tr_b16 v[206:207], v241 offset:12544
  s_waitcnt lgkmcnt(15)
  v_mfma_f32_16x16x32_bf16 v[0:3], v[208:211], a[16:19], v[0:3]
  s_waitcnt lgkmcnt(2)
  s_add_u32 s15, s14, 3
  s_and_b32 s15, s15, 7
  v_mfma_f32_16x16x32_bf16 v[4:7], v[208:211], a[20:23], v[4:7]
  s_lshl_b32 s15, s15, 7
  s_add_u32 s15, s15, s100
  v_mfma_f32_16x16x32_bf16 v[8:11], v[208:211], a[24:27], v[8:11]
  s_add_u32 m0, s101, 8192
  s_nop 0
  v_mfma_f32_16x16x32_bf16 v[12:15], v[208:211], a[28:31], v[12:15]
  ds_read_b64_tr_b16 v[208:209], v240 offset:10240
  ds_read_b64_tr_b16 v[210:211], v240 offset:10496
  v_mfma_f32_16x16x32_bf16 v[16:19], v[212:215], a[16:19], v[16:19]
  buffer_load_dwordx4 v250, s[52:55], s15 offen offset:0 lds
  buffer_load_dwordx4 v251, s[52:55], s15 offen offset:1024 lds
  v_mfma_f32_16x16x32_bf16 v[20:23], v[212:215], a[20:23], v[20:23]
  s_add_u32 m0, s101, 10240
  s_add_u32 s15, s15, 16384
  v_mfma_f32_16x16x32_bf16 v[24:27], v[212:215], a[24:27], v[24:27]
  buffer_load_dwordx4 v250, s[52:55], s15 offen offset:0 lds
  buffer_load_dwordx4 v251, s[52:55], s15 offen offset:1024 lds
  v_mfma_f32_16x16x32_bf16 v[28:31], v[212:215], a[28:31], v[28:31]
  ds_read_b64_tr_b16 v[212:213], v241 offset:10240
  ds_read_b64_tr_b16 v[214:215], v241 offset:10496
  v_mfma_f32_16x16x32_bf16 v[32:35], v[216:219], a[16:19], v[32:35]
  s_add_u32 m0, s101, 12288
  s_add_u32 s15, s15, 16384
  v_mfma_f32_16x16x32_bf16 v[36:39], v[216:219], a[20:23], v[36:39]
  buffer_load_dwordx4 v250, s[52:55], s15 offen offset:0 lds
  buffer_load_dwordx4 v251, s[52:55], s15 offen offset:1024 lds
  v_mfma_f32_16x16x32_bf16 v[40:43], v[216:219], a[24:27], v[40:43]
  s_add_u32 m0, s101, 14336
  s_add_u32 s15, s15, 16384
  v_mfma_f32_16x16x32_bf16 v[44:47], v[216:219], a[28:31], v[44:47]
  ds_read_b64_tr_b16 v[216:217], v240 offset:14336
  ds_read_b64_tr_b16 v[218:219], v240 offset:14592
  v_mfma_f32_16x16x32_bf16 v[48:51], v[220:223], a[16:19], v[48:51]
  buffer_load_dwordx4 v250, s[52:55], s15 offen offset:0 lds
  buffer_load_dwordx4 v251, s[52:55], s15 offen offset:1024 lds
  v_mfma_f32_16x16x32_bf16 v[52:55], v[220:223], a[20:23], v[52:55]
  v_mfma_f32_16x16x32_bf16 v[56:59], v[220:223], a[24:27], v[56:59]
  v_mfma_f32_16x16x32_bf16 v[60:63], v[220:223], a[28:31], v[60:63]
  ds_read_b64_tr_b16 v[220:221], v241 offset:14336
  ds_read_b64_tr_b16 v[222:223], v241 offset:14592
  v_mfma_f32_16x16x32_bf16 v[0:3], v[192:195], a[32:35], v[0:3]
  v_mfma_f32_16x16x32_bf16 v[4:7], v[192:195], a[36:39], v[4:7]
  v_mfma_f32_16x16x32_bf16 v[8:11], v[192:195], a[40:43], v[8:11]
  s_lshr_b32 s6, s3, 1
  s_add_u32 s6, s6, s14
  v_mfma_f32_16x16x32_bf16 v[12:15], v[192:195], a[44:47], v[12:15]
  ds_read_b64_tr_b16 v[192:193], v240 offset:16384
  ds_read_b64_tr_b16 v[194:195], v240 offset:16640
  v_mfma_f32_16x16x32_bf16 v[16:19], v[196:199], a[32:35], v[16:19]
  s_add_u32 s6, s6, 6
  s_and_b32 s6, s6, 7
  v_mfma_f32_16x16x32_bf16 v[20:23], v[196:199], a[36:39], v[20:23]
  s_lshl_b32 s6, s6, 19
  s_add_u32 m0, s9, 49152
  v_mfma_f32_16x16x32_bf16 v[24:27], v[196:199], a[40:43], v[24:27]
  s_add_u32 s6, s6, s10
  buffer_load_dwordx4 v244, s[56:59], s6 offen offset:0 lds
  v_mfma_f32_16x16x32_bf16 v[28:31], v[196:199], a[44:47], v[28:31]
  ds_read_b64_tr_b16 v[196:197], v241 offset:16384
  ds_read_b64_tr_b16 v[198:199], v241 offset:16640
  v_mfma_f32_16x16x32_bf16 v[32:35], v[200:203], a[32:35], v[32:35]
  buffer_load_dwordx4 v245, s[56:59], s6 offen offset:1024 lds
  buffer_load_dwordx4 v246, s[56:59], s6 offen offset:2048 lds
  v_mfma_f32_16x16x32_bf16 v[36:39], v[200:203], a[36:39], v[36:39]
  buffer_load_dwordx4 v247, s[56:59], s6 offen offset:3072 lds
  s_waitcnt vmcnt(16)
  ds_read_b128 a[64:67], v252 offset:0
  v_mfma_f32_16x16x32_bf16 v[40:43], v[200:203], a[40:43], v[40:43]
  ds_read_b128 a[68:71], v252 offset:2048
  ds_read_b128 a[72:75], v252 offset:4096
  v_mfma_f32_16x16x32_bf16 v[44:47], v[200:203], a[44:47], v[44:47]
  ds_read_b64_tr_b16 v[200:201], v240 offset:20480
  ds_read_b64_tr_b16 v[202:203], v240 offset:20736
  s_waitcnt lgkmcnt(15)
  v_mfma_f32_16x16x32_bf16 v[48:51], v[204:207], a[32:35], v[48:51]
  ds_read_b128 a[76:79], v252 offset:6144
  ds_read_b128 a[80:83], v253 offset:0
  v_mfma_f32_16x16x32_bf16 v[52:55], v[204:207], a[36:39], v[52:55]
  ds_read_b128 a[84:87], v253 offset:2048
  ds_read_b128 a[88:91], v253 offset:4096
  v_mfma_f32_16x16x32_bf16 v[56:59], v[204:207], a[40:43], v[56:59]
  ds_read_b128 a[92:95], v253 offset:6144
  v_mfma_f32_16x16x32_bf16 v[60:63], v[204:207], a[44:47], v[60:63]
  ds_read_b64_tr_b16 v[204:205], v241 offset:20480
  ds_read_b64_tr_b16 v[206:207], v241 offset:20736
  s_waitcnt lgkmcnt(15)
  v_mfma_f32_16x16x32_bf16 v[0:3], v[208:211], a[48:51], v[0:3]
  s_waitcnt lgkmcnt(2)
  s_add_u32 s15, s14, 4
  s_and_b32 s15, s15, 7
  v_mfma_f32_16x16x32_bf16 v[4:7], v[208:211], a[52:55], v[4:7]
  s_lshl_b32 s15, s15, 7
  s_add_u32 s15, s15, s100
  v_mfma_f32_16x16x32_bf16 v[8:11], v[208:211], a[56:59], v[8:11]
  s_add_u32 m0, s101, 0
  s_nop 0
  v_mfma_f32_16x16x32_bf16 v[12:15], v[208:211], a[60:63], v[12:15]
  ds_read_b64_tr_b16 v[208:209], v240 offset:18432
  ds_read_b64_tr_b16 v[210:211], v240 offset:18688
  v_mfma_f32_16x16x32_bf16 v[16:19], v[212:215], a[48:51], v[16:19]
  buffer_load_dwordx4 v250, s[52:55], s15 offen offset:0 lds
  buffer_load_dwordx4 v251, s[52:55], s15 offen offset:1024 lds
  v_mfma_f32_16x16x32_bf16 v[20:23], v[212:215], a[52:55], v[20:23]
  s_add_u32 m0, s101, 2048
  s_add_u32 s15, s15, 16384
  v_mfma_f32_16x16x32_bf16 v[24:27], v[212:215], a[56:59], v[24:27]
  buffer_load_dwordx4 v250, s[52:55], s15 offen offset:0 lds
  buffer_load_dwordx4 v251, s[52:55], s15 offen offset:1024 lds
  v_mfma_f32_16x16x32_bf16 v[28:31], v[212:215], a[60:63], v[28:31]
  ds_read_b64_tr_b16 v[212:213], v241 offset:18432
  ds_read_b64_tr_b16 v[214:215], v241 offset:18688
  v_mfma_f32_16x16x32_bf16 v[32:35], v[216:219], a[48:51], v[32:35]
  s_add_u32 m0, s101, 4096
  s_add_u32 s15, s15, 16384
  v_mfma_f32_16x16x32_bf16 v[36:39], v[216:219], a[52:55], v[36:39]
  buffer_load_dwordx4 v250, s[52:55], s15 offen offset:0 lds
  buffer_load_dwordx4 v251, s[52:55], s15 offen offset:1024 lds
  v_mfma_f32_16x16x32_bf16 v[40:43], v[216:219], a[56:59], v[40:43]
  s_add_u32 m0, s101, 6144
  s_add_u32 s15, s15, 16384
  v_mfma_f32_16x16x32_bf16 v[44:47], v[216:219], a[60:63], v[44:47]
  ds_read_b64_tr_b16 v[216:217], v240 offset:22528
  ds_read_b64_tr_b16 v[218:219], v240 offset:22784
  v_mfma_f32_16x16x32_bf16 v[48:51], v[220:223], a[48:51], v[48:51]
  buffer_load_dwordx4 v250, s[52:55], s15 offen offset:0 lds
  buffer_load_dwordx4 v251, s[52:55], s15 offen offset:1024 lds
  v_mfma_f32_16x16x32_bf16 v[52:55], v[220:223], a[52:55], v[52:55]
  v_mfma_f32_16x16x32_bf16 v[56:59], v[220:223], a[56:59], v[56:59]
  v_mfma_f32_16x16x32_bf16 v[60:63], v[220:223], a[60:63], v[60:63]
  ds_read_b64_tr_b16 v[220:221], v241 offset:22528
  ds_read_b64_tr_b16 v[222:223], v241 offset:22784
  s_waitcnt vmcnt(20)
  s_barrier
  v_mfma_f32_16x16x32_bf16 v[0:3], v[192:195], a[64:67], v[0:3]
  v_mfma_f32_16x16x32_bf16 v[4:7], v[192:195], a[68:71], v[4:7]
  v_mfma_f32_16x16x32_bf16 v[8:11], v[192:195], a[72:75], v[8:11]
  s_lshr_b32 s6, s3, 1
  s_add_u32 s6, s6, s14
  v_mfma_f32_16x16x32_bf16 v[12:15], v[192:195], a[76:79], v[12:15]
  ds_read_b64_tr_b16 v[192:193], v240 offset:24576
  ds_read_b64_tr_b16 v[194:195], v240 offset:24832
  v_mfma_f32_16x16x32_bf16 v[16:19], v[196:199], a[64:67], v[16:19]
  s_add_u32 s6, s6, 0
  s_and_b32 s6, s6, 7
  v_mfma_f32_16x16x32_bf16 v[20:23], v[196:199], a[68:71], v[20:23]
  s_lshl_b32 s6, s6, 19
  s_add_u32 m0, s9, 65536
  v_mfma_f32_16x16x32_bf16 v[24:27], v[196:199], a[72:75], v[24:27]
  s_add_u32 s6, s6, s11
  buffer_load_dwordx4 v244, s[56:59], s6 offen offset:0 lds
  v_mfma_f32_16x16x32_bf16 v[28:31], v[196:199], a[76:79], v[28:31]
  ds_read_b64_tr_b16 v[196:197], v241 offset:24576
  ds_read_b64_tr_b16 v[198:199], v241 offset:24832
  v_mfma_f32_16x16x32_bf16 v[32:35], v[200:203], a[64:67], v[32:35]
  buffer_load_dwordx4 v245, s[56:59], s6 offen offset:1024 lds
  buffer_load_dwordx4 v246, s[56:59], s6 offen offset:2048 lds
  v_mfma_f32_16x16x32_bf16 v[36:39], v[200:203], a[68:71], v[36:39]
  buffer_load_dwordx4 v247, s[56:59], s6 offen offset:3072 lds
  s_waitcnt vmcnt(16)
  ds_read_b128 a[96:99], v252 offset:8192
  v_mfma_f32_16x16x32_bf16 v[40:43], v[200:203], a[72:75], v[40:43]
  ds_read_b128 a[100:103], v252 offset:10240
  ds_read_b128 a[104:107], v252 offset:12288
  v_mfma_f32_16x16x32_bf16 v[44:47], v[200:203], a[76:79], v[44:47]
  ds_read_b64_tr_b16 v[200:201], v240 offset:28672
  ds_read_b64_tr_b16 v[202:203], v240 offset:28928
  s_waitcnt lgkmcnt(15)
  v_mfma_f32_16x16x32_bf16 v[48:51], v[204:207], a[64:67], v[48:51]
  ds_read_b128 a[108:111], v252 offset:14336
  ds_read_b128 a[112:115], v253 offset:8192
  v_mfma_f32_16x16x32_bf16 v[52:55], v[204:207], a[68:71], v[52:55]
  ds_read_b128 a[116:119], v253 offset:10240
  ds_read_b128 a[120:123], v253 offset:12288
  v_mfma_f32_16x16x32_bf16 v[56:59], v[204:207], a[72:75], v[56:59]
  ds_read_b128 a[124:127], v253 offset:14336
  v_mfma_f32_16x16x32_bf16 v[60:63], v[204:207], a[76:79], v[60:63]
  ds_read_b64_tr_b16 v[204:205], v241 offset:28672
  ds_read_b64_tr_b16 v[206:207], v241 offset:28928
  s_waitcnt lgkmcnt(15)
  v_mfma_f32_16x16x32_bf16 v[0:3], v[208:211], a[80:83], v[0:3]
  s_waitcnt lgkmcnt(2)
  s_add_u32 s15, s14, 5
  s_and_b32 s15, s15, 7
  v_mfma_f32_16x16x32_bf16 v[4:7], v[208:211], a[84:87], v[4:7]
  s_lshl_b32 s15, s15, 7
  s_add_u32 s15, s15, s100
  v_mfma_f32_16x16x32_bf16 v[8:11], v[208:211], a[88:91], v[8:11]
  s_add_u32 m0, s101, 8192
  s_nop 0
  v_mfma_f32_16x16x32_bf16 v[12:15], v[208:211], a[92:95], v[12:15]
  ds_read_b64_tr_b16 v[208:209], v240 offset:26624
  ds_read_b64_tr_b16 v[210:211], v240 offset:26880
  v_mfma_f32_16x16x32_bf16 v[16:19], v[212:215], a[80:83], v[16:19]
  buffer_load_dwordx4 v250, s[52:55], s15 offen offset:0 lds
  buffer_load_dwordx4 v251, s[52:55], s15 offen offset:1024 lds
  v_mfma_f32_16x16x32_bf16 v[20:23], v[212:215], a[84:87], v[20:23]
  s_add_u32 m0, s101, 10240
  s_add_u32 s15, s15, 16384
  v_mfma_f32_16x16x32_bf16 v[24:27], v[212:215], a[88:91], v[24:27]
  buffer_load_dwordx4 v250, s[52:55], s15 offen offset:0 lds
  buffer_load_dwordx4 v251, s[52:55], s15 offen offset:1024 lds
  v_mfma_f32_16x16x32_bf16 v[28:31], v[212:215], a[92:95], v[28:31]
  ds_read_b64_tr_b16 v[212:213], v241 offset:26624
  ds_read_b64_tr_b16 v[214:215], v241 offset:26880
  v_mfma_f32_16x16x32_bf16 v[32:35], v[216:219], a[80:83], v[32:35]
  s_add_u32 m0, s101, 12288
  s_add_u32 s15, s15, 16384
  v_mfma_f32_16x16x32_bf16 v[36:39], v[216:219], a[84:87], v[36:39]
  buffer_load_dwordx4 v250, s[52:55], s15 offen offset:0 lds
  buffer_load_dwordx4 v251, s[52:55], s15 offen offset:1024 lds
  v_mfma_f32_16x16x32_bf16 v[40:43], v[216:219], a[88:91], v[40:43]
  s_add_u32 m0, s101, 14336
  s_add_u32 s15, s15, 16384
  v_mfma_f32_16x16x32_bf16 v[44:47], v[216:219], a[92:95], v[44:47]
  ds_read_b64_tr_b16 v[216:217], v240 offset:30720
  ds_read_b64_tr_b16 v[218:219], v240 offset:30976
  v_mfma_f32_16x16x32_bf16 v[48:51], v[220:223], a[80:83], v[48:51]
  buffer_load_dwordx4 v250, s[52:55], s15 offen offset:0 lds
  buffer_load_dwordx4 v251, s[52:55], s15 offen offset:1024 lds
  v_mfma_f32_16x16x32_bf16 v[52:55], v[220:223], a[84:87], v[52:55]
  v_mfma_f32_16x16x32_bf16 v[56:59], v[220:223], a[88:91], v[56:59]
  v_mfma_f32_16x16x32_bf16 v[60:63], v[220:223], a[92:95], v[60:63]
  ds_read_b64_tr_b16 v[220:221], v241 offset:30720
  ds_read_b64_tr_b16 v[222:223], v241 offset:30976
  v_mfma_f32_16x16x32_bf16 v[0:3], v[192:195], a[96:99], v[0:3]
  v_mfma_f32_16x16x32_bf16 v[4:7], v[192:195], a[100:103], v[4:7]
  v_mfma_f32_16x16x32_bf16 v[8:11], v[192:195], a[104:107], v[8:11]
  s_lshr_b32 s6, s3, 1
  s_add_u32 s6, s6, s14
  v_mfma_f32_16x16x32_bf16 v[12:15], v[192:195], a[108:111], v[12:15]
  ds_read_b64_tr_b16 v[192:193], v240 offset:32768
  ds_read_b64_tr_b16 v[194:195], v240 offset:33024
  v_mfma_f32_16x16x32_bf16 v[16:19], v[196:199], a[96:99], v[16:19]
  s_add_u32 s6, s6, 2
  s_and_b32 s6, s6, 7
  v_mfma_f32_16x16x32_bf16 v[20:23], v[196:199], a[100:103], v[20:23]
  s_lshl_b32 s6, s6, 19
  s_add_u32 m0, s9, 0
  v_mfma_f32_16x16x32_bf16 v[24:27], v[196:199], a[104:107], v[24:27]
  s_add_u32 s6, s6, s11
  buffer_load_dwordx4 v244, s[56:59], s6 offen offset:0 lds
  v_mfma_f32_16x16x32_bf16 v[28:31], v[196:199], a[108:111], v[28:31]
  ds_read_b64_tr_b16 v[196:197], v241 offset:32768
  ds_read_b64_tr_b16 v[198:199], v241 offset:33024
  v_mfma_f32_16x16x32_bf16 v[32:35], v[200:203], a[96:99], v[32:35]
  buffer_load_dwordx4 v245, s[56:59], s6 offen offset:1024 lds
  buffer_load_dwordx4 v246, s[56:59], s6 offen offset:2048 lds
  v_mfma_f32_16x16x32_bf16 v[36:39], v[200:203], a[100:103], v[36:39]
  buffer_load_dwordx4 v247, s[56:59], s6 offen offset:3072 lds
  s_waitcnt vmcnt(16)
  ds_read_b128 a[128:131], v252 offset:0
  v_mfma_f32_16x16x32_bf16 v[40:43], v[200:203], a[104:107], v[40:43]
  ds_read_b128 a[132:135], v252 offset:2048
  ds_read_b128 a[136:139], v252 offset:4096
  v_mfma_f32_16x16x32_bf16 v[44:47], v[200:203], a[108:111], v[44:47]
  ds_read_b64_tr_b16 v[200:201], v240 offset:36864
  ds_read_b64_tr_b16 v[202:203], v240 offset:37120
  s_waitcnt lgkmcnt(15)
  v_mfma_f32_16x16x32_bf16 v[48:51], v[204:207], a[96:99], v[48:51]
  ds_read_b128 a[140:143], v252 offset:6144
  ds_read_b128 a[144:147], v253 offset:0
  v_mfma_f32_16x16x32_bf16 v[52:55], v[204:207], a[100:103], v[52:55]
  ds_read_b128 a[148:151], v253 offset:2048
  ds_read_b128 a[152:155], v253 offset:4096
  v_mfma_f32_16x16x32_bf16 v[56:59], v[204:207], a[104:107], v[56:59]
  ds_read_b128 a[156:159], v253 offset:6144
  v_mfma_f32_16x16x32_bf16 v[60:63], v[204:207], a[108:111], v[60:63]
  ds_read_b64_tr_b16 v[204:205], v241 offset:36864
  ds_read_b64_tr_b16 v[206:207], v241 offset:37120
  s_waitcnt lgkmcnt(15)
  v_mfma_f32_16x16x32_bf16 v[0:3], v[208:211], a[112:115], v[0:3]
  s_waitcnt lgkmcnt(2)
  s_add_u32 s15, s14, 6
  s_and_b32 s15, s15, 7
  v_mfma_f32_16x16x32_bf16 v[4:7], v[208:211], a[116:119], v[4:7]
  s_lshl_b32 s15, s15, 7
  s_add_u32 s15, s15, s100
  v_mfma_f32_16x16x32_bf16 v[8:11], v[208:211], a[120:123], v[8:11]
  s_add_u32 m0, s101, 0
  s_nop 0
  v_mfma_f32_16x16x32_bf16 v[12:15], v[208:211], a[124:127], v[12:15]
  ds_read_b64_tr_b16 v[208:209], v240 offset:34816
  ds_read_b64_tr_b16 v[210:211], v240 offset:35072
  v_mfma_f32_16x16x32_bf16 v[16:19], v[212:215], a[112:115], v[16:19]
  buffer_load_dwordx4 v250, s[52:55], s15 offen offset:0 lds
  buffer_load_dwordx4 v251, s[52:55], s15 offen offset:1024 lds
  v_mfma_f32_16x16x32_bf16 v[20:23], v[212:215], a[116:119], v[20:23]
  s_add_u32 m0, s101, 2048
  s_add_u32 s15, s15, 16384
  v_mfma_f32_16x16x32_bf16 v[24:27], v[212:215], a[120:123], v[24:27]
  buffer_load_dwordx4 v250, s[52:55], s15 offen offset:0 lds
  buffer_load_dwordx4 v251, s[52:55], s15 offen offset:1024 lds
  v_mfma_f32_16x16x32_bf16 v[28:31], v[212:215], a[124:127], v[28:31]
  ds_read_b64_tr_b16 v[212:213], v241 offset:34816
  ds_read_b64_tr_b16 v[214:215], v241 offset:35072
  v_mfma_f32_16x16x32_bf16 v[32:35], v[216:219], a[112:115], v[32:35]
  s_add_u32 m0, s101, 4096
  s_add_u32 s15, s15, 16384
  v_mfma_f32_16x16x32_bf16 v[36:39], v[216:219], a[116:119], v[36:39]
  buffer_load_dwordx4 v250, s[52:55], s15 offen offset:0 lds
  buffer_load_dwordx4 v251, s[52:55], s15 offen offset:1024 lds
  v_mfma_f32_16x16x32_bf16 v[40:43], v[216:219], a[120:123], v[40:43]
  s_add_u32 m0, s101, 6144
  s_add_u32 s15, s15, 16384
  v_mfma_f32_16x16x32_bf16 v[44:47], v[216:219], a[124:127], v[44:47]
  ds_read_b64_tr_b16 v[216:217], v240 offset:38912
  ds_read_b64_tr_b16 v[218:219], v240 offset:39168
  v_mfma_f32_16x16x32_bf16 v[48:51], v[220:223], a[112:115], v[48:51]
  buffer_load_dwordx4 v250, s[52:55], s15 offen offset:0 lds
  buffer_load_dwordx4 v251, s[52:55], s15 offen offset:1024 lds
  v_mfma_f32_16x16x32_bf16 v[52:55], v[220:223], a[116:119], v[52:55]
  v_mfma_f32_16x16x32_bf16 v[56:59], v[220:223], a[120:123], v[56:59]
  v_mfma_f32_16x16x32_bf16 v[60:63], v[220:223], a[124:127], v[60:63]
  ds_read_b64_tr_b16 v[220:221], v241 offset:38912
  ds_read_b64_tr_b16 v[222:223], v241 offset:39168
  s_barrier
  v_mfma_f32_16x16x32_bf16 v[0:3], v[192:195], a[128:131], v[0:3]
  v_mfma_f32_16x16x32_bf16 v[4:7], v[192:195], a[132:135], v[4:7]
  v_mfma_f32_16x16x32_bf16 v[8:11], v[192:195], a[136:139], v[8:11]
  s_lshr_b32 s6, s3, 1
  s_add_u32 s6, s6, s14
  v_mfma_f32_16x16x32_bf16 v[12:15], v[192:195], a[140:143], v[12:15]
  ds_read_b64_tr_b16 v[192:193], v240 offset:40960
  ds_read_b64_tr_b16 v[194:195], v240 offset:41216
  v_mfma_f32_16x16x32_bf16 v[16:19], v[196:199], a[128:131], v[16:19]
  s_add_u32 s6, s6, 4
  s_and_b32 s6, s6, 7
  v_mfma_f32_16x16x32_bf16 v[20:23], v[196:199], a[132:135], v[20:23]
  s_lshl_b32 s6, s6, 19
  s_add_u32 m0, s9, 16384
  v_mfma_f32_16x16x32_bf16 v[24:27], v[196:199], a[136:139], v[24:27]
  s_add_u32 s6, s6, s11
  buffer_load_dwordx4 v244, s[56:59], s6 offen offset:0 lds
  v_mfma_f32_16x16x32_bf16 v[28:31], v[196:199], a[140:143], v[28:31]
  ds_read_b64_tr_b16 v[196:197], v241 offset:40960
  ds_read_b64_tr_b16 v[198:199], v241 offset:41216
  v_mfma_f32_16x16x32_bf16 v[32:35], v[200:203], a[128:131], v[32:35]
  buffer_load_dwordx4 v245, s[56:59], s6 offen offset:1024 lds
  buffer_load_dwordx4 v246, s[56:59], s6 offen offset:2048 lds
  v_mfma_f32_16x16x32_bf16 v[36:39], v[200:203], a[132:135], v[36:39]
  buffer_load_dwordx4 v247, s[56:59], s6 offen offset:3072 lds
  s_waitcnt vmcnt(16)
  ds_read_b128 a[160:163], v252 offset:8192
  v_mfma_f32_16x16x32_bf16 v[40:43], v[200:203], a[136:139], v[40:43]
  ds_read_b128 a[164:167], v252 offset:10240
  ds_read_b128 a[168:171], v252 offset:12288
  v_mfma_f32_16x16x32_bf16 v[44:47], v[200:203], a[140:143], v[44:47]
  ds_read_b64_tr_b16 v[200:201], v240 offset:45056
  ds_read_b64_tr_b16 v[202:203], v240 offset:45312
  s_waitcnt lgkmcnt(15)
  v_mfma_f32_16x16x32_bf16 v[48:51], v[204:207], a[128:131], v[48:51]
  ds_read_b128 a[172:175], v252 offset:14336
  ds_read_b128 a[176:179], v253 offset:8192
  v_mfma_f32_16x16x32_bf16 v[52:55], v[204:207], a[132:135], v[52:55]
  ds_read_b128 a[180:183], v253 offset:10240
  ds_read_b128 a[184:187], v253 offset:12288
  v_mfma_f32_16x16x32_bf16 v[56:59], v[204:207], a[136:139], v[56:59]
  ds_read_b128 a[188:191], v253 offset:14336
  v_mfma_f32_16x16x32_bf16 v[60:63], v[204:207], a[140:143], v[60:63]
  ds_read_b64_tr_b16 v[204:205], v241 offset:45056
  ds_read_b64_tr_b16 v[206:207], v241 offset:45312
  s_waitcnt lgkmcnt(15)
  v_mfma_f32_16x16x32_bf16 v[0:3], v[208:211], a[144:147], v[0:3]
  s_waitcnt lgkmcnt(2)
  s_add_u32 s15, s14, 7
  s_and_b32 s15, s15, 7
  v_mfma_f32_16x16x32_bf16 v[4:7], v[208:211], a[148:151], v[4:7]
  s_lshl_b32 s15, s15, 7
  s_add_u32 s15, s15, s100
  v_mfma_f32_16x16x32_bf16 v[8:11], v[208:211], a[152:155], v[8:11]
  s_add_u32 m0, s101, 8192
  s_nop 0
  v_mfma_f32_16x16x32_bf16 v[12:15], v[208:211], a[156:159], v[12:15]
  ds_read_b64_tr_b16 v[208:209], v240 offset:43008
  ds_read_b64_tr_b16 v[210:211], v240 offset:43264
  v_mfma_f32_16x16x32_bf16 v[16:19], v[212:215], a[144:147], v[16:19]
  buffer_load_dwordx4 v250, s[52:55], s15 offen offset:0 lds
  buffer_load_dwordx4 v251, s[52:55], s15 offen offset:1024 lds
  v_mfma_f32_16x16x32_bf16 v[20:23], v[212:215], a[148:151], v[20:23]
  s_add_u32 m0, s101, 10240
  s_add_u32 s15, s15, 16384
  v_mfma_f32_16x16x32_bf16 v[24:27], v[212:215], a[152:155], v[24:27]
  buffer_load_dwordx4 v250, s[52:55], s15 offen offset:0 lds
  buffer_load_dwordx4 v251, s[52:55], s15 offen offset:1024 lds
  v_mfma_f32_16x16x32_bf16 v[28:31], v[212:215], a[156:159], v[28:31]
  ds_read_b64_tr_b16 v[212:213], v241 offset:43008
  ds_read_b64_tr_b16 v[214:215], v241 offset:43264
  v_mfma_f32_16x16x32_bf16 v[32:35], v[216:219], a[144:147], v[32:35]
  s_add_u32 m0, s101, 12288
  s_add_u32 s15, s15, 16384
  v_mfma_f32_16x16x32_bf16 v[36:39], v[216:219], a[148:151], v[36:39]
  buffer_load_dwordx4 v250, s[52:55], s15 offen offset:0 lds
  buffer_load_dwordx4 v251, s[52:55], s15 offen offset:1024 lds
  v_mfma_f32_16x16x32_bf16 v[40:43], v[216:219], a[152:155], v[40:43]
  s_add_u32 m0, s101, 14336
  s_add_u32 s15, s15, 16384
  v_mfma_f32_16x16x32_bf16 v[44:47], v[216:219], a[156:159], v[44:47]
  ds_read_b64_tr_b16 v[216:217], v240 offset:47104
  ds_read_b64_tr_b16 v[218:219], v240 offset:47360
  v_mfma_f32_16x16x32_bf16 v[48:51], v[220:223], a[144:147], v[48:51]
  buffer_load_dwordx4 v250, s[52:55], s15 offen offset:0 lds
  buffer_load_dwordx4 v251, s[52:55], s15 offen offset:1024 lds
  v_mfma_f32_16x16x32_bf16 v[52:55], v[220:223], a[148:151], v[52:55]
  v_mfma_f32_16x16x32_bf16 v[56:59], v[220:223], a[152:155], v[56:59]
  v_mfma_f32_16x16x32_bf16 v[60:63], v[220:223], a[156:159], v[60:63]
  ds_read_b64_tr_b16 v[220:221], v241 offset:47104
  ds_read_b64_tr_b16 v[222:223], v241 offset:47360
  v_mfma_f32_16x16x32_bf16 v[0:3], v[192:195], a[160:163], v[0:3]
  v_mfma_f32_16x16x32_bf16 v[4:7], v[192:195], a[164:167], v[4:7]
  v_mfma_f32_16x16x32_bf16 v[8:11], v[192:195], a[168:171], v[8:11]
  v_mfma_f32_16x16x32_bf16 v[12:15], v[192:195], a[172:175], v[12:15]
  ds_read_b64_tr_b16 v[192:193], v240 offset:49152
  ds_read_b64_tr_b16 v[194:195], v240 offset:49408
  v_mfma_f32_16x16x32_bf16 v[16:19], v[196:199], a[160:163], v[16:19]
  s_waitcnt vmcnt(12)
  ds_read_b128 a[192:195], v252 offset:0
  ds_read_b128 a[196:199], v252 offset:2048
  v_mfma_f32_16x16x32_bf16 v[20:23], v[196:199], a[164:167], v[20:23]
  ds_read_b128 a[200:203], v252 offset:4096
  ds_read_b128 a[204:207], v252 offset:6144
  v_mfma_f32_16x16x32_bf16 v[24:27], v[196:199], a[168:171], v[24:27]
  ds_read_b128 a[208:211], v253 offset:0
  ds_read_b128 a[212:215], v253 offset:2048
  v_mfma_f32_16x16x32_bf16 v[28:31], v[196:199], a[172:175], v[28:31]
  ds_read_b64_tr_b16 v[196:197], v241 offset:49152
  ds_read_b64_tr_b16 v[198:199], v241 offset:49408
  v_mfma_f32_16x16x32_bf16 v[32:35], v[200:203], a[160:163], v[32:35]
  ds_read_b128 a[216:219], v253 offset:4096
  ds_read_b128 a[220:223], v253 offset:6144
  v_mfma_f32_16x16x32_bf16 v[36:39], v[200:203], a[164:167], v[36:39]
  v_mfma_f32_16x16x32_bf16 v[40:43], v[200:203], a[168:171], v[40:43]
  v_mfma_f32_16x16x32_bf16 v[44:47], v[200:203], a[172:175], v[44:47]
  ds_read_b64_tr_b16 v[200:201], v240 offset:53248
  ds_read_b64_tr_b16 v[202:203], v240 offset:53504
  s_waitcnt lgkmcnt(15)
  v_mfma_f32_16x16x32_bf16 v[48:51], v[204:207], a[160:163], v[48:51]
  v_mfma_f32_16x16x32_bf16 v[52:55], v[204:207], a[164:167], v[52:55]
  v_mfma_f32_16x16x32_bf16 v[56:59], v[204:207], a[168:171], v[56:59]
  v_mfma_f32_16x16x32_bf16 v[60:63], v[204:207], a[172:175], v[60:63]
  ds_read_b64_tr_b16 v[204:205], v241 offset:53248
  ds_read_b64_tr_b16 v[206:207], v241 offset:53504
  s_waitcnt lgkmcnt(15)
  v_mfma_f32_16x16x32_bf16 v[0:3], v[208:211], a[176:179], v[0:3]
  v_mfma_f32_16x16x32_bf16 v[4:7], v[208:211], a[180:183], v[4:7]
  v_mfma_f32_16x16x32_bf16 v[8:11], v[208:211], a[184:187], v[8:11]
  v_mfma_f32_16x16x32_bf16 v[12:15], v[208:211], a[188:191], v[12:15]
  ds_read_b64_tr_b16 v[208:209], v240 offset:51200
  ds_read_b64_tr_b16 v[210:211], v240 offset:51456
  s_waitcnt lgkmcnt(15)
  v_mfma_f32_16x16x32_bf16 v[16:19], v[212:215], a[176:179], v[16:19]
  v_mfma_f32_16x16x32_bf16 v[20:23], v[212:215], a[180:183], v[20:23]
  v_mfma_f32_16x16x32_bf16 v[24:27], v[212:215], a[184:187], v[24:27]
  v_mfma_f32_16x16x32_bf16 v[28:31], v[212:215], a[188:191], v[28:31]
  ds_read_b64_tr_b16 v[212:213], v241 offset:51200
  ds_read_b64_tr_b16 v[214:215], v241 offset:51456
  s_waitcnt lgkmcnt(15)
  v_mfma_f32_16x16x32_bf16 v[32:35], v[216:219], a[176:179], v[32:35]
  v_mfma_f32_16x16x32_bf16 v[36:39], v[216:219], a[180:183], v[36:39]
  v_mfma_f32_16x16x32_bf16 v[40:43], v[216:219], a[184:187], v[40:43]
  v_mfma_f32_16x16x32_bf16 v[44:47], v[216:219], a[188:191], v[44:47]
  ds_read_b64_tr_b16 v[216:217], v240 offset:55296
  ds_read_b64_tr_b16 v[218:219], v240 offset:55552
  s_waitcnt lgkmcnt(15)
  v_mfma_f32_16x16x32_bf16 v[48:51], v[220:223], a[176:179], v[48:51]
  v_mfma_f32_16x16x32_bf16 v[52:55], v[220:223], a[180:183], v[52:55]
  v_mfma_f32_16x16x32_bf16 v[56:59], v[220:223], a[184:187], v[56:59]
  v_mfma_f32_16x16x32_bf16 v[60:63], v[220:223], a[188:191], v[60:63]
  ds_read_b64_tr_b16 v[220:221], v241 offset:55296
  ds_read_b64_tr_b16 v[222:223], v241 offset:55552
  s_barrier
  s_waitcnt lgkmcnt(15)
  s_waitcnt lgkmcnt(12)
  v_mfma_f32_16x16x32_bf16 v[0:3], v[192:195], a[192:195], v[0:3]
  v_mfma_f32_16x16x32_bf16 v[4:7], v[192:195], a[196:199], v[4:7]
  v_mfma_f32_16x16x32_bf16 v[8:11], v[192:195], a[200:203], v[8:11]
  s_lshr_b32 s6, s3, 1
  s_add_u32 s6, s6, s14
  v_mfma_f32_16x16x32_bf16 v[12:15], v[192:195], a[204:207], v[12:15]
  ds_read_b64_tr_b16 v[192:193], v240 offset:57344
  ds_read_b64_tr_b16 v[194:195], v240 offset:57600
  v_mfma_f32_16x16x32_bf16 v[16:19], v[196:199], a[192:195], v[16:19]
  s_add_u32 s6, s6, 6
  s_and_b32 s6, s6, 7
  v_mfma_f32_16x16x32_bf16 v[20:23], v[196:199], a[196:199], v[20:23]
  s_lshl_b32 s6, s6, 19
  s_add_u32 m0, s9, 32768
  v_mfma_f32_16x16x32_bf16 v[24:27], v[196:199], a[200:203], v[24:27]
  s_add_u32 s6, s6, s11
  buffer_load_dwordx4 v244, s[56:59], s6 offen offset:0 lds
  v_mfma_f32_16x16x32_bf16 v[28:31], v[196:199], a[204:207], v[28:31]
  ds_read_b64_tr_b16 v[196:197], v241 offset:57344
  ds_read_b64_tr_b16 v[198:199], v241 offset:57600
  s_waitcnt lgkmcnt(14)
  v_mfma_f32_16x16x32_bf16 v[32:35], v[200:203], a[192:195], v[32:35]
  buffer_load_dwordx4 v245, s[56:59], s6 offen offset:1024 lds
  buffer_load_dwordx4 v246, s[56:59], s6 offen offset:2048 lds
  v_mfma_f32_16x16x32_bf16 v[36:39], v[200:203], a[196:199], v[36:39]
  buffer_load_dwordx4 v247, s[56:59], s6 offen offset:3072 lds
  s_waitcnt vmcnt(4)
  ds_read_b128 a[224:227], v252 offset:8192
  v_mfma_f32_16x16x32_bf16 v[40:43], v[200:203], a[200:203], v[40:43]
  ds_read_b128 a[228:231], v252 offset:10240
  ds_read_b128 a[232:235], v252 offset:12288
  v_mfma_f32_16x16x32_bf16 v[44:47], v[200:203], a[204:207], v[44:47]
  ds_read_b64_tr_b16 v[200:201], v240 offset:61440
  ds_read_b64_tr_b16 v[202:203], v240 offset:61696
  s_waitcnt lgkmcnt(15)
  v_mfma_f32_16x16x32_bf16 v[48:51], v[204:207], a[192:195], v[48:51]
  ds_read_b128 a[236:239], v252 offset:14336
  ds_read_b128 a[240:243], v253 offset:8192
  v_mfma_f32_16x16x32_bf16 v[52:55], v[204:207], a[196:199], v[52:55]
  ds_read_b128 a[244:247], v253 offset:10240
  ds_read_b128 a[248:251], v253 offset:12288
  v_mfma_f32_16x16x32_bf16 v[56:59], v[204:207], a[200:203], v[56:59]
  ds_read_b128 a[252:255], v253 offset:14336
  v_mfma_f32_16x16x32_bf16 v[60:63], v[204:207], a[204:207], v[60:63]
  ds_read_b64_tr_b16 v[204:205], v241 offset:61440
  ds_read_b64_tr_b16 v[206:207], v241 offset:61696
  s_waitcnt lgkmcnt(15)
  v_mfma_f32_16x16x32_bf16 v[0:3], v[208:211], a[208:211], v[0:3]
  v_mfma_f32_16x16x32_bf16 v[4:7], v[208:211], a[212:215], v[4:7]
  v_mfma_f32_16x16x32_bf16 v[8:11], v[208:211], a[216:219], v[8:11]
  v_mfma_f32_16x16x32_bf16 v[12:15], v[208:211], a[220:223], v[12:15]
  ds_read_b64_tr_b16 v[208:209], v240 offset:59392
  ds_read_b64_tr_b16 v[210:211], v240 offset:59648
  s_waitcnt lgkmcnt(15)
  v_mfma_f32_16x16x32_bf16 v[16:19], v[212:215], a[208:211], v[16:19]
  v_mfma_f32_16x16x32_bf16 v[20:23], v[212:215], a[212:215], v[20:23]
  v_mfma_f32_16x16x32_bf16 v[24:27], v[212:215], a[216:219], v[24:27]
  v_mfma_f32_16x16x32_bf16 v[28:31], v[212:215], a[220:223], v[28:31]
  ds_read_b64_tr_b16 v[212:213], v241 offset:59392
  ds_read_b64_tr_b16 v[214:215], v241 offset:59648
  s_waitcnt lgkmcnt(15)
  v_mfma_f32_16x16x32_bf16 v[32:35], v[216:219], a[208:211], v[32:35]
  v_mfma_f32_16x16x32_bf16 v[36:39], v[216:219], a[212:215], v[36:39]
  v_mfma_f32_16x16x32_bf16 v[40:43], v[216:219], a[216:219], v[40:43]
  v_mfma_f32_16x16x32_bf16 v[44:47], v[216:219], a[220:223], v[44:47]
  ds_read_b64_tr_b16 v[216:217], v240 offset:63488
  ds_read_b64_tr_b16 v[218:219], v240 offset:63744
  s_waitcnt lgkmcnt(15)
  v_mfma_f32_16x16x32_bf16 v[48:51], v[220:223], a[208:211], v[48:51]
  v_mfma_f32_16x16x32_bf16 v[52:55], v[220:223], a[212:215], v[52:55]
  v_mfma_f32_16x16x32_bf16 v[56:59], v[220:223], a[216:219], v[56:59]
  v_mfma_f32_16x16x32_bf16 v[60:63], v[220:223], a[220:223], v[60:63]
  ds_read_b64_tr_b16 v[220:221], v241 offset:63488
  ds_read_b64_tr_b16 v[222:223], v241 offset:63744
  s_waitcnt lgkmcnt(15)
  s_waitcnt lgkmcnt(10)
  v_mfma_f32_16x16x32_bf16 v[0:3], v[192:195], a[224:227], v[0:3]
  v_mfma_f32_16x16x32_bf16 v[4:7], v[192:195], a[228:231], v[4:7]
  v_mfma_f32_16x16x32_bf16 v[8:11], v[192:195], a[232:235], v[8:11]
  v_mfma_f32_16x16x32_bf16 v[12:15], v[192:195], a[236:239], v[12:15]
  ds_read_b64_tr_b16 v[192:193], v242 offset:0
  ds_read_b64_tr_b16 v[194:195], v242 offset:256
  v_mfma_f32_16x16x32_bf16 v[16:19], v[196:199], a[224:227], v[16:19]
  v_mfma_f32_16x16x32_bf16 v[20:23], v[196:199], a[228:231], v[20:23]
  v_mfma_f32_16x16x32_bf16 v[24:27], v[196:199], a[232:235], v[24:27]
  v_mfma_f32_16x16x32_bf16 v[28:31], v[196:199], a[236:239], v[28:31]
  ds_read_b64_tr_b16 v[196:197], v243 offset:0
  ds_read_b64_tr_b16 v[198:199], v243 offset:256
  v_mfma_f32_16x16x32_bf16 v[32:35], v[200:203], a[224:227], v[32:35]
  v_mfma_f32_16x16x32_bf16 v[36:39], v[200:203], a[228:231], v[36:39]
  v_mfma_f32_16x16x32_bf16 v[40:43], v[200:203], a[232:235], v[40:43]
  v_mfma_f32_16x16x32_bf16 v[44:47], v[200:203], a[236:239], v[44:47]
  ds_read_b64_tr_b16 v[200:201], v242 offset:4096
  ds_read_b64_tr_b16 v[202:203], v242 offset:4352
  s_waitcnt lgkmcnt(14)
  v_mfma_f32_16x16x32_bf16 v[48:51], v[204:207], a[224:227], v[48:51]
  v_mfma_f32_16x16x32_bf16 v[52:55], v[204:207], a[228:231], v[52:55]
  v_mfma_f32_16x16x32_bf16 v[56:59], v[204:207], a[232:235], v[56:59]
  v_mfma_f32_16x16x32_bf16 v[60:63], v[204:207], a[236:239], v[60:63]
  ds_read_b64_tr_b16 v[204:205], v243 offset:4096
  ds_read_b64_tr_b16 v[206:207], v243 offset:4352
  s_waitcnt lgkmcnt(14)
  v_mfma_f32_16x16x32_bf16 v[0:3], v[208:211], a[240:243], v[0:3]
  v_mfma_f32_16x16x32_bf16 v[4:7], v[208:211], a[244:247], v[4:7]
  v_mfma_f32_16x16x32_bf16 v[8:11], v[208:211], a[248:251], v[8:11]
  v_mfma_f32_16x16x32_bf16 v[12:15], v[208:211], a[252:255], v[12:15]
  ds_read_b64_tr_b16 v[208:209], v242 offset:2048
  ds_read_b64_tr_b16 v[210:211], v242 offset:2304
  s_waitcnt lgkmcnt(14)
  v_mfma_f32_16x16x32_bf16 v[16:19], v[212:215], a[240:243], v[16:19]
  v_mfma_f32_16x16x32_bf16 v[20:23], v[212:215], a[244:247], v[20:23]
  v_mfma_f32_16x16x32_bf16 v[24:27], v[212:215], a[248:251], v[24:27]
  v_mfma_f32_16x16x32_bf16 v[28:31], v[212:215], a[252:255], v[28:31]
  ds_read_b64_tr_b16 v[212:213], v243 offset:2048
  ds_read_b64_tr_b16 v[214:215], v243 offset:2304
  s_waitcnt lgkmcnt(14)
  v_mfma_f32_16x16x32_bf16 v[32:35], v[216:219], a[240:243], v[32:35]
  v_mfma_f32_16x16x32_bf16 v[36:39], v[216:219], a[244:247], v[36:39]
  v_mfma_f32_16x16x32_bf16 v[40:43], v[216:219], a[248:251], v[40:43]
  v_mfma_f32_16x16x32_bf16 v[44:47], v[216:219], a[252:255], v[44:47]
  ds_read_b64_tr_b16 v[216:217], v242 offset:6144
  ds_read_b64_tr_b16 v[218:219], v242 offset:6400
  s_waitcnt lgkmcnt(14)
  v_mfma_f32_16x16x32_bf16 v[48:51], v[220:223], a[240:243], v[48:51]
  v_mfma_f32_16x16x32_bf16 v[52:55], v[220:223], a[244:247], v[52:55]
  v_mfma_f32_16x16x32_bf16 v[56:59], v[220:223], a[248:251], v[56:59]
  v_mfma_f32_16x16x32_bf16 v[60:63], v[220:223], a[252:255], v[60:63]
  ds_read_b64_tr_b16 v[220:221], v243 offset:6144
  ds_read_b64_tr_b16 v[222:223], v243 offset:6400
  s_barrier
  s_waitcnt lgkmcnt(14)
  v_mfma_f32_16x16x32_bf16 v[64:67], v[192:195], a[0:3], 0
  v_mfma_f32_16x16x32_bf16 v[68:71], v[192:195], a[4:7], 0
  v_mfma_f32_16x16x32_bf16 v[72:75], v[192:195], a[8:11], 0
  s_lshr_b32 s6, s3, 1
  s_add_u32 s6, s6, s14
  v_mfma_f32_16x16x32_bf16 v[76:79], v[192:195], a[12:15], 0
  ds_read_b64_tr_b16 v[192:193], v242 offset:8192
  ds_read_b64_tr_b16 v[194:195], v242 offset:8448
  s_waitcnt lgkmcnt(14)
  v_mfma_f32_16x16x32_bf16 v[80:83], v[196:199], a[0:3], 0
  s_add_u32 s6, s6, 0
  s_and_b32 s6, s6, 7
  v_mfma_f32_16x16x32_bf16 v[84:87], v[196:199], a[4:7], 0
  s_lshl_b32 s6, s6, 19
  s_add_u32 m0, s9, 49152
  v_mfma_f32_16x16x32_bf16 v[88:91], v[196:199], a[8:11], 0
  s_add_u32 s6, s6, s12
  buffer_load_dwordx4 v244, s[56:59], s6 offen offset:0 lds
  v_mfma_f32_16x16x32_bf16 v[92:95], v[196:199], a[12:15], 0
  ds_read_b64_tr_b16 v[196:197], v243 offset:8192
  ds_read_b64_tr_b16 v[198:199], v243 offset:8448
  s_waitcnt lgkmcnt(14)
  v_mfma_f32_16x16x32_bf16 v[96:99], v[200:203], a[0:3], 0
  buffer_load_dwordx4 v245, s[56:59], s6 offen offset:1024 lds
  buffer_load_dwordx4 v246, s[56:59], s6 offen offset:2048 lds
  v_mfma_f32_16x16x32_bf16 v[100:103], v[200:203], a[4:7], 0
  buffer_load_dwordx4 v247, s[56:59], s6 offen offset:3072 lds
  v_cvt_pk_bf16_f32 v224, v0, v1
  v_mfma_f32_16x16x32_bf16 v[104:107], v[200:203], a[8:11], 0
  v_mfma_f32_16x16x32_bf16 v[108:111], v[200:203], a[12:15], 0
  ds_read_b64_tr_b16 v[200:201], v242 offset:12288
  ds_read_b64_tr_b16 v[202:203], v242 offset:12544
  s_waitcnt lgkmcnt(14)
  v_mfma_f32_16x16x32_bf16 v[112:115], v[204:207], a[0:3], 0
  v_cvt_pk_bf16_f32 v225, v2, v3
  v_mfma_f32_16x16x32_bf16 v[116:119], v[204:207], a[4:7], 0
  v_mfma_f32_16x16x32_bf16 v[120:123], v[204:207], a[8:11], 0
  v_mfma_f32_16x16x32_bf16 v[124:127], v[204:207], a[12:15], 0
  ds_read_b64_tr_b16 v[204:205], v243 offset:12288
  ds_read_b64_tr_b16 v[206:207], v243 offset:12544
  s_waitcnt lgkmcnt(14)
  v_mfma_f32_16x16x32_bf16 v[64:67], v[208:211], a[16:19], v[64:67]
  v_cvt_pk_bf16_f32 v226, v16, v17
  v_mfma_f32_16x16x32_bf16 v[68:71], v[208:211], a[20:23], v[68:71]
  v_mfma_f32_16x16x32_bf16 v[72:75], v[208:211], a[24:27], v[72:75]
  v_cvt_pk_bf16_f32 v227, v18, v19
  v_mfma_f32_16x16x32_bf16 v[76:79], v[208:211], a[28:31], v[76:79]
  ds_read_b64_tr_b16 v[208:209], v242 offset:10240
  ds_read_b64_tr_b16 v[210:211], v242 offset:10496
  s_waitcnt lgkmcnt(14)
  v_mfma_f32_16x16x32_bf16 v[80:83], v[212:215], a[16:19], v[80:83]
  v_mfma_f32_16x16x32_bf16 v[84:87], v[212:215], a[20:23], v[84:87]
  buffer_store_dwordx4 v[224:227], v128, s[64:67], s84 offen offset:0 sc1
  v_mfma_f32_16x16x32_bf16 v[88:91], v[212:215], a[24:27], v[88:91]
  v_mfma_f32_16x16x32_bf16 v[92:95], v[212:215], a[28:31], v[92:95]
  ds_read_b64_tr_b16 v[212:213], v243 offset:10240
  ds_read_b64_tr_b16 v[214:215], v243 offset:10496
  s_waitcnt lgkmcnt(14)
  v_mfma_f32_16x16x32_bf16 v[96:99], v[216:219], a[16:19], v[96:99]
  v_cvt_pk_bf16_f32 v228, v4, v5
  v_mfma_f32_16x16x32_bf16 v[100:103], v[216:219], a[20:23], v[100:103]
  v_mfma_f32_16x16x32_bf16 v[104:107], v[216:219], a[24:27], v[104:107]
  v_mfma_f32_16x16x32_bf16 v[108:111], v[216:219], a[28:31], v[108:111]
  ds_read_b64_tr_b16 v[216:217], v242 offset:14336
  ds_read_b64_tr_b16 v[218:219], v242 offset:14592
  s_waitcnt lgkmcnt(14)
  v_mfma_f32_16x16x32_bf16 v[112:115], v[220:223], a[16:19], v[112:115]
  v_cvt_pk_bf16_f32 v229, v6, v7
  v_mfma_f32_16x16x32_bf16 v[116:119], v[220:223], a[20:23], v[116:119]
  v_mfma_f32_16x16x32_bf16 v[120:123], v[220:223], a[24:27], v[120:123]
  v_cvt_pk_bf16_f32 v230, v20, v21
  v_mfma_f32_16x16x32_bf16 v[124:127], v[220:223], a[28:31], v[124:127]
  ds_read_b64_tr_b16 v[220:221], v243 offset:14336
  ds_read_b64_tr_b16 v[222:223], v243 offset:14592
  s_waitcnt lgkmcnt(14)
  v_mfma_f32_16x16x32_bf16 v[64:67], v[192:195], a[32:35], v[64:67]
  v_mfma_f32_16x16x32_bf16 v[68:71], v[192:195], a[36:39], v[68:71]
  v_mfma_f32_16x16x32_bf16 v[72:75], v[192:195], a[40:43], v[72:75]
  v_cvt_pk_bf16_f32 v231, v22, v23
  v_mfma_f32_16x16x32_bf16 v[76:79], v[192:195], a[44:47], v[76:79]
  ds_read_b64_tr_b16 v[192:193], v240 offset:0
  ds_read_b64_tr_b16 v[194:195], v240 offset:256
  s_waitcnt lgkmcnt(14)
  v_mfma_f32_16x16x32_bf16 v[80:83], v[196:199], a[32:35], v[80:83]
  v_mfma_f32_16x16x32_bf16 v[84:87], v[196:199], a[36:39], v[84:87]
  buffer_store_dwordx4 v[228:231], v129, s[64:67], s84 offen offset:0 sc1
  v_mfma_f32_16x16x32_bf16 v[88:91], v[196:199], a[40:43], v[88:91]
  v_mfma_f32_16x16x32_bf16 v[92:95], v[196:199], a[44:47], v[92:95]
  ds_read_b64_tr_b16 v[196:197], v241 offset:0
  ds_read_b64_tr_b16 v[198:199], v241 offset:256
  s_waitcnt lgkmcnt(14)
  v_mfma_f32_16x16x32_bf16 v[96:99], v[200:203], a[32:35], v[96:99]
  v_mfma_f32_16x16x32_bf16 v[100:103], v[200:203], a[36:39], v[100:103]
  v_cvt_pk_bf16_f32 v232, v8, v9
  v_mfma_f32_16x16x32_bf16 v[104:107], v[200:203], a[40:43], v[104:107]
  v_mfma_f32_16x16x32_bf16 v[108:111], v[200:203], a[44:47], v[108:111]
  ds_read_b64_tr_b16 v[200:201], v240 offset:4096
  ds_read_b64_tr_b16 v[202:203], v240 offset:4352
  s_waitcnt lgkmcnt(14)
  v_mfma_f32_16x16x32_bf16 v[112:115], v[204:207], a[32:35], v[112:115]
  v_cvt_pk_bf16_f32 v233, v10, v11
  v_mfma_f32_16x16x32_bf16 v[116:119], v[204:207], a[36:39], v[116:119]
  v_mfma_f32_16x16x32_bf16 v[120:123], v[204:207], a[40:43], v[120:123]
  v_mfma_f32_16x16x32_bf16 v[124:127], v[204:207], a[44:47], v[124:127]
  ds_read_b64_tr_b16 v[204:205], v241 offset:4096
  ds_read_b64_tr_b16 v[206:207], v241 offset:4352
  s_waitcnt lgkmcnt(14)
  v_mfma_f32_16x16x32_bf16 v[64:67], v[208:211], a[48:51], v[64:67]
  v_cvt_pk_bf16_f32 v234, v24, v25
  v_mfma_f32_16x16x32_bf16 v[68:71], v[208:211], a[52:55], v[68:71]
  v_mfma_f32_16x16x32_bf16 v[72:75], v[208:211], a[56:59], v[72:75]
  v_mfma_f32_16x16x32_bf16 v[76:79], v[208:211], a[60:63], v[76:79]
  ds_read_b64_tr_b16 v[208:209], v240 offset:2048
  ds_read_b64_tr_b16 v[210:211], v240 offset:2304
  s_waitcnt lgkmcnt(14)
  v_mfma_f32_16x16x32_bf16 v[80:83], v[212:215], a[48:51], v[80:83]
  v_cvt_pk_bf16_f32 v235, v26, v27
  v_mfma_f32_16x16x32_bf16 v[84:87], v[212:215], a[52:55], v[84:87]
  v_mfma_f32_16x16x32_bf16 v[88:91], v[212:215], a[56:59], v[88:91]
  v_mfma_f32_16x16x32_bf16 v[92:95], v[212:215], a[60:63], v[92:95]
  ds_read_b64_tr_b16 v[212:213], v241 offset:2048
  ds_read_b64_tr_b16 v[214:215], v241 offset:2304
  s_waitcnt lgkmcnt(14)
  v_mfma_f32_16x16x32_bf16 v[96:99], v[216:219], a[48:51], v[96:99]
  buffer_store_dwordx4 v[232:235], v130, s[64:67], s84 offen offset:0 sc1
  v_mfma_f32_16x16x32_bf16 v[100:103], v[216:219], a[52:55], v[100:103]
  v_mfma_f32_16x16x32_bf16 v[104:107], v[216:219], a[56:59], v[104:107]
  v_mfma_f32_16x16x32_bf16 v[108:111], v[216:219], a[60:63], v[108:111]
  ds_read_b64_tr_b16 v[216:217], v240 offset:6144
  ds_read_b64_tr_b16 v[218:219], v240 offset:6400
  s_waitcnt lgkmcnt(14)
  v_mfma_f32_16x16x32_bf16 v[112:115], v[220:223], a[48:51], v[112:115]
  v_cvt_pk_bf16_f32 v224, v12, v13
  v_mfma_f32_16x16x32_bf16 v[116:119], v[220:223], a[52:55], v[116:119]
  v_mfma_f32_16x16x32_bf16 v[120:123], v[220:223], a[56:59], v[120:123]
  v_mfma_f32_16x16x32_bf16 v[124:127], v[220:223], a[60:63], v[124:127]
  ds_read_b64_tr_b16 v[220:221], v241 offset:6144
  ds_read_b64_tr_b16 v[222:223], v241 offset:6400
  s_barrier
  s_waitcnt lgkmcnt(14)
  v_mfma_f32_16x16x32_bf16 v[64:67], v[192:195], a[64:67], v[64:67]
  v_cvt_pk_bf16_f32 v225, v14, v15
  v_mfma_f32_16x16x32_bf16 v[68:71], v[192:195], a[68:71], v[68:71]
  v_mfma_f32_16x16x32_bf16 v[72:75], v[192:195], a[72:75], v[72:75]
  s_lshr_b32 s6, s3, 1
  s_add_u32 s6, s6, s14
  v_mfma_f32_16x16x32_bf16 v[76:79], v[192:195], a[76:79], v[76:79]
  ds_read_b64_tr_b16 v[192:193], v240 offset:8192
  ds_read_b64_tr_b16 v[194:195], v240 offset:8448
  s_waitcnt lgkmcnt(14)
  v_mfma_f32_16x16x32_bf16 v[80:83], v[196:199], a[64:67], v[80:83]
  s_add_u32 s6, s6, 2
  s_and_b32 s6, s6, 7
  v_mfma_f32_16x16x32_bf16 v[84:87], v[196:199], a[68:71], v[84:87]
  s_lshl_b32 s6, s6, 19
  s_add_u32 m0, s9, 65536
  v_mfma_f32_16x16x32_bf16 v[88:91], v[196:199], a[72:75], v[88:91]
  s_add_u32 s6, s6, s12
  buffer_load_dwordx4 v244, s[56:59], s6 offen offset:0 lds
  v_mfma_f32_16x16x32_bf16 v[92:95], v[196:199], a[76:79], v[92:95]
  ds_read_b64_tr_b16 v[196:197], v241 offset:8192
  ds_read_b64_tr_b16 v[198:199], v241 offset:8448
  s_waitcnt lgkmcnt(14)
  v_mfma_f32_16x16x32_bf16 v[96:99], v[200:203], a[64:67], v[96:99]
  buffer_load_dwordx4 v245, s[56:59], s6 offen offset:1024 lds
  buffer_load_dwordx4 v246, s[56:59], s6 offen offset:2048 lds
  v_mfma_f32_16x16x32_bf16 v[100:103], v[200:203], a[68:71], v[100:103]
  buffer_load_dwordx4 v247, s[56:59], s6 offen offset:3072 lds
  v_cvt_pk_bf16_f32 v226, v28, v29
  v_mfma_f32_16x16x32_bf16 v[104:107], v[200:203], a[72:75], v[104:107]
  v_cvt_pk_bf16_f32 v227, v30, v31
  v_mfma_f32_16x16x32_bf16 v[108:111], v[200:203], a[76:79], v[108:111]
  ds_read_b64_tr_b16 v[200:201], v240 offset:12288
  ds_read_b64_tr_b16 v[202:203], v240 offset:12544
  s_waitcnt lgkmcnt(14)
  v_mfma_f32_16x16x32_bf16 v[112:115], v[204:207], a[64:67], v[112:115]
  buffer_store_dwordx4 v[224:227], v131, s[64:67], s84 offen offset:0 sc1
  v_mfma_f32_16x16x32_bf16 v[116:119], v[204:207], a[68:71], v[116:119]
  v_mfma_f32_16x16x32_bf16 v[120:123], v[204:207], a[72:75], v[120:123]
  v_mfma_f32_16x16x32_bf16 v[124:127], v[204:207], a[76:79], v[124:127]
  ds_read_b64_tr_b16 v[204:205], v241 offset:12288
  ds_read_b64_tr_b16 v[206:207], v241 offset:12544
  s_waitcnt lgkmcnt(14)
  v_mfma_f32_16x16x32_bf16 v[64:67], v[208:211], a[80:83], v[64:67]
  v_mfma_f32_16x16x32_bf16 v[68:71], v[208:211], a[84:87], v[68:71]
  v_cvt_pk_bf16_f32 v228, v32, v33
  v_mfma_f32_16x16x32_bf16 v[72:75], v[208:211], a[88:91], v[72:75]
  v_mfma_f32_16x16x32_bf16 v[76:79], v[208:211], a[92:95], v[76:79]
  ds_read_b64_tr_b16 v[208:209], v240 offset:10240
  ds_read_b64_tr_b16 v[210:211], v240 offset:10496
  s_waitcnt lgkmcnt(14)
  v_mfma_f32_16x16x32_bf16 v[80:83], v[212:215], a[80:83], v[80:83]
  v_mfma_f32_16x16x32_bf16 v[84:87], v[212:215], a[84:87], v[84:87]
  v_cvt_pk_bf16_f32 v229, v34, v35
  v_mfma_f32_16x16x32_bf16 v[88:91], v[212:215], a[88:91], v[88:91]
  v_mfma_f32_16x16x32_bf16 v[92:95], v[212:215], a[92:95], v[92:95]
  ds_read_b64_tr_b16 v[212:213], v241 offset:10240
  ds_read_b64_tr_b16 v[214:215], v241 offset:10496
  s_waitcnt lgkmcnt(14)
  v_mfma_f32_16x16x32_bf16 v[96:99], v[216:219], a[80:83], v[96:99]
  v_mfma_f32_16x16x32_bf16 v[100:103], v[216:219], a[84:87], v[100:103]
  v_cvt_pk_bf16_f32 v230, v48, v49
  v_mfma_f32_16x16x32_bf16 v[104:107], v[216:219], a[88:91], v[104:107]
  v_mfma_f32_16x16x32_bf16 v[108:111], v[216:219], a[92:95], v[108:111]
  ds_read_b64_tr_b16 v[216:217], v240 offset:14336
  ds_read_b64_tr_b16 v[218:219], v240 offset:14592
  s_waitcnt lgkmcnt(14)
  v_mfma_f32_16x16x32_bf16 v[112:115], v[220:223], a[80:83], v[112:115]
  v_mfma_f32_16x16x32_bf16 v[116:119], v[220:223], a[84:87], v[116:119]
  v_mfma_f32_16x16x32_bf16 v[120:123], v[220:223], a[88:91], v[120:123]
  v_cvt_pk_bf16_f32 v231, v50, v51
  v_mfma_f32_16x16x32_bf16 v[124:127], v[220:223], a[92:95], v[124:127]
  ds_read_b64_tr_b16 v[220:221], v241 offset:14336
  ds_read_b64_tr_b16 v[222:223], v241 offset:14592
  s_waitcnt lgkmcnt(14)
  v_mfma_f32_16x16x32_bf16 v[64:67], v[192:195], a[96:99], v[64:67]
  v_mfma_f32_16x16x32_bf16 v[68:71], v[192:195], a[100:103], v[68:71]
  v_mfma_f32_16x16x32_bf16 v[72:75], v[192:195], a[104:107], v[72:75]
  v_mfma_f32_16x16x32_bf16 v[76:79], v[192:195], a[108:111], v[76:79]
  ds_read_b64_tr_b16 v[192:193], v240 offset:16384
  ds_read_b64_tr_b16 v[194:195], v240 offset:16640
  s_waitcnt lgkmcnt(14)
  v_mfma_f32_16x16x32_bf16 v[80:83], v[196:199], a[96:99], v[80:83]
  buffer_store_dwordx4 v[228:231], v128, s[64:67], s85 offen offset:0 sc1
  v_mfma_f32_16x16x32_bf16 v[84:87], v[196:199], a[100:103], v[84:87]
  v_mfma_f32_16x16x32_bf16 v[88:91], v[196:199], a[104:107], v[88:91]
  v_mfma_f32_16x16x32_bf16 v[92:95], v[196:199], a[108:111], v[92:95]
  ds_read_b64_tr_b16 v[196:197], v241 offset:16384
  ds_read_b64_tr_b16 v[198:199], v241 offset:16640
  s_waitcnt lgkmcnt(14)
  v_mfma_f32_16x16x32_bf16 v[96:99], v[200:203], a[96:99], v[96:99]
  v_cvt_pk_bf16_f32 v232, v36, v37
  v_mfma_f32_16x16x32_bf16 v[100:103], v[200:203], a[100:103], v[100:103]
  v_mfma_f32_16x16x32_bf16 v[104:107], v[200:203], a[104:107], v[104:107]
  v_mfma_f32_16x16x32_bf16 v[108:111], v[200:203], a[108:111], v[108:111]
  ds_read_b64_tr_b16 v[200:201], v240 offset:20480
  ds_read_b64_tr_b16 v[202:203], v240 offset:20736
  s_waitcnt lgkmcnt(14)
  v_mfma_f32_16x16x32_bf16 v[112:115], v[204:207], a[96:99], v[112:115]
  v_cvt_pk_bf16_f32 v233, v38, v39
  v_mfma_f32_16x16x32_bf16 v[116:119], v[204:207], a[100:103], v[116:119]
  v_mfma_f32_16x16x32_bf16 v[120:123], v[204:207], a[104:107], v[120:123]
  v_mfma_f32_16x16x32_bf16 v[124:127], v[204:207], a[108:111], v[124:127]
  ds_read_b64_tr_b16 v[204:205], v241 offset:20480
  ds_read_b64_tr_b16 v[206:207], v241 offset:20736
  s_waitcnt lgkmcnt(14)
  v_mfma_f32_16x16x32_bf16 v[64:67], v[208:211], a[112:115], v[64:67]
  v_mfma_f32_16x16x32_bf16 v[68:71], v[208:211], a[116:119], v[68:71]
  v_mfma_f32_16x16x32_bf16 v[72:75], v[208:211], a[120:123], v[72:75]
  v_cvt_pk_bf16_f32 v234, v52, v53
  v_mfma_f32_16x16x32_bf16 v[76:79], v[208:211], a[124:127], v[76:79]
  ds_read_b64_tr_b16 v[208:209], v240 offset:18432
  ds_read_b64_tr_b16 v[210:211], v240 offset:18688
  s_waitcnt lgkmcnt(14)
  v_mfma_f32_16x16x32_bf16 v[80:83], v[212:215], a[112:115], v[80:83]
  v_mfma_f32_16x16x32_bf16 v[84:87], v[212:215], a[116:119], v[84:87]
  v_mfma_f32_16x16x32_bf16 v[88:91], v[212:215], a[120:123], v[88:91]
  v_mfma_f32_16x16x32_bf16 v[92:95], v[212:215], a[124:127], v[92:95]
  ds_read_b64_tr_b16 v[212:213], v241 offset:18432
  ds_read_b64_tr_b16 v[214:215], v241 offset:18688
  s_waitcnt lgkmcnt(14)
  v_mfma_f32_16x16x32_bf16 v[96:99], v[216:219], a[112:115], v[96:99]
  v_cvt_pk_bf16_f32 v235, v54, v55
  v_mfma_f32_16x16x32_bf16 v[100:103], v[216:219], a[116:119], v[100:103]
  v_mfma_f32_16x16x32_bf16 v[104:107], v[216:219], a[120:123], v[104:107]
  v_mfma_f32_16x16x32_bf16 v[108:111], v[216:219], a[124:127], v[108:111]
  ds_read_b64_tr_b16 v[216:217], v240 offset:22528
  ds_read_b64_tr_b16 v[218:219], v240 offset:22784
  s_waitcnt lgkmcnt(14)
  v_mfma_f32_16x16x32_bf16 v[112:115], v[220:223], a[112:115], v[112:115]
  buffer_store_dwordx4 v[232:235], v129, s[64:67], s85 offen offset:0 sc1
  v_mfma_f32_16x16x32_bf16 v[116:119], v[220:223], a[116:119], v[116:119]
  v_mfma_f32_16x16x32_bf16 v[120:123], v[220:223], a[120:123], v[120:123]
  v_mfma_f32_16x16x32_bf16 v[124:127], v[220:223], a[124:127], v[124:127]
  ds_read_b64_tr_b16 v[220:221], v241 offset:22528
  ds_read_b64_tr_b16 v[222:223], v241 offset:22784
  s_waitcnt vmcnt(14)
  s_barrier
  s_waitcnt lgkmcnt(14)
  v_mfma_f32_16x16x32_bf16 v[64:67], v[192:195], a[128:131], v[64:67]
  v_mfma_f32_16x16x32_bf16 v[68:71], v[192:195], a[132:135], v[68:71]
  v_mfma_f32_16x16x32_bf16 v[72:75], v[192:195], a[136:139], v[72:75]
  s_lshr_b32 s6, s3, 1
  s_add_u32 s6, s6, s14
  v_mfma_f32_16x16x32_bf16 v[76:79], v[192:195], a[140:143], v[76:79]
  ds_read_b64_tr_b16 v[192:193], v240 offset:24576
  ds_read_b64_tr_b16 v[194:195], v240 offset:24832
  s_waitcnt lgkmcnt(14)
  v_mfma_f32_16x16x32_bf16 v[80:83], v[196:199], a[128:131], v[80:83]
  s_add_u32 s6, s6, 4
  s_and_b32 s6, s6, 7
  v_mfma_f32_16x16x32_bf16 v[84:87], v[196:199], a[132:135], v[84:87]
  s_lshl_b32 s6, s6, 19
  s_add_u32 m0, s9, 0
  v_mfma_f32_16x16x32_bf16 v[88:91], v[196:199], a[136:139], v[88:91]
  s_add_u32 s6, s6, s12
  buffer_load_dwordx4 v244, s[56:59], s6 offen offset:0 lds
  v_mfma_f32_16x16x32_bf16 v[92:95], v[196:199], a[140:143], v[92:95]
  ds_read_b64_tr_b16 v[196:197], v241 offset:24576
  ds_read_b64_tr_b16 v[198:199], v241 offset:24832
  s_waitcnt lgkmcnt(14)
  v_mfma_f32_16x16x32_bf16 v[96:99], v[200:203], a[128:131], v[96:99]
  buffer_load_dwordx4 v245, s[56:59], s6 offen offset:1024 lds
  buffer_load_dwordx4 v246, s[56:59], s6 offen offset:2048 lds
  v_mfma_f32_16x16x32_bf16 v[100:103], v[200:203], a[132:135], v[100:103]
  buffer_load_dwordx4 v247, s[56:59], s6 offen offset:3072 lds
  v_cvt_pk_bf16_f32 v224, v40, v41
  v_mfma_f32_16x16x32_bf16 v[104:107], v[200:203], a[136:139], v[104:107]
  v_cvt_pk_bf16_f32 v225, v42, v43
  v_mfma_f32_16x16x32_bf16 v[108:111], v[200:203], a[140:143], v[108:111]
  ds_read_b64_tr_b16 v[200:201], v240 offset:28672
  ds_read_b64_tr_b16 v[202:203], v240 offset:28928
  s_waitcnt lgkmcnt(14)
  v_mfma_f32_16x16x32_bf16 v[112:115], v[204:207], a[128:131], v[112:115]
  v_mfma_f32_16x16x32_bf16 v[116:119], v[204:207], a[132:135], v[116:119]
  v_mfma_f32_16x16x32_bf16 v[120:123], v[204:207], a[136:139], v[120:123]
  v_mfma_f32_16x16x32_bf16 v[124:127], v[204:207], a[140:143], v[124:127]
  ds_read_b64_tr_b16 v[204:205], v241 offset:28672
  ds_read_b64_tr_b16 v[206:207], v241 offset:28928
  s_waitcnt lgkmcnt(14)
  v_mfma_f32_16x16x32_bf16 v[64:67], v[208:211], a[144:147], v[64:67]
  v_cvt_pk_bf16_f32 v226, v56, v57
  v_mfma_f32_16x16x32_bf16 v[68:71], v[208:211], a[148:151], v[68:71]
  v_mfma_f32_16x16x32_bf16 v[72:75], v[208:211], a[152:155], v[72:75]
  v_mfma_f32_16x16x32_bf16 v[76:79], v[208:211], a[156:159], v[76:79]
  ds_read_b64_tr_b16 v[208:209], v240 offset:26624
  ds_read_b64_tr_b16 v[210:211], v240 offset:26880
  s_waitcnt lgkmcnt(14)
  v_mfma_f32_16x16x32_bf16 v[80:83], v[212:215], a[144:147], v[80:83]
  v_mfma_f32_16x16x32_bf16 v[84:87], v[212:215], a[148:151], v[84:87]
  v_mfma_f32_16x16x32_bf16 v[88:91], v[212:215], a[152:155], v[88:91]
  v_cvt_pk_bf16_f32 v227, v58, v59
  v_mfma_f32_16x16x32_bf16 v[92:95], v[212:215], a[156:159], v[92:95]
  ds_read_b64_tr_b16 v[212:213], v241 offset:26624
  ds_read_b64_tr_b16 v[214:215], v241 offset:26880
  s_waitcnt lgkmcnt(14)
  v_mfma_f32_16x16x32_bf16 v[96:99], v[216:219], a[144:147], v[96:99]
  v_mfma_f32_16x16x32_bf16 v[100:103], v[216:219], a[148:151], v[100:103]
  v_mfma_f32_16x16x32_bf16 v[104:107], v[216:219], a[152:155], v[104:107]
  v_mfma_f32_16x16x32_bf16 v[108:111], v[216:219], a[156:159], v[108:111]
  ds_read_b64_tr_b16 v[216:217], v240 offset:30720
  ds_read_b64_tr_b16 v[218:219], v240 offset:30976
  s_waitcnt lgkmcnt(14)
  v_mfma_f32_16x16x32_bf16 v[112:115], v[220:223], a[144:147], v[112:115]
  v_mfma_f32_16x16x32_bf16 v[116:119], v[220:223], a[148:151], v[116:119]
  buffer_store_dwordx4 v[224:227], v130, s[64:67], s85 offen offset:0 sc1
  v_mfma_f32_16x16x32_bf16 v[120:123], v[220:223], a[152:155], v[120:123]
  v_mfma_f32_16x16x32_bf16 v[124:127], v[220:223], a[156:159], v[124:127]
  ds_read_b64_tr_b16 v[220:221], v241 offset:30720
  ds_read_b64_tr_b16 v[222:223], v241 offset:30976
  s_waitcnt lgkmcnt(14)
  v_mfma_f32_16x16x32_bf16 v[64:67], v[192:195], a[160:163], v[64:67]
  v_mfma_f32_16x16x32_bf16 v[68:71], v[192:195], a[164:167], v[68:71]
  v_mfma_f32_16x16x32_bf16 v[72:75], v[192:195], a[168:171], v[72:75]
  v_mfma_f32_16x16x32_bf16 v[76:79], v[192:195], a[172:175], v[76:79]
  ds_read_b64_tr_b16 v[192:193], v240 offset:32768
  ds_read_b64_tr_b16 v[194:195], v240 offset:33024
  s_waitcnt lgkmcnt(14)
  v_mfma_f32_16x16x32_bf16 v[80:83], v[196:199], a[160:163], v[80:83]
  v_mfma_f32_16x16x32_bf16 v[84:87], v[196:199], a[164:167], v[84:87]
  v_mfma_f32_16x16x32_bf16 v[88:91], v[196:199], a[168:171], v[88:91]
  v_cvt_pk_bf16_f32 v228, v44, v45
  v_mfma_f32_16x16x32_bf16 v[92:95], v[196:199], a[172:175], v[92:95]
  ds_read_b64_tr_b16 v[196:197], v241 offset:32768
  ds_read_b64_tr_b16 v[198:199], v241 offset:33024
  s_waitcnt lgkmcnt(14)
  v_mfma_f32_16x16x32_bf16 v[96:99], v[200:203], a[160:163], v[96:99]
  v_mfma_f32_16x16x32_bf16 v[100:103], v[200:203], a[164:167], v[100:103]
  v_mfma_f32_16x16x32_bf16 v[104:107], v[200:203], a[168:171], v[104:107]
  v_mfma_f32_16x16x32_bf16 v[108:111], v[200:203], a[172:175], v[108:111]
  ds_read_b64_tr_b16 v[200:201], v240 offset:36864
  ds_read_b64_tr_b16 v[202:203], v240 offset:37120
  s_waitcnt lgkmcnt(14)
  v_mfma_f32_16x16x32_bf16 v[112:115], v[204:207], a[160:163], v[112:115]
  v_mfma_f32_16x16x32_bf16 v[116:119], v[204:207], a[164:167], v[116:119]
  v_mfma_f32_16x16x32_bf16 v[120:123], v[204:207], a[168:171], v[120:123]
  v_mfma_f32_16x16x32_bf16 v[124:127], v[204:207], a[172:175], v[124:127]
  ds_read_b64_tr_b16 v[204:205], v241 offset:36864
  ds_read_b64_tr_b16 v[206:207], v241 offset:37120
  s_waitcnt lgkmcnt(14)
  v_mfma_f32_16x16x32_bf16 v[64:67], v[208:211], a[176:179], v[64:67]
  v_cvt_pk_bf16_f32 v229, v46, v47
  v_mfma_f32_16x16x32_bf16 v[68:71], v[208:211], a[180:183], v[68:71]
  v_mfma_f32_16x16x32_bf16 v[72:75], v[208:211], a[184:187], v[72:75]
  v_mfma_f32_16x16x32_bf16 v[76:79], v[208:211], a[188:191], v[76:79]
  ds_read_b64_tr_b16 v[208:209], v240 offset:34816
  ds_read_b64_tr_b16 v[210:211], v240 offset:35072
  s_waitcnt lgkmcnt(14)
  v_mfma_f32_16x16x32_bf16 v[80:83], v[212:215], a[176:179], v[80:83]
  v_mfma_f32_16x16x32_bf16 v[84:87], v[212:215], a[180:183], v[84:87]
  v_mfma_f32_16x16x32_bf16 v[88:91], v[212:215], a[184:187], v[88:91]
  v_mfma_f32_16x16x32_bf16 v[92:95], v[212:215], a[188:191], v[92:95]
  ds_read_b64_tr_b16 v[212:213], v241 offset:34816
  ds_read_b64_tr_b16 v[214:215], v241 offset:35072
  s_waitcnt lgkmcnt(14)
  v_mfma_f32_16x16x32_bf16 v[96:99], v[216:219], a[176:179], v[96:99]
  v_mfma_f32_16x16x32_bf16 v[100:103], v[216:219], a[180:183], v[100:103]
  v_mfma_f32_16x16x32_bf16 v[104:107], v[216:219], a[184:187], v[104:107]
  v_cvt_pk_bf16_f32 v230, v60, v61
  v_mfma_f32_16x16x32_bf16 v[108:111], v[216:219], a[188:191], v[108:111]
  ds_read_b64_tr_b16 v[216:217], v240 offset:38912
  ds_read_b64_tr_b16 v[218:219], v240 offset:39168
  s_waitcnt lgkmcnt(14)
  v_mfma_f32_16x16x32_bf16 v[112:115], v[220:223], a[176:179], v[112:115]
  v_mfma_f32_16x16x32_bf16 v[116:119], v[220:223], a[180:183], v[116:119]
  v_mfma_f32_16x16x32_bf16 v[120:123], v[220:223], a[184:187], v[120:123]
  v_mfma_f32_16x16x32_bf16 v[124:127], v[220:223], a[188:191], v[124:127]
  ds_read_b64_tr_b16 v[220:221], v241 offset:38912
  ds_read_b64_tr_b16 v[222:223], v241 offset:39168
  s_waitcnt vmcnt(15)
  s_barrier
  s_waitcnt lgkmcnt(14)
  v_mfma_f32_16x16x32_bf16 v[64:67], v[192:195], a[192:195], v[64:67]
  v_mfma_f32_16x16x32_bf16 v[68:71], v[192:195], a[196:199], v[68:71]
  v_mfma_f32_16x16x32_bf16 v[72:75], v[192:195], a[200:203], v[72:75]
  s_lshr_b32 s6, s3, 1
  s_add_u32 s6, s6, s14
  v_mfma_f32_16x16x32_bf16 v[76:79], v[192:195], a[204:207], v[76:79]
  ds_read_b64_tr_b16 v[192:193], v240 offset:40960
  ds_read_b64_tr_b16 v[194:195], v240 offset:41216
  s_waitcnt lgkmcnt(14)
  v_mfma_f32_16x16x32_bf16 v[80:83], v[196:199], a[192:195], v[80:83]
  s_add_u32 s6, s6, 6
  s_and_b32 s6, s6, 7
  v_mfma_f32_16x16x32_bf16 v[84:87], v[196:199], a[196:199], v[84:87]
  s_lshl_b32 s6, s6, 19
  s_add_u32 m0, s9, 16384
  v_mfma_f32_16x16x32_bf16 v[88:91], v[196:199], a[200:203], v[88:91]
  s_add_u32 s6, s6, s12
  buffer_load_dwordx4 v244, s[56:59], s6 offen offset:0 lds
  v_mfma_f32_16x16x32_bf16 v[92:95], v[196:199], a[204:207], v[92:95]
  ds_read_b64_tr_b16 v[196:197], v241 offset:40960
  ds_read_b64_tr_b16 v[198:199], v241 offset:41216
  s_waitcnt lgkmcnt(14)
  v_mfma_f32_16x16x32_bf16 v[96:99], v[200:203], a[192:195], v[96:99]
  buffer_load_dwordx4 v245, s[56:59], s6 offen offset:1024 lds
  buffer_load_dwordx4 v246, s[56:59], s6 offen offset:2048 lds
  v_mfma_f32_16x16x32_bf16 v[100:103], v[200:203], a[196:199], v[100:103]
  buffer_load_dwordx4 v247, s[56:59], s6 offen offset:3072 lds
  v_cvt_pk_bf16_f32 v231, v62, v63
  v_mfma_f32_16x16x32_bf16 v[104:107], v[200:203], a[200:203], v[104:107]
  v_mfma_f32_16x16x32_bf16 v[108:111], v[200:203], a[204:207], v[108:111]
  ds_read_b64_tr_b16 v[200:201], v240 offset:45056
  ds_read_b64_tr_b16 v[202:203], v240 offset:45312
  s_waitcnt lgkmcnt(14)
  v_mfma_f32_16x16x32_bf16 v[112:115], v[204:207], a[192:195], v[112:115]
  v_mfma_f32_16x16x32_bf16 v[116:119], v[204:207], a[196:199], v[116:119]
  v_mfma_f32_16x16x32_bf16 v[120:123], v[204:207], a[200:203], v[120:123]
  v_mfma_f32_16x16x32_bf16 v[124:127], v[204:207], a[204:207], v[124:127]
  ds_read_b64_tr_b16 v[204:205], v241 offset:45056
  ds_read_b64_tr_b16 v[206:207], v241 offset:45312
  s_waitcnt lgkmcnt(14)
  v_mfma_f32_16x16x32_bf16 v[64:67], v[208:211], a[208:211], v[64:67]
  v_mfma_f32_16x16x32_bf16 v[68:71], v[208:211], a[212:215], v[68:71]
  v_mfma_f32_16x16x32_bf16 v[72:75], v[208:211], a[216:219], v[72:75]
  v_mfma_f32_16x16x32_bf16 v[76:79], v[208:211], a[220:223], v[76:79]
  ds_read_b64_tr_b16 v[208:209], v240 offset:43008
  ds_read_b64_tr_b16 v[210:211], v240 offset:43264
  s_waitcnt lgkmcnt(14)
  v_mfma_f32_16x16x32_bf16 v[80:83], v[212:215], a[208:211], v[80:83]
  v_mfma_f32_16x16x32_bf16 v[84:87], v[212:215], a[212:215], v[84:87]
  v_mfma_f32_16x16x32_bf16 v[88:91], v[212:215], a[216:219], v[88:91]
  v_mfma_f32_16x16x32_bf16 v[92:95], v[212:215], a[220:223], v[92:95]
  ds_read_b64_tr_b16 v[212:213], v241 offset:43008
  ds_read_b64_tr_b16 v[214:215], v241 offset:43264
  s_waitcnt lgkmcnt(14)
  v_mfma_f32_16x16x32_bf16 v[96:99], v[216:219], a[208:211], v[96:99]
  v_mfma_f32_16x16x32_bf16 v[100:103], v[216:219], a[212:215], v[100:103]
  buffer_store_dwordx4 v[228:231], v131, s[64:67], s85 offen offset:0 sc1
  v_mfma_f32_16x16x32_bf16 v[104:107], v[216:219], a[216:219], v[104:107]
  v_mfma_f32_16x16x32_bf16 v[108:111], v[216:219], a[220:223], v[108:111]
  ds_read_b64_tr_b16 v[216:217], v240 offset:47104
  ds_read_b64_tr_b16 v[218:219], v240 offset:47360
  s_waitcnt lgkmcnt(14)
  v_mfma_f32_16x16x32_bf16 v[112:115], v[220:223], a[208:211], v[112:115]
  v_mfma_f32_16x16x32_bf16 v[116:119], v[220:223], a[212:215], v[116:119]
  v_mfma_f32_16x16x32_bf16 v[120:123], v[220:223], a[216:219], v[120:123]
  v_mfma_f32_16x16x32_bf16 v[124:127], v[220:223], a[220:223], v[124:127]
  ds_read_b64_tr_b16 v[220:221], v241 offset:47104
  ds_read_b64_tr_b16 v[222:223], v241 offset:47360
  s_waitcnt lgkmcnt(14)
  v_mfma_f32_16x16x32_bf16 v[64:67], v[192:195], a[224:227], v[64:67]
  v_mfma_f32_16x16x32_bf16 v[68:71], v[192:195], a[228:231], v[68:71]
  v_mfma_f32_16x16x32_bf16 v[72:75], v[192:195], a[232:235], v[72:75]
  v_mfma_f32_16x16x32_bf16 v[76:79], v[192:195], a[236:239], v[76:79]
  ds_read_b64_tr_b16 v[192:193], v240 offset:49152
  ds_read_b64_tr_b16 v[194:195], v240 offset:49408
  s_waitcnt lgkmcnt(14)
  v_mfma_f32_16x16x32_bf16 v[80:83], v[196:199], a[224:227], v[80:83]
  v_mfma_f32_16x16x32_bf16 v[84:87], v[196:199], a[228:231], v[84:87]
  v_mfma_f32_16x16x32_bf16 v[88:91], v[196:199], a[232:235], v[88:91]
  v_mfma_f32_16x16x32_bf16 v[92:95], v[196:199], a[236:239], v[92:95]
  ds_read_b64_tr_b16 v[196:197], v241 offset:49152
  ds_read_b64_tr_b16 v[198:199], v241 offset:49408
  s_waitcnt lgkmcnt(14)
  v_mfma_f32_16x16x32_bf16 v[96:99], v[200:203], a[224:227], v[96:99]
  v_mfma_f32_16x16x32_bf16 v[100:103], v[200:203], a[228:231], v[100:103]
  v_mfma_f32_16x16x32_bf16 v[104:107], v[200:203], a[232:235], v[104:107]
  v_mfma_f32_16x16x32_bf16 v[108:111], v[200:203], a[236:239], v[108:111]
  ds_read_b64_tr_b16 v[200:201], v240 offset:53248
  ds_read_b64_tr_b16 v[202:203], v240 offset:53504
  s_waitcnt lgkmcnt(14)
  v_mfma_f32_16x16x32_bf16 v[112:115], v[204:207], a[224:227], v[112:115]
  v_mfma_f32_16x16x32_bf16 v[116:119], v[204:207], a[228:231], v[116:119]
  v_mfma_f32_16x16x32_bf16 v[120:123], v[204:207], a[232:235], v[120:123]
  v_mfma_f32_16x16x32_bf16 v[124:127], v[204:207], a[236:239], v[124:127]
  ds_read_b64_tr_b16 v[204:205], v241 offset:53248
  ds_read_b64_tr_b16 v[206:207], v241 offset:53504
  s_waitcnt lgkmcnt(14)
  v_mfma_f32_16x16x32_bf16 v[64:67], v[208:211], a[240:243], v[64:67]
  v_mfma_f32_16x16x32_bf16 v[68:71], v[208:211], a[244:247], v[68:71]
  v_mfma_f32_16x16x32_bf16 v[72:75], v[208:211], a[248:251], v[72:75]
  v_mfma_f32_16x16x32_bf16 v[76:79], v[208:211], a[252:255], v[76:79]
  ds_read_b64_tr_b16 v[208:209], v240 offset:51200
  ds_read_b64_tr_b16 v[210:211], v240 offset:51456
  s_waitcnt lgkmcnt(14)
  v_mfma_f32_16x16x32_bf16 v[80:83], v[212:215], a[240:243], v[80:83]
  v_mfma_f32_16x16x32_bf16 v[84:87], v[212:215], a[244:247], v[84:87]
  v_mfma_f32_16x16x32_bf16 v[88:91], v[212:215], a[248:251], v[88:91]
  v_mfma_f32_16x16x32_bf16 v[92:95], v[212:215], a[252:255], v[92:95]
  ds_read_b64_tr_b16 v[212:213], v241 offset:51200
  ds_read_b64_tr_b16 v[214:215], v241 offset:51456
  s_waitcnt lgkmcnt(14)
  v_mfma_f32_16x16x32_bf16 v[96:99], v[216:219], a[240:243], v[96:99]
  v_mfma_f32_16x16x32_bf16 v[100:103], v[216:219], a[244:247], v[100:103]
  v_mfma_f32_16x16x32_bf16 v[104:107], v[216:219], a[248:251], v[104:107]
  v_mfma_f32_16x16x32_bf16 v[108:111], v[216:219], a[252:255], v[108:111]
  ds_read_b64_tr_b16 v[216:217], v240 offset:55296
  ds_read_b64_tr_b16 v[218:219], v240 offset:55552
  s_waitcnt lgkmcnt(14)
  v_mfma_f32_16x16x32_bf16 v[112:115], v[220:223], a[240:243], v[112:115]
  v_mfma_f32_16x16x32_bf16 v[116:119], v[220:223], a[244:247], v[116:119]
  v_mfma_f32_16x16x32_bf16 v[120:123], v[220:223], a[248:251], v[120:123]
  v_mfma_f32_16x16x32_bf16 v[124:127], v[220:223], a[252:255], v[124:127]
  ds_read_b64_tr_b16 v[220:221], v241 offset:55296
  ds_read_b64_tr_b16 v[222:223], v241 offset:55552
  s_waitcnt vmcnt(13)
  s_barrier
  s_waitcnt lgkmcnt(14)
  v_mfma_f32_16x16x32_bf16 v[0:3], v[192:195], a[0:3], 0
  v_mfma_f32_16x16x32_bf16 v[4:7], v[192:195], a[4:7], 0
  v_mfma_f32_16x16x32_bf16 v[8:11], v[192:195], a[8:11], 0
  s_lshr_b32 s6, s3, 1
  s_add_u32 s6, s6, s14
  v_mfma_f32_16x16x32_bf16 v[12:15], v[192:195], a[12:15], 0
  ds_read_b64_tr_b16 v[192:193], v240 offset:57344
  ds_read_b64_tr_b16 v[194:195], v240 offset:57600
  s_waitcnt lgkmcnt(14)
  v_mfma_f32_16x16x32_bf16 v[16:19], v[196:199], a[0:3], 0
  s_add_u32 s6, s6, 0
  s_and_b32 s6, s6, 7
  v_mfma_f32_16x16x32_bf16 v[20:23], v[196:199], a[4:7], 0
  s_lshl_b32 s6, s6, 19
  s_add_u32 m0, s9, 32768
  v_mfma_f32_16x16x32_bf16 v[24:27], v[196:199], a[8:11], 0
  s_add_u32 s6, s6, s13
  buffer_load_dwordx4 v244, s[56:59], s6 offen offset:0 lds
  v_mfma_f32_16x16x32_bf16 v[28:31], v[196:199], a[12:15], 0
  ds_read_b64_tr_b16 v[196:197], v241 offset:57344
  ds_read_b64_tr_b16 v[198:199], v241 offset:57600
  s_waitcnt lgkmcnt(14)
  v_mfma_f32_16x16x32_bf16 v[32:35], v[200:203], a[0:3], 0
  buffer_load_dwordx4 v245, s[56:59], s6 offen offset:1024 lds
  buffer_load_dwordx4 v246, s[56:59], s6 offen offset:2048 lds
  v_mfma_f32_16x16x32_bf16 v[36:39], v[200:203], a[4:7], 0
  buffer_load_dwordx4 v247, s[56:59], s6 offen offset:3072 lds
  v_cvt_pk_bf16_f32 v232, v64, v65
  v_mfma_f32_16x16x32_bf16 v[40:43], v[200:203], a[8:11], 0
  v_mfma_f32_16x16x32_bf16 v[44:47], v[200:203], a[12:15], 0
  ds_read_b64_tr_b16 v[200:201], v240 offset:61440
  ds_read_b64_tr_b16 v[202:203], v240 offset:61696
  s_waitcnt lgkmcnt(14)
  v_mfma_f32_16x16x32_bf16 v[48:51], v[204:207], a[0:3], 0
  v_cvt_pk_bf16_f32 v233, v66, v67
  v_mfma_f32_16x16x32_bf16 v[52:55], v[204:207], a[4:7], 0
  v_mfma_f32_16x16x32_bf16 v[56:59], v[204:207], a[8:11], 0
  v_cvt_pk_bf16_f32 v234, v80, v81
  v_mfma_f32_16x16x32_bf16 v[60:63], v[204:207], a[12:15], 0
  ds_read_b64_tr_b16 v[204:205], v241 offset:61440
  ds_read_b64_tr_b16 v[206:207], v241 offset:61696
  s_waitcnt lgkmcnt(14)
  v_mfma_f32_16x16x32_bf16 v[0:3], v[208:211], a[16:19], v[0:3]
  v_mfma_f32_16x16x32_bf16 v[4:7], v[208:211], a[20:23], v[4:7]
  v_mfma_f32_16x16x32_bf16 v[8:11], v[208:211], a[24:27], v[8:11]
  v_cvt_pk_bf16_f32 v235, v82, v83
  v_mfma_f32_16x16x32_bf16 v[12:15], v[208:211], a[28:31], v[12:15]
  ds_read_b64_tr_b16 v[208:209], v240 offset:59392
  ds_read_b64_tr_b16 v[210:211], v240 offset:59648
  s_waitcnt lgkmcnt(14)
  v_mfma_f32_16x16x32_bf16 v[16:19], v[212:215], a[16:19], v[16:19]
  v_mfma_f32_16x16x32_bf16 v[20:23], v[212:215], a[20:23], v[20:23]
  buffer_store_dwordx4 v[232:235], v128, s[64:67], s86 offen offset:0 sc1
  v_mfma_f32_16x16x32_bf16 v[24:27], v[212:215], a[24:27], v[24:27]
  v_mfma_f32_16x16x32_bf16 v[28:31], v[212:215], a[28:31], v[28:31]
  ds_read_b64_tr_b16 v[212:213], v241 offset:59392
  ds_read_b64_tr_b16 v[214:215], v241 offset:59648
  s_waitcnt lgkmcnt(14)
  v_mfma_f32_16x16x32_bf16 v[32:35], v[216:219], a[16:19], v[32:35]
  v_cvt_pk_bf16_f32 v224, v68, v69
  v_mfma_f32_16x16x32_bf16 v[36:39], v[216:219], a[20:23], v[36:39]
  v_mfma_f32_16x16x32_bf16 v[40:43], v[216:219], a[24:27], v[40:43]
  v_mfma_f32_16x16x32_bf16 v[44:47], v[216:219], a[28:31], v[44:47]
  ds_read_b64_tr_b16 v[216:217], v240 offset:63488
  ds_read_b64_tr_b16 v[218:219], v240 offset:63744
  s_waitcnt lgkmcnt(14)
  v_mfma_f32_16x16x32_bf16 v[48:51], v[220:223], a[16:19], v[48:51]
  v_cvt_pk_bf16_f32 v225, v70, v71
  v_mfma_f32_16x16x32_bf16 v[52:55], v[220:223], a[20:23], v[52:55]
  v_mfma_f32_16x16x32_bf16 v[56:59], v[220:223], a[24:27], v[56:59]
  v_cvt_pk_bf16_f32 v226, v84, v85
  v_mfma_f32_16x16x32_bf16 v[60:63], v[220:223], a[28:31], v[60:63]
  ds_read_b64_tr_b16 v[220:221], v241 offset:63488
  ds_read_b64_tr_b16 v[222:223], v241 offset:63744
  s_waitcnt lgkmcnt(14)
  v_mfma_f32_16x16x32_bf16 v[0:3], v[192:195], a[32:35], v[0:3]
  v_mfma_f32_16x16x32_bf16 v[4:7], v[192:195], a[36:39], v[4:7]
  v_mfma_f32_16x16x32_bf16 v[8:11], v[192:195], a[40:43], v[8:11]
  v_cvt_pk_bf16_f32 v227, v86, v87
  v_mfma_f32_16x16x32_bf16 v[12:15], v[192:195], a[44:47], v[12:15]
  ds_read_b64_tr_b16 v[192:193], v242 offset:0
  ds_read_b64_tr_b16 v[194:195], v242 offset:256
  s_waitcnt lgkmcnt(14)
  v_mfma_f32_16x16x32_bf16 v[16:19], v[196:199], a[32:35], v[16:19]
  v_mfma_f32_16x16x32_bf16 v[20:23], v[196:199], a[36:39], v[20:23]
  buffer_store_dwordx4 v[224:227], v129, s[64:67], s86 offen offset:0 sc1
  v_mfma_f32_16x16x32_bf16 v[24:27], v[196:199], a[40:43], v[24:27]
  v_mfma_f32_16x16x32_bf16 v[28:31], v[196:199], a[44:47], v[28:31]
  ds_read_b64_tr_b16 v[196:197], v243 offset:0
  ds_read_b64_tr_b16 v[198:199], v243 offset:256
  s_waitcnt lgkmcnt(14)
  v_mfma_f32_16x16x32_bf16 v[32:35], v[200:203], a[32:35], v[32:35]
  v_mfma_f32_16x16x32_bf16 v[36:39], v[200:203], a[36:39], v[36:39]
  v_cvt_pk_bf16_f32 v228, v72, v73
  v_mfma_f32_16x16x32_bf16 v[40:43], v[200:203], a[40:43], v[40:43]
  v_mfma_f32_16x16x32_bf16 v[44:47], v[200:203], a[44:47], v[44:47]
  ds_read_b64_tr_b16 v[200:201], v242 offset:4096
  ds_read_b64_tr_b16 v[202:203], v242 offset:4352
  s_waitcnt lgkmcnt(14)
  v_mfma_f32_16x16x32_bf16 v[48:51], v[204:207], a[32:35], v[48:51]
  v_cvt_pk_bf16_f32 v229, v74, v75
  v_mfma_f32_16x16x32_bf16 v[52:55], v[204:207], a[36:39], v[52:55]
  v_mfma_f32_16x16x32_bf16 v[56:59], v[204:207], a[40:43], v[56:59]
  v_mfma_f32_16x16x32_bf16 v[60:63], v[204:207], a[44:47], v[60:63]
  ds_read_b64_tr_b16 v[204:205], v243 offset:4096
  ds_read_b64_tr_b16 v[206:207], v243 offset:4352
  s_waitcnt lgkmcnt(14)
  v_mfma_f32_16x16x32_bf16 v[0:3], v[208:211], a[48:51], v[0:3]
  v_cvt_pk_bf16_f32 v230, v88, v89
  v_mfma_f32_16x16x32_bf16 v[4:7], v[208:211], a[52:55], v[4:7]
  v_mfma_f32_16x16x32_bf16 v[8:11], v[208:211], a[56:59], v[8:11]
  v_mfma_f32_16x16x32_bf16 v[12:15], v[208:211], a[60:63], v[12:15]
  ds_read_b64_tr_b16 v[208:209], v242 offset:2048
  ds_read_b64_tr_b16 v[210:211], v242 offset:2304
  s_waitcnt lgkmcnt(14)
  v_mfma_f32_16x16x32_bf16 v[16:19], v[212:215], a[48:51], v[16:19]
  v_cvt_pk_bf16_f32 v231, v90, v91
  v_mfma_f32_16x16x32_bf16 v[20:23], v[212:215], a[52:55], v[20:23]
  v_mfma_f32_16x16x32_bf16 v[24:27], v[212:215], a[56:59], v[24:27]
  v_mfma_f32_16x16x32_bf16 v[28:31], v[212:215], a[60:63], v[28:31]
  ds_read_b64_tr_b16 v[212:213], v243 offset:2048
  ds_read_b64_tr_b16 v[214:215], v243 offset:2304
  s_waitcnt lgkmcnt(14)
  v_mfma_f32_16x16x32_bf16 v[32:35], v[216:219], a[48:51], v[32:35]
  buffer_store_dwordx4 v[228:231], v130, s[64:67], s86 offen offset:0 sc1
  v_mfma_f32_16x16x32_bf16 v[36:39], v[216:219], a[52:55], v[36:39]
  v_mfma_f32_16x16x32_bf16 v[40:43], v[216:219], a[56:59], v[40:43]
  v_mfma_f32_16x16x32_bf16 v[44:47], v[216:219], a[60:63], v[44:47]
  ds_read_b64_tr_b16 v[216:217], v242 offset:6144
  ds_read_b64_tr_b16 v[218:219], v242 offset:6400
  s_waitcnt lgkmcnt(14)
  v_mfma_f32_16x16x32_bf16 v[48:51], v[220:223], a[48:51], v[48:51]
  v_cvt_pk_bf16_f32 v232, v76, v77
  v_mfma_f32_16x16x32_bf16 v[52:55], v[220:223], a[52:55], v[52:55]
  v_mfma_f32_16x16x32_bf16 v[56:59], v[220:223], a[56:59], v[56:59]
  v_cvt_pk_bf16_f32 v233, v78, v79
  v_mfma_f32_16x16x32_bf16 v[60:63], v[220:223], a[60:63], v[60:63]
  ds_read_b64_tr_b16 v[220:221], v243 offset:6144
  ds_read_b64_tr_b16 v[222:223], v243 offset:6400
  s_waitcnt vmcnt(13)
  s_barrier
  s_waitcnt lgkmcnt(14)
  v_mfma_f32_16x16x32_bf16 v[0:3], v[192:195], a[64:67], v[0:3]
  v_mfma_f32_16x16x32_bf16 v[4:7], v[192:195], a[68:71], v[4:7]
  v_mfma_f32_16x16x32_bf16 v[8:11], v[192:195], a[72:75], v[8:11]
  s_lshr_b32 s6, s3, 1
  s_add_u32 s6, s6, s14
  v_mfma_f32_16x16x32_bf16 v[12:15], v[192:195], a[76:79], v[12:15]
  ds_read_b64_tr_b16 v[192:193], v242 offset:8192
  ds_read_b64_tr_b16 v[194:195], v242 offset:8448
  s_waitcnt lgkmcnt(14)
  v_mfma_f32_16x16x32_bf16 v[16:19], v[196:199], a[64:67], v[16:19]
  s_add_u32 s6, s6, 2
  s_and_b32 s6, s6, 7
  v_mfma_f32_16x16x32_bf16 v[20:23], v[196:199], a[68:71], v[20:23]
  s_lshl_b32 s6, s6, 19
  s_add_u32 m0, s9, 49152
  v_mfma_f32_16x16x32_bf16 v[24:27], v[196:199], a[72:75], v[24:27]
  s_add_u32 s6, s6, s13
  buffer_load_dwordx4 v244, s[56:59], s6 offen offset:0 lds
  v_mfma_f32_16x16x32_bf16 v[28:31], v[196:199], a[76:79], v[28:31]
  ds_read_b64_tr_b16 v[196:197], v243 offset:8192
  ds_read_b64_tr_b16 v[198:199], v243 offset:8448
  s_waitcnt lgkmcnt(14)
  v_mfma_f32_16x16x32_bf16 v[32:35], v[200:203], a[64:67], v[32:35]
  buffer_load_dwordx4 v245, s[56:59], s6 offen offset:1024 lds
  buffer_load_dwordx4 v246, s[56:59], s6 offen offset:2048 lds
  v_mfma_f32_16x16x32_bf16 v[36:39], v[200:203], a[68:71], v[36:39]
  buffer_load_dwordx4 v247, s[56:59], s6 offen offset:3072 lds
  v_cvt_pk_bf16_f32 v234, v92, v93
  v_mfma_f32_16x16x32_bf16 v[40:43], v[200:203], a[72:75], v[40:43]
  v_cvt_pk_bf16_f32 v235, v94, v95
  v_mfma_f32_16x16x32_bf16 v[44:47], v[200:203], a[76:79], v[44:47]
  ds_read_b64_tr_b16 v[200:201], v242 offset:12288
  ds_read_b64_tr_b16 v[202:203], v242 offset:12544
  s_waitcnt lgkmcnt(14)
  v_mfma_f32_16x16x32_bf16 v[48:51], v[204:207], a[64:67], v[48:51]
  buffer_store_dwordx4 v[232:235], v131, s[64:67], s86 offen offset:0 sc1
  v_mfma_f32_16x16x32_bf16 v[52:55], v[204:207], a[68:71], v[52:55]
  v_mfma_f32_16x16x32_bf16 v[56:59], v[204:207], a[72:75], v[56:59]
  v_mfma_f32_16x16x32_bf16 v[60:63], v[204:207], a[76:79], v[60:63]
  ds_read_b64_tr_b16 v[204:205], v243 offset:12288
  ds_read_b64_tr_b16 v[206:207], v243 offset:12544
  s_waitcnt lgkmcnt(14)
  v_mfma_f32_16x16x32_bf16 v[0:3], v[208:211], a[80:83], v[0:3]
  v_mfma_f32_16x16x32_bf16 v[4:7], v[208:211], a[84:87], v[4:7]
  v_cvt_pk_bf16_f32 v224, v96, v97
  v_mfma_f32_16x16x32_bf16 v[8:11], v[208:211], a[88:91], v[8:11]
  v_mfma_f32_16x16x32_bf16 v[12:15], v[208:211], a[92:95], v[12:15]
  ds_read_b64_tr_b16 v[208:209], v242 offset:10240
  ds_read_b64_tr_b16 v[210:211], v242 offset:10496
  s_waitcnt lgkmcnt(14)
  v_mfma_f32_16x16x32_bf16 v[16:19], v[212:215], a[80:83], v[16:19]
  v_mfma_f32_16x16x32_bf16 v[20:23], v[212:215], a[84:87], v[20:23]
  v_cvt_pk_bf16_f32 v225, v98, v99
  v_mfma_f32_16x16x32_bf16 v[24:27], v[212:215], a[88:91], v[24:27]
  v_mfma_f32_16x16x32_bf16 v[28:31], v[212:215], a[92:95], v[28:31]
  ds_read_b64_tr_b16 v[212:213], v243 offset:10240
  ds_read_b64_tr_b16 v[214:215], v243 offset:10496
  s_waitcnt lgkmcnt(14)
  v_mfma_f32_16x16x32_bf16 v[32:35], v[216:219], a[80:83], v[32:35]
  v_mfma_f32_16x16x32_bf16 v[36:39], v[216:219], a[84:87], v[36:39]
  v_cvt_pk_bf16_f32 v226, v112, v113
  v_mfma_f32_16x16x32_bf16 v[40:43], v[216:219], a[88:91], v[40:43]
  v_mfma_f32_16x16x32_bf16 v[44:47], v[216:219], a[92:95], v[44:47]
  ds_read_b64_tr_b16 v[216:217], v242 offset:14336
  ds_read_b64_tr_b16 v[218:219], v242 offset:14592
  s_waitcnt lgkmcnt(14)
  v_mfma_f32_16x16x32_bf16 v[48:51], v[220:223], a[80:83], v[48:51]
  v_mfma_f32_16x16x32_bf16 v[52:55], v[220:223], a[84:87], v[52:55]
  v_mfma_f32_16x16x32_bf16 v[56:59], v[220:223], a[88:91], v[56:59]
  v_cvt_pk_bf16_f32 v227, v114, v115
  v_mfma_f32_16x16x32_bf16 v[60:63], v[220:223], a[92:95], v[60:63]
  ds_read_b64_tr_b16 v[220:221], v243 offset:14336
  ds_read_b64_tr_b16 v[222:223], v243 offset:14592
  s_waitcnt lgkmcnt(14)
  v_mfma_f32_16x16x32_bf16 v[0:3], v[192:195], a[96:99], v[0:3]
  v_mfma_f32_16x16x32_bf16 v[4:7], v[192:195], a[100:103], v[4:7]
  v_mfma_f32_16x16x32_bf16 v[8:11], v[192:195], a[104:107], v[8:11]
  v_mfma_f32_16x16x32_bf16 v[12:15], v[192:195], a[108:111], v[12:15]
  ds_read_b64_tr_b16 v[192:193], v240 offset:0
  ds_read_b64_tr_b16 v[194:195], v240 offset:256
  s_waitcnt lgkmcnt(14)
  v_mfma_f32_16x16x32_bf16 v[16:19], v[196:199], a[96:99], v[16:19]
  buffer_store_dwordx4 v[224:227], v128, s[64:67], s87 offen offset:0 sc1
  v_mfma_f32_16x16x32_bf16 v[20:23], v[196:199], a[100:103], v[20:23]
  v_mfma_f32_16x16x32_bf16 v[24:27], v[196:199], a[104:107], v[24:27]
  v_mfma_f32_16x16x32_bf16 v[28:31], v[196:199], a[108:111], v[28:31]
  ds_read_b64_tr_b16 v[196:197], v241 offset:0
  ds_read_b64_tr_b16 v[198:199], v241 offset:256
  s_waitcnt lgkmcnt(14)
  v_mfma_f32_16x16x32_bf16 v[32:35], v[200:203], a[96:99], v[32:35]
  v_cvt_pk_bf16_f32 v228, v100, v101
  v_mfma_f32_16x16x32_bf16 v[36:39], v[200:203], a[100:103], v[36:39]
  v_mfma_f32_16x16x32_bf16 v[40:43], v[200:203], a[104:107], v[40:43]
  v_mfma_f32_16x16x32_bf16 v[44:47], v[200:203], a[108:111], v[44:47]
  ds_read_b64_tr_b16 v[200:201], v240 offset:4096
  ds_read_b64_tr_b16 v[202:203], v240 offset:4352
  s_waitcnt lgkmcnt(14)
  v_mfma_f32_16x16x32_bf16 v[48:51], v[204:207], a[96:99], v[48:51]
  v_cvt_pk_bf16_f32 v229, v102, v103
  v_mfma_f32_16x16x32_bf16 v[52:55], v[204:207], a[100:103], v[52:55]
  v_mfma_f32_16x16x32_bf16 v[56:59], v[204:207], a[104:107], v[56:59]
  v_mfma_f32_16x16x32_bf16 v[60:63], v[204:207], a[108:111], v[60:63]
  ds_read_b64_tr_b16 v[204:205], v241 offset:4096
  ds_read_b64_tr_b16 v[206:207], v241 offset:4352
  s_waitcnt lgkmcnt(14)
  v_mfma_f32_16x16x32_bf16 v[0:3], v[208:211], a[112:115], v[0:3]
  v_mfma_f32_16x16x32_bf16 v[4:7], v[208:211], a[116:119], v[4:7]
  v_mfma_f32_16x16x32_bf16 v[8:11], v[208:211], a[120:123], v[8:11]
  v_cvt_pk_bf16_f32 v230, v116, v117
  v_mfma_f32_16x16x32_bf16 v[12:15], v[208:211], a[124:127], v[12:15]
  ds_read_b64_tr_b16 v[208:209], v240 offset:2048
  ds_read_b64_tr_b16 v[210:211], v240 offset:2304
  s_waitcnt lgkmcnt(14)
  v_mfma_f32_16x16x32_bf16 v[16:19], v[212:215], a[112:115], v[16:19]
  v_mfma_f32_16x16x32_bf16 v[20:23], v[212:215], a[116:119], v[20:23]
  v_mfma_f32_16x16x32_bf16 v[24:27], v[212:215], a[120:123], v[24:27]
  v_mfma_f32_16x16x32_bf16 v[28:31], v[212:215], a[124:127], v[28:31]
  ds_read_b64_tr_b16 v[212:213], v241 offset:2048
  ds_read_b64_tr_b16 v[214:215], v241 offset:2304
  s_waitcnt lgkmcnt(14)
  v_mfma_f32_16x16x32_bf16 v[32:35], v[216:219], a[112:115], v[32:35]
  v_cvt_pk_bf16_f32 v231, v118, v119
  v_mfma_f32_16x16x32_bf16 v[36:39], v[216:219], a[116:119], v[36:39]
  v_mfma_f32_16x16x32_bf16 v[40:43], v[216:219], a[120:123], v[40:43]
  v_mfma_f32_16x16x32_bf16 v[44:47], v[216:219], a[124:127], v[44:47]
  ds_read_b64_tr_b16 v[216:217], v240 offset:6144
  ds_read_b64_tr_b16 v[218:219], v240 offset:6400
  s_waitcnt lgkmcnt(14)
  v_mfma_f32_16x16x32_bf16 v[48:51], v[220:223], a[112:115], v[48:51]
  buffer_store_dwordx4 v[228:231], v129, s[64:67], s87 offen offset:0 sc1
  v_mfma_f32_16x16x32_bf16 v[52:55], v[220:223], a[116:119], v[52:55]
  v_mfma_f32_16x16x32_bf16 v[56:59], v[220:223], a[120:123], v[56:59]
  v_mfma_f32_16x16x32_bf16 v[60:63], v[220:223], a[124:127], v[60:63]
  ds_read_b64_tr_b16 v[220:221], v241 offset:6144
  ds_read_b64_tr_b16 v[222:223], v241 offset:6400
  s_waitcnt vmcnt(15)
  s_barrier
  s_waitcnt lgkmcnt(14)
  v_mfma_f32_16x16x32_bf16 v[0:3], v[192:195], a[128:131], v[0:3]
  v_mfma_f32_16x16x32_bf16 v[4:7], v[192:195], a[132:135], v[4:7]
  v_mfma_f32_16x16x32_bf16 v[8:11], v[192:195], a[136:139], v[8:11]
  s_lshr_b32 s6, s3, 1
  s_add_u32 s6, s6, s14
  v_mfma_f32_16x16x32_bf16 v[12:15], v[192:195], a[140:143], v[12:15]
  ds_read_b64_tr_b16 v[192:193], v240 offset:8192
  ds_read_b64_tr_b16 v[194:195], v240 offset:8448
  s_waitcnt lgkmcnt(14)
  v_mfma_f32_16x16x32_bf16 v[16:19], v[196:199], a[128:131], v[16:19]
  s_add_u32 s6, s6, 4
  s_and_b32 s6, s6, 7
  v_mfma_f32_16x16x32_bf16 v[20:23], v[196:199], a[132:135], v[20:23]
  s_lshl_b32 s6, s6, 19
  s_add_u32 m0, s9, 65536
  v_mfma_f32_16x16x32_bf16 v[24:27], v[196:199], a[136:139], v[24:27]
  s_add_u32 s6, s6, s13
  buffer_load_dwordx4 v244, s[56:59], s6 offen offset:0 lds
  v_mfma_f32_16x16x32_bf16 v[28:31], v[196:199], a[140:143], v[28:31]
  ds_read_b64_tr_b16 v[196:197], v241 offset:8192
  ds_read_b64_tr_b16 v[198:199], v241 offset:8448
  s_waitcnt lgkmcnt(14)
  v_mfma_f32_16x16x32_bf16 v[32:35], v[200:203], a[128:131], v[32:35]
  buffer_load_dwordx4 v245, s[56:59], s6 offen offset:1024 lds
  buffer_load_dwordx4 v246, s[56:59], s6 offen offset:2048 lds
  v_mfma_f32_16x16x32_bf16 v[36:39], v[200:203], a[132:135], v[36:39]
  buffer_load_dwordx4 v247, s[56:59], s6 offen offset:3072 lds
  v_cvt_pk_bf16_f32 v232, v104, v105
  v_mfma_f32_16x16x32_bf16 v[40:43], v[200:203], a[136:139], v[40:43]
  v_cvt_pk_bf16_f32 v233, v106, v107
  v_mfma_f32_16x16x32_bf16 v[44:47], v[200:203], a[140:143], v[44:47]
  ds_read_b64_tr_b16 v[200:201], v240 offset:12288
  ds_read_b64_tr_b16 v[202:203], v240 offset:12544
  s_waitcnt lgkmcnt(14)
  v_mfma_f32_16x16x32_bf16 v[48:51], v[204:207], a[128:131], v[48:51]
  v_mfma_f32_16x16x32_bf16 v[52:55], v[204:207], a[132:135], v[52:55]
  v_mfma_f32_16x16x32_bf16 v[56:59], v[204:207], a[136:139], v[56:59]
  v_mfma_f32_16x16x32_bf16 v[60:63], v[204:207], a[140:143], v[60:63]
  ds_read_b64_tr_b16 v[204:205], v241 offset:12288
  ds_read_b64_tr_b16 v[206:207], v241 offset:12544
  s_waitcnt lgkmcnt(14)
  v_mfma_f32_16x16x32_bf16 v[0:3], v[208:211], a[144:147], v[0:3]
  v_cvt_pk_bf16_f32 v234, v120, v121
  v_mfma_f32_16x16x32_bf16 v[4:7], v[208:211], a[148:151], v[4:7]
  v_mfma_f32_16x16x32_bf16 v[8:11], v[208:211], a[152:155], v[8:11]
  v_mfma_f32_16x16x32_bf16 v[12:15], v[208:211], a[156:159], v[12:15]
  ds_read_b64_tr_b16 v[208:209], v240 offset:10240
  ds_read_b64_tr_b16 v[210:211], v240 offset:10496
  s_waitcnt lgkmcnt(14)
  v_mfma_f32_16x16x32_bf16 v[16:19], v[212:215], a[144:147], v[16:19]
  v_mfma_f32_16x16x32_bf16 v[20:23], v[212:215], a[148:151], v[20:23]
  v_mfma_f32_16x16x32_bf16 v[24:27], v[212:215], a[152:155], v[24:27]
  v_cvt_pk_bf16_f32 v235, v122, v123
  v_mfma_f32_16x16x32_bf16 v[28:31], v[212:215], a[156:159], v[28:31]
  ds_read_b64_tr_b16 v[212:213], v241 offset:10240
  ds_read_b64_tr_b16 v[214:215], v241 offset:10496
  s_waitcnt lgkmcnt(14)
  v_mfma_f32_16x16x32_bf16 v[32:35], v[216:219], a[144:147], v[32:35]
  v_mfma_f32_16x16x32_bf16 v[36:39], v[216:219], a[148:151], v[36:39]
  v_mfma_f32_16x16x32_bf16 v[40:43], v[216:219], a[152:155], v[40:43]
  v_mfma_f32_16x16x32_bf16 v[44:47], v[216:219], a[156:159], v[44:47]
  ds_read_b64_tr_b16 v[216:217], v240 offset:14336
  ds_read_b64_tr_b16 v[218:219], v240 offset:14592
  s_waitcnt lgkmcnt(14)
  v_mfma_f32_16x16x32_bf16 v[48:51], v[220:223], a[144:147], v[48:51]
  v_mfma_f32_16x16x32_bf16 v[52:55], v[220:223], a[148:151], v[52:55]
  buffer_store_dwordx4 v[232:235], v130, s[64:67], s87 offen offset:0 sc1
  v_mfma_f32_16x16x32_bf16 v[56:59], v[220:223], a[152:155], v[56:59]
  v_mfma_f32_16x16x32_bf16 v[60:63], v[220:223], a[156:159], v[60:63]
  ds_read_b64_tr_b16 v[220:221], v241 offset:14336
  ds_read_b64_tr_b16 v[222:223], v241 offset:14592
  s_waitcnt lgkmcnt(14)
  v_mfma_f32_16x16x32_bf16 v[0:3], v[192:195], a[160:163], v[0:3]
  v_mfma_f32_16x16x32_bf16 v[4:7], v[192:195], a[164:167], v[4:7]
  v_mfma_f32_16x16x32_bf16 v[8:11], v[192:195], a[168:171], v[8:11]
  v_mfma_f32_16x16x32_bf16 v[12:15], v[192:195], a[172:175], v[12:15]
  ds_read_b64_tr_b16 v[192:193], v240 offset:16384
  ds_read_b64_tr_b16 v[194:195], v240 offset:16640
  s_waitcnt lgkmcnt(14)
  v_mfma_f32_16x16x32_bf16 v[16:19], v[196:199], a[160:163], v[16:19]
  v_mfma_f32_16x16x32_bf16 v[20:23], v[196:199], a[164:167], v[20:23]
  v_mfma_f32_16x16x32_bf16 v[24:27], v[196:199], a[168:171], v[24:27]
  v_cvt_pk_bf16_f32 v224, v108, v109
  v_mfma_f32_16x16x32_bf16 v[28:31], v[196:199], a[172:175], v[28:31]
  ds_read_b64_tr_b16 v[196:197], v241 offset:16384
  ds_read_b64_tr_b16 v[198:199], v241 offset:16640
  s_waitcnt lgkmcnt(14)
  v_mfma_f32_16x16x32_bf16 v[32:35], v[200:203], a[160:163], v[32:35]
  v_mfma_f32_16x16x32_bf16 v[36:39], v[200:203], a[164:167], v[36:39]
  v_mfma_f32_16x16x32_bf16 v[40:43], v[200:203], a[168:171], v[40:43]
  v_mfma_f32_16x16x32_bf16 v[44:47], v[200:203], a[172:175], v[44:47]
  ds_read_b64_tr_b16 v[200:201], v240 offset:20480
  ds_read_b64_tr_b16 v[202:203], v240 offset:20736
  s_waitcnt lgkmcnt(14)
  v_mfma_f32_16x16x32_bf16 v[48:51], v[204:207], a[160:163], v[48:51]
  v_mfma_f32_16x16x32_bf16 v[52:55], v[204:207], a[164:167], v[52:55]
  v_mfma_f32_16x16x32_bf16 v[56:59], v[204:207], a[168:171], v[56:59]
  v_mfma_f32_16x16x32_bf16 v[60:63], v[204:207], a[172:175], v[60:63]
  ds_read_b64_tr_b16 v[204:205], v241 offset:20480
  ds_read_b64_tr_b16 v[206:207], v241 offset:20736
  s_waitcnt lgkmcnt(14)
  v_mfma_f32_16x16x32_bf16 v[0:3], v[208:211], a[176:179], v[0:3]
  v_cvt_pk_bf16_f32 v225, v110, v111
  v_mfma_f32_16x16x32_bf16 v[4:7], v[208:211], a[180:183], v[4:7]
  v_mfma_f32_16x16x32_bf16 v[8:11], v[208:211], a[184:187], v[8:11]
  v_mfma_f32_16x16x32_bf16 v[12:15], v[208:211], a[188:191], v[12:15]
  ds_read_b64_tr_b16 v[208:209], v240 offset:18432
  ds_read_b64_tr_b16 v[210:211], v240 offset:18688
  s_waitcnt lgkmcnt(14)
  v_mfma_f32_16x16x32_bf16 v[16:19], v[212:215], a[176:179], v[16:19]
  v_mfma_f32_16x16x32_bf16 v[20:23], v[212:215], a[180:183], v[20:23]
  v_mfma_f32_16x16x32_bf16 v[24:27], v[212:215], a[184:187], v[24:27]
  v_mfma_f32_16x16x32_bf16 v[28:31], v[212:215], a[188:191], v[28:31]
  ds_read_b64_tr_b16 v[212:213], v241 offset:18432
  ds_read_b64_tr_b16 v[214:215], v241 offset:18688
  s_waitcnt lgkmcnt(14)
  v_mfma_f32_16x16x32_bf16 v[32:35], v[216:219], a[176:179], v[32:35]
  v_mfma_f32_16x16x32_bf16 v[36:39], v[216:219], a[180:183], v[36:39]
  v_mfma_f32_16x16x32_bf16 v[40:43], v[216:219], a[184:187], v[40:43]
  v_cvt_pk_bf16_f32 v226, v124, v125
  v_mfma_f32_16x16x32_bf16 v[44:47], v[216:219], a[188:191], v[44:47]
  ds_read_b64_tr_b16 v[216:217], v240 offset:22528
  ds_read_b64_tr_b16 v[218:219], v240 offset:22784
  s_waitcnt lgkmcnt(14)
  v_mfma_f32_16x16x32_bf16 v[48:51], v[220:223], a[176:179], v[48:51]
  v_mfma_f32_16x16x32_bf16 v[52:55], v[220:223], a[180:183], v[52:55]
  v_mfma_f32_16x16x32_bf16 v[56:59], v[220:223], a[184:187], v[56:59]
  v_mfma_f32_16x16x32_bf16 v[60:63], v[220:223], a[188:191], v[60:63]
  ds_read_b64_tr_b16 v[220:221], v241 offset:22528
  ds_read_b64_tr_b16 v[222:223], v241 offset:22784
  s_waitcnt vmcnt(15)
  s_barrier
  s_waitcnt lgkmcnt(14)
  v_mfma_f32_16x16x32_bf16 v[0:3], v[192:195], a[192:195], v[0:3]
  v_mfma_f32_16x16x32_bf16 v[4:7], v[192:195], a[196:199], v[4:7]
  v_mfma_f32_16x16x32_bf16 v[8:11], v[192:195], a[200:203], v[8:11]
  s_lshr_b32 s6, s3, 1
  s_add_u32 s6, s6, s14
  v_mfma_f32_16x16x32_bf16 v[12:15], v[192:195], a[204:207], v[12:15]
  ds_read_b64_tr_b16 v[192:193], v240 offset:24576
  ds_read_b64_tr_b16 v[194:195], v240 offset:24832
  s_waitcnt lgkmcnt(14)
  v_mfma_f32_16x16x32_bf16 v[16:19], v[196:199], a[192:195], v[16:19]
  s_add_u32 s6, s6, 6
  s_and_b32 s6, s6, 7
  v_mfma_f32_16x16x32_bf16 v[20:23], v[196:199], a[196:199], v[20:23]
  s_lshl_b32 s6, s6, 19
  s_add_u32 m0, s9, 0
  v_mfma_f32_16x16x32_bf16 v[24:27], v[196:199], a[200:203], v[24:27]
  s_add_u32 s6, s6, s13
  buffer_load_dwordx4 v244, s[56:59], s6 offen offset:0 lds
  v_mfma_f32_16x16x32_bf16 v[28:31], v[196:199], a[204:207], v[28:31]
  ds_read_b64_tr_b16 v[196:197], v241 offset:24576
  ds_read_b64_tr_b16 v[198:199], v241 offset:24832
  s_waitcnt lgkmcnt(14)
  v_mfma_f32_16x16x32_bf16 v[32:35], v[200:203], a[192:195], v[32:35]
  buffer_load_dwordx4 v245, s[56:59], s6 offen offset:1024 lds
  buffer_load_dwordx4 v246, s[56:59], s6 offen offset:2048 lds
  v_mfma_f32_16x16x32_bf16 v[36:39], v[200:203], a[196:199], v[36:39]
  buffer_load_dwordx4 v247, s[56:59], s6 offen offset:3072 lds
  v_cvt_pk_bf16_f32 v227, v126, v127
  v_mfma_f32_16x16x32_bf16 v[40:43], v[200:203], a[200:203], v[40:43]
  v_mfma_f32_16x16x32_bf16 v[44:47], v[200:203], a[204:207], v[44:47]
  ds_read_b64_tr_b16 v[200:201], v240 offset:28672
  ds_read_b64_tr_b16 v[202:203], v240 offset:28928
  s_waitcnt lgkmcnt(14)
  v_mfma_f32_16x16x32_bf16 v[48:51], v[204:207], a[192:195], v[48:51]
  v_mfma_f32_16x16x32_bf16 v[52:55], v[204:207], a[196:199], v[52:55]
  v_mfma_f32_16x16x32_bf16 v[56:59], v[204:207], a[200:203], v[56:59]
  v_mfma_f32_16x16x32_bf16 v[60:63], v[204:207], a[204:207], v[60:63]
  ds_read_b64_tr_b16 v[204:205], v241 offset:28672
  ds_read_b64_tr_b16 v[206:207], v241 offset:28928
  s_waitcnt lgkmcnt(14)
  v_mfma_f32_16x16x32_bf16 v[0:3], v[208:211], a[208:211], v[0:3]
  v_mfma_f32_16x16x32_bf16 v[4:7], v[208:211], a[212:215], v[4:7]
  v_mfma_f32_16x16x32_bf16 v[8:11], v[208:211], a[216:219], v[8:11]
  v_mfma_f32_16x16x32_bf16 v[12:15], v[208:211], a[220:223], v[12:15]
  ds_read_b64_tr_b16 v[208:209], v240 offset:26624
  ds_read_b64_tr_b16 v[210:211], v240 offset:26880
  s_waitcnt lgkmcnt(14)
  v_mfma_f32_16x16x32_bf16 v[16:19], v[212:215], a[208:211], v[16:19]
  v_mfma_f32_16x16x32_bf16 v[20:23], v[212:215], a[212:215], v[20:23]
  v_mfma_f32_16x16x32_bf16 v[24:27], v[212:215], a[216:219], v[24:27]
  v_mfma_f32_16x16x32_bf16 v[28:31], v[212:215], a[220:223], v[28:31]
  ds_read_b64_tr_b16 v[212:213], v241 offset:26624
  ds_read_b64_tr_b16 v[214:215], v241 offset:26880
  s_waitcnt lgkmcnt(14)
  v_mfma_f32_16x16x32_bf16 v[32:35], v[216:219], a[208:211], v[32:35]
  v_mfma_f32_16x16x32_bf16 v[36:39], v[216:219], a[212:215], v[36:39]
  buffer_store_dwordx4 v[224:227], v131, s[64:67], s87 offen offset:0 sc1
  v_mfma_f32_16x16x32_bf16 v[40:43], v[216:219], a[216:219], v[40:43]
  v_mfma_f32_16x16x32_bf16 v[44:47], v[216:219], a[220:223], v[44:47]
  ds_read_b64_tr_b16 v[216:217], v240 offset:30720
  ds_read_b64_tr_b16 v[218:219], v240 offset:30976
  s_waitcnt lgkmcnt(14)
  v_mfma_f32_16x16x32_bf16 v[48:51], v[220:223], a[208:211], v[48:51]
  v_mfma_f32_16x16x32_bf16 v[52:55], v[220:223], a[212:215], v[52:55]
  v_mfma_f32_16x16x32_bf16 v[56:59], v[220:223], a[216:219], v[56:59]
  v_mfma_f32_16x16x32_bf16 v[60:63], v[220:223], a[220:223], v[60:63]
  ds_read_b64_tr_b16 v[220:221], v241 offset:30720
  ds_read_b64_tr_b16 v[222:223], v241 offset:30976
  s_waitcnt lgkmcnt(14)
  v_mfma_f32_16x16x32_bf16 v[0:3], v[192:195], a[224:227], v[0:3]
  v_mfma_f32_16x16x32_bf16 v[4:7], v[192:195], a[228:231], v[4:7]
  v_mfma_f32_16x16x32_bf16 v[8:11], v[192:195], a[232:235], v[8:11]
  v_mfma_f32_16x16x32_bf16 v[12:15], v[192:195], a[236:239], v[12:15]
  ds_read_b64_tr_b16 v[192:193], v240 offset:32768
  ds_read_b64_tr_b16 v[194:195], v240 offset:33024
  s_waitcnt lgkmcnt(14)
  v_mfma_f32_16x16x32_bf16 v[16:19], v[196:199], a[224:227], v[16:19]
  v_mfma_f32_16x16x32_bf16 v[20:23], v[196:199], a[228:231], v[20:23]
  v_mfma_f32_16x16x32_bf16 v[24:27], v[196:199], a[232:235], v[24:27]
  v_mfma_f32_16x16x32_bf16 v[28:31], v[196:199], a[236:239], v[28:31]
  ds_read_b64_tr_b16 v[196:197], v241 offset:32768
  ds_read_b64_tr_b16 v[198:199], v241 offset:33024
  s_waitcnt lgkmcnt(14)
  v_mfma_f32_16x16x32_bf16 v[32:35], v[200:203], a[224:227], v[32:35]
  v_mfma_f32_16x16x32_bf16 v[36:39], v[200:203], a[228:231], v[36:39]
  v_mfma_f32_16x16x32_bf16 v[40:43], v[200:203], a[232:235], v[40:43]
  v_mfma_f32_16x16x32_bf16 v[44:47], v[200:203], a[236:239], v[44:47]
  ds_read_b64_tr_b16 v[200:201], v240 offset:36864
  ds_read_b64_tr_b16 v[202:203], v240 offset:37120
  s_waitcnt lgkmcnt(14)
  v_mfma_f32_16x16x32_bf16 v[48:51], v[204:207], a[224:227], v[48:51]
  v_mfma_f32_16x16x32_bf16 v[52:55], v[204:207], a[228:231], v[52:55]
  v_mfma_f32_16x16x32_bf16 v[56:59], v[204:207], a[232:235], v[56:59]
  v_mfma_f32_16x16x32_bf16 v[60:63], v[204:207], a[236:239], v[60:63]
  ds_read_b64_tr_b16 v[204:205], v241 offset:36864
  ds_read_b64_tr_b16 v[206:207], v241 offset:37120
  s_waitcnt lgkmcnt(14)
  v_mfma_f32_16x16x32_bf16 v[0:3], v[208:211], a[240:243], v[0:3]
  v_mfma_f32_16x16x32_bf16 v[4:7], v[208:211], a[244:247], v[4:7]
  v_mfma_f32_16x16x32_bf16 v[8:11], v[208:211], a[248:251], v[8:11]
  v_mfma_f32_16x16x32_bf16 v[12:15], v[208:211], a[252:255], v[12:15]
  ds_read_b64_tr_b16 v[208:209], v240 offset:34816
  ds_read_b64_tr_b16 v[210:211], v240 offset:35072
  s_waitcnt lgkmcnt(14)
  v_mfma_f32_16x16x32_bf16 v[16:19], v[212:215], a[240:243], v[16:19]
  v_mfma_f32_16x16x32_bf16 v[20:23], v[212:215], a[244:247], v[20:23]
  v_mfma_f32_16x16x32_bf16 v[24:27], v[212:215], a[248:251], v[24:27]
  v_mfma_f32_16x16x32_bf16 v[28:31], v[212:215], a[252:255], v[28:31]
  ds_read_b64_tr_b16 v[212:213], v241 offset:34816
  ds_read_b64_tr_b16 v[214:215], v241 offset:35072
  s_waitcnt lgkmcnt(14)
  v_mfma_f32_16x16x32_bf16 v[32:35], v[216:219], a[240:243], v[32:35]
  v_mfma_f32_16x16x32_bf16 v[36:39], v[216:219], a[244:247], v[36:39]
  v_mfma_f32_16x16x32_bf16 v[40:43], v[216:219], a[248:251], v[40:43]
  v_mfma_f32_16x16x32_bf16 v[44:47], v[216:219], a[252:255], v[44:47]
  ds_read_b64_tr_b16 v[216:217], v240 offset:38912
  ds_read_b64_tr_b16 v[218:219], v240 offset:39168
  s_waitcnt lgkmcnt(14)
  v_mfma_f32_16x16x32_bf16 v[48:51], v[220:223], a[240:243], v[48:51]
  v_mfma_f32_16x16x32_bf16 v[52:55], v[220:223], a[244:247], v[52:55]
  v_mfma_f32_16x16x32_bf16 v[56:59], v[220:223], a[248:251], v[56:59]
  v_mfma_f32_16x16x32_bf16 v[60:63], v[220:223], a[252:255], v[60:63]
  ds_read_b64_tr_b16 v[220:221], v241 offset:38912
  ds_read_b64_tr_b16 v[222:223], v241 offset:39168
  s_waitcnt vmcnt(13)
  s_barrier
  s_waitcnt lgkmcnt(14)
  v_mfma_f32_16x16x32_bf16 v[64:67], v[192:195], a[0:3], 0
  v_mfma_f32_16x16x32_bf16 v[68:71], v[192:195], a[4:7], 0
  v_mfma_f32_16x16x32_bf16 v[72:75], v[192:195], a[8:11], 0
  s_lshr_b32 s6, s3, 1
  s_add_u32 s6, s6, s14
  v_mfma_f32_16x16x32_bf16 v[76:79], v[192:195], a[12:15], 0
  ds_read_b64_tr_b16 v[192:193], v240 offset:40960
  ds_read_b64_tr_b16 v[194:195], v240 offset:41216
  s_waitcnt lgkmcnt(14)
  v_mfma_f32_16x16x32_bf16 v[80:83], v[196:199], a[0:3], 0
  s_add_u32 s6, s6, 0
  s_and_b32 s6, s6, 7
  v_mfma_f32_16x16x32_bf16 v[84:87], v[196:199], a[4:7], 0
  s_lshl_b32 s6, s6, 19
  s_add_u32 m0, s9, 16384
  v_mfma_f32_16x16x32_bf16 v[88:91], v[196:199], a[8:11], 0
  s_add_u32 s6, s6, s97
  buffer_load_dwordx4 v244, s[56:59], s6 offen offset:0 lds
  v_mfma_f32_16x16x32_bf16 v[92:95], v[196:199], a[12:15], 0
  ds_read_b64_tr_b16 v[196:197], v241 offset:40960
  ds_read_b64_tr_b16 v[198:199], v241 offset:41216
  s_waitcnt lgkmcnt(14)
  v_mfma_f32_16x16x32_bf16 v[96:99], v[200:203], a[0:3], 0
  buffer_load_dwordx4 v245, s[56:59], s6 offen offset:1024 lds
  buffer_load_dwordx4 v246, s[56:59], s6 offen offset:2048 lds
  v_mfma_f32_16x16x32_bf16 v[100:103], v[200:203], a[4:7], 0
  buffer_load_dwordx4 v247, s[56:59], s6 offen offset:3072 lds
  v_cvt_pk_bf16_f32 v228, v0, v1
  v_mfma_f32_16x16x32_bf16 v[104:107], v[200:203], a[8:11], 0
  v_mfma_f32_16x16x32_bf16 v[108:111], v[200:203], a[12:15], 0
  ds_read_b64_tr_b16 v[200:201], v240 offset:45056
  ds_read_b64_tr_b16 v[202:203], v240 offset:45312
  s_waitcnt lgkmcnt(14)
  v_mfma_f32_16x16x32_bf16 v[112:115], v[204:207], a[0:3], 0
  v_cvt_pk_bf16_f32 v229, v2, v3
  v_mfma_f32_16x16x32_bf16 v[116:119], v[204:207], a[4:7], 0
  v_mfma_f32_16x16x32_bf16 v[120:123], v[204:207], a[8:11], 0
  v_cvt_pk_bf16_f32 v230, v16, v17
  v_mfma_f32_16x16x32_bf16 v[124:127], v[204:207], a[12:15], 0
  ds_read_b64_tr_b16 v[204:205], v241 offset:45056
  ds_read_b64_tr_b16 v[206:207], v241 offset:45312
  s_waitcnt lgkmcnt(14)
  v_mfma_f32_16x16x32_bf16 v[64:67], v[208:211], a[16:19], v[64:67]
  v_mfma_f32_16x16x32_bf16 v[68:71], v[208:211], a[20:23], v[68:71]
  v_mfma_f32_16x16x32_bf16 v[72:75], v[208:211], a[24:27], v[72:75]
  v_cvt_pk_bf16_f32 v231, v18, v19
  v_mfma_f32_16x16x32_bf16 v[76:79], v[208:211], a[28:31], v[76:79]
  ds_read_b64_tr_b16 v[208:209], v240 offset:43008
  ds_read_b64_tr_b16 v[210:211], v240 offset:43264
  s_waitcnt lgkmcnt(14)
  v_mfma_f32_16x16x32_bf16 v[80:83], v[212:215], a[16:19], v[80:83]
  v_mfma_f32_16x16x32_bf16 v[84:87], v[212:215], a[20:23], v[84:87]
  buffer_store_dwordx4 v[228:231], v128, s[64:67], s88 offen offset:0 sc1
  v_mfma_f32_16x16x32_bf16 v[88:91], v[212:215], a[24:27], v[88:91]
  v_mfma_f32_16x16x32_bf16 v[92:95], v[212:215], a[28:31], v[92:95]
  ds_read_b64_tr_b16 v[212:213], v241 offset:43008
  ds_read_b64_tr_b16 v[214:215], v241 offset:43264
  s_waitcnt lgkmcnt(14)
  v_mfma_f32_16x16x32_bf16 v[96:99], v[216:219], a[16:19], v[96:99]
  v_cvt_pk_bf16_f32 v232, v4, v5
  v_mfma_f32_16x16x32_bf16 v[100:103], v[216:219], a[20:23], v[100:103]
  v_mfma_f32_16x16x32_bf16 v[104:107], v[216:219], a[24:27], v[104:107]
  v_mfma_f32_16x16x32_bf16 v[108:111], v[216:219], a[28:31], v[108:111]
  ds_read_b64_tr_b16 v[216:217], v240 offset:47104
  ds_read_b64_tr_b16 v[218:219], v240 offset:47360
  s_waitcnt lgkmcnt(14)
  v_mfma_f32_16x16x32_bf16 v[112:115], v[220:223], a[16:19], v[112:115]
  v_cvt_pk_bf16_f32 v233, v6, v7
  v_mfma_f32_16x16x32_bf16 v[116:119], v[220:223], a[20:23], v[116:119]
  v_mfma_f32_16x16x32_bf16 v[120:123], v[220:223], a[24:27], v[120:123]
  v_cvt_pk_bf16_f32 v234, v20, v21
  v_mfma_f32_16x16x32_bf16 v[124:127], v[220:223], a[28:31], v[124:127]
  ds_read_b64_tr_b16 v[220:221], v241 offset:47104
  ds_read_b64_tr_b16 v[222:223], v241 offset:47360
  s_waitcnt lgkmcnt(14)
  v_mfma_f32_16x16x32_bf16 v[64:67], v[192:195], a[32:35], v[64:67]
  v_mfma_f32_16x16x32_bf16 v[68:71], v[192:195], a[36:39], v[68:71]
  v_mfma_f32_16x16x32_bf16 v[72:75], v[192:195], a[40:43], v[72:75]
  v_cvt_pk_bf16_f32 v235, v22, v23
  v_mfma_f32_16x16x32_bf16 v[76:79], v[192:195], a[44:47], v[76:79]
  ds_read_b64_tr_b16 v[192:193], v240 offset:49152
  ds_read_b64_tr_b16 v[194:195], v240 offset:49408
  s_waitcnt lgkmcnt(14)
  v_mfma_f32_16x16x32_bf16 v[80:83], v[196:199], a[32:35], v[80:83]
  v_mfma_f32_16x16x32_bf16 v[84:87], v[196:199], a[36:39], v[84:87]
  buffer_store_dwordx4 v[232:235], v129, s[64:67], s88 offen offset:0 sc1
  v_mfma_f32_16x16x32_bf16 v[88:91], v[196:199], a[40:43], v[88:91]
  v_mfma_f32_16x16x32_bf16 v[92:95], v[196:199], a[44:47], v[92:95]
  ds_read_b64_tr_b16 v[196:197], v241 offset:49152
  ds_read_b64_tr_b16 v[198:199], v241 offset:49408
  s_waitcnt lgkmcnt(14)
  v_mfma_f32_16x16x32_bf16 v[96:99], v[200:203], a[32:35], v[96:99]
  v_mfma_f32_16x16x32_bf16 v[100:103], v[200:203], a[36:39], v[100:103]
  v_cvt_pk_bf16_f32 v224, v8, v9
  v_mfma_f32_16x16x32_bf16 v[104:107], v[200:203], a[40:43], v[104:107]
  v_mfma_f32_16x16x32_bf16 v[108:111], v[200:203], a[44:47], v[108:111]
  ds_read_b64_tr_b16 v[200:201], v240 offset:53248
  ds_read_b64_tr_b16 v[202:203], v240 offset:53504
  s_waitcnt lgkmcnt(14)
  v_mfma_f32_16x16x32_bf16 v[112:115], v[204:207], a[32:35], v[112:115]
  v_cvt_pk_bf16_f32 v225, v10, v11
  v_mfma_f32_16x16x32_bf16 v[116:119], v[204:207], a[36:39], v[116:119]
  v_mfma_f32_16x16x32_bf16 v[120:123], v[204:207], a[40:43], v[120:123]
  v_mfma_f32_16x16x32_bf16 v[124:127], v[204:207], a[44:47], v[124:127]
  ds_read_b64_tr_b16 v[204:205], v241 offset:53248
  ds_read_b64_tr_b16 v[206:207], v241 offset:53504
  s_waitcnt lgkmcnt(14)
  v_mfma_f32_16x16x32_bf16 v[64:67], v[208:211], a[48:51], v[64:67]
  v_cvt_pk_bf16_f32 v226, v24, v25
  v_mfma_f32_16x16x32_bf16 v[68:71], v[208:211], a[52:55], v[68:71]
  v_mfma_f32_16x16x32_bf16 v[72:75], v[208:211], a[56:59], v[72:75]
  v_mfma_f32_16x16x32_bf16 v[76:79], v[208:211], a[60:63], v[76:79]
  ds_read_b64_tr_b16 v[208:209], v240 offset:51200
  ds_read_b64_tr_b16 v[210:211], v240 offset:51456
  s_waitcnt lgkmcnt(14)
  v_mfma_f32_16x16x32_bf16 v[80:83], v[212:215], a[48:51], v[80:83]
  v_cvt_pk_bf16_f32 v227, v26, v27
  v_mfma_f32_16x16x32_bf16 v[84:87], v[212:215], a[52:55], v[84:87]
  v_mfma_f32_16x16x32_bf16 v[88:91], v[212:215], a[56:59], v[88:91]
  v_mfma_f32_16x16x32_bf16 v[92:95], v[212:215], a[60:63], v[92:95]
  ds_read_b64_tr_b16 v[212:213], v241 offset:51200
  ds_read_b64_tr_b16 v[214:215], v241 offset:51456
  s_waitcnt lgkmcnt(14)
  v_mfma_f32_16x16x32_bf16 v[96:99], v[216:219], a[48:51], v[96:99]
  buffer_store_dwordx4 v[224:227], v130, s[64:67], s88 offen offset:0 sc1
  v_mfma_f32_16x16x32_bf16 v[100:103], v[216:219], a[52:55], v[100:103]
  v_mfma_f32_16x16x32_bf16 v[104:107], v[216:219], a[56:59], v[104:107]
  v_mfma_f32_16x16x32_bf16 v[108:111], v[216:219], a[60:63], v[108:111]
  ds_read_b64_tr_b16 v[216:217], v240 offset:55296
  ds_read_b64_tr_b16 v[218:219], v240 offset:55552
  s_waitcnt lgkmcnt(14)
  v_mfma_f32_16x16x32_bf16 v[112:115], v[220:223], a[48:51], v[112:115]
  v_cvt_pk_bf16_f32 v228, v12, v13
  v_mfma_f32_16x16x32_bf16 v[116:119], v[220:223], a[52:55], v[116:119]
  v_mfma_f32_16x16x32_bf16 v[120:123], v[220:223], a[56:59], v[120:123]
  v_cvt_pk_bf16_f32 v229, v14, v15
  v_mfma_f32_16x16x32_bf16 v[124:127], v[220:223], a[60:63], v[124:127]
  ds_read_b64_tr_b16 v[220:221], v241 offset:55296
  ds_read_b64_tr_b16 v[222:223], v241 offset:55552
  s_waitcnt vmcnt(13)
  s_barrier
  s_waitcnt lgkmcnt(14)
  v_mfma_f32_16x16x32_bf16 v[64:67], v[192:195], a[64:67], v[64:67]
  v_mfma_f32_16x16x32_bf16 v[68:71], v[192:195], a[68:71], v[68:71]
  v_mfma_f32_16x16x32_bf16 v[72:75], v[192:195], a[72:75], v[72:75]
  s_lshr_b32 s6, s3, 1
  s_add_u32 s6, s6, s14
  v_mfma_f32_16x16x32_bf16 v[76:79], v[192:195], a[76:79], v[76:79]
  ds_read_b64_tr_b16 v[192:193], v240 offset:57344
  ds_read_b64_tr_b16 v[194:195], v240 offset:57600
  s_waitcnt lgkmcnt(14)
  v_mfma_f32_16x16x32_bf16 v[80:83], v[196:199], a[64:67], v[80:83]
  s_add_u32 s6, s6, 2
  s_and_b32 s6, s6, 7
  v_mfma_f32_16x16x32_bf16 v[84:87], v[196:199], a[68:71], v[84:87]
  s_lshl_b32 s6, s6, 19
  s_add_u32 m0, s9, 32768
  v_mfma_f32_16x16x32_bf16 v[88:91], v[196:199], a[72:75], v[88:91]
  s_add_u32 s6, s6, s97
  buffer_load_dwordx4 v244, s[56:59], s6 offen offset:0 lds
  v_mfma_f32_16x16x32_bf16 v[92:95], v[196:199], a[76:79], v[92:95]
  ds_read_b64_tr_b16 v[196:197], v241 offset:57344
  ds_read_b64_tr_b16 v[198:199], v241 offset:57600
  s_waitcnt lgkmcnt(14)
  v_mfma_f32_16x16x32_bf16 v[96:99], v[200:203], a[64:67], v[96:99]
  buffer_load_dwordx4 v245, s[56:59], s6 offen offset:1024 lds
  buffer_load_dwordx4 v246, s[56:59], s6 offen offset:2048 lds
  v_mfma_f32_16x16x32_bf16 v[100:103], v[200:203], a[68:71], v[100:103]
  buffer_load_dwordx4 v247, s[56:59], s6 offen offset:3072 lds
  v_cvt_pk_bf16_f32 v230, v28, v29
  v_mfma_f32_16x16x32_bf16 v[104:107], v[200:203], a[72:75], v[104:107]
  v_cvt_pk_bf16_f32 v231, v30, v31
  v_mfma_f32_16x16x32_bf16 v[108:111], v[200:203], a[76:79], v[108:111]
  ds_read_b64_tr_b16 v[200:201], v240 offset:61440
  ds_read_b64_tr_b16 v[202:203], v240 offset:61696
  s_waitcnt lgkmcnt(14)
  v_mfma_f32_16x16x32_bf16 v[112:115], v[204:207], a[64:67], v[112:115]
  buffer_store_dwordx4 v[228:231], v131, s[64:67], s88 offen offset:0 sc1
  v_mfma_f32_16x16x32_bf16 v[116:119], v[204:207], a[68:71], v[116:119]
  v_mfma_f32_16x16x32_bf16 v[120:123], v[204:207], a[72:75], v[120:123]
  v_mfma_f32_16x16x32_bf16 v[124:127], v[204:207], a[76:79], v[124:127]
  ds_read_b64_tr_b16 v[204:205], v241 offset:61440
  ds_read_b64_tr_b16 v[206:207], v241 offset:61696
  s_waitcnt lgkmcnt(14)
  v_mfma_f32_16x16x32_bf16 v[64:67], v[208:211], a[80:83], v[64:67]
  v_mfma_f32_16x16x32_bf16 v[68:71], v[208:211], a[84:87], v[68:71]
  v_cvt_pk_bf16_f32 v232, v32, v33
  v_mfma_f32_16x16x32_bf16 v[72:75], v[208:211], a[88:91], v[72:75]
  v_mfma_f32_16x16x32_bf16 v[76:79], v[208:211], a[92:95], v[76:79]
  ds_read_b64_tr_b16 v[208:209], v240 offset:59392
  ds_read_b64_tr_b16 v[210:211], v240 offset:59648
  s_waitcnt lgkmcnt(14)
  v_mfma_f32_16x16x32_bf16 v[80:83], v[212:215], a[80:83], v[80:83]
  v_mfma_f32_16x16x32_bf16 v[84:87], v[212:215], a[84:87], v[84:87]
  v_cvt_pk_bf16_f32 v233, v34, v35
  v_mfma_f32_16x16x32_bf16 v[88:91], v[212:215], a[88:91], v[88:91]
  v_mfma_f32_16x16x32_bf16 v[92:95], v[212:215], a[92:95], v[92:95]
  ds_read_b64_tr_b16 v[212:213], v241 offset:59392
  ds_read_b64_tr_b16 v[214:215], v241 offset:59648
  s_waitcnt lgkmcnt(14)
  v_mfma_f32_16x16x32_bf16 v[96:99], v[216:219], a[80:83], v[96:99]
  v_mfma_f32_16x16x32_bf16 v[100:103], v[216:219], a[84:87], v[100:103]
  v_cvt_pk_bf16_f32 v234, v48, v49
  v_mfma_f32_16x16x32_bf16 v[104:107], v[216:219], a[88:91], v[104:107]
  v_mfma_f32_16x16x32_bf16 v[108:111], v[216:219], a[92:95], v[108:111]
  ds_read_b64_tr_b16 v[216:217], v240 offset:63488
  ds_read_b64_tr_b16 v[218:219], v240 offset:63744
  s_waitcnt lgkmcnt(14)
  v_mfma_f32_16x16x32_bf16 v[112:115], v[220:223], a[80:83], v[112:115]
  v_mfma_f32_16x16x32_bf16 v[116:119], v[220:223], a[84:87], v[116:119]
  v_mfma_f32_16x16x32_bf16 v[120:123], v[220:223], a[88:91], v[120:123]
  v_cvt_pk_bf16_f32 v235, v50, v51
  v_mfma_f32_16x16x32_bf16 v[124:127], v[220:223], a[92:95], v[124:127]
  ds_read_b64_tr_b16 v[220:221], v241 offset:63488
  ds_read_b64_tr_b16 v[222:223], v241 offset:63744
  s_waitcnt lgkmcnt(14)
  v_mfma_f32_16x16x32_bf16 v[64:67], v[192:195], a[96:99], v[64:67]
  v_mfma_f32_16x16x32_bf16 v[68:71], v[192:195], a[100:103], v[68:71]
  v_mfma_f32_16x16x32_bf16 v[72:75], v[192:195], a[104:107], v[72:75]
  v_mfma_f32_16x16x32_bf16 v[76:79], v[192:195], a[108:111], v[76:79]
  ds_read_b64_tr_b16 v[192:193], v242 offset:0
  ds_read_b64_tr_b16 v[194:195], v242 offset:256
  s_waitcnt lgkmcnt(14)
  v_mfma_f32_16x16x32_bf16 v[80:83], v[196:199], a[96:99], v[80:83]
  buffer_store_dwordx4 v[232:235], v128, s[64:67], s89 offen offset:0 sc1
  v_mfma_f32_16x16x32_bf16 v[84:87], v[196:199], a[100:103], v[84:87]
  v_mfma_f32_16x16x32_bf16 v[88:91], v[196:199], a[104:107], v[88:91]
  v_mfma_f32_16x16x32_bf16 v[92:95], v[196:199], a[108:111], v[92:95]
  ds_read_b64_tr_b16 v[196:197], v243 offset:0
  ds_read_b64_tr_b16 v[198:199], v243 offset:256
  s_waitcnt lgkmcnt(14)
  v_mfma_f32_16x16x32_bf16 v[96:99], v[200:203], a[96:99], v[96:99]
  v_cvt_pk_bf16_f32 v224, v36, v37
  v_mfma_f32_16x16x32_bf16 v[100:103], v[200:203], a[100:103], v[100:103]
  v_mfma_f32_16x16x32_bf16 v[104:107], v[200:203], a[104:107], v[104:107]
  v_mfma_f32_16x16x32_bf16 v[108:111], v[200:203], a[108:111], v[108:111]
  ds_read_b64_tr_b16 v[200:201], v242 offset:4096
  ds_read_b64_tr_b16 v[202:203], v242 offset:4352
  s_waitcnt lgkmcnt(14)
  v_mfma_f32_16x16x32_bf16 v[112:115], v[204:207], a[96:99], v[112:115]
  v_cvt_pk_bf16_f32 v225, v38, v39
  v_mfma_f32_16x16x32_bf16 v[116:119], v[204:207], a[100:103], v[116:119]
  v_mfma_f32_16x16x32_bf16 v[120:123], v[204:207], a[104:107], v[120:123]
  v_mfma_f32_16x16x32_bf16 v[124:127], v[204:207], a[108:111], v[124:127]
  ds_read_b64_tr_b16 v[204:205], v243 offset:4096
  ds_read_b64_tr_b16 v[206:207], v243 offset:4352
  s_waitcnt lgkmcnt(14)
  v_mfma_f32_16x16x32_bf16 v[64:67], v[208:211], a[112:115], v[64:67]
  v_mfma_f32_16x16x32_bf16 v[68:71], v[208:211], a[116:119], v[68:71]
  v_mfma_f32_16x16x32_bf16 v[72:75], v[208:211], a[120:123], v[72:75]
  v_cvt_pk_bf16_f32 v226, v52, v53
  v_mfma_f32_16x16x32_bf16 v[76:79], v[208:211], a[124:127], v[76:79]
  ds_read_b64_tr_b16 v[208:209], v242 offset:2048
  ds_read_b64_tr_b16 v[210:211], v242 offset:2304
  s_waitcnt lgkmcnt(14)
  v_mfma_f32_16x16x32_bf16 v[80:83], v[212:215], a[112:115], v[80:83]
  v_mfma_f32_16x16x32_bf16 v[84:87], v[212:215], a[116:119], v[84:87]
  v_mfma_f32_16x16x32_bf16 v[88:91], v[212:215], a[120:123], v[88:91]
  v_mfma_f32_16x16x32_bf16 v[92:95], v[212:215], a[124:127], v[92:95]
  ds_read_b64_tr_b16 v[212:213], v243 offset:2048
  ds_read_b64_tr_b16 v[214:215], v243 offset:2304
  s_waitcnt lgkmcnt(14)
  v_mfma_f32_16x16x32_bf16 v[96:99], v[216:219], a[112:115], v[96:99]
  v_cvt_pk_bf16_f32 v227, v54, v55
  v_mfma_f32_16x16x32_bf16 v[100:103], v[216:219], a[116:119], v[100:103]
  v_mfma_f32_16x16x32_bf16 v[104:107], v[216:219], a[120:123], v[104:107]
  v_mfma_f32_16x16x32_bf16 v[108:111], v[216:219], a[124:127], v[108:111]
  ds_read_b64_tr_b16 v[216:217], v242 offset:6144
  ds_read_b64_tr_b16 v[218:219], v242 offset:6400
  s_waitcnt lgkmcnt(14)
  v_mfma_f32_16x16x32_bf16 v[112:115], v[220:223], a[112:115], v[112:115]
  buffer_store_dwordx4 v[224:227], v129, s[64:67], s89 offen offset:0 sc1
  v_mfma_f32_16x16x32_bf16 v[116:119], v[220:223], a[116:119], v[116:119]
  v_mfma_f32_16x16x32_bf16 v[120:123], v[220:223], a[120:123], v[120:123]
  v_mfma_f32_16x16x32_bf16 v[124:127], v[220:223], a[124:127], v[124:127]
  ds_read_b64_tr_b16 v[220:221], v243 offset:6144
  ds_read_b64_tr_b16 v[222:223], v243 offset:6400
  s_waitcnt vmcnt(15)
  s_barrier
  s_waitcnt lgkmcnt(14)
  v_mfma_f32_16x16x32_bf16 v[64:67], v[192:195], a[128:131], v[64:67]
  v_mfma_f32_16x16x32_bf16 v[68:71], v[192:195], a[132:135], v[68:71]
  v_mfma_f32_16x16x32_bf16 v[72:75], v[192:195], a[136:139], v[72:75]
  s_lshr_b32 s6, s3, 1
  s_add_u32 s6, s6, s14
  v_mfma_f32_16x16x32_bf16 v[76:79], v[192:195], a[140:143], v[76:79]
  ds_read_b64_tr_b16 v[192:193], v242 offset:8192
  ds_read_b64_tr_b16 v[194:195], v242 offset:8448
  s_waitcnt lgkmcnt(14)
  v_mfma_f32_16x16x32_bf16 v[80:83], v[196:199], a[128:131], v[80:83]
  s_add_u32 s6, s6, 4
  s_and_b32 s6, s6, 7
  v_mfma_f32_16x16x32_bf16 v[84:87], v[196:199], a[132:135], v[84:87]
  s_lshl_b32 s6, s6, 19
  s_add_u32 m0, s9, 49152
  v_mfma_f32_16x16x32_bf16 v[88:91], v[196:199], a[136:139], v[88:91]
  s_add_u32 s6, s6, s97
  buffer_load_dwordx4 v244, s[56:59], s6 offen offset:0 lds
  v_mfma_f32_16x16x32_bf16 v[92:95], v[196:199], a[140:143], v[92:95]
  ds_read_b64_tr_b16 v[196:197], v243 offset:8192
  ds_read_b64_tr_b16 v[198:199], v243 offset:8448
  s_waitcnt lgkmcnt(14)
  v_mfma_f32_16x16x32_bf16 v[96:99], v[200:203], a[128:131], v[96:99]
  buffer_load_dwordx4 v245, s[56:59], s6 offen offset:1024 lds
  buffer_load_dwordx4 v246, s[56:59], s6 offen offset:2048 lds
  v_mfma_f32_16x16x32_bf16 v[100:103], v[200:203], a[132:135], v[100:103]
  buffer_load_dwordx4 v247, s[56:59], s6 offen offset:3072 lds
  v_cvt_pk_bf16_f32 v228, v40, v41
  v_mfma_f32_16x16x32_bf16 v[104:107], v[200:203], a[136:139], v[104:107]
  v_cvt_pk_bf16_f32 v229, v42, v43
  v_mfma_f32_16x16x32_bf16 v[108:111], v[200:203], a[140:143], v[108:111]
  ds_read_b64_tr_b16 v[200:201], v242 offset:12288
  ds_read_b64_tr_b16 v[202:203], v242 offset:12544
  s_waitcnt lgkmcnt(14)
  v_mfma_f32_16x16x32_bf16 v[112:115], v[204:207], a[128:131], v[112:115]
  v_mfma_f32_16x16x32_bf16 v[116:119], v[204:207], a[132:135], v[116:119]
  v_mfma_f32_16x16x32_bf16 v[120:123], v[204:207], a[136:139], v[120:123]
  v_mfma_f32_16x16x32_bf16 v[124:127], v[204:207], a[140:143], v[124:127]
  ds_read_b64_tr_b16 v[204:205], v243 offset:12288
  ds_read_b64_tr_b16 v[206:207], v243 offset:12544
  s_waitcnt lgkmcnt(14)
  v_mfma_f32_16x16x32_bf16 v[64:67], v[208:211], a[144:147], v[64:67]
  v_cvt_pk_bf16_f32 v230, v56, v57
  v_mfma_f32_16x16x32_bf16 v[68:71], v[208:211], a[148:151], v[68:71]
  v_mfma_f32_16x16x32_bf16 v[72:75], v[208:211], a[152:155], v[72:75]
  v_mfma_f32_16x16x32_bf16 v[76:79], v[208:211], a[156:159], v[76:79]
  ds_read_b64_tr_b16 v[208:209], v242 offset:10240
  ds_read_b64_tr_b16 v[210:211], v242 offset:10496
  s_waitcnt lgkmcnt(14)
  v_mfma_f32_16x16x32_bf16 v[80:83], v[212:215], a[144:147], v[80:83]
  v_mfma_f32_16x16x32_bf16 v[84:87], v[212:215], a[148:151], v[84:87]
  v_mfma_f32_16x16x32_bf16 v[88:91], v[212:215], a[152:155], v[88:91]
  v_cvt_pk_bf16_f32 v231, v58, v59
  v_mfma_f32_16x16x32_bf16 v[92:95], v[212:215], a[156:159], v[92:95]
  ds_read_b64_tr_b16 v[212:213], v243 offset:10240
  ds_read_b64_tr_b16 v[214:215], v243 offset:10496
  s_waitcnt lgkmcnt(14)
  v_mfma_f32_16x16x32_bf16 v[96:99], v[216:219], a[144:147], v[96:99]
  v_mfma_f32_16x16x32_bf16 v[100:103], v[216:219], a[148:151], v[100:103]
  v_mfma_f32_16x16x32_bf16 v[104:107], v[216:219], a[152:155], v[104:107]
  v_mfma_f32_16x16x32_bf16 v[108:111], v[216:219], a[156:159], v[108:111]
  ds_read_b64_tr_b16 v[216:217], v242 offset:14336
  ds_read_b64_tr_b16 v[218:219], v242 offset:14592
  s_waitcnt lgkmcnt(14)
  v_mfma_f32_16x16x32_bf16 v[112:115], v[220:223], a[144:147], v[112:115]
  v_mfma_f32_16x16x32_bf16 v[116:119], v[220:223], a[148:151], v[116:119]
  buffer_store_dwordx4 v[228:231], v130, s[64:67], s89 offen offset:0 sc1
  v_mfma_f32_16x16x32_bf16 v[120:123], v[220:223], a[152:155], v[120:123]
  v_mfma_f32_16x16x32_bf16 v[124:127], v[220:223], a[156:159], v[124:127]
  ds_read_b64_tr_b16 v[220:221], v243 offset:14336
  ds_read_b64_tr_b16 v[222:223], v243 offset:14592
  s_waitcnt lgkmcnt(14)
  v_mfma_f32_16x16x32_bf16 v[64:67], v[192:195], a[160:163], v[64:67]
  v_mfma_f32_16x16x32_bf16 v[68:71], v[192:195], a[164:167], v[68:71]
  v_mfma_f32_16x16x32_bf16 v[72:75], v[192:195], a[168:171], v[72:75]
  v_mfma_f32_16x16x32_bf16 v[76:79], v[192:195], a[172:175], v[76:79]
  ds_read_b64_tr_b16 v[192:193], v240 offset:0
  ds_read_b64_tr_b16 v[194:195], v240 offset:256
  s_waitcnt lgkmcnt(14)
  v_mfma_f32_16x16x32_bf16 v[80:83], v[196:199], a[160:163], v[80:83]
  v_mfma_f32_16x16x32_bf16 v[84:87], v[196:199], a[164:167], v[84:87]
  v_mfma_f32_16x16x32_bf16 v[88:91], v[196:199], a[168:171], v[88:91]
  v_cvt_pk_bf16_f32 v232, v44, v45
  v_mfma_f32_16x16x32_bf16 v[92:95], v[196:199], a[172:175], v[92:95]
  ds_read_b64_tr_b16 v[196:197], v241 offset:0
  ds_read_b64_tr_b16 v[198:199], v241 offset:256
  s_waitcnt lgkmcnt(14)
  v_mfma_f32_16x16x32_bf16 v[96:99], v[200:203], a[160:163], v[96:99]
  v_mfma_f32_16x16x32_bf16 v[100:103], v[200:203], a[164:167], v[100:103]
  v_mfma_f32_16x16x32_bf16 v[104:107], v[200:203], a[168:171], v[104:107]
  v_mfma_f32_16x16x32_bf16 v[108:111], v[200:203], a[172:175], v[108:111]
  ds_read_b64_tr_b16 v[200:201], v240 offset:4096
  ds_read_b64_tr_b16 v[202:203], v240 offset:4352
  s_waitcnt lgkmcnt(14)
  v_mfma_f32_16x16x32_bf16 v[112:115], v[204:207], a[160:163], v[112:115]
  v_mfma_f32_16x16x32_bf16 v[116:119], v[204:207], a[164:167], v[116:119]
  v_mfma_f32_16x16x32_bf16 v[120:123], v[204:207], a[168:171], v[120:123]
  v_mfma_f32_16x16x32_bf16 v[124:127], v[204:207], a[172:175], v[124:127]
  ds_read_b64_tr_b16 v[204:205], v241 offset:4096
  ds_read_b64_tr_b16 v[206:207], v241 offset:4352
  s_waitcnt lgkmcnt(14)
  v_mfma_f32_16x16x32_bf16 v[64:67], v[208:211], a[176:179], v[64:67]
  v_cvt_pk_bf16_f32 v233, v46, v47
  v_mfma_f32_16x16x32_bf16 v[68:71], v[208:211], a[180:183], v[68:71]
  v_mfma_f32_16x16x32_bf16 v[72:75], v[208:211], a[184:187], v[72:75]
  v_mfma_f32_16x16x32_bf16 v[76:79], v[208:211], a[188:191], v[76:79]
  ds_read_b64_tr_b16 v[208:209], v240 offset:2048
  ds_read_b64_tr_b16 v[210:211], v240 offset:2304
  s_waitcnt lgkmcnt(14)
  v_mfma_f32_16x16x32_bf16 v[80:83], v[212:215], a[176:179], v[80:83]
  v_mfma_f32_16x16x32_bf16 v[84:87], v[212:215], a[180:183], v[84:87]
  v_mfma_f32_16x16x32_bf16 v[88:91], v[212:215], a[184:187], v[88:91]
  v_mfma_f32_16x16x32_bf16 v[92:95], v[212:215], a[188:191], v[92:95]
  ds_read_b64_tr_b16 v[212:213], v241 offset:2048
  ds_read_b64_tr_b16 v[214:215], v241 offset:2304
  s_waitcnt lgkmcnt(14)
  v_mfma_f32_16x16x32_bf16 v[96:99], v[216:219], a[176:179], v[96:99]
  v_mfma_f32_16x16x32_bf16 v[100:103], v[216:219], a[180:183], v[100:103]
  v_mfma_f32_16x16x32_bf16 v[104:107], v[216:219], a[184:187], v[104:107]
  v_cvt_pk_bf16_f32 v234, v60, v61
  v_mfma_f32_16x16x32_bf16 v[108:111], v[216:219], a[188:191], v[108:111]
  ds_read_b64_tr_b16 v[216:217], v240 offset:6144
  ds_read_b64_tr_b16 v[218:219], v240 offset:6400
  s_waitcnt lgkmcnt(14)
  v_mfma_f32_16x16x32_bf16 v[112:115], v[220:223], a[176:179], v[112:115]
  v_mfma_f32_16x16x32_bf16 v[116:119], v[220:223], a[180:183], v[116:119]
  v_mfma_f32_16x16x32_bf16 v[120:123], v[220:223], a[184:187], v[120:123]
  v_mfma_f32_16x16x32_bf16 v[124:127], v[220:223], a[188:191], v[124:127]
  ds_read_b64_tr_b16 v[220:221], v241 offset:6144
  ds_read_b64_tr_b16 v[222:223], v241 offset:6400
  s_waitcnt vmcnt(15)
  s_barrier
  s_waitcnt lgkmcnt(14)
  v_mfma_f32_16x16x32_bf16 v[64:67], v[192:195], a[192:195], v[64:67]
  v_mfma_f32_16x16x32_bf16 v[68:71], v[192:195], a[196:199], v[68:71]
  v_mfma_f32_16x16x32_bf16 v[72:75], v[192:195], a[200:203], v[72:75]
  s_lshr_b32 s6, s3, 1
  s_add_u32 s6, s6, s14
  v_mfma_f32_16x16x32_bf16 v[76:79], v[192:195], a[204:207], v[76:79]
  ds_read_b64_tr_b16 v[192:193], v240 offset:8192
  ds_read_b64_tr_b16 v[194:195], v240 offset:8448
  s_waitcnt lgkmcnt(14)
  v_mfma_f32_16x16x32_bf16 v[80:83], v[196:199], a[192:195], v[80:83]
  s_add_u32 s6, s6, 6
  s_and_b32 s6, s6, 7
  v_mfma_f32_16x16x32_bf16 v[84:87], v[196:199], a[196:199], v[84:87]
  s_lshl_b32 s6, s6, 19
  s_add_u32 m0, s9, 65536
  v_mfma_f32_16x16x32_bf16 v[88:91], v[196:199], a[200:203], v[88:91]
  s_add_u32 s6, s6, s97
  buffer_load_dwordx4 v244, s[56:59], s6 offen offset:0 lds
  v_mfma_f32_16x16x32_bf16 v[92:95], v[196:199], a[204:207], v[92:95]
  ds_read_b64_tr_b16 v[196:197], v241 offset:8192
  ds_read_b64_tr_b16 v[198:199], v241 offset:8448
  s_waitcnt lgkmcnt(14)
  v_mfma_f32_16x16x32_bf16 v[96:99], v[200:203], a[192:195], v[96:99]
  buffer_load_dwordx4 v245, s[56:59], s6 offen offset:1024 lds
  buffer_load_dwordx4 v246, s[56:59], s6 offen offset:2048 lds
  v_mfma_f32_16x16x32_bf16 v[100:103], v[200:203], a[196:199], v[100:103]
  buffer_load_dwordx4 v247, s[56:59], s6 offen offset:3072 lds
  v_cvt_pk_bf16_f32 v235, v62, v63
  v_mfma_f32_16x16x32_bf16 v[104:107], v[200:203], a[200:203], v[104:107]
  v_mfma_f32_16x16x32_bf16 v[108:111], v[200:203], a[204:207], v[108:111]
  ds_read_b64_tr_b16 v[200:201], v240 offset:12288
  ds_read_b64_tr_b16 v[202:203], v240 offset:12544
  s_waitcnt lgkmcnt(14)
  v_mfma_f32_16x16x32_bf16 v[112:115], v[204:207], a[192:195], v[112:115]
  v_mfma_f32_16x16x32_bf16 v[116:119], v[204:207], a[196:199], v[116:119]
  v_mfma_f32_16x16x32_bf16 v[120:123], v[204:207], a[200:203], v[120:123]
  v_mfma_f32_16x16x32_bf16 v[124:127], v[204:207], a[204:207], v[124:127]
  ds_read_b64_tr_b16 v[204:205], v241 offset:12288
  ds_read_b64_tr_b16 v[206:207], v241 offset:12544
  s_waitcnt lgkmcnt(14)
  v_mfma_f32_16x16x32_bf16 v[64:67], v[208:211], a[208:211], v[64:67]
  v_mfma_f32_16x16x32_bf16 v[68:71], v[208:211], a[212:215], v[68:71]
  v_mfma_f32_16x16x32_bf16 v[72:75], v[208:211], a[216:219], v[72:75]
  v_mfma_f32_16x16x32_bf16 v[76:79], v[208:211], a[220:223], v[76:79]
  ds_read_b64_tr_b16 v[208:209], v240 offset:10240
  ds_read_b64_tr_b16 v[210:211], v240 offset:10496
  s_waitcnt lgkmcnt(14)
  v_mfma_f32_16x16x32_bf16 v[80:83], v[212:215], a[208:211], v[80:83]
  v_mfma_f32_16x16x32_bf16 v[84:87], v[212:215], a[212:215], v[84:87]
  v_mfma_f32_16x16x32_bf16 v[88:91], v[212:215], a[216:219], v[88:91]
  v_mfma_f32_16x16x32_bf16 v[92:95], v[212:215], a[220:223], v[92:95]
  ds_read_b64_tr_b16 v[212:213], v241 offset:10240
  ds_read_b64_tr_b16 v[214:215], v241 offset:10496
  s_waitcnt lgkmcnt(14)
  v_mfma_f32_16x16x32_bf16 v[96:99], v[216:219], a[208:211], v[96:99]
  v_mfma_f32_16x16x32_bf16 v[100:103], v[216:219], a[212:215], v[100:103]
  buffer_store_dwordx4 v[232:235], v131, s[64:67], s89 offen offset:0 sc1
  v_mfma_f32_16x16x32_bf16 v[104:107], v[216:219], a[216:219], v[104:107]
  v_mfma_f32_16x16x32_bf16 v[108:111], v[216:219], a[220:223], v[108:111]
  ds_read_b64_tr_b16 v[216:217], v240 offset:14336
  ds_read_b64_tr_b16 v[218:219], v240 offset:14592
  s_waitcnt lgkmcnt(14)
  v_mfma_f32_16x16x32_bf16 v[112:115], v[220:223], a[208:211], v[112:115]
  v_mfma_f32_16x16x32_bf16 v[116:119], v[220:223], a[212:215], v[116:119]
  v_mfma_f32_16x16x32_bf16 v[120:123], v[220:223], a[216:219], v[120:123]
  v_mfma_f32_16x16x32_bf16 v[124:127], v[220:223], a[220:223], v[124:127]
  ds_read_b64_tr_b16 v[220:221], v241 offset:14336
  ds_read_b64_tr_b16 v[222:223], v241 offset:14592
  s_waitcnt lgkmcnt(14)
  v_mfma_f32_16x16x32_bf16 v[64:67], v[192:195], a[224:227], v[64:67]
  v_mfma_f32_16x16x32_bf16 v[68:71], v[192:195], a[228:231], v[68:71]
  v_mfma_f32_16x16x32_bf16 v[72:75], v[192:195], a[232:235], v[72:75]
  v_mfma_f32_16x16x32_bf16 v[76:79], v[192:195], a[236:239], v[76:79]
  ds_read_b64_tr_b16 v[192:193], v240 offset:16384
  ds_read_b64_tr_b16 v[194:195], v240 offset:16640
  s_waitcnt lgkmcnt(14)
  v_mfma_f32_16x16x32_bf16 v[80:83], v[196:199], a[224:227], v[80:83]
  v_mfma_f32_16x16x32_bf16 v[84:87], v[196:199], a[228:231], v[84:87]
  v_mfma_f32_16x16x32_bf16 v[88:91], v[196:199], a[232:235], v[88:91]
  v_mfma_f32_16x16x32_bf16 v[92:95], v[196:199], a[236:239], v[92:95]
  ds_read_b64_tr_b16 v[196:197], v241 offset:16384
  ds_read_b64_tr_b16 v[198:199], v241 offset:16640
  s_waitcnt lgkmcnt(14)
  v_mfma_f32_16x16x32_bf16 v[96:99], v[200:203], a[224:227], v[96:99]
  v_mfma_f32_16x16x32_bf16 v[100:103], v[200:203], a[228:231], v[100:103]
  v_mfma_f32_16x16x32_bf16 v[104:107], v[200:203], a[232:235], v[104:107]
  v_mfma_f32_16x16x32_bf16 v[108:111], v[200:203], a[236:239], v[108:111]
  ds_read_b64_tr_b16 v[200:201], v240 offset:20480
  ds_read_b64_tr_b16 v[202:203], v240 offset:20736
  s_waitcnt lgkmcnt(14)
  v_mfma_f32_16x16x32_bf16 v[112:115], v[204:207], a[224:227], v[112:115]
  v_mfma_f32_16x16x32_bf16 v[116:119], v[204:207], a[228:231], v[116:119]
  v_mfma_f32_16x16x32_bf16 v[120:123], v[204:207], a[232:235], v[120:123]
  v_mfma_f32_16x16x32_bf16 v[124:127], v[204:207], a[236:239], v[124:127]
  ds_read_b64_tr_b16 v[204:205], v241 offset:20480
  ds_read_b64_tr_b16 v[206:207], v241 offset:20736
  s_waitcnt lgkmcnt(14)
  v_mfma_f32_16x16x32_bf16 v[64:67], v[208:211], a[240:243], v[64:67]
  v_mfma_f32_16x16x32_bf16 v[68:71], v[208:211], a[244:247], v[68:71]
  v_mfma_f32_16x16x32_bf16 v[72:75], v[208:211], a[248:251], v[72:75]
  v_mfma_f32_16x16x32_bf16 v[76:79], v[208:211], a[252:255], v[76:79]
  ds_read_b64_tr_b16 v[208:209], v240 offset:18432
  ds_read_b64_tr_b16 v[210:211], v240 offset:18688
  s_waitcnt lgkmcnt(14)
  v_mfma_f32_16x16x32_bf16 v[80:83], v[212:215], a[240:243], v[80:83]
  v_mfma_f32_16x16x32_bf16 v[84:87], v[212:215], a[244:247], v[84:87]
  v_mfma_f32_16x16x32_bf16 v[88:91], v[212:215], a[248:251], v[88:91]
  v_mfma_f32_16x16x32_bf16 v[92:95], v[212:215], a[252:255], v[92:95]
  ds_read_b64_tr_b16 v[212:213], v241 offset:18432
  ds_read_b64_tr_b16 v[214:215], v241 offset:18688
  s_waitcnt lgkmcnt(14)
  v_mfma_f32_16x16x32_bf16 v[96:99], v[216:219], a[240:243], v[96:99]
  v_mfma_f32_16x16x32_bf16 v[100:103], v[216:219], a[244:247], v[100:103]
  v_mfma_f32_16x16x32_bf16 v[104:107], v[216:219], a[248:251], v[104:107]
  v_mfma_f32_16x16x32_bf16 v[108:111], v[216:219], a[252:255], v[108:111]
  ds_read_b64_tr_b16 v[216:217], v240 offset:22528
  ds_read_b64_tr_b16 v[218:219], v240 offset:22784
  s_waitcnt lgkmcnt(14)
  v_mfma_f32_16x16x32_bf16 v[112:115], v[220:223], a[240:243], v[112:115]
  v_mfma_f32_16x16x32_bf16 v[116:119], v[220:223], a[244:247], v[116:119]
  v_mfma_f32_16x16x32_bf16 v[120:123], v[220:223], a[248:251], v[120:123]
  v_mfma_f32_16x16x32_bf16 v[124:127], v[220:223], a[252:255], v[124:127]
  ds_read_b64_tr_b16 v[220:221], v241 offset:22528
  ds_read_b64_tr_b16 v[222:223], v241 offset:22784
  s_waitcnt vmcnt(13)
  s_barrier
  s_waitcnt lgkmcnt(14)
  v_mfma_f32_16x16x32_bf16 v[0:3], v[192:195], a[0:3], 0
  v_mfma_f32_16x16x32_bf16 v[4:7], v[192:195], a[4:7], 0
  v_mfma_f32_16x16x32_bf16 v[8:11], v[192:195], a[8:11], 0
  v_mfma_f32_16x16x32_bf16 v[12:15], v[192:195], a[12:15], 0
  ds_read_b64_tr_b16 v[192:193], v240 offset:24576
  ds_read_b64_tr_b16 v[194:195], v240 offset:24832
  s_waitcnt lgkmcnt(14)
  v_mfma_f32_16x16x32_bf16 v[16:19], v[196:199], a[0:3], 0
  v_mfma_f32_16x16x32_bf16 v[20:23], v[196:199], a[4:7], 0
  v_mfma_f32_16x16x32_bf16 v[24:27], v[196:199], a[8:11], 0
  v_mfma_f32_16x16x32_bf16 v[28:31], v[196:199], a[12:15], 0
  ds_read_b64_tr_b16 v[196:197], v241 offset:24576
  ds_read_b64_tr_b16 v[198:199], v241 offset:24832
  s_waitcnt lgkmcnt(14)
  v_mfma_f32_16x16x32_bf16 v[32:35], v[200:203], a[0:3], 0
  s_mov_b32 s72, s16
  v_mfma_f32_16x16x32_bf16 v[36:39], v[200:203], a[4:7], 0
  s_and_b32 s73, s17, 0xffff
  v_mfma_f32_16x16x32_bf16 v[40:43], v[200:203], a[8:11], 0
  v_mfma_f32_16x16x32_bf16 v[44:47], v[200:203], a[12:15], 0
  ds_read_b64_tr_b16 v[200:201], v240 offset:28672
  ds_read_b64_tr_b16 v[202:203], v240 offset:28928
  s_waitcnt lgkmcnt(14)
  v_mfma_f32_16x16x32_bf16 v[48:51], v[204:207], a[0:3], 0
  s_mov_b32 s74, 2097152
  s_mov_b32 s75, 0x00020000
  v_mfma_f32_16x16x32_bf16 v[52:55], v[204:207], a[4:7], 0
  v_mfma_f32_16x16x32_bf16 v[56:59], v[204:207], a[8:11], 0
  s_lshl_b32 s8, s2, 2
  v_mfma_f32_16x16x32_bf16 v[60:63], v[204:207], a[12:15], 0
  ds_read_b64_tr_b16 v[204:205], v241 offset:28672
  ds_read_b64_tr_b16 v[206:207], v241 offset:28928
  s_waitcnt lgkmcnt(14)
  v_mfma_f32_16x16x32_bf16 v[0:3], v[208:211], a[16:19], v[0:3]
  s_add_u32 s8, s8, s3
  v_mfma_f32_16x16x32_bf16 v[4:7], v[208:211], a[20:23], v[4:7]
  s_mul_i32 s8, s8, 2048
  v_mfma_f32_16x16x32_bf16 v[8:11], v[208:211], a[24:27], v[8:11]
  v_mfma_f32_16x16x32_bf16 v[12:15], v[208:211], a[28:31], v[12:15]
  ds_read_b64_tr_b16 v[208:209], v240 offset:26624
  ds_read_b64_tr_b16 v[210:211], v240 offset:26880
  s_waitcnt lgkmcnt(14)
  v_mfma_f32_16x16x32_bf16 v[16:19], v[212:215], a[16:19], v[16:19]
  buffer_load_dwordx4 v[144:147], v140, s[72:75], s8 offen offset:0
  v_mfma_f32_16x16x32_bf16 v[20:23], v[212:215], a[20:23], v[20:23]
  buffer_load_dwordx4 v[144:147], v140, s[72:75], s8 offen offset:1024
  v_mfma_f32_16x16x32_bf16 v[24:27], v[212:215], a[24:27], v[24:27]
  v_mfma_f32_16x16x32_bf16 v[28:31], v[212:215], a[28:31], v[28:31]
  ds_read_b64_tr_b16 v[212:213], v241 offset:26624
  ds_read_b64_tr_b16 v[214:215], v241 offset:26880
  s_waitcnt lgkmcnt(14)
  v_mfma_f32_16x16x32_bf16 v[32:35], v[216:219], a[16:19], v[32:35]
  s_mov_b32 s72, s20
  v_mfma_f32_16x16x32_bf16 v[36:39], v[216:219], a[20:23], v[36:39]
  s_and_b32 s73, s21, 0xffff
  v_mfma_f32_16x16x32_bf16 v[40:43], v[216:219], a[24:27], v[40:43]
  s_mov_b32 s74, 4194304
  v_mfma_f32_16x16x32_bf16 v[44:47], v[216:219], a[28:31], v[44:47]
  ds_read_b64_tr_b16 v[216:217], v240 offset:30720
  ds_read_b64_tr_b16 v[218:219], v240 offset:30976
  s_waitcnt lgkmcnt(14)
  v_mfma_f32_16x16x32_bf16 v[48:51], v[220:223], a[16:19], v[48:51]
  s_mov_b32 s75, 0x00020000
  v_mfma_f32_16x16x32_bf16 v[52:55], v[220:223], a[20:23], v[52:55]
  v_mfma_f32_16x16x32_bf16 v[56:59], v[220:223], a[24:27], v[56:59]
  s_lshl_b32 s8, s2, 2
  v_mfma_f32_16x16x32_bf16 v[60:63], v[220:223], a[28:31], v[60:63]
  ds_read_b64_tr_b16 v[220:221], v241 offset:30720
  ds_read_b64_tr_b16 v[222:223], v241 offset:30976
  s_waitcnt lgkmcnt(14)
  v_mfma_f32_16x16x32_bf16 v[0:3], v[192:195], a[32:35], v[0:3]
  s_add_u32 s8, s8, s3
  v_mfma_f32_16x16x32_bf16 v[4:7], v[192:195], a[36:39], v[4:7]
  v_mfma_f32_16x16x32_bf16 v[8:11], v[192:195], a[40:43], v[8:11]
  s_mul_i32 s8, s8, 4096
  v_mfma_f32_16x16x32_bf16 v[12:15], v[192:195], a[44:47], v[12:15]
  ds_read_b64_tr_b16 v[192:193], v240 offset:32768
  ds_read_b64_tr_b16 v[194:195], v240 offset:33024
  s_waitcnt lgkmcnt(14)
  v_mfma_f32_16x16x32_bf16 v[16:19], v[196:199], a[32:35], v[16:19]
  buffer_load_dwordx4 v[144:147], v140, s[72:75], s8 offen offset:0
  v_mfma_f32_16x16x32_bf16 v[20:23], v[196:199], a[36:39], v[20:23]
  v_mfma_f32_16x16x32_bf16 v[24:27], v[196:199], a[40:43], v[24:27]
  buffer_load_dwordx4 v[144:147], v140, s[72:75], s8 offen offset:1024
  v_mfma_f32_16x16x32_bf16 v[28:31], v[196:199], a[44:47], v[28:31]
  ds_read_b64_tr_b16 v[196:197], v241 offset:32768
  ds_read_b64_tr_b16 v[198:199], v241 offset:33024
  s_waitcnt lgkmcnt(14)
  v_mfma_f32_16x16x32_bf16 v[32:35], v[200:203], a[32:35], v[32:35]
  buffer_load_dwordx4 v[144:147], v140, s[72:75], s8 offen offset:2048
  v_mfma_f32_16x16x32_bf16 v[36:39], v[200:203], a[36:39], v[36:39]
  v_mfma_f32_16x16x32_bf16 v[40:43], v[200:203], a[40:43], v[40:43]
  buffer_load_dwordx4 v[144:147], v140, s[72:75], s8 offen offset:3072
  v_mfma_f32_16x16x32_bf16 v[44:47], v[200:203], a[44:47], v[44:47]
  ds_read_b64_tr_b16 v[200:201], v240 offset:36864
  ds_read_b64_tr_b16 v[202:203], v240 offset:37120
  s_waitcnt lgkmcnt(14)
  v_mfma_f32_16x16x32_bf16 v[48:51], v[204:207], a[32:35], v[48:51]
  s_getpc_b64 s[76:77]
  K1n_K10: s_add_u32 s76, s76, k2_kernel-K1n_K10
  s_addc_u32 s77, s77, 0
  v_mfma_f32_16x16x32_bf16 v[52:55], v[204:207], a[36:39], v[52:55]
  v_mfma_f32_16x16x32_bf16 v[56:59], v[204:207], a[40:43], v[56:59]
  s_lshl_b32 s8, s2, 2
  v_mfma_f32_16x16x32_bf16 v[60:63], v[204:207], a[44:47], v[60:63]
  ds_read_b64_tr_b16 v[204:205], v241 offset:36864
  ds_read_b64_tr_b16 v[206:207], v241 offset:37120
  s_waitcnt lgkmcnt(14)
  v_mfma_f32_16x16x32_bf16 v[0:3], v[208:211], a[48:51], v[0:3]
  s_add_u32 s8, s8, s3
  v_mfma_f32_16x16x32_bf16 v[4:7], v[208:211], a[52:55], v[4:7]
  v_mfma_f32_16x16x32_bf16 v[8:11], v[208:211], a[56:59], v[8:11]
  s_lshl_b32 s8, s8, 10
  v_mfma_f32_16x16x32_bf16 v[12:15], v[208:211], a[60:63], v[12:15]
  ds_read_b64_tr_b16 v[208:209], v240 offset:34816
  ds_read_b64_tr_b16 v[210:211], v240 offset:35072
  s_waitcnt lgkmcnt(14)
  v_mfma_f32_16x16x32_bf16 v[16:19], v[212:215], a[48:51], v[16:19]
  v_mfma_f32_16x16x32_bf16 v[20:23], v[212:215], a[52:55], v[20:23]
  v_add_u32 v142, s8, v140
  v_mfma_f32_16x16x32_bf16 v[24:27], v[212:215], a[56:59], v[24:27]
  v_mfma_f32_16x16x32_bf16 v[28:31], v[212:215], a[60:63], v[28:31]
  ds_read_b64_tr_b16 v[212:213], v241 offset:34816
  ds_read_b64_tr_b16 v[214:215], v241 offset:35072
  s_waitcnt lgkmcnt(14)
  v_mfma_f32_16x16x32_bf16 v[32:35], v[216:219], a[48:51], v[32:35]
  v_min_u32 v142, K3e-k2_kernel-16, v142
  v_mfma_f32_16x16x32_bf16 v[36:39], v[216:219], a[52:55], v[36:39]
  global_load_dwordx4 v[144:147], v142, s[76:77]
  v_mfma_f32_16x16x32_bf16 v[40:43], v[216:219], a[56:59], v[40:43]
  v_mfma_f32_16x16x32_bf16 v[44:47], v[216:219], a[60:63], v[44:47]
  ds_read_b64_tr_b16 v[216:217], v240 offset:38912
  ds_read_b64_tr_b16 v[218:219], v240 offset:39168
  s_waitcnt lgkmcnt(14)
  v_mfma_f32_16x16x32_bf16 v[48:51], v[220:223], a[48:51], v[48:51]
  v_cvt_pk_bf16_f32 v224, v64, v65
  v_mfma_f32_16x16x32_bf16 v[52:55], v[220:223], a[52:55], v[52:55]
  v_mfma_f32_16x16x32_bf16 v[56:59], v[220:223], a[56:59], v[56:59]
  v_cvt_pk_bf16_f32 v225, v66, v67
  v_mfma_f32_16x16x32_bf16 v[60:63], v[220:223], a[60:63], v[60:63]
  ds_read_b64_tr_b16 v[220:221], v241 offset:38912
  ds_read_b64_tr_b16 v[222:223], v241 offset:39168
  s_waitcnt vmcnt(13)
  s_barrier
  s_waitcnt lgkmcnt(14)
  v_mfma_f32_16x16x32_bf16 v[0:3], v[192:195], a[64:67], v[0:3]
  v_cvt_pk_bf16_f32 v226, v80, v81
  v_mfma_f32_16x16x32_bf16 v[4:7], v[192:195], a[68:71], v[4:7]
  v_mfma_f32_16x16x32_bf16 v[8:11], v[192:195], a[72:75], v[8:11]
  v_mfma_f32_16x16x32_bf16 v[12:15], v[192:195], a[76:79], v[12:15]
  ds_read_b64_tr_b16 v[192:193], v240 offset:40960
  ds_read_b64_tr_b16 v[194:195], v240 offset:41216
  s_waitcnt lgkmcnt(14)
  v_mfma_f32_16x16x32_bf16 v[16:19], v[196:199], a[64:67], v[16:19]
  v_cvt_pk_bf16_f32 v227, v82, v83
  v_mfma_f32_16x16x32_bf16 v[20:23], v[196:199], a[68:71], v[20:23]
  buffer_store_dwordx4 v[224:227], v128, s[64:67], s90 offen offset:0 sc1
  v_mfma_f32_16x16x32_bf16 v[24:27], v[196:199], a[72:75], v[24:27]
  v_mfma_f32_16x16x32_bf16 v[28:31], v[196:199], a[76:79], v[28:31]
  ds_read_b64_tr_b16 v[196:197], v241 offset:40960
  ds_read_b64_tr_b16 v[198:199], v241 offset:41216
  s_waitcnt lgkmcnt(14)
  v_mfma_f32_16x16x32_bf16 v[32:35], v[200:203], a[64:67], v[32:35]
  v_cvt_pk_bf16_f32 v228, v68, v69
  v_mfma_f32_16x16x32_bf16 v[36:39], v[200:203], a[68:71], v[36:39]
  v_mfma_f32_16x16x32_bf16 v[40:43], v[200:203], a[72:75], v[40:43]
  v_cvt_pk_bf16_f32 v229, v70, v71
  v_mfma_f32_16x16x32_bf16 v[44:47], v[200:203], a[76:79], v[44:47]
  ds_read_b64_tr_b16 v[200:201], v240 offset:45056
  ds_read_b64_tr_b16 v[202:203], v240 offset:45312
  s_waitcnt lgkmcnt(14)
  v_mfma_f32_16x16x32_bf16 v[48:51], v[204:207], a[64:67], v[48:51]
  v_mfma_f32_16x16x32_bf16 v[52:55], v[204:207], a[68:71], v[52:55]
  v_cvt_pk_bf16_f32 v230, v84, v85
  v_mfma_f32_16x16x32_bf16 v[56:59], v[204:207], a[72:75], v[56:59]
  v_mfma_f32_16x16x32_bf16 v[60:63], v[204:207], a[76:79], v[60:63]
  ds_read_b64_tr_b16 v[204:205], v241 offset:45056
  ds_read_b64_tr_b16 v[206:207], v241 offset:45312
  s_waitcnt lgkmcnt(14)
  v_mfma_f32_16x16x32_bf16 v[0:3], v[208:211], a[80:83], v[0:3]
  v_cvt_pk_bf16_f32 v231, v86, v87
  v_mfma_f32_16x16x32_bf16 v[4:7], v[208:211], a[84:87], v[4:7]
  v_mfma_f32_16x16x32_bf16 v[8:11], v[208:211], a[88:91], v[8:11]
  buffer_store_dwordx4 v[228:231], v129, s[64:67], s90 offen offset:0 sc1
  v_mfma_f32_16x16x32_bf16 v[12:15], v[208:211], a[92:95], v[12:15]
  ds_read_b64_tr_b16 v[208:209], v240 offset:43008
  ds_read_b64_tr_b16 v[210:211], v240 offset:43264
  s_waitcnt lgkmcnt(14)
  v_mfma_f32_16x16x32_bf16 v[16:19], v[212:215], a[80:83], v[16:19]
  v_mfma_f32_16x16x32_bf16 v[20:23], v[212:215], a[84:87], v[20:23]
  v_cvt_pk_bf16_f32 v232, v72, v73
  v_mfma_f32_16x16x32_bf16 v[24:27], v[212:215], a[88:91], v[24:27]
  v_mfma_f32_16x16x32_bf16 v[28:31], v[212:215], a[92:95], v[28:31]
  ds_read_b64_tr_b16 v[212:213], v241 offset:43008
  ds_read_b64_tr_b16 v[214:215], v241 offset:43264
  s_waitcnt lgkmcnt(14)
  v_mfma_f32_16x16x32_bf16 v[32:35], v[216:219], a[80:83], v[32:35]
  v_cvt_pk_bf16_f32 v233, v74, v75
  v_mfma_f32_16x16x32_bf16 v[36:39], v[216:219], a[84:87], v[36:39]
  v_mfma_f32_16x16x32_bf16 v[40:43], v[216:219], a[88:91], v[40:43]
  v_cvt_pk_bf16_f32 v234, v88, v89
  v_mfma_f32_16x16x32_bf16 v[44:47], v[216:219], a[92:95], v[44:47]
  ds_read_b64_tr_b16 v[216:217], v240 offset:47104
  ds_read_b64_tr_b16 v[218:219], v240 offset:47360
  s_waitcnt lgkmcnt(14)
  v_mfma_f32_16x16x32_bf16 v[48:51], v[220:223], a[80:83], v[48:51]
  v_mfma_f32_16x16x32_bf16 v[52:55], v[220:223], a[84:87], v[52:55]
  v_cvt_pk_bf16_f32 v235, v90, v91
  v_mfma_f32_16x16x32_bf16 v[56:59], v[220:223], a[88:91], v[56:59]
  v_mfma_f32_16x16x32_bf16 v[60:63], v[220:223], a[92:95], v[60:63]
  ds_read_b64_tr_b16 v[220:221], v241 offset:47104
  ds_read_b64_tr_b16 v[222:223], v241 offset:47360
  s_waitcnt lgkmcnt(14)
  v_mfma_f32_16x16x32_bf16 v[0:3], v[192:195], a[96:99], v[0:3]
  buffer_store_dwordx4 v[232:235], v130, s[64:67], s90 offen offset:0 sc1
  v_mfma_f32_16x16x32_bf16 v[4:7], v[192:195], a[100:103], v[4:7]
  v_mfma_f32_16x16x32_bf16 v[8:11], v[192:195], a[104:107], v[8:11]
  v_mfma_f32_16x16x32_bf16 v[12:15], v[192:195], a[108:111], v[12:15]
  ds_read_b64_tr_b16 v[192:193], v240 offset:49152
  ds_read_b64_tr_b16 v[194:195], v240 offset:49408
  s_waitcnt lgkmcnt(14)
  v_mfma_f32_16x16x32_bf16 v[16:19], v[196:199], a[96:99], v[16:19]
  v_cvt_pk_bf16_f32 v224, v76, v77
  v_mfma_f32_16x16x32_bf16 v[20:23], v[196:199], a[100:103], v[20:23]
  v_mfma_f32_16x16x32_bf16 v[24:27], v[196:199], a[104:107], v[24:27]
  v_cvt_pk_bf16_f32 v225, v78, v79
  v_mfma_f32_16x16x32_bf16 v[28:31], v[196:199], a[108:111], v[28:31]
  ds_read_b64_tr_b16 v[196:197], v241 offset:49152
  ds_read_b64_tr_b16 v[198:199], v241 offset:49408
  s_waitcnt lgkmcnt(14)
  v_mfma_f32_16x16x32_bf16 v[32:35], v[200:203], a[96:99], v[32:35]
  v_mfma_f32_16x16x32_bf16 v[36:39], v[200:203], a[100:103], v[36:39]
  v_cvt_pk_bf16_f32 v226, v92, v93
  v_mfma_f32_16x16x32_bf16 v[40:43], v[200:203], a[104:107], v[40:43]
  v_mfma_f32_16x16x32_bf16 v[44:47], v[200:203], a[108:111], v[44:47]
  ds_read_b64_tr_b16 v[200:201], v240 offset:53248
  ds_read_b64_tr_b16 v[202:203], v240 offset:53504
  s_waitcnt lgkmcnt(14)
  v_mfma_f32_16x16x32_bf16 v[48:51], v[204:207], a[96:99], v[48:51]
  v_cvt_pk_bf16_f32 v227, v94, v95
  v_mfma_f32_16x16x32_bf16 v[52:55], v[204:207], a[100:103], v[52:55]
  v_mfma_f32_16x16x32_bf16 v[56:59], v[204:207], a[104:107], v[56:59]
  v_mfma_f32_16x16x32_bf16 v[60:63], v[204:207], a[108:111], v[60:63]
  ds_read_b64_tr_b16 v[204:205], v241 offset:53248
  ds_read_b64_tr_b16 v[206:207], v241 offset:53504
  s_waitcnt lgkmcnt(14)
  v_mfma_f32_16x16x32_bf16 v[0:3], v[208:211], a[112:115], v[0:3]
  buffer_store_dwordx4 v[224:227], v131, s[64:67], s90 offen offset:0 sc1
  v_mfma_f32_16x16x32_bf16 v[4:7], v[208:211], a[116:119], v[4:7]
  v_mfma_f32_16x16x32_bf16 v[8:11], v[208:211], a[120:123], v[8:11]
  v_mfma_f32_16x16x32_bf16 v[12:15], v[208:211], a[124:127], v[12:15]
  ds_read_b64_tr_b16 v[208:209], v240 offset:51200
  ds_read_b64_tr_b16 v[210:211], v240 offset:51456
  s_waitcnt lgkmcnt(14)
  v_mfma_f32_16x16x32_bf16 v[16:19], v[212:215], a[112:115], v[16:19]
  v_cvt_pk_bf16_f32 v228, v96, v97
  v_mfma_f32_16x16x32_bf16 v[20:23], v[212:215], a[116:119], v[20:23]
  v_mfma_f32_16x16x32_bf16 v[24:27], v[212:215], a[120:123], v[24:27]
  v_cvt_pk_bf16_f32 v229, v98, v99
  v_mfma_f32_16x16x32_bf16 v[28:31], v[212:215], a[124:127], v[28:31]
  ds_read_b64_tr_b16 v[212:213], v241 offset:51200
  ds_read_b64_tr_b16 v[214:215], v241 offset:51456
  s_waitcnt lgkmcnt(14)
  v_mfma_f32_16x16x32_bf16 v[32:35], v[216:219], a[112:115], v[32:35]
  v_mfma_f32_16x16x32_bf16 v[36:39], v[216:219], a[116:119], v[36:39]
  v_mfma_f32_16x16x32_bf16 v[40:43], v[216:219], a[120:123], v[40:43]
  v_cvt_pk_bf16_f32 v230, v112, v113
  v_mfma_f32_16x16x32_bf16 v[44:47], v[216:219], a[124:127], v[44:47]
  ds_read_b64_tr_b16 v[216:217], v240 offset:55296
  ds_read_b64_tr_b16 v[218:219], v240 offset:55552
  s_waitcnt lgkmcnt(14)
  v_mfma_f32_16x16x32_bf16 v[48:51], v[220:223], a[112:115], v[48:51]
  v_mfma_f32_16x16x32_bf16 v[52:55], v[220:223], a[116:119], v[52:55]
  v_cvt_pk_bf16_f32 v231, v114, v115
  v_mfma_f32_16x16x32_bf16 v[56:59], v[220:223], a[120:123], v[56:59]
  v_mfma_f32_16x16x32_bf16 v[60:63], v[220:223], a[124:127], v[60:63]
  ds_read_b64_tr_b16 v[220:221], v241 offset:55296
  ds_read_b64_tr_b16 v[222:223], v241 offset:55552
  s_waitcnt vmcnt(12)
  s_barrier
  s_waitcnt lgkmcnt(14)
  v_mfma_f32_16x16x32_bf16 v[0:3], v[192:195], a[128:131], v[0:3]
  v_mfma_f32_16x16x32_bf16 v[4:7], v[192:195], a[132:135], v[4:7]
  buffer_store_dwordx4 v[228:231], v128, s[64:67], s91 offen offset:0 sc1
  v_mfma_f32_16x16x32_bf16 v[8:11], v[192:195], a[136:139], v[8:11]
  v_mfma_f32_16x16x32_bf16 v[12:15], v[192:195], a[140:143], v[12:15]
  ds_read_b64_tr_b16 v[192:193], v240 offset:57344
  ds_read_b64_tr_b16 v[194:195], v240 offset:57600
  s_waitcnt lgkmcnt(14)
  v_mfma_f32_16x16x32_bf16 v[16:19], v[196:199], a[128:131], v[16:19]
  v_mfma_f32_16x16x32_bf16 v[20:23], v[196:199], a[132:135], v[20:23]
  v_cvt_pk_bf16_f32 v232, v100, v101
  v_mfma_f32_16x16x32_bf16 v[24:27], v[196:199], a[136:139], v[24:27]
  v_mfma_f32_16x16x32_bf16 v[28:31], v[196:199], a[140:143], v[28:31]
  ds_read_b64_tr_b16 v[196:197], v241 offset:57344
  ds_read_b64_tr_b16 v[198:199], v241 offset:57600
  s_waitcnt lgkmcnt(14)
  v_mfma_f32_16x16x32_bf16 v[32:35], v[200:203], a[128:131], v[32:35]
  v_mfma_f32_16x16x32_bf16 v[36:39], v[200:203], a[132:135], v[36:39]
  v_cvt_pk_bf16_f32 v233, v102, v103
  v_mfma_f32_16x16x32_bf16 v[40:43], v[200:203], a[136:139], v[40:43]
  v_mfma_f32_16x16x32_bf16 v[44:47], v[200:203], a[140:143], v[44:47]
  ds_read_b64_tr_b16 v[200:201], v240 offset:61440
  ds_read_b64_tr_b16 v[202:203], v240 offset:61696
  s_waitcnt lgkmcnt(14)
  v_mfma_f32_16x16x32_bf16 v[48:51], v[204:207], a[128:131], v[48:51]
  v_mfma_f32_16x16x32_bf16 v[52:55], v[204:207], a[132:135], v[52:55]
  v_cvt_pk_bf16_f32 v234, v116, v117
  v_mfma_f32_16x16x32_bf16 v[56:59], v[204:207], a[136:139], v[56:59]
  v_mfma_f32_16x16x32_bf16 v[60:63], v[204:207], a[140:143], v[60:63]
  ds_read_b64_tr_b16 v[204:205], v241 offset:61440
  ds_read_b64_tr_b16 v[206:207], v241 offset:61696
  s_waitcnt lgkmcnt(14)
  v_mfma_f32_16x16x32_bf16 v[0:3], v[208:211], a[144:147], v[0:3]
  v_mfma_f32_16x16x32_bf16 v[4:7], v[208:211], a[148:151], v[4:7]
  v_cvt_pk_bf16_f32 v235, v118, v119
  v_mfma_f32_16x16x32_bf16 v[8:11], v[208:211], a[152:155], v[8:11]
  v_mfma_f32_16x16x32_bf16 v[12:15], v[208:211], a[156:159], v[12:15]
  ds_read_b64_tr_b16 v[208:209], v240 offset:59392
  ds_read_b64_tr_b16 v[210:211], v240 offset:59648
  s_waitcnt lgkmcnt(14)
  v_mfma_f32_16x16x32_bf16 v[16:19], v[212:215], a[144:147], v[16:19]
  v_mfma_f32_16x16x32_bf16 v[20:23], v[212:215], a[148:151], v[20:23]
  v_mfma_f32_16x16x32_bf16 v[24:27], v[212:215], a[152:155], v[24:27]
  buffer_store_dwordx4 v[232:235], v129, s[64:67], s91 offen offset:0 sc1
  v_mfma_f32_16x16x32_bf16 v[28:31], v[212:215], a[156:159], v[28:31]
  ds_read_b64_tr_b16 v[212:213], v241 offset:59392
  ds_read_b64_tr_b16 v[214:215], v241 offset:59648
  s_waitcnt lgkmcnt(14)
  v_mfma_f32_16x16x32_bf16 v[32:35], v[216:219], a[144:147], v[32:35]
  v_mfma_f32_16x16x32_bf16 v[36:39], v[216:219], a[148:151], v[36:39]
  v_mfma_f32_16x16x32_bf16 v[40:43], v[216:219], a[152:155], v[40:43]
  v_cvt_pk_bf16_f32 v224, v104, v105
  v_mfma_f32_16x16x32_bf16 v[44:47], v[216:219], a[156:159], v[44:47]
  ds_read_b64_tr_b16 v[216:217], v240 offset:63488
  ds_read_b64_tr_b16 v[218:219], v240 offset:63744
  s_waitcnt lgkmcnt(14)
  v_mfma_f32_16x16x32_bf16 v[48:51], v[220:223], a[144:147], v[48:51]
  v_mfma_f32_16x16x32_bf16 v[52:55], v[220:223], a[148:151], v[52:55]
  v_mfma_f32_16x16x32_bf16 v[56:59], v[220:223], a[152:155], v[56:59]
  v_mfma_f32_16x16x32_bf16 v[60:63], v[220:223], a[156:159], v[60:63]
  ds_read_b64_tr_b16 v[220:221], v241 offset:63488
  ds_read_b64_tr_b16 v[222:223], v241 offset:63744
  s_waitcnt lgkmcnt(14)
  v_mfma_f32_16x16x32_bf16 v[0:3], v[192:195], a[160:163], v[0:3]
  v_cvt_pk_bf16_f32 v225, v106, v107
  v_mfma_f32_16x16x32_bf16 v[4:7], v[192:195], a[164:167], v[4:7]
  v_mfma_f32_16x16x32_bf16 v[8:11], v[192:195], a[168:171], v[8:11]
  v_mfma_f32_16x16x32_bf16 v[12:15], v[192:195], a[172:175], v[12:15]
  ds_read_b64_tr_b16 v[192:193], v242 offset:0
  ds_read_b64_tr_b16 v[194:195], v242 offset:256
  s_waitcnt lgkmcnt(14)
  v_mfma_f32_16x16x32_bf16 v[16:19], v[196:199], a[160:163], v[16:19]
  v_mfma_f32_16x16x32_bf16 v[20:23], v[196:199], a[164:167], v[20:23]
  v_cvt_pk_bf16_f32 v226, v120, v121
  v_mfma_f32_16x16x32_bf16 v[24:27], v[196:199], a[168:171], v[24:27]
  v_mfma_f32_16x16x32_bf16 v[28:31], v[196:199], a[172:175], v[28:31]
  ds_read_b64_tr_b16 v[196:197], v243 offset:0
  ds_read_b64_tr_b16 v[198:199], v243 offset:256
  s_waitcnt lgkmcnt(14)
  v_mfma_f32_16x16x32_bf16 v[32:35], v[200:203], a[160:163], v[32:35]
  v_mfma_f32_16x16x32_bf16 v[36:39], v[200:203], a[164:167], v[36:39]
  v_mfma_f32_16x16x32_bf16 v[40:43], v[200:203], a[168:171], v[40:43]
  v_cvt_pk_bf16_f32 v227, v122, v123
  v_mfma_f32_16x16x32_bf16 v[44:47], v[200:203], a[172:175], v[44:47]
  ds_read_b64_tr_b16 v[200:201], v242 offset:4096
  ds_read_b64_tr_b16 v[202:203], v242 offset:4352
  s_waitcnt lgkmcnt(14)
  v_mfma_f32_16x16x32_bf16 v[48:51], v[204:207], a[160:163], v[48:51]
  v_mfma_f32_16x16x32_bf16 v[52:55], v[204:207], a[164:167], v[52:55]
  v_mfma_f32_16x16x32_bf16 v[56:59], v[204:207], a[168:171], v[56:59]
  v_mfma_f32_16x16x32_bf16 v[60:63], v[204:207], a[172:175], v[60:63]
  ds_read_b64_tr_b16 v[204:205], v243 offset:4096
  ds_read_b64_tr_b16 v[206:207], v243 offset:4352
  s_waitcnt lgkmcnt(14)
  v_mfma_f32_16x16x32_bf16 v[0:3], v[208:211], a[176:179], v[0:3]
  buffer_store_dwordx4 v[224:227], v130, s[64:67], s91 offen offset:0 sc1
  v_mfma_f32_16x16x32_bf16 v[4:7], v[208:211], a[180:183], v[4:7]
  v_mfma_f32_16x16x32_bf16 v[8:11], v[208:211], a[184:187], v[8:11]
  v_mfma_f32_16x16x32_bf16 v[12:15], v[208:211], a[188:191], v[12:15]
  ds_read_b64_tr_b16 v[208:209], v242 offset:2048
  ds_read_b64_tr_b16 v[210:211], v242 offset:2304
  s_waitcnt lgkmcnt(14)
  v_mfma_f32_16x16x32_bf16 v[16:19], v[212:215], a[176:179], v[16:19]
  v_mfma_f32_16x16x32_bf16 v[20:23], v[212:215], a[180:183], v[20:23]
  v_mfma_f32_16x16x32_bf16 v[24:27], v[212:215], a[184:187], v[24:27]
  v_mfma_f32_16x16x32_bf16 v[28:31], v[212:215], a[188:191], v[28:31]
  ds_read_b64_tr_b16 v[212:213], v243 offset:2048
  ds_read_b64_tr_b16 v[214:215], v243 offset:2304
  s_waitcnt lgkmcnt(14)
  v_mfma_f32_16x16x32_bf16 v[32:35], v[216:219], a[176:179], v[32:35]
  v_cvt_pk_bf16_f32 v228, v108, v109
  v_mfma_f32_16x16x32_bf16 v[36:39], v[216:219], a[180:183], v[36:39]
  v_mfma_f32_16x16x32_bf16 v[40:43], v[216:219], a[184:187], v[40:43]
  v_mfma_f32_16x16x32_bf16 v[44:47], v[216:219], a[188:191], v[44:47]
  ds_read_b64_tr_b16 v[216:217], v242 offset:6144
  ds_read_b64_tr_b16 v[218:219], v242 offset:6400
  s_waitcnt lgkmcnt(14)
  v_mfma_f32_16x16x32_bf16 v[48:51], v[220:223], a[176:179], v[48:51]
  v_mfma_f32_16x16x32_bf16 v[52:55], v[220:223], a[180:183], v[52:55]
  v_mfma_f32_16x16x32_bf16 v[56:59], v[220:223], a[184:187], v[56:59]
  v_cvt_pk_bf16_f32 v229, v110, v111
  v_mfma_f32_16x16x32_bf16 v[60:63], v[220:223], a[188:191], v[60:63]
  ds_read_b64_tr_b16 v[220:221], v243 offset:6144
  ds_read_b64_tr_b16 v[222:223], v243 offset:6400
  s_barrier
  s_waitcnt lgkmcnt(14)
  v_mfma_f32_16x16x32_bf16 v[0:3], v[192:195], a[192:195], v[0:3]
  v_mfma_f32_16x16x32_bf16 v[4:7], v[192:195], a[196:199], v[4:7]
  v_mfma_f32_16x16x32_bf16 v[8:11], v[192:195], a[200:203], v[8:11]
  v_mfma_f32_16x16x32_bf16 v[12:15], v[192:195], a[204:207], v[12:15]
  ds_read_b64_tr_b16 v[192:193], v242 offset:8192
  ds_read_b64_tr_b16 v[194:195], v242 offset:8448
  s_waitcnt lgkmcnt(14)
  v_mfma_f32_16x16x32_bf16 v[16:19], v[196:199], a[192:195], v[16:19]
  v_mfma_f32_16x16x32_bf16 v[20:23], v[196:199], a[196:199], v[20:23]
  v_mfma_f32_16x16x32_bf16 v[24:27], v[196:199], a[200:203], v[24:27]
  v_mfma_f32_16x16x32_bf16 v[28:31], v[196:199], a[204:207], v[28:31]
  ds_read_b64_tr_b16 v[196:197], v243 offset:8192
  ds_read_b64_tr_b16 v[198:199], v243 offset:8448
  s_waitcnt lgkmcnt(14)
  v_mfma_f32_16x16x32_bf16 v[32:35], v[200:203], a[192:195], v[32:35]
  v_cvt_pk_bf16_f32 v230, v124, v125
  v_mfma_f32_16x16x32_bf16 v[36:39], v[200:203], a[196:199], v[36:39]
  v_mfma_f32_16x16x32_bf16 v[40:43], v[200:203], a[200:203], v[40:43]
  v_mfma_f32_16x16x32_bf16 v[44:47], v[200:203], a[204:207], v[44:47]
  ds_read_b64_tr_b16 v[200:201], v242 offset:12288
  ds_read_b64_tr_b16 v[202:203], v242 offset:12544
  s_waitcnt lgkmcnt(14)
  v_mfma_f32_16x16x32_bf16 v[48:51], v[204:207], a[192:195], v[48:51]
  v_mfma_f32_16x16x32_bf16 v[52:55], v[204:207], a[196:199], v[52:55]
  v_mfma_f32_16x16x32_bf16 v[56:59], v[204:207], a[200:203], v[56:59]
  v_mfma_f32_16x16x32_bf16 v[60:63], v[204:207], a[204:207], v[60:63]
  ds_read_b64_tr_b16 v[204:205], v243 offset:12288
  ds_read_b64_tr_b16 v[206:207], v243 offset:12544
  s_waitcnt lgkmcnt(14)
  v_mfma_f32_16x16x32_bf16 v[0:3], v[208:211], a[208:211], v[0:3]
  v_mfma_f32_16x16x32_bf16 v[4:7], v[208:211], a[212:215], v[4:7]
  v_cvt_pk_bf16_f32 v231, v126, v127
  v_mfma_f32_16x16x32_bf16 v[8:11], v[208:211], a[216:219], v[8:11]
  v_mfma_f32_16x16x32_bf16 v[12:15], v[208:211], a[220:223], v[12:15]
  ds_read_b64_tr_b16 v[208:209], v242 offset:10240
  ds_read_b64_tr_b16 v[210:211], v242 offset:10496
  s_waitcnt lgkmcnt(14)
  v_mfma_f32_16x16x32_bf16 v[16:19], v[212:215], a[208:211], v[16:19]
  v_mfma_f32_16x16x32_bf16 v[20:23], v[212:215], a[212:215], v[20:23]
  v_mfma_f32_16x16x32_bf16 v[24:27], v[212:215], a[216:219], v[24:27]
  v_mfma_f32_16x16x32_bf16 v[28:31], v[212:215], a[220:223], v[28:31]
  ds_read_b64_tr_b16 v[212:213], v243 offset:10240
  ds_read_b64_tr_b16 v[214:215], v243 offset:10496
  s_waitcnt lgkmcnt(14)
  v_mfma_f32_16x16x32_bf16 v[32:35], v[216:219], a[208:211], v[32:35]
  v_mfma_f32_16x16x32_bf16 v[36:39], v[216:219], a[212:215], v[36:39]
  v_mfma_f32_16x16x32_bf16 v[40:43], v[216:219], a[216:219], v[40:43]
  v_mfma_f32_16x16x32_bf16 v[44:47], v[216:219], a[220:223], v[44:47]
  ds_read_b64_tr_b16 v[216:217], v242 offset:14336
  ds_read_b64_tr_b16 v[218:219], v242 offset:14592
  s_waitcnt lgkmcnt(14)
  v_mfma_f32_16x16x32_bf16 v[48:51], v[220:223], a[208:211], v[48:51]
  v_mfma_f32_16x16x32_bf16 v[52:55], v[220:223], a[212:215], v[52:55]
  v_mfma_f32_16x16x32_bf16 v[56:59], v[220:223], a[216:219], v[56:59]
  v_mfma_f32_16x16x32_bf16 v[60:63], v[220:223], a[220:223], v[60:63]
  ds_read_b64_tr_b16 v[220:221], v243 offset:14336
  ds_read_b64_tr_b16 v[222:223], v243 offset:14592
  s_waitcnt lgkmcnt(14)
  v_mfma_f32_16x16x32_bf16 v[0:3], v[192:195], a[224:227], v[0:3]
  buffer_store_dwordx4 v[228:231], v131, s[64:67], s91 offen offset:0 sc1
  v_mfma_f32_16x16x32_bf16 v[4:7], v[192:195], a[228:231], v[4:7]
  v_mfma_f32_16x16x32_bf16 v[8:11], v[192:195], a[232:235], v[8:11]
  v_mfma_f32_16x16x32_bf16 v[12:15], v[192:195], a[236:239], v[12:15]
  s_waitcnt lgkmcnt(12)
  v_mfma_f32_16x16x32_bf16 v[16:19], v[196:199], a[224:227], v[16:19]
  v_mfma_f32_16x16x32_bf16 v[20:23], v[196:199], a[228:231], v[20:23]
  v_mfma_f32_16x16x32_bf16 v[24:27], v[196:199], a[232:235], v[24:27]
  v_mfma_f32_16x16x32_bf16 v[28:31], v[196:199], a[236:239], v[28:31]
  s_waitcnt lgkmcnt(10)
  v_mfma_f32_16x16x32_bf16 v[32:35], v[200:203], a[224:227], v[32:35]
  v_mfma_f32_16x16x32_bf16 v[36:39], v[200:203], a[228:231], v[36:39]
  v_mfma_f32_16x16x32_bf16 v[40:43], v[200:203], a[232:235], v[40:43]
  v_mfma_f32_16x16x32_bf16 v[44:47], v[200:203], a[236:239], v[44:47]
  s_waitcnt lgkmcnt(8)
  v_mfma_f32_16x16x32_bf16 v[48:51], v[204:207], a[224:227], v[48:51]
  v_mfma_f32_16x16x32_bf16 v[52:55], v[204:207], a[228:231], v[52:55]
  v_mfma_f32_16x16x32_bf16 v[56:59], v[204:207], a[232:235], v[56:59]
  v_mfma_f32_16x16x32_bf16 v[60:63], v[204:207], a[236:239], v[60:63]
  s_waitcnt lgkmcnt(6)
  v_mfma_f32_16x16x32_bf16 v[0:3], v[208:211], a[240:243], v[0:3]
  v_mfma_f32_16x16x32_bf16 v[4:7], v[208:211], a[244:247], v[4:7]
  v_mfma_f32_16x16x32_bf16 v[8:11], v[208:211], a[248:251], v[8:11]
  v_mfma_f32_16x16x32_bf16 v[12:15], v[208:211], a[252:255], v[12:15]
  s_waitcnt lgkmcnt(4)
  v_mfma_f32_16x16x32_bf16 v[16:19], v[212:215], a[240:243], v[16:19]
  v_mfma_f32_16x16x32_bf16 v[20:23], v[212:215], a[244:247], v[20:23]
  v_mfma_f32_16x16x32_bf16 v[24:27], v[212:215], a[248:251], v[24:27]
  v_mfma_f32_16x16x32_bf16 v[28:31], v[212:215], a[252:255], v[28:31]
  s_waitcnt lgkmcnt(2)
  v_mfma_f32_16x16x32_bf16 v[32:35], v[216:219], a[240:243], v[32:35]
  v_mfma_f32_16x16x32_bf16 v[36:39], v[216:219], a[244:247], v[36:39]
  v_mfma_f32_16x16x32_bf16 v[40:43], v[216:219], a[248:251], v[40:43]
  v_mfma_f32_16x16x32_bf16 v[44:47], v[216:219], a[252:255], v[44:47]
  s_waitcnt lgkmcnt(0)
  v_mfma_f32_16x16x32_bf16 v[48:51], v[220:223], a[240:243], v[48:51]
  v_mfma_f32_16x16x32_bf16 v[52:55], v[220:223], a[244:247], v[52:55]
  v_mfma_f32_16x16x32_bf16 v[56:59], v[220:223], a[248:251], v[56:59]
  v_mfma_f32_16x16x32_bf16 v[60:63], v[220:223], a[252:255], v[60:63]
  s_nop 15
  v_cvt_pk_bf16_f32 v232, v0, v1
  v_cvt_pk_bf16_f32 v233, v2, v3
  v_cvt_pk_bf16_f32 v234, v16, v17
  v_cvt_pk_bf16_f32 v235, v18, v19
  buffer_store_dwordx4 v[232:235], v128, s[64:67], s92 offen offset:0 sc1
  v_cvt_pk_bf16_f32 v224, v4, v5
  v_cvt_pk_bf16_f32 v225, v6, v7
  v_cvt_pk_bf16_f32 v226, v20, v21
  v_cvt_pk_bf16_f32 v227, v22, v23
  buffer_store_dwordx4 v[224:227], v129, s[64:67], s92 offen offset:0 sc1
  v_cvt_pk_bf16_f32 v228, v8, v9
  v_cvt_pk_bf16_f32 v229, v10, v11
  v_cvt_pk_bf16_f32 v230, v24, v25
  v_cvt_pk_bf16_f32 v231, v26, v27
  buffer_store_dwordx4 v[228:231], v130, s[64:67], s92 offen offset:0 sc1
  v_cvt_pk_bf16_f32 v232, v12, v13
  v_cvt_pk_bf16_f32 v233, v14, v15
  v_cvt_pk_bf16_f32 v234, v28, v29
  v_cvt_pk_bf16_f32 v235, v30, v31
  buffer_store_dwordx4 v[232:235], v131, s[64:67], s92 offen offset:0 sc1
  v_cvt_pk_bf16_f32 v224, v32, v33
  v_cvt_pk_bf16_f32 v225, v34, v35
  v_cvt_pk_bf16_f32 v226, v48, v49
  v_cvt_pk_bf16_f32 v227, v50, v51
  buffer_store_dwordx4 v[224:227], v128, s[64:67], s93 offen offset:0 sc1
  v_cvt_pk_bf16_f32 v228, v36, v37
  v_cvt_pk_bf16_f32 v229, v38, v39
  v_cvt_pk_bf16_f32 v230, v52, v53
  v_cvt_pk_bf16_f32 v231, v54, v55
  buffer_store_dwordx4 v[228:231], v129, s[64:67], s93 offen offset:0 sc1
  v_cvt_pk_bf16_f32 v232, v40, v41
  v_cvt_pk_bf16_f32 v233, v42, v43
  v_cvt_pk_bf16_f32 v234, v56, v57
  v_cvt_pk_bf16_f32 v235, v58, v59
  buffer_store_dwordx4 v[232:235], v130, s[64:67], s93 offen offset:0 sc1
  v_cvt_pk_bf16_f32 v224, v44, v45
  v_cvt_pk_bf16_f32 v225, v46, v47
  v_cvt_pk_bf16_f32 v226, v60, v61
  v_cvt_pk_bf16_f32 v227, v62, v63
  buffer_store_dwordx4 v[224:227], v131, s[64:67], s93 offen offset:0 sc1
  s_endpgm
K1e_K10:
K1_V10:
  v_and_b32 v239, 63, v0
  v_lshlrev_b32 v140, 4, v239
  s_getpc_b64 s[76:77]
K1c_V10:
  s_lshl_b32 s78, s3, 10
  v_add_u32 v142, s78, v140
  v_min_u32 v143, K1e_V10-K1c_V10-16, v142
  global_load_dwordx4 v[144:147], v143, s[76:77]
  v_add_u32 v142, 4096, v142
  v_min_u32 v143, K1e_V10-K1c_V10-16, v142
  global_load_dwordx4 v[144:147], v143, s[76:77]
  v_add_u32 v142, 4096, v142
  v_min_u32 v143, K1e_V10-K1c_V10-16, v142
  global_load_dwordx4 v[144:147], v143, s[76:77]
  v_add_u32 v142, 4096, v142
  v_min_u32 v143, K1e_V10-K1c_V10-16, v142
  global_load_dwordx4 v[144:147], v143, s[76:77]
  v_add_u32 v142, 4096, v142
  v_min_u32 v143, K1e_V10-K1c_V10-16, v142
  global_load_dwordx4 v[144:147], v143, s[76:77]
  v_add_u32 v142, 4096, v142
  v_min_u32 v143, K1e_V10-K1c_V10-16, v142
  global_load_dwordx4 v[144:147], v143, s[76:77]
  v_lshrrev_b32 v224, 3, v239
  v_and_b32 v225, 7, v239
  v_add_u32 v226, 0, v224
  v_bfe_u32 v227, v226, 1, 3
  v_xor_b32 v227, v227, v225
  v_lshlrev_b32 v227, 4, v227
  v_lshl_add_u32 v227, v226, 10, v227
  v_subrev_u32 v250, 0, v227
  v_add_u32 v226, 8, v224
  v_bfe_u32 v227, v226, 1, 3
  v_xor_b32 v227, v227, v225
  v_lshlrev_b32 v227, 4, v227
  v_lshl_add_u32 v227, v226, 10, v227
  v_subrev_u32 v251, 1024, v227
  s_lshl_b32 s6, s4, 18
  s_lshl_b32 s7, s3, 16
  s_add_u32 s100, s6, s7
  s_mul_i32 s101, s3, 16384
  s_add_u32 s101, s101, 81920
  v_and_b32 v234, 15, v239
  v_lshlrev_b32 v224, 7, v234
  v_bfe_u32 v225, v239, 1, 3
  v_lshrrev_b32 v226, 4, v239
  v_xor_b32 v225, v225, v226
  v_lshl_add_u32 v228, v225, 4, v224
  v_add_u32 v252, s101, v228
  v_xor_b32 v253, 64, v252
  s_mov_b32 s56, s24
  s_and_b32 s57, s25, 0xffff
  s_mov_b32 s58, 4194304
  s_mov_b32 s59, 0x00020000
  s_lshl_b32 s9, s3, 12
  s_mov_b32 s52, s18
  s_and_b32 s53, s19, 0xffff
  s_mov_b32 s54, 2097152
  s_mov_b32 s55, 0x00020000
  s_sub_u32 s94, s5, 13
  s_mul_i32 s94, s94, 10
  s_min_u32 s94, s94, 118
  s_and_b32 s7, s3, 1
  s_add_u32 s7, s7, s94
  s_lshl_b32 s10, s7, 6
  s_and_b32 s7, s3, 1
  s_add_u32 s7, s7, s94
  s_add_u32 s7, s7, 2
  s_lshl_b32 s11, s7, 6
  s_and_b32 s7, s3, 1
  s_add_u32 s7, s7, s94
  s_add_u32 s7, s7, 4
  s_lshl_b32 s12, s7, 6
  s_and_b32 s7, s3, 1
  s_add_u32 s7, s7, s94
  s_add_u32 s7, s7, 6
  s_lshl_b32 s13, s7, 6
  s_and_b32 s7, s3, 1
  s_add_u32 s7, s7, s94
  s_add_u32 s7, s7, 8
  s_lshl_b32 s97, s7, 6
  v_mbcnt_lo_u32_b32 v239, -1, 0
  v_mbcnt_hi_u32_b32 v239, -1, v239
  v_lshrrev_b32 v234, 4, v239
  v_lshlrev_b32 v240, 9, v234
  v_bfe_u32 v235, v239, 2, 2
  v_lshl_add_u32 v240, v235, 6, v240
  v_and_b32 v235, 3, v239
  v_lshl_add_u32 v240, v235, 3, v240
  v_and_b32 v234, 1, v234
  v_lshl_add_u32 v240, v234, 5, v240
  v_xor_b32 v241, 32, v240
  v_add_u32 v242, 0x10000, v240
  v_add_u32 v243, 0x10000, v241
  v_lshrrev_b32 v234, 5, v239
  v_lshlrev_b32 v234, 1, v234
  v_xor_b32 v235, v234, v235
  v_lshlrev_b32 v244, 4, v235
  v_lshrrev_b32 v234, 2, v239
  v_lshl_add_u32 v244, v234, 13, v244
  v_add_u32 v245, 130048, v244
  v_add_u32 v246, 260096, v244
  v_add_u32 v247, 390144, v244
  v_lshlrev_b32 v234, 4, v239
  s_lshl_b32 s6, s4, 16
  s_lshl_b32 s7, s3, 14
  s_add_u32 s6, s6, s7
  v_add_u32 v128, s6, v234
  v_add_u32 v129, 4096, v128
  v_add_u32 v130, 8192, v128
  v_add_u32 v131, 12288, v128
  s_lshr_b32 s6, s3, 1
  s_add_u32 s6, s6, s14
  s_add_u32 s6, s6, 0
  s_and_b32 s6, s6, 7
  s_lshl_b32 s6, s6, 19
  s_add_u32 m0, s9, 0
  s_add_u32 s6, s6, s10
  buffer_load_dwordx4 v244, s[56:59], s6 offen offset:0 lds
  buffer_load_dwordx4 v245, s[56:59], s6 offen offset:1024 lds
  buffer_load_dwordx4 v246, s[56:59], s6 offen offset:2048 lds
  buffer_load_dwordx4 v247, s[56:59], s6 offen offset:3072 lds
  s_add_u32 s15, s14, 0
  s_and_b32 s15, s15, 7
  s_lshl_b32 s15, s15, 7
  s_add_u32 s15, s15, s100
  s_add_u32 m0, s101, 0
  s_nop 0
  buffer_load_dwordx4 v250, s[52:55], s15 offen offset:0 lds
  buffer_load_dwordx4 v251, s[52:55], s15 offen offset:1024 lds
  s_add_u32 m0, s101, 2048
  s_add_u32 s15, s15, 16384
  buffer_load_dwordx4 v250, s[52:55], s15 offen offset:0 lds
  buffer_load_dwordx4 v251, s[52:55], s15 offen offset:1024 lds
  s_add_u32 m0, s101, 4096
  s_add_u32 s15, s15, 16384
  buffer_load_dwordx4 v250, s[52:55], s15 offen offset:0 lds
  buffer_load_dwordx4 v251, s[52:55], s15 offen offset:1024 lds
  s_add_u32 m0, s101, 6144
  s_add_u32 s15, s15, 16384
  buffer_load_dwordx4 v250, s[52:55], s15 offen offset:0 lds
  buffer_load_dwordx4 v251, s[52:55], s15 offen offset:1024 lds
  s_add_u32 s15, s14, 1
  s_and_b32 s15, s15, 7
  s_lshl_b32 s15, s15, 7
  s_add_u32 s15, s15, s100
  s_add_u32 m0, s101, 8192
  s_nop 0
  buffer_load_dwordx4 v250, s[52:55], s15 offen offset:0 lds
  buffer_load_dwordx4 v251, s[52:55], s15 offen offset:1024 lds
  s_add_u32 m0, s101, 10240
  s_add_u32 s15, s15, 16384
  buffer_load_dwordx4 v250, s[52:55], s15 offen offset:0 lds
  buffer_load_dwordx4 v251, s[52:55], s15 offen offset:1024 lds
  s_add_u32 m0, s101, 12288
  s_add_u32 s15, s15, 16384
  buffer_load_dwordx4 v250, s[52:55], s15 offen offset:0 lds
  buffer_load_dwordx4 v251, s[52:55], s15 offen offset:1024 lds
  s_add_u32 m0, s101, 14336
  s_add_u32 s15, s15, 16384
  buffer_load_dwordx4 v250, s[52:55], s15 offen offset:0 lds
  buffer_load_dwordx4 v251, s[52:55], s15 offen offset:1024 lds
  s_lshr_b32 s6, s3, 1
  s_add_u32 s6, s6, s14
  s_add_u32 s6, s6, 2
  s_and_b32 s6, s6, 7
  s_lshl_b32 s6, s6, 19
  s_add_u32 m0, s9, 16384
  s_add_u32 s6, s6, s10
  buffer_load_dwordx4 v244, s[56:59], s6 offen offset:0 lds
  buffer_load_dwordx4 v245, s[56:59], s6 offen offset:1024 lds
  buffer_load_dwordx4 v246, s[56:59], s6 offen offset:2048 lds
  buffer_load_dwordx4 v247, s[56:59], s6 offen offset:3072 lds
  s_mov_b32 s64, s50
  s_and_b32 s65, s51, 0xffff
  s_mov_b32 s66, 67108864
  s_mov_b32 s67, 0x00020000
  s_add_u32 s6, s94, 0
  s_lshr_b32 s7, s6, 2
  s_lshl_b32 s7, s7, 19
  s_and_b32 s6, s6, 3
  s_lshl_b32 s6, s6, 11
  s_add_u32 s6, s6, s7
  s_add_u32 s84, s6, 16777216
  s_add_u32 s6, s94, 1
  s_lshr_b32 s7, s6, 2
  s_lshl_b32 s7, s7, 19
  s_and_b32 s6, s6, 3
  s_lshl_b32 s6, s6, 11
  s_add_u32 s6, s6, s7
  s_add_u32 s85, s6, 16777216
  s_add_u32 s6, s94, 2
  s_lshr_b32 s7, s6, 2
  s_lshl_b32 s7, s7, 19
  s_and_b32 s6, s6, 3
  s_lshl_b32 s6, s6, 11
  s_add_u32 s6, s6, s7
  s_add_u32 s86, s6, 16777216
  s_add_u32 s6, s94, 3
  s_lshr_b32 s7, s6, 2
  s_lshl_b32 s7, s7, 19
  s_and_b32 s6, s6, 3
  s_lshl_b32 s6, s6, 11
  s_add_u32 s6, s6, s7
  s_add_u32 s87, s6, 16777216
  s_add_u32 s6, s94, 4
  s_lshr_b32 s7, s6, 2
  s_lshl_b32 s7, s7, 19
  s_and_b32 s6, s6, 3
  s_lshl_b32 s6, s6, 11
  s_add_u32 s6, s6, s7
  s_add_u32 s88, s6, 16777216
  s_add_u32 s6, s94, 5
  s_lshr_b32 s7, s6, 2
  s_lshl_b32 s7, s7, 19
  s_and_b32 s6, s6, 3
  s_lshl_b32 s6, s6, 11
  s_add_u32 s6, s6, s7
  s_add_u32 s89, s6, 16777216
  s_add_u32 s6, s94, 6
  s_lshr_b32 s7, s6, 2
  s_lshl_b32 s7, s7, 19
  s_and_b32 s6, s6, 3
  s_lshl_b32 s6, s6, 11
  s_add_u32 s6, s6, s7
  s_add_u32 s90, s6, 16777216
  s_add_u32 s6, s94, 7
  s_lshr_b32 s7, s6, 2
  s_lshl_b32 s7, s7, 19
  s_and_b32 s6, s6, 3
  s_lshl_b32 s6, s6, 11
  s_add_u32 s6, s6, s7
  s_add_u32 s91, s6, 16777216
  s_add_u32 s6, s94, 8
  s_lshr_b32 s7, s6, 2
  s_lshl_b32 s7, s7, 19
  s_and_b32 s6, s6, 3
  s_lshl_b32 s6, s6, 11
  s_add_u32 s6, s6, s7
  s_add_u32 s92, s6, 16777216
  s_add_u32 s6, s94, 9
  s_lshr_b32 s7, s6, 2
  s_lshl_b32 s7, s7, 19
  s_and_b32 s6, s6, 3
  s_lshl_b32 s6, s6, 11
  s_add_u32 s6, s6, s7
  s_add_u32 s93, s6, 16777216
  v_mbcnt_lo_u32_b32 v140, -1, 0
  v_mbcnt_hi_u32_b32 v140, -1, v140
  v_lshlrev_b32 v140, 4, v140
  s_waitcnt vmcnt(12)
  ds_read_b128 a[0:3], v252 offset:0
  ds_read_b128 a[4:7], v252 offset:2048
  ds_read_b128 a[8:11], v252 offset:4096
  ds_read_b128 a[12:15], v252 offset:6144
  ds_read_b128 a[16:19], v253 offset:0
  ds_read_b128 a[20:23], v253 offset:2048
  ds_read_b128 a[24:27], v253 offset:4096
  ds_read_b128 a[28:31], v253 offset:6144
  s_barrier
  s_waitcnt lgkmcnt(0)
  s_add_u32 s15, s14, 2
  s_and_b32 s15, s15, 7
  s_lshl_b32 s15, s15, 7
  s_add_u32 s15, s15, s100
  s_add_u32 m0, s101, 0
  s_nop 0
  buffer_load_dwordx4 v250, s[52:55], s15 offen offset:0 lds
  buffer_load_dwordx4 v251, s[52:55], s15 offen offset:1024 lds
  s_add_u32 m0, s101, 2048
  s_add_u32 s15, s15, 16384
  buffer_load_dwordx4 v250, s[52:55], s15 offen offset:0 lds
  buffer_load_dwordx4 v251, s[52:55], s15 offen offset:1024 lds
  s_add_u32 m0, s101, 4096
  s_add_u32 s15, s15, 16384
  buffer_load_dwordx4 v250, s[52:55], s15 offen offset:0 lds
  buffer_load_dwordx4 v251, s[52:55], s15 offen offset:1024 lds
  s_add_u32 m0, s101, 6144
  s_add_u32 s15, s15, 16384
  buffer_load_dwordx4 v250, s[52:55], s15 offen offset:0 lds
  buffer_load_dwordx4 v251, s[52:55], s15 offen offset:1024 lds
  s_waitcnt vmcnt(8)
  s_barrier
  ds_read_b64_tr_b16 v[192:193], v240 offset:0
  ds_read_b64_tr_b16 v[194:195], v240 offset:256
  ds_read_b64_tr_b16 v[196:197], v241 offset:0
  ds_read_b64_tr_b16 v[198:199], v241 offset:256
  ds_read_b64_tr_b16 v[200:201], v240 offset:4096
  ds_read_b64_tr_b16 v[202:203], v240 offset:4352
  ds_read_b64_tr_b16 v[204:205], v241 offset:4096
  ds_read_b64_tr_b16 v[206:207], v241 offset:4352
  ds_read_b64_tr_b16 v[208:209], v240 offset:2048
  ds_read_b64_tr_b16 v[210:211], v240 offset:2304
  ds_read_b64_tr_b16 v[212:213], v241 offset:2048
  ds_read_b64_tr_b16 v[214:215], v241 offset:2304
  ds_read_b64_tr_b16 v[216:217], v240 offset:6144
  ds_read_b64_tr_b16 v[218:219], v240 offset:6400
  ds_read_b64_tr_b16 v[220:221], v241 offset:6144
  ds_read_b64_tr_b16 v[222:223], v241 offset:6400
  s_waitcnt lgkmcnt(14)
  v_mfma_f32_16x16x32_bf16 v[0:3], a[0:3], v[192:195], 0
  v_mfma_f32_16x16x32_bf16 v[4:7], a[4:7], v[192:195], 0
  v_mfma_f32_16x16x32_bf16 v[8:11], a[8:11], v[192:195], 0
  s_lshr_b32 s6, s3, 1
  s_add_u32 s6, s6, s14
  v_mfma_f32_16x16x32_bf16 v[12:15], a[12:15], v[192:195], 0
  ds_read_b64_tr_b16 v[192:193], v240 offset:8192
  ds_read_b64_tr_b16 v[194:195], v240 offset:8448
  s_waitcnt lgkmcnt(14)
  v_mfma_f32_16x16x32_bf16 v[16:19], a[0:3], v[196:199], 0
  s_add_u32 s6, s6, 4
  s_and_b32 s6, s6, 7
  v_mfma_f32_16x16x32_bf16 v[20:23], a[4:7], v[196:199], 0
  s_lshl_b32 s6, s6, 19
  s_add_u32 m0, s9, 32768
  v_mfma_f32_16x16x32_bf16 v[24:27], a[8:11], v[196:199], 0
  s_add_u32 s6, s6, s10
  buffer_load_dwordx4 v244, s[56:59], s6 offen offset:0 lds
  v_mfma_f32_16x16x32_bf16 v[28:31], a[12:15], v[196:199], 0
  ds_read_b64_tr_b16 v[196:197], v241 offset:8192
  ds_read_b64_tr_b16 v[198:199], v241 offset:8448
  s_waitcnt lgkmcnt(14)
  v_mfma_f32_16x16x32_bf16 v[32:35], a[0:3], v[200:203], 0
  buffer_load_dwordx4 v245, s[56:59], s6 offen offset:1024 lds
  buffer_load_dwordx4 v246, s[56:59], s6 offen offset:2048 lds
  v_mfma_f32_16x16x32_bf16 v[36:39], a[4:7], v[200:203], 0
  buffer_load_dwordx4 v247, s[56:59], s6 offen offset:3072 lds
  ds_read_b128 a[32:35], v252 offset:8192
  v_mfma_f32_16x16x32_bf16 v[40:43], a[8:11], v[200:203], 0
  ds_read_b128 a[36:39], v252 offset:10240
  ds_read_b128 a[40:43], v252 offset:12288
  v_mfma_f32_16x16x32_bf16 v[44:47], a[12:15], v[200:203], 0
  ds_read_b64_tr_b16 v[200:201], v240 offset:12288
  ds_read_b64_tr_b16 v[202:203], v240 offset:12544
  s_waitcnt lgkmcnt(15)
  v_mfma_f32_16x16x32_bf16 v[48:51], a[0:3], v[204:207], 0
  ds_read_b128 a[44:47], v252 offset:14336
  ds_read_b128 a[48:51], v253 offset:8192
  v_mfma_f32_16x16x32_bf16 v[52:55], a[4:7], v[204:207], 0
  ds_read_b128 a[52:55], v253 offset:10240
  ds_read_b128 a[56:59], v253 offset:12288
  v_mfma_f32_16x16x32_bf16 v[56:59], a[8:11], v[204:207], 0
  ds_read_b128 a[60:63], v253 offset:14336
  v_mfma_f32_16x16x32_bf16 v[60:63], a[12:15], v[204:207], 0
  ds_read_b64_tr_b16 v[204:205], v241 offset:12288
  ds_read_b64_tr_b16 v[206:207], v241 offset:12544
  s_waitcnt lgkmcnt(15)
  v_mfma_f32_16x16x32_bf16 v[0:3], a[16:19], v[208:211], v[0:3]
  s_waitcnt lgkmcnt(2)
  s_add_u32 s15, s14, 3
  s_and_b32 s15, s15, 7
  v_mfma_f32_16x16x32_bf16 v[4:7], a[20:23], v[208:211], v[4:7]
  s_lshl_b32 s15, s15, 7
  s_add_u32 s15, s15, s100
  v_mfma_f32_16x16x32_bf16 v[8:11], a[24:27], v[208:211], v[8:11]
  s_add_u32 m0, s101, 8192
  s_nop 0
  v_mfma_f32_16x16x32_bf16 v[12:15], a[28:31], v[208:211], v[12:15]
  ds_read_b64_tr_b16 v[208:209], v240 offset:10240
  ds_read_b64_tr_b16 v[210:211], v240 offset:10496
  v_mfma_f32_16x16x32_bf16 v[16:19], a[16:19], v[212:215], v[16:19]
  buffer_load_dwordx4 v250, s[52:55], s15 offen offset:0 lds
  buffer_load_dwordx4 v251, s[52:55], s15 offen offset:1024 lds
  v_mfma_f32_16x16x32_bf16 v[20:23], a[20:23], v[212:215], v[20:23]
  s_add_u32 m0, s101, 10240
  s_add_u32 s15, s15, 16384
  v_mfma_f32_16x16x32_bf16 v[24:27], a[24:27], v[212:215], v[24:27]
  buffer_load_dwordx4 v250, s[52:55], s15 offen offset:0 lds
  buffer_load_dwordx4 v251, s[52:55], s15 offen offset:1024 lds
  v_mfma_f32_16x16x32_bf16 v[28:31], a[28:31], v[212:215], v[28:31]
  ds_read_b64_tr_b16 v[212:213], v241 offset:10240
  ds_read_b64_tr_b16 v[214:215], v241 offset:10496
  v_mfma_f32_16x16x32_bf16 v[32:35], a[16:19], v[216:219], v[32:35]
  s_add_u32 m0, s101, 12288
  s_add_u32 s15, s15, 16384
  v_mfma_f32_16x16x32_bf16 v[36:39], a[20:23], v[216:219], v[36:39]
  buffer_load_dwordx4 v250, s[52:55], s15 offen offset:0 lds
  buffer_load_dwordx4 v251, s[52:55], s15 offen offset:1024 lds
  v_mfma_f32_16x16x32_bf16 v[40:43], a[24:27], v[216:219], v[40:43]
  s_add_u32 m0, s101, 14336
  s_add_u32 s15, s15, 16384
  v_mfma_f32_16x16x32_bf16 v[44:47], a[28:31], v[216:219], v[44:47]
  ds_read_b64_tr_b16 v[216:217], v240 offset:14336
  ds_read_b64_tr_b16 v[218:219], v240 offset:14592
  v_mfma_f32_16x16x32_bf16 v[48:51], a[16:19], v[220:223], v[48:51]
  buffer_load_dwordx4 v250, s[52:55], s15 offen offset:0 lds
  buffer_load_dwordx4 v251, s[52:55], s15 offen offset:1024 lds
  v_mfma_f32_16x16x32_bf16 v[52:55], a[20:23], v[220:223], v[52:55]
  v_mfma_f32_16x16x32_bf16 v[56:59], a[24:27], v[220:223], v[56:59]
  v_mfma_f32_16x16x32_bf16 v[60:63], a[28:31], v[220:223], v[60:63]
  ds_read_b64_tr_b16 v[220:221], v241 offset:14336
  ds_read_b64_tr_b16 v[222:223], v241 offset:14592
  v_mfma_f32_16x16x32_bf16 v[0:3], a[32:35], v[192:195], v[0:3]
  v_mfma_f32_16x16x32_bf16 v[4:7], a[36:39], v[192:195], v[4:7]
  v_mfma_f32_16x16x32_bf16 v[8:11], a[40:43], v[192:195], v[8:11]
  s_lshr_b32 s6, s3, 1
  s_add_u32 s6, s6, s14
  v_mfma_f32_16x16x32_bf16 v[12:15], a[44:47], v[192:195], v[12:15]
  ds_read_b64_tr_b16 v[192:193], v240 offset:16384
  ds_read_b64_tr_b16 v[194:195], v240 offset:16640
  v_mfma_f32_16x16x32_bf16 v[16:19], a[32:35], v[196:199], v[16:19]
  s_add_u32 s6, s6, 6
  s_and_b32 s6, s6, 7
  v_mfma_f32_16x16x32_bf16 v[20:23], a[36:39], v[196:199], v[20:23]
  s_lshl_b32 s6, s6, 19
  s_add_u32 m0, s9, 49152
  v_mfma_f32_16x16x32_bf16 v[24:27], a[40:43], v[196:199], v[24:27]
  s_add_u32 s6, s6, s10
  buffer_load_dwordx4 v244, s[56:59], s6 offen offset:0 lds
  v_mfma_f32_16x16x32_bf16 v[28:31], a[44:47], v[196:199], v[28:31]
  ds_read_b64_tr_b16 v[196:197], v241 offset:16384
  ds_read_b64_tr_b16 v[198:199], v241 offset:16640
  v_mfma_f32_16x16x32_bf16 v[32:35], a[32:35], v[200:203], v[32:35]
  buffer_load_dwordx4 v245, s[56:59], s6 offen offset:1024 lds
  buffer_load_dwordx4 v246, s[56:59], s6 offen offset:2048 lds
  v_mfma_f32_16x16x32_bf16 v[36:39], a[36:39], v[200:203], v[36:39]
  buffer_load_dwordx4 v247, s[56:59], s6 offen offset:3072 lds
  s_waitcnt vmcnt(16)
  ds_read_b128 a[64:67], v252 offset:0
  v_mfma_f32_16x16x32_bf16 v[40:43], a[40:43], v[200:203], v[40:43]
  ds_read_b128 a[68:71], v252 offset:2048
  ds_read_b128 a[72:75], v252 offset:4096
  v_mfma_f32_16x16x32_bf16 v[44:47], a[44:47], v[200:203], v[44:47]
  ds_read_b64_tr_b16 v[200:201], v240 offset:20480
  ds_read_b64_tr_b16 v[202:203], v240 offset:20736
  s_waitcnt lgkmcnt(15)
  v_mfma_f32_16x16x32_bf16 v[48:51], a[32:35], v[204:207], v[48:51]
  ds_read_b128 a[76:79], v252 offset:6144
  ds_read_b128 a[80:83], v253 offset:0
  v_mfma_f32_16x16x32_bf16 v[52:55], a[36:39], v[204:207], v[52:55]
  ds_read_b128 a[84:87], v253 offset:2048
  ds_read_b128 a[88:91], v253 offset:4096
  v_mfma_f32_16x16x32_bf16 v[56:59], a[40:43], v[204:207], v[56:59]
  ds_read_b128 a[92:95], v253 offset:6144
  v_mfma_f32_16x16x32_bf16 v[60:63], a[44:47], v[204:207], v[60:63]
  ds_read_b64_tr_b16 v[204:205], v241 offset:20480
  ds_read_b64_tr_b16 v[206:207], v241 offset:20736
  s_waitcnt lgkmcnt(15)
  v_mfma_f32_16x16x32_bf16 v[0:3], a[48:51], v[208:211], v[0:3]
  s_waitcnt lgkmcnt(2)
  s_add_u32 s15, s14, 4
  s_and_b32 s15, s15, 7
  v_mfma_f32_16x16x32_bf16 v[4:7], a[52:55], v[208:211], v[4:7]
  s_lshl_b32 s15, s15, 7
  s_add_u32 s15, s15, s100
  v_mfma_f32_16x16x32_bf16 v[8:11], a[56:59], v[208:211], v[8:11]
  s_add_u32 m0, s101, 0
  s_nop 0
  v_mfma_f32_16x16x32_bf16 v[12:15], a[60:63], v[208:211], v[12:15]
  ds_read_b64_tr_b16 v[208:209], v240 offset:18432
  ds_read_b64_tr_b16 v[210:211], v240 offset:18688
  v_mfma_f32_16x16x32_bf16 v[16:19], a[48:51], v[212:215], v[16:19]
  buffer_load_dwordx4 v250, s[52:55], s15 offen offset:0 lds
  buffer_load_dwordx4 v251, s[52:55], s15 offen offset:1024 lds
  v_mfma_f32_16x16x32_bf16 v[20:23], a[52:55], v[212:215], v[20:23]
  s_add_u32 m0, s101, 2048
  s_add_u32 s15, s15, 16384
  v_mfma_f32_16x16x32_bf16 v[24:27], a[56:59], v[212:215], v[24:27]
  buffer_load_dwordx4 v250, s[52:55], s15 offen offset:0 lds
  buffer_load_dwordx4 v251, s[52:55], s15 offen offset:1024 lds
  v_mfma_f32_16x16x32_bf16 v[28:31], a[60:63], v[212:215], v[28:31]
  ds_read_b64_tr_b16 v[212:213], v241 offset:18432
  ds_read_b64_tr_b16 v[214:215], v241 offset:18688
  v_mfma_f32_16x16x32_bf16 v[32:35], a[48:51], v[216:219], v[32:35]
  s_add_u32 m0, s101, 4096
  s_add_u32 s15, s15, 16384
  v_mfma_f32_16x16x32_bf16 v[36:39], a[52:55], v[216:219], v[36:39]
  buffer_load_dwordx4 v250, s[52:55], s15 offen offset:0 lds
  buffer_load_dwordx4 v251, s[52:55], s15 offen offset:1024 lds
  v_mfma_f32_16x16x32_bf16 v[40:43], a[56:59], v[216:219], v[40:43]
  s_add_u32 m0, s101, 6144
  s_add_u32 s15, s15, 16384
  v_mfma_f32_16x16x32_bf16 v[44:47], a[60:63], v[216:219], v[44:47]
  ds_read_b64_tr_b16 v[216:217], v240 offset:22528
  ds_read_b64_tr_b16 v[218:219], v240 offset:22784
  v_mfma_f32_16x16x32_bf16 v[48:51], a[48:51], v[220:223], v[48:51]
  buffer_load_dwordx4 v250, s[52:55], s15 offen offset:0 lds
  buffer_load_dwordx4 v251, s[52:55], s15 offen offset:1024 lds
  v_mfma_f32_16x16x32_bf16 v[52:55], a[52:55], v[220:223], v[52:55]
  v_mfma_f32_16x16x32_bf16 v[56:59], a[56:59], v[220:223], v[56:59]
  v_mfma_f32_16x16x32_bf16 v[60:63], a[60:63], v[220:223], v[60:63]
  ds_read_b64_tr_b16 v[220:221], v241 offset:22528
  ds_read_b64_tr_b16 v[222:223], v241 offset:22784
  s_waitcnt vmcnt(20)
  s_barrier
  v_mfma_f32_16x16x32_bf16 v[0:3], a[64:67], v[192:195], v[0:3]
  v_mfma_f32_16x16x32_bf16 v[4:7], a[68:71], v[192:195], v[4:7]
  v_mfma_f32_16x16x32_bf16 v[8:11], a[72:75], v[192:195], v[8:11]
  s_lshr_b32 s6, s3, 1
  s_add_u32 s6, s6, s14
  v_mfma_f32_16x16x32_bf16 v[12:15], a[76:79], v[192:195], v[12:15]
  ds_read_b64_tr_b16 v[192:193], v240 offset:24576
  ds_read_b64_tr_b16 v[194:195], v240 offset:24832
  v_mfma_f32_16x16x32_bf16 v[16:19], a[64:67], v[196:199], v[16:19]
  s_add_u32 s6, s6, 0
  s_and_b32 s6, s6, 7
  v_mfma_f32_16x16x32_bf16 v[20:23], a[68:71], v[196:199], v[20:23]
  s_lshl_b32 s6, s6, 19
  s_add_u32 m0, s9, 65536
  v_mfma_f32_16x16x32_bf16 v[24:27], a[72:75], v[196:199], v[24:27]
  s_add_u32 s6, s6, s11
  buffer_load_dwordx4 v244, s[56:59], s6 offen offset:0 lds
  v_mfma_f32_16x16x32_bf16 v[28:31], a[76:79], v[196:199], v[28:31]
  ds_read_b64_tr_b16 v[196:197], v241 offset:24576
  ds_read_b64_tr_b16 v[198:199], v241 offset:24832
  v_mfma_f32_16x16x32_bf16 v[32:35], a[64:67], v[200:203], v[32:35]
  buffer_load_dwordx4 v245, s[56:59], s6 offen offset:1024 lds
  buffer_load_dwordx4 v246, s[56:59], s6 offen offset:2048 lds
  v_mfma_f32_16x16x32_bf16 v[36:39], a[68:71], v[200:203], v[36:39]
  buffer_load_dwordx4 v247, s[56:59], s6 offen offset:3072 lds
  s_waitcnt vmcnt(16)
  ds_read_b128 a[96:99], v252 offset:8192
  v_mfma_f32_16x16x32_bf16 v[40:43], a[72:75], v[200:203], v[40:43]
  ds_read_b128 a[100:103], v252 offset:10240
  ds_read_b128 a[104:107], v252 offset:12288
  v_mfma_f32_16x16x32_bf16 v[44:47], a[76:79], v[200:203], v[44:47]
  ds_read_b64_tr_b16 v[200:201], v240 offset:28672
  ds_read_b64_tr_b16 v[202:203], v240 offset:28928
  s_waitcnt lgkmcnt(15)
  v_mfma_f32_16x16x32_bf16 v[48:51], a[64:67], v[204:207], v[48:51]
  ds_read_b128 a[108:111], v252 offset:14336
  ds_read_b128 a[112:115], v253 offset:8192
  v_mfma_f32_16x16x32_bf16 v[52:55], a[68:71], v[204:207], v[52:55]
  ds_read_b128 a[116:119], v253 offset:10240
  ds_read_b128 a[120:123], v253 offset:12288
  v_mfma_f32_16x16x32_bf16 v[56:59], a[72:75], v[204:207], v[56:59]
  ds_read_b128 a[124:127], v253 offset:14336
  v_mfma_f32_16x16x32_bf16 v[60:63], a[76:79], v[204:207], v[60:63]
  ds_read_b64_tr_b16 v[204:205], v241 offset:28672
  ds_read_b64_tr_b16 v[206:207], v241 offset:28928
  s_waitcnt lgkmcnt(15)
  v_mfma_f32_16x16x32_bf16 v[0:3], a[80:83], v[208:211], v[0:3]
  s_waitcnt lgkmcnt(2)
  s_add_u32 s15, s14, 5
  s_and_b32 s15, s15, 7
  v_mfma_f32_16x16x32_bf16 v[4:7], a[84:87], v[208:211], v[4:7]
  s_lshl_b32 s15, s15, 7
  s_add_u32 s15, s15, s100
  v_mfma_f32_16x16x32_bf16 v[8:11], a[88:91], v[208:211], v[8:11]
  s_add_u32 m0, s101, 8192
  s_nop 0
  v_mfma_f32_16x16x32_bf16 v[12:15], a[92:95], v[208:211], v[12:15]
  ds_read_b64_tr_b16 v[208:209], v240 offset:26624
  ds_read_b64_tr_b16 v[210:211], v240 offset:26880
  v_mfma_f32_16x16x32_bf16 v[16:19], a[80:83], v[212:215], v[16:19]
  buffer_load_dwordx4 v250, s[52:55], s15 offen offset:0 lds
  buffer_load_dwordx4 v251, s[52:55], s15 offen offset:1024 lds
  v_mfma_f32_16x16x32_bf16 v[20:23], a[84:87], v[212:215], v[20:23]
  s_add_u32 m0, s101, 10240
  s_add_u32 s15, s15, 16384
  v_mfma_f32_16x16x32_bf16 v[24:27], a[88:91], v[212:215], v[24:27]
  buffer_load_dwordx4 v250, s[52:55], s15 offen offset:0 lds
  buffer_load_dwordx4 v251, s[52:55], s15 offen offset:1024 lds
  v_mfma_f32_16x16x32_bf16 v[28:31], a[92:95], v[212:215], v[28:31]
  ds_read_b64_tr_b16 v[212:213], v241 offset:26624
  ds_read_b64_tr_b16 v[214:215], v241 offset:26880
  v_mfma_f32_16x16x32_bf16 v[32:35], a[80:83], v[216:219], v[32:35]
  s_add_u32 m0, s101, 12288
  s_add_u32 s15, s15, 16384
  v_mfma_f32_16x16x32_bf16 v[36:39], a[84:87], v[216:219], v[36:39]
  buffer_load_dwordx4 v250, s[52:55], s15 offen offset:0 lds
  buffer_load_dwordx4 v251, s[52:55], s15 offen offset:1024 lds
  v_mfma_f32_16x16x32_bf16 v[40:43], a[88:91], v[216:219], v[40:43]
  s_add_u32 m0, s101, 14336
  s_add_u32 s15, s15, 16384
  v_mfma_f32_16x16x32_bf16 v[44:47], a[92:95], v[216:219], v[44:47]
  ds_read_b64_tr_b16 v[216:217], v240 offset:30720
  ds_read_b64_tr_b16 v[218:219], v240 offset:30976
  v_mfma_f32_16x16x32_bf16 v[48:51], a[80:83], v[220:223], v[48:51]
  buffer_load_dwordx4 v250, s[52:55], s15 offen offset:0 lds
  buffer_load_dwordx4 v251, s[52:55], s15 offen offset:1024 lds
  v_mfma_f32_16x16x32_bf16 v[52:55], a[84:87], v[220:223], v[52:55]
  v_mfma_f32_16x16x32_bf16 v[56:59], a[88:91], v[220:223], v[56:59]
  v_mfma_f32_16x16x32_bf16 v[60:63], a[92:95], v[220:223], v[60:63]
  ds_read_b64_tr_b16 v[220:221], v241 offset:30720
  ds_read_b64_tr_b16 v[222:223], v241 offset:30976
  v_mfma_f32_16x16x32_bf16 v[0:3], a[96:99], v[192:195], v[0:3]
  v_mfma_f32_16x16x32_bf16 v[4:7], a[100:103], v[192:195], v[4:7]
  v_mfma_f32_16x16x32_bf16 v[8:11], a[104:107], v[192:195], v[8:11]
  s_lshr_b32 s6, s3, 1
  s_add_u32 s6, s6, s14
  v_mfma_f32_16x16x32_bf16 v[12:15], a[108:111], v[192:195], v[12:15]
  ds_read_b64_tr_b16 v[192:193], v240 offset:32768
  ds_read_b64_tr_b16 v[194:195], v240 offset:33024
  v_mfma_f32_16x16x32_bf16 v[16:19], a[96:99], v[196:199], v[16:19]
  s_add_u32 s6, s6, 2
  s_and_b32 s6, s6, 7
  v_mfma_f32_16x16x32_bf16 v[20:23], a[100:103], v[196:199], v[20:23]
  s_lshl_b32 s6, s6, 19
  s_add_u32 m0, s9, 0
  v_mfma_f32_16x16x32_bf16 v[24:27], a[104:107], v[196:199], v[24:27]
  s_add_u32 s6, s6, s11
  buffer_load_dwordx4 v244, s[56:59], s6 offen offset:0 lds
  v_mfma_f32_16x16x32_bf16 v[28:31], a[108:111], v[196:199], v[28:31]
  ds_read_b64_tr_b16 v[196:197], v241 offset:32768
  ds_read_b64_tr_b16 v[198:199], v241 offset:33024
  v_mfma_f32_16x16x32_bf16 v[32:35], a[96:99], v[200:203], v[32:35]
  buffer_load_dwordx4 v245, s[56:59], s6 offen offset:1024 lds
  buffer_load_dwordx4 v246, s[56:59], s6 offen offset:2048 lds
  v_mfma_f32_16x16x32_bf16 v[36:39], a[100:103], v[200:203], v[36:39]
  buffer_load_dwordx4 v247, s[56:59], s6 offen offset:3072 lds
  s_waitcnt vmcnt(16)
  ds_read_b128 a[128:131], v252 offset:0
  v_mfma_f32_16x16x32_bf16 v[40:43], a[104:107], v[200:203], v[40:43]
  ds_read_b128 a[132:135], v252 offset:2048
  ds_read_b128 a[136:139], v252 offset:4096
  v_mfma_f32_16x16x32_bf16 v[44:47], a[108:111], v[200:203], v[44:47]
  ds_read_b64_tr_b16 v[200:201], v240 offset:36864
  ds_read_b64_tr_b16 v[202:203], v240 offset:37120
  s_waitcnt lgkmcnt(15)
  v_mfma_f32_16x16x32_bf16 v[48:51], a[96:99], v[204:207], v[48:51]
  ds_read_b128 a[140:143], v252 offset:6144
  ds_read_b128 a[144:147], v253 offset:0
  v_mfma_f32_16x16x32_bf16 v[52:55], a[100:103], v[204:207], v[52:55]
  ds_read_b128 a[148:151], v253 offset:2048
  ds_read_b128 a[152:155], v253 offset:4096
  v_mfma_f32_16x16x32_bf16 v[56:59], a[104:107], v[204:207], v[56:59]
  ds_read_b128 a[156:159], v253 offset:6144
  v_mfma_f32_16x16x32_bf16 v[60:63], a[108:111], v[204:207], v[60:63]
  ds_read_b64_tr_b16 v[204:205], v241 offset:36864
  ds_read_b64_tr_b16 v[206:207], v241 offset:37120
  s_waitcnt lgkmcnt(15)
  v_mfma_f32_16x16x32_bf16 v[0:3], a[112:115], v[208:211], v[0:3]
  s_waitcnt lgkmcnt(2)
  s_add_u32 s15, s14, 6
  s_and_b32 s15, s15, 7
  v_mfma_f32_16x16x32_bf16 v[4:7], a[116:119], v[208:211], v[4:7]
  s_lshl_b32 s15, s15, 7
  s_add_u32 s15, s15, s100
  v_mfma_f32_16x16x32_bf16 v[8:11], a[120:123], v[208:211], v[8:11]
  s_add_u32 m0, s101, 0
  s_nop 0
  v_mfma_f32_16x16x32_bf16 v[12:15], a[124:127], v[208:211], v[12:15]
  ds_read_b64_tr_b16 v[208:209], v240 offset:34816
  ds_read_b64_tr_b16 v[210:211], v240 offset:35072
  v_mfma_f32_16x16x32_bf16 v[16:19], a[112:115], v[212:215], v[16:19]
  buffer_load_dwordx4 v250, s[52:55], s15 offen offset:0 lds
  buffer_load_dwordx4 v251, s[52:55], s15 offen offset:1024 lds
  v_mfma_f32_16x16x32_bf16 v[20:23], a[116:119], v[212:215], v[20:23]
  s_add_u32 m0, s101, 2048
  s_add_u32 s15, s15, 16384
  v_mfma_f32_16x16x32_bf16 v[24:27], a[120:123], v[212:215], v[24:27]
  buffer_load_dwordx4 v250, s[52:55], s15 offen offset:0 lds
  buffer_load_dwordx4 v251, s[52:55], s15 offen offset:1024 lds
  v_mfma_f32_16x16x32_bf16 v[28:31], a[124:127], v[212:215], v[28:31]
  ds_read_b64_tr_b16 v[212:213], v241 offset:34816
  ds_read_b64_tr_b16 v[214:215], v241 offset:35072
  v_mfma_f32_16x16x32_bf16 v[32:35], a[112:115], v[216:219], v[32:35]
  s_add_u32 m0, s101, 4096
  s_add_u32 s15, s15, 16384
  v_mfma_f32_16x16x32_bf16 v[36:39], a[116:119], v[216:219], v[36:39]
  buffer_load_dwordx4 v250, s[52:55], s15 offen offset:0 lds
  buffer_load_dwordx4 v251, s[52:55], s15 offen offset:1024 lds
  v_mfma_f32_16x16x32_bf16 v[40:43], a[120:123], v[216:219], v[40:43]
  s_add_u32 m0, s101, 6144
  s_add_u32 s15, s15, 16384
  v_mfma_f32_16x16x32_bf16 v[44:47], a[124:127], v[216:219], v[44:47]
  ds_read_b64_tr_b16 v[216:217], v240 offset:38912
  ds_read_b64_tr_b16 v[218:219], v240 offset:39168
  v_mfma_f32_16x16x32_bf16 v[48:51], a[112:115], v[220:223], v[48:51]
  buffer_load_dwordx4 v250, s[52:55], s15 offen offset:0 lds
  buffer_load_dwordx4 v251, s[52:55], s15 offen offset:1024 lds
  v_mfma_f32_16x16x32_bf16 v[52:55], a[116:119], v[220:223], v[52:55]
  v_mfma_f32_16x16x32_bf16 v[56:59], a[120:123], v[220:223], v[56:59]
  v_mfma_f32_16x16x32_bf16 v[60:63], a[124:127], v[220:223], v[60:63]
  ds_read_b64_tr_b16 v[220:221], v241 offset:38912
  ds_read_b64_tr_b16 v[222:223], v241 offset:39168
  s_barrier
  v_mfma_f32_16x16x32_bf16 v[0:3], a[128:131], v[192:195], v[0:3]
  v_mfma_f32_16x16x32_bf16 v[4:7], a[132:135], v[192:195], v[4:7]
  v_mfma_f32_16x16x32_bf16 v[8:11], a[136:139], v[192:195], v[8:11]
  s_lshr_b32 s6, s3, 1
  s_add_u32 s6, s6, s14
  v_mfma_f32_16x16x32_bf16 v[12:15], a[140:143], v[192:195], v[12:15]
  ds_read_b64_tr_b16 v[192:193], v240 offset:40960
  ds_read_b64_tr_b16 v[194:195], v240 offset:41216
  v_mfma_f32_16x16x32_bf16 v[16:19], a[128:131], v[196:199], v[16:19]
  s_add_u32 s6, s6, 4
  s_and_b32 s6, s6, 7
  v_mfma_f32_16x16x32_bf16 v[20:23], a[132:135], v[196:199], v[20:23]
  s_lshl_b32 s6, s6, 19
  s_add_u32 m0, s9, 16384
  v_mfma_f32_16x16x32_bf16 v[24:27], a[136:139], v[196:199], v[24:27]
  s_add_u32 s6, s6, s11
  buffer_load_dwordx4 v244, s[56:59], s6 offen offset:0 lds
  v_mfma_f32_16x16x32_bf16 v[28:31], a[140:143], v[196:199], v[28:31]
  ds_read_b64_tr_b16 v[196:197], v241 offset:40960
  ds_read_b64_tr_b16 v[198:199], v241 offset:41216
  v_mfma_f32_16x16x32_bf16 v[32:35], a[128:131], v[200:203], v[32:35]
  buffer_load_dwordx4 v245, s[56:59], s6 offen offset:1024 lds
  buffer_load_dwordx4 v246, s[56:59], s6 offen offset:2048 lds
  v_mfma_f32_16x16x32_bf16 v[36:39], a[132:135], v[200:203], v[36:39]
  buffer_load_dwordx4 v247, s[56:59], s6 offen offset:3072 lds
  s_waitcnt vmcnt(16)
  ds_read_b128 a[160:163], v252 offset:8192
  v_mfma_f32_16x16x32_bf16 v[40:43], a[136:139], v[200:203], v[40:43]
  ds_read_b128 a[164:167], v252 offset:10240
  ds_read_b128 a[168:171], v252 offset:12288
  v_mfma_f32_16x16x32_bf16 v[44:47], a[140:143], v[200:203], v[44:47]
  ds_read_b64_tr_b16 v[200:201], v240 offset:45056
  ds_read_b64_tr_b16 v[202:203], v240 offset:45312
  s_waitcnt lgkmcnt(15)
  v_mfma_f32_16x16x32_bf16 v[48:51], a[128:131], v[204:207], v[48:51]
  ds_read_b128 a[172:175], v252 offset:14336
  ds_read_b128 a[176:179], v253 offset:8192
  v_mfma_f32_16x16x32_bf16 v[52:55], a[132:135], v[204:207], v[52:55]
  ds_read_b128 a[180:183], v253 offset:10240
  ds_read_b128 a[184:187], v253 offset:12288
  v_mfma_f32_16x16x32_bf16 v[56:59], a[136:139], v[204:207], v[56:59]
  ds_read_b128 a[188:191], v253 offset:14336
  v_mfma_f32_16x16x32_bf16 v[60:63], a[140:143], v[204:207], v[60:63]
  ds_read_b64_tr_b16 v[204:205], v241 offset:45056
  ds_read_b64_tr_b16 v[206:207], v241 offset:45312
  s_waitcnt lgkmcnt(15)
  v_mfma_f32_16x16x32_bf16 v[0:3], a[144:147], v[208:211], v[0:3]
  s_waitcnt lgkmcnt(2)
  s_add_u32 s15, s14, 7
  s_and_b32 s15, s15, 7
  v_mfma_f32_16x16x32_bf16 v[4:7], a[148:151], v[208:211], v[4:7]
  s_lshl_b32 s15, s15, 7
  s_add_u32 s15, s15, s100
  v_mfma_f32_16x16x32_bf16 v[8:11], a[152:155], v[208:211], v[8:11]
  s_add_u32 m0, s101, 8192
  s_nop 0
  v_mfma_f32_16x16x32_bf16 v[12:15], a[156:159], v[208:211], v[12:15]
  ds_read_b64_tr_b16 v[208:209], v240 offset:43008
  ds_read_b64_tr_b16 v[210:211], v240 offset:43264
  v_mfma_f32_16x16x32_bf16 v[16:19], a[144:147], v[212:215], v[16:19]
  buffer_load_dwordx4 v250, s[52:55], s15 offen offset:0 lds
  buffer_load_dwordx4 v251, s[52:55], s15 offen offset:1024 lds
  v_mfma_f32_16x16x32_bf16 v[20:23], a[148:151], v[212:215], v[20:23]
  s_add_u32 m0, s101, 10240
  s_add_u32 s15, s15, 16384
  v_mfma_f32_16x16x32_bf16 v[24:27], a[152:155], v[212:215], v[24:27]
  buffer_load_dwordx4 v250, s[52:55], s15 offen offset:0 lds
  buffer_load_dwordx4 v251, s[52:55], s15 offen offset:1024 lds
  v_mfma_f32_16x16x32_bf16 v[28:31], a[156:159], v[212:215], v[28:31]
  ds_read_b64_tr_b16 v[212:213], v241 offset:43008
  ds_read_b64_tr_b16 v[214:215], v241 offset:43264
  v_mfma_f32_16x16x32_bf16 v[32:35], a[144:147], v[216:219], v[32:35]
  s_add_u32 m0, s101, 12288
  s_add_u32 s15, s15, 16384
  v_mfma_f32_16x16x32_bf16 v[36:39], a[148:151], v[216:219], v[36:39]
  buffer_load_dwordx4 v250, s[52:55], s15 offen offset:0 lds
  buffer_load_dwordx4 v251, s[52:55], s15 offen offset:1024 lds
  v_mfma_f32_16x16x32_bf16 v[40:43], a[152:155], v[216:219], v[40:43]
  s_add_u32 m0, s101, 14336
  s_add_u32 s15, s15, 16384
  v_mfma_f32_16x16x32_bf16 v[44:47], a[156:159], v[216:219], v[44:47]
  ds_read_b64_tr_b16 v[216:217], v240 offset:47104
  ds_read_b64_tr_b16 v[218:219], v240 offset:47360
  v_mfma_f32_16x16x32_bf16 v[48:51], a[144:147], v[220:223], v[48:51]
  buffer_load_dwordx4 v250, s[52:55], s15 offen offset:0 lds
  buffer_load_dwordx4 v251, s[52:55], s15 offen offset:1024 lds
  v_mfma_f32_16x16x32_bf16 v[52:55], a[148:151], v[220:223], v[52:55]
  v_mfma_f32_16x16x32_bf16 v[56:59], a[152:155], v[220:223], v[56:59]
  v_mfma_f32_16x16x32_bf16 v[60:63], a[156:159], v[220:223], v[60:63]
  ds_read_b64_tr_b16 v[220:221], v241 offset:47104
  ds_read_b64_tr_b16 v[222:223], v241 offset:47360
  v_mfma_f32_16x16x32_bf16 v[0:3], a[160:163], v[192:195], v[0:3]
  v_mfma_f32_16x16x32_bf16 v[4:7], a[164:167], v[192:195], v[4:7]
  v_mfma_f32_16x16x32_bf16 v[8:11], a[168:171], v[192:195], v[8:11]
  v_mfma_f32_16x16x32_bf16 v[12:15], a[172:175], v[192:195], v[12:15]
  ds_read_b64_tr_b16 v[192:193], v240 offset:49152
  ds_read_b64_tr_b16 v[194:195], v240 offset:49408
  v_mfma_f32_16x16x32_bf16 v[16:19], a[160:163], v[196:199], v[16:19]
  s_waitcnt vmcnt(12)
  ds_read_b128 a[192:195], v252 offset:0
  ds_read_b128 a[196:199], v252 offset:2048
  v_mfma_f32_16x16x32_bf16 v[20:23], a[164:167], v[196:199], v[20:23]
  ds_read_b128 a[200:203], v252 offset:4096
  ds_read_b128 a[204:207], v252 offset:6144
  v_mfma_f32_16x16x32_bf16 v[24:27], a[168:171], v[196:199], v[24:27]
  ds_read_b128 a[208:211], v253 offset:0
  ds_read_b128 a[212:215], v253 offset:2048
  v_mfma_f32_16x16x32_bf16 v[28:31], a[172:175], v[196:199], v[28:31]
  ds_read_b64_tr_b16 v[196:197], v241 offset:49152
  ds_read_b64_tr_b16 v[198:199], v241 offset:49408
  v_mfma_f32_16x16x32_bf16 v[32:35], a[160:163], v[200:203], v[32:35]
  ds_read_b128 a[216:219], v253 offset:4096
  ds_read_b128 a[220:223], v253 offset:6144
  v_mfma_f32_16x16x32_bf16 v[36:39], a[164:167], v[200:203], v[36:39]
  v_mfma_f32_16x16x32_bf16 v[40:43], a[168:171], v[200:203], v[40:43]
  v_mfma_f32_16x16x32_bf16 v[44:47], a[172:175], v[200:203], v[44:47]
  ds_read_b64_tr_b16 v[200:201], v240 offset:53248
  ds_read_b64_tr_b16 v[202:203], v240 offset:53504
  s_waitcnt lgkmcnt(15)
  v_mfma_f32_16x16x32_bf16 v[48:51], a[160:163], v[204:207], v[48:51]
  v_mfma_f32_16x16x32_bf16 v[52:55], a[164:167], v[204:207], v[52:55]
  v_mfma_f32_16x16x32_bf16 v[56:59], a[168:171], v[204:207], v[56:59]
  v_mfma_f32_16x16x32_bf16 v[60:63], a[172:175], v[204:207], v[60:63]
  ds_read_b64_tr_b16 v[204:205], v241 offset:53248
  ds_read_b64_tr_b16 v[206:207], v241 offset:53504
  s_waitcnt lgkmcnt(15)
  v_mfma_f32_16x16x32_bf16 v[0:3], a[176:179], v[208:211], v[0:3]
  v_mfma_f32_16x16x32_bf16 v[4:7], a[180:183], v[208:211], v[4:7]
  v_mfma_f32_16x16x32_bf16 v[8:11], a[184:187], v[208:211], v[8:11]
  v_mfma_f32_16x16x32_bf16 v[12:15], a[188:191], v[208:211], v[12:15]
  ds_read_b64_tr_b16 v[208:209], v240 offset:51200
  ds_read_b64_tr_b16 v[210:211], v240 offset:51456
  s_waitcnt lgkmcnt(15)
  v_mfma_f32_16x16x32_bf16 v[16:19], a[176:179], v[212:215], v[16:19]
  v_mfma_f32_16x16x32_bf16 v[20:23], a[180:183], v[212:215], v[20:23]
  v_mfma_f32_16x16x32_bf16 v[24:27], a[184:187], v[212:215], v[24:27]
  v_mfma_f32_16x16x32_bf16 v[28:31], a[188:191], v[212:215], v[28:31]
  ds_read_b64_tr_b16 v[212:213], v241 offset:51200
  ds_read_b64_tr_b16 v[214:215], v241 offset:51456
  s_waitcnt lgkmcnt(15)
  v_mfma_f32_16x16x32_bf16 v[32:35], a[176:179], v[216:219], v[32:35]
  v_mfma_f32_16x16x32_bf16 v[36:39], a[180:183], v[216:219], v[36:39]
  v_mfma_f32_16x16x32_bf16 v[40:43], a[184:187], v[216:219], v[40:43]
  v_mfma_f32_16x16x32_bf16 v[44:47], a[188:191], v[216:219], v[44:47]
  ds_read_b64_tr_b16 v[216:217], v240 offset:55296
  ds_read_b64_tr_b16 v[218:219], v240 offset:55552
  s_waitcnt lgkmcnt(15)
  v_mfma_f32_16x16x32_bf16 v[48:51], a[176:179], v[220:223], v[48:51]
  v_mfma_f32_16x16x32_bf16 v[52:55], a[180:183], v[220:223], v[52:55]
  v_mfma_f32_16x16x32_bf16 v[56:59], a[184:187], v[220:223], v[56:59]
  v_mfma_f32_16x16x32_bf16 v[60:63], a[188:191], v[220:223], v[60:63]
  ds_read_b64_tr_b16 v[220:221], v241 offset:55296
  ds_read_b64_tr_b16 v[222:223], v241 offset:55552
  s_barrier
  s_waitcnt lgkmcnt(15)
  s_waitcnt lgkmcnt(12)
  v_mfma_f32_16x16x32_bf16 v[0:3], a[192:195], v[192:195], v[0:3]
  v_mfma_f32_16x16x32_bf16 v[4:7], a[196:199], v[192:195], v[4:7]
  v_mfma_f32_16x16x32_bf16 v[8:11], a[200:203], v[192:195], v[8:11]
  s_lshr_b32 s6, s3, 1
  s_add_u32 s6, s6, s14
  v_mfma_f32_16x16x32_bf16 v[12:15], a[204:207], v[192:195], v[12:15]
  ds_read_b64_tr_b16 v[192:193], v240 offset:57344
  ds_read_b64_tr_b16 v[194:195], v240 offset:57600
  v_mfma_f32_16x16x32_bf16 v[16:19], a[192:195], v[196:199], v[16:19]
  s_add_u32 s6, s6, 6
  s_and_b32 s6, s6, 7
  v_mfma_f32_16x16x32_bf16 v[20:23], a[196:199], v[196:199], v[20:23]
  s_lshl_b32 s6, s6, 19
  s_add_u32 m0, s9, 32768
  v_mfma_f32_16x16x32_bf16 v[24:27], a[200:203], v[196:199], v[24:27]
  s_add_u32 s6, s6, s11
  buffer_load_dwordx4 v244, s[56:59], s6 offen offset:0 lds
  v_mfma_f32_16x16x32_bf16 v[28:31], a[204:207], v[196:199], v[28:31]
  ds_read_b64_tr_b16 v[196:197], v241 offset:57344
  ds_read_b64_tr_b16 v[198:199], v241 offset:57600
  s_waitcnt lgkmcnt(14)
  v_mfma_f32_16x16x32_bf16 v[32:35], a[192:195], v[200:203], v[32:35]
  buffer_load_dwordx4 v245, s[56:59], s6 offen offset:1024 lds
  buffer_load_dwordx4 v246, s[56:59], s6 offen offset:2048 lds
  v_mfma_f32_16x16x32_bf16 v[36:39], a[196:199], v[200:203], v[36:39]
  buffer_load_dwordx4 v247, s[56:59], s6 offen offset:3072 lds
  s_waitcnt vmcnt(4)
  ds_read_b128 a[224:227], v252 offset:8192
  v_mfma_f32_16x16x32_bf16 v[40:43], a[200:203], v[200:203], v[40:43]
  ds_read_b128 a[228:231], v252 offset:10240
  ds_read_b128 a[232:235], v252 offset:12288
  v_mfma_f32_16x16x32_bf16 v[44:47], a[204:207], v[200:203], v[44:47]
  ds_read_b64_tr_b16 v[200:201], v240 offset:61440
  ds_read_b64_tr_b16 v[202:203], v240 offset:61696
  s_waitcnt lgkmcnt(15)
  v_mfma_f32_16x16x32_bf16 v[48:51], a[192:195], v[204:207], v[48:51]
  ds_read_b128 a[236:239], v252 offset:14336
  ds_read_b128 a[240:243], v253 offset:8192
  v_mfma_f32_16x16x32_bf16 v[52:55], a[196:199], v[204:207], v[52:55]
  ds_read_b128 a[244:247], v253 offset:10240
  ds_read_b128 a[248:251], v253 offset:12288
  v_mfma_f32_16x16x32_bf16 v[56:59], a[200:203], v[204:207], v[56:59]
  ds_read_b128 a[252:255], v253 offset:14336
  v_mfma_f32_16x16x32_bf16 v[60:63], a[204:207], v[204:207], v[60:63]
  ds_read_b64_tr_b16 v[204:205], v241 offset:61440
  ds_read_b64_tr_b16 v[206:207], v241 offset:61696
  s_waitcnt lgkmcnt(15)
  v_mfma_f32_16x16x32_bf16 v[0:3], a[208:211], v[208:211], v[0:3]
  v_mfma_f32_16x16x32_bf16 v[4:7], a[212:215], v[208:211], v[4:7]
  v_mfma_f32_16x16x32_bf16 v[8:11], a[216:219], v[208:211], v[8:11]
  v_mfma_f32_16x16x32_bf16 v[12:15], a[220:223], v[208:211], v[12:15]
  ds_read_b64_tr_b16 v[208:209], v240 offset:59392
  ds_read_b64_tr_b16 v[210:211], v240 offset:59648
  s_waitcnt lgkmcnt(15)
  v_mfma_f32_16x16x32_bf16 v[16:19], a[208:211], v[212:215], v[16:19]
  v_mfma_f32_16x16x32_bf16 v[20:23], a[212:215], v[212:215], v[20:23]
  v_mfma_f32_16x16x32_bf16 v[24:27], a[216:219], v[212:215], v[24:27]
  v_mfma_f32_16x16x32_bf16 v[28:31], a[220:223], v[212:215], v[28:31]
  ds_read_b64_tr_b16 v[212:213], v241 offset:59392
  ds_read_b64_tr_b16 v[214:215], v241 offset:59648
  s_waitcnt lgkmcnt(15)
  v_mfma_f32_16x16x32_bf16 v[32:35], a[208:211], v[216:219], v[32:35]
  v_mfma_f32_16x16x32_bf16 v[36:39], a[212:215], v[216:219], v[36:39]
  v_mfma_f32_16x16x32_bf16 v[40:43], a[216:219], v[216:219], v[40:43]
  v_mfma_f32_16x16x32_bf16 v[44:47], a[220:223], v[216:219], v[44:47]
  ds_read_b64_tr_b16 v[216:217], v240 offset:63488
  ds_read_b64_tr_b16 v[218:219], v240 offset:63744
  s_waitcnt lgkmcnt(15)
  v_mfma_f32_16x16x32_bf16 v[48:51], a[208:211], v[220:223], v[48:51]
  v_mfma_f32_16x16x32_bf16 v[52:55], a[212:215], v[220:223], v[52:55]
  v_mfma_f32_16x16x32_bf16 v[56:59], a[216:219], v[220:223], v[56:59]
  v_mfma_f32_16x16x32_bf16 v[60:63], a[220:223], v[220:223], v[60:63]
  ds_read_b64_tr_b16 v[220:221], v241 offset:63488
  ds_read_b64_tr_b16 v[222:223], v241 offset:63744
  s_waitcnt lgkmcnt(15)
  s_waitcnt lgkmcnt(10)
  v_mfma_f32_16x16x32_bf16 v[0:3], a[224:227], v[192:195], v[0:3]
  v_mfma_f32_16x16x32_bf16 v[4:7], a[228:231], v[192:195], v[4:7]
  v_mfma_f32_16x16x32_bf16 v[8:11], a[232:235], v[192:195], v[8:11]
  v_mfma_f32_16x16x32_bf16 v[12:15], a[236:239], v[192:195], v[12:15]
  ds_read_b64_tr_b16 v[192:193], v242 offset:0
  ds_read_b64_tr_b16 v[194:195], v242 offset:256
  v_mfma_f32_16x16x32_bf16 v[16:19], a[224:227], v[196:199], v[16:19]
  v_mfma_f32_16x16x32_bf16 v[20:23], a[228:231], v[196:199], v[20:23]
  v_mfma_f32_16x16x32_bf16 v[24:27], a[232:235], v[196:199], v[24:27]
  v_mfma_f32_16x16x32_bf16 v[28:31], a[236:239], v[196:199], v[28:31]
  ds_read_b64_tr_b16 v[196:197], v243 offset:0
  ds_read_b64_tr_b16 v[198:199], v243 offset:256
  v_mfma_f32_16x16x32_bf16 v[32:35], a[224:227], v[200:203], v[32:35]
  v_mfma_f32_16x16x32_bf16 v[36:39], a[228:231], v[200:203], v[36:39]
  v_mfma_f32_16x16x32_bf16 v[40:43], a[232:235], v[200:203], v[40:43]
  v_mfma_f32_16x16x32_bf16 v[44:47], a[236:239], v[200:203], v[44:47]
  ds_read_b64_tr_b16 v[200:201], v242 offset:4096
  ds_read_b64_tr_b16 v[202:203], v242 offset:4352
  s_waitcnt lgkmcnt(14)
  v_mfma_f32_16x16x32_bf16 v[48:51], a[224:227], v[204:207], v[48:51]
  v_mfma_f32_16x16x32_bf16 v[52:55], a[228:231], v[204:207], v[52:55]
  v_mfma_f32_16x16x32_bf16 v[56:59], a[232:235], v[204:207], v[56:59]
  v_mfma_f32_16x16x32_bf16 v[60:63], a[236:239], v[204:207], v[60:63]
  ds_read_b64_tr_b16 v[204:205], v243 offset:4096
  ds_read_b64_tr_b16 v[206:207], v243 offset:4352
  s_waitcnt lgkmcnt(14)
  v_mfma_f32_16x16x32_bf16 v[0:3], a[240:243], v[208:211], v[0:3]
  v_mfma_f32_16x16x32_bf16 v[4:7], a[244:247], v[208:211], v[4:7]
  v_mfma_f32_16x16x32_bf16 v[8:11], a[248:251], v[208:211], v[8:11]
  v_mfma_f32_16x16x32_bf16 v[12:15], a[252:255], v[208:211], v[12:15]
  ds_read_b64_tr_b16 v[208:209], v242 offset:2048
  ds_read_b64_tr_b16 v[210:211], v242 offset:2304
  s_waitcnt lgkmcnt(14)
  v_mfma_f32_16x16x32_bf16 v[16:19], a[240:243], v[212:215], v[16:19]
  v_mfma_f32_16x16x32_bf16 v[20:23], a[244:247], v[212:215], v[20:23]
  v_mfma_f32_16x16x32_bf16 v[24:27], a[248:251], v[212:215], v[24:27]
  v_mfma_f32_16x16x32_bf16 v[28:31], a[252:255], v[212:215], v[28:31]
  ds_read_b64_tr_b16 v[212:213], v243 offset:2048
  ds_read_b64_tr_b16 v[214:215], v243 offset:2304
  s_waitcnt lgkmcnt(14)
  v_mfma_f32_16x16x32_bf16 v[32:35], a[240:243], v[216:219], v[32:35]
  v_mfma_f32_16x16x32_bf16 v[36:39], a[244:247], v[216:219], v[36:39]
  v_mfma_f32_16x16x32_bf16 v[40:43], a[248:251], v[216:219], v[40:43]
  v_mfma_f32_16x16x32_bf16 v[44:47], a[252:255], v[216:219], v[44:47]
  ds_read_b64_tr_b16 v[216:217], v242 offset:6144
  ds_read_b64_tr_b16 v[218:219], v242 offset:6400
  s_waitcnt lgkmcnt(14)
  v_mfma_f32_16x16x32_bf16 v[48:51], a[240:243], v[220:223], v[48:51]
  v_mfma_f32_16x16x32_bf16 v[52:55], a[244:247], v[220:223], v[52:55]
  v_mfma_f32_16x16x32_bf16 v[56:59], a[248:251], v[220:223], v[56:59]
  v_mfma_f32_16x16x32_bf16 v[60:63], a[252:255], v[220:223], v[60:63]
  ds_read_b64_tr_b16 v[220:221], v243 offset:6144
  ds_read_b64_tr_b16 v[222:223], v243 offset:6400
  s_barrier
  s_waitcnt lgkmcnt(14)
  v_mfma_f32_16x16x32_bf16 v[64:67], a[0:3], v[192:195], 0
  v_mfma_f32_16x16x32_bf16 v[68:71], a[4:7], v[192:195], 0
  v_mfma_f32_16x16x32_bf16 v[72:75], a[8:11], v[192:195], 0
  s_lshr_b32 s6, s3, 1
  s_add_u32 s6, s6, s14
  v_mfma_f32_16x16x32_bf16 v[76:79], a[12:15], v[192:195], 0
  ds_read_b64_tr_b16 v[192:193], v242 offset:8192
  ds_read_b64_tr_b16 v[194:195], v242 offset:8448
  s_waitcnt lgkmcnt(14)
  v_mfma_f32_16x16x32_bf16 v[80:83], a[0:3], v[196:199], 0
  s_add_u32 s6, s6, 0
  s_and_b32 s6, s6, 7
  v_mfma_f32_16x16x32_bf16 v[84:87], a[4:7], v[196:199], 0
  s_lshl_b32 s6, s6, 19
  s_add_u32 m0, s9, 49152
  v_mfma_f32_16x16x32_bf16 v[88:91], a[8:11], v[196:199], 0
  s_add_u32 s6, s6, s12
  buffer_load_dwordx4 v244, s[56:59], s6 offen offset:0 lds
  v_mfma_f32_16x16x32_bf16 v[92:95], a[12:15], v[196:199], 0
  ds_read_b64_tr_b16 v[196:197], v243 offset:8192
  ds_read_b64_tr_b16 v[198:199], v243 offset:8448
  s_waitcnt lgkmcnt(14)
  v_mfma_f32_16x16x32_bf16 v[96:99], a[0:3], v[200:203], 0
  buffer_load_dwordx4 v245, s[56:59], s6 offen offset:1024 lds
  buffer_load_dwordx4 v246, s[56:59], s6 offen offset:2048 lds
  v_mfma_f32_16x16x32_bf16 v[100:103], a[4:7], v[200:203], 0
  buffer_load_dwordx4 v247, s[56:59], s6 offen offset:3072 lds
  v_cvt_pk_bf16_f32 v224, v0, v1
  v_mfma_f32_16x16x32_bf16 v[104:107], a[8:11], v[200:203], 0
  v_mfma_f32_16x16x32_bf16 v[108:111], a[12:15], v[200:203], 0
  ds_read_b64_tr_b16 v[200:201], v242 offset:12288
  ds_read_b64_tr_b16 v[202:203], v242 offset:12544
  s_waitcnt lgkmcnt(14)
  v_mfma_f32_16x16x32_bf16 v[112:115], a[0:3], v[204:207], 0
  v_cvt_pk_bf16_f32 v225, v2, v3
  v_mfma_f32_16x16x32_bf16 v[116:119], a[4:7], v[204:207], 0
  v_mfma_f32_16x16x32_bf16 v[120:123], a[8:11], v[204:207], 0
  v_mfma_f32_16x16x32_bf16 v[124:127], a[12:15], v[204:207], 0
  ds_read_b64_tr_b16 v[204:205], v243 offset:12288
  ds_read_b64_tr_b16 v[206:207], v243 offset:12544
  s_waitcnt lgkmcnt(14)
  v_mfma_f32_16x16x32_bf16 v[64:67], a[16:19], v[208:211], v[64:67]
  v_cvt_pk_bf16_f32 v226, v4, v5
  v_mfma_f32_16x16x32_bf16 v[68:71], a[20:23], v[208:211], v[68:71]
  v_mfma_f32_16x16x32_bf16 v[72:75], a[24:27], v[208:211], v[72:75]
  v_cvt_pk_bf16_f32 v227, v6, v7
  v_mfma_f32_16x16x32_bf16 v[76:79], a[28:31], v[208:211], v[76:79]
  ds_read_b64_tr_b16 v[208:209], v242 offset:10240
  ds_read_b64_tr_b16 v[210:211], v242 offset:10496
  s_waitcnt lgkmcnt(14)
  v_mfma_f32_16x16x32_bf16 v[80:83], a[16:19], v[212:215], v[80:83]
  v_mfma_f32_16x16x32_bf16 v[84:87], a[20:23], v[212:215], v[84:87]
  buffer_store_dwordx4 v[224:227], v128, s[64:67], s84 offen offset:0 sc1
  v_mfma_f32_16x16x32_bf16 v[88:91], a[24:27], v[212:215], v[88:91]
  v_mfma_f32_16x16x32_bf16 v[92:95], a[28:31], v[212:215], v[92:95]
  ds_read_b64_tr_b16 v[212:213], v243 offset:10240
  ds_read_b64_tr_b16 v[214:215], v243 offset:10496
  s_waitcnt lgkmcnt(14)
  v_mfma_f32_16x16x32_bf16 v[96:99], a[16:19], v[216:219], v[96:99]
  v_cvt_pk_bf16_f32 v228, v16, v17
  v_mfma_f32_16x16x32_bf16 v[100:103], a[20:23], v[216:219], v[100:103]
  v_mfma_f32_16x16x32_bf16 v[104:107], a[24:27], v[216:219], v[104:107]
  v_mfma_f32_16x16x32_bf16 v[108:111], a[28:31], v[216:219], v[108:111]
  ds_read_b64_tr_b16 v[216:217], v242 offset:14336
  ds_read_b64_tr_b16 v[218:219], v242 offset:14592
  s_waitcnt lgkmcnt(14)
  v_mfma_f32_16x16x32_bf16 v[112:115], a[16:19], v[220:223], v[112:115]
  v_cvt_pk_bf16_f32 v229, v18, v19
  v_mfma_f32_16x16x32_bf16 v[116:119], a[20:23], v[220:223], v[116:119]
  v_mfma_f32_16x16x32_bf16 v[120:123], a[24:27], v[220:223], v[120:123]
  v_cvt_pk_bf16_f32 v230, v20, v21
  v_mfma_f32_16x16x32_bf16 v[124:127], a[28:31], v[220:223], v[124:127]
  ds_read_b64_tr_b16 v[220:221], v243 offset:14336
  ds_read_b64_tr_b16 v[222:223], v243 offset:14592
  s_waitcnt lgkmcnt(14)
  v_mfma_f32_16x16x32_bf16 v[64:67], a[32:35], v[192:195], v[64:67]
  v_mfma_f32_16x16x32_bf16 v[68:71], a[36:39], v[192:195], v[68:71]
  v_mfma_f32_16x16x32_bf16 v[72:75], a[40:43], v[192:195], v[72:75]
  v_cvt_pk_bf16_f32 v231, v22, v23
  v_mfma_f32_16x16x32_bf16 v[76:79], a[44:47], v[192:195], v[76:79]
  ds_read_b64_tr_b16 v[192:193], v240 offset:0
  ds_read_b64_tr_b16 v[194:195], v240 offset:256
  s_waitcnt lgkmcnt(14)
  v_mfma_f32_16x16x32_bf16 v[80:83], a[32:35], v[196:199], v[80:83]
  v_mfma_f32_16x16x32_bf16 v[84:87], a[36:39], v[196:199], v[84:87]
  buffer_store_dwordx4 v[228:231], v128, s[64:67], s84 offen offset:1024 sc1
  v_mfma_f32_16x16x32_bf16 v[88:91], a[40:43], v[196:199], v[88:91]
  v_mfma_f32_16x16x32_bf16 v[92:95], a[44:47], v[196:199], v[92:95]
  ds_read_b64_tr_b16 v[196:197], v241 offset:0
  ds_read_b64_tr_b16 v[198:199], v241 offset:256
  s_waitcnt lgkmcnt(14)
  v_mfma_f32_16x16x32_bf16 v[96:99], a[32:35], v[200:203], v[96:99]
  v_mfma_f32_16x16x32_bf16 v[100:103], a[36:39], v[200:203], v[100:103]
  v_cvt_pk_bf16_f32 v232, v8, v9
  v_mfma_f32_16x16x32_bf16 v[104:107], a[40:43], v[200:203], v[104:107]
  v_mfma_f32_16x16x32_bf16 v[108:111], a[44:47], v[200:203], v[108:111]
  ds_read_b64_tr_b16 v[200:201], v240 offset:4096
  ds_read_b64_tr_b16 v[202:203], v240 offset:4352
  s_waitcnt lgkmcnt(14)
  v_mfma_f32_16x16x32_bf16 v[112:115], a[32:35], v[204:207], v[112:115]
  v_cvt_pk_bf16_f32 v233, v10, v11
  v_mfma_f32_16x16x32_bf16 v[116:119], a[36:39], v[204:207], v[116:119]
  v_mfma_f32_16x16x32_bf16 v[120:123], a[40:43], v[204:207], v[120:123]
  v_mfma_f32_16x16x32_bf16 v[124:127], a[44:47], v[204:207], v[124:127]
  ds_read_b64_tr_b16 v[204:205], v241 offset:4096
  ds_read_b64_tr_b16 v[206:207], v241 offset:4352
  s_waitcnt lgkmcnt(14)
  v_mfma_f32_16x16x32_bf16 v[64:67], a[48:51], v[208:211], v[64:67]
  v_cvt_pk_bf16_f32 v234, v12, v13
  v_mfma_f32_16x16x32_bf16 v[68:71], a[52:55], v[208:211], v[68:71]
  v_mfma_f32_16x16x32_bf16 v[72:75], a[56:59], v[208:211], v[72:75]
  v_mfma_f32_16x16x32_bf16 v[76:79], a[60:63], v[208:211], v[76:79]
  ds_read_b64_tr_b16 v[208:209], v240 offset:2048
  ds_read_b64_tr_b16 v[210:211], v240 offset:2304
  s_waitcnt lgkmcnt(14)
  v_mfma_f32_16x16x32_bf16 v[80:83], a[48:51], v[212:215], v[80:83]
  v_cvt_pk_bf16_f32 v235, v14, v15
  v_mfma_f32_16x16x32_bf16 v[84:87], a[52:55], v[212:215], v[84:87]
  v_mfma_f32_16x16x32_bf16 v[88:91], a[56:59], v[212:215], v[88:91]
  v_mfma_f32_16x16x32_bf16 v[92:95], a[60:63], v[212:215], v[92:95]
  ds_read_b64_tr_b16 v[212:213], v241 offset:2048
  ds_read_b64_tr_b16 v[214:215], v241 offset:2304
  s_waitcnt lgkmcnt(14)
  v_mfma_f32_16x16x32_bf16 v[96:99], a[48:51], v[216:219], v[96:99]
  buffer_store_dwordx4 v[232:235], v130, s[64:67], s84 offen offset:0 sc1
  v_mfma_f32_16x16x32_bf16 v[100:103], a[52:55], v[216:219], v[100:103]
  v_mfma_f32_16x16x32_bf16 v[104:107], a[56:59], v[216:219], v[104:107]
  v_mfma_f32_16x16x32_bf16 v[108:111], a[60:63], v[216:219], v[108:111]
  ds_read_b64_tr_b16 v[216:217], v240 offset:6144
  ds_read_b64_tr_b16 v[218:219], v240 offset:6400
  s_waitcnt lgkmcnt(14)
  v_mfma_f32_16x16x32_bf16 v[112:115], a[48:51], v[220:223], v[112:115]
  v_cvt_pk_bf16_f32 v224, v24, v25
  v_mfma_f32_16x16x32_bf16 v[116:119], a[52:55], v[220:223], v[116:119]
  v_mfma_f32_16x16x32_bf16 v[120:123], a[56:59], v[220:223], v[120:123]
  v_mfma_f32_16x16x32_bf16 v[124:127], a[60:63], v[220:223], v[124:127]
  ds_read_b64_tr_b16 v[220:221], v241 offset:6144
  ds_read_b64_tr_b16 v[222:223], v241 offset:6400
  s_barrier
  s_waitcnt lgkmcnt(14)
  v_mfma_f32_16x16x32_bf16 v[64:67], a[64:67], v[192:195], v[64:67]
  v_cvt_pk_bf16_f32 v225, v26, v27
  v_mfma_f32_16x16x32_bf16 v[68:71], a[68:71], v[192:195], v[68:71]
  v_mfma_f32_16x16x32_bf16 v[72:75], a[72:75], v[192:195], v[72:75]
  s_lshr_b32 s6, s3, 1
  s_add_u32 s6, s6, s14
  v_mfma_f32_16x16x32_bf16 v[76:79], a[76:79], v[192:195], v[76:79]
  ds_read_b64_tr_b16 v[192:193], v240 offset:8192
  ds_read_b64_tr_b16 v[194:195], v240 offset:8448
  s_waitcnt lgkmcnt(14)
  v_mfma_f32_16x16x32_bf16 v[80:83], a[64:67], v[196:199], v[80:83]
  s_add_u32 s6, s6, 2
  s_and_b32 s6, s6, 7
  v_mfma_f32_16x16x32_bf16 v[84:87], a[68:71], v[196:199], v[84:87]
  s_lshl_b32 s6, s6, 19
  s_add_u32 m0, s9, 65536
  v_mfma_f32_16x16x32_bf16 v[88:91], a[72:75], v[196:199], v[88:91]
  s_add_u32 s6, s6, s12
  buffer_load_dwordx4 v244, s[56:59], s6 offen offset:0 lds
  v_mfma_f32_16x16x32_bf16 v[92:95], a[76:79], v[196:199], v[92:95]
  ds_read_b64_tr_b16 v[196:197], v241 offset:8192
  ds_read_b64_tr_b16 v[198:199], v241 offset:8448
  s_waitcnt lgkmcnt(14)
  v_mfma_f32_16x16x32_bf16 v[96:99], a[64:67], v[200:203], v[96:99]
  buffer_load_dwordx4 v245, s[56:59], s6 offen offset:1024 lds
  buffer_load_dwordx4 v246, s[56:59], s6 offen offset:2048 lds
  v_mfma_f32_16x16x32_bf16 v[100:103], a[68:71], v[200:203], v[100:103]
  buffer_load_dwordx4 v247, s[56:59], s6 offen offset:3072 lds
  v_cvt_pk_bf16_f32 v226, v28, v29
  v_mfma_f32_16x16x32_bf16 v[104:107], a[72:75], v[200:203], v[104:107]
  v_cvt_pk_bf16_f32 v227, v30, v31
  v_mfma_f32_16x16x32_bf16 v[108:111], a[76:79], v[200:203], v[108:111]
  ds_read_b64_tr_b16 v[200:201], v240 offset:12288
  ds_read_b64_tr_b16 v[202:203], v240 offset:12544
  s_waitcnt lgkmcnt(14)
  v_mfma_f32_16x16x32_bf16 v[112:115], a[64:67], v[204:207], v[112:115]
  buffer_store_dwordx4 v[224:227], v130, s[64:67], s84 offen offset:1024 sc1
  v_mfma_f32_16x16x32_bf16 v[116:119], a[68:71], v[204:207], v[116:119]
  v_mfma_f32_16x16x32_bf16 v[120:123], a[72:75], v[204:207], v[120:123]
  v_mfma_f32_16x16x32_bf16 v[124:127], a[76:79], v[204:207], v[124:127]
  ds_read_b64_tr_b16 v[204:205], v241 offset:12288
  ds_read_b64_tr_b16 v[206:207], v241 offset:12544
  s_waitcnt lgkmcnt(14)
  v_mfma_f32_16x16x32_bf16 v[64:67], a[80:83], v[208:211], v[64:67]
  v_mfma_f32_16x16x32_bf16 v[68:71], a[84:87], v[208:211], v[68:71]
  v_cvt_pk_bf16_f32 v228, v32, v33
  v_mfma_f32_16x16x32_bf16 v[72:75], a[88:91], v[208:211], v[72:75]
  v_mfma_f32_16x16x32_bf16 v[76:79], a[92:95], v[208:211], v[76:79]
  ds_read_b64_tr_b16 v[208:209], v240 offset:10240
  ds_read_b64_tr_b16 v[210:211], v240 offset:10496
  s_waitcnt lgkmcnt(14)
  v_mfma_f32_16x16x32_bf16 v[80:83], a[80:83], v[212:215], v[80:83]
  v_mfma_f32_16x16x32_bf16 v[84:87], a[84:87], v[212:215], v[84:87]
  v_cvt_pk_bf16_f32 v229, v34, v35
  v_mfma_f32_16x16x32_bf16 v[88:91], a[88:91], v[212:215], v[88:91]
  v_mfma_f32_16x16x32_bf16 v[92:95], a[92:95], v[212:215], v[92:95]
  ds_read_b64_tr_b16 v[212:213], v241 offset:10240
  ds_read_b64_tr_b16 v[214:215], v241 offset:10496
  s_waitcnt lgkmcnt(14)
  v_mfma_f32_16x16x32_bf16 v[96:99], a[80:83], v[216:219], v[96:99]
  v_mfma_f32_16x16x32_bf16 v[100:103], a[84:87], v[216:219], v[100:103]
  v_cvt_pk_bf16_f32 v230, v36, v37
  v_mfma_f32_16x16x32_bf16 v[104:107], a[88:91], v[216:219], v[104:107]
  v_mfma_f32_16x16x32_bf16 v[108:111], a[92:95], v[216:219], v[108:111]
  ds_read_b64_tr_b16 v[216:217], v240 offset:14336
  ds_read_b64_tr_b16 v[218:219], v240 offset:14592
  s_waitcnt lgkmcnt(14)
  v_mfma_f32_16x16x32_bf16 v[112:115], a[80:83], v[220:223], v[112:115]
  v_mfma_f32_16x16x32_bf16 v[116:119], a[84:87], v[220:223], v[116:119]
  v_mfma_f32_16x16x32_bf16 v[120:123], a[88:91], v[220:223], v[120:123]
  v_cvt_pk_bf16_f32 v231, v38, v39
  v_mfma_f32_16x16x32_bf16 v[124:127], a[92:95], v[220:223], v[124:127]
  ds_read_b64_tr_b16 v[220:221], v241 offset:14336
  ds_read_b64_tr_b16 v[222:223], v241 offset:14592
  s_waitcnt lgkmcnt(14)
  v_mfma_f32_16x16x32_bf16 v[64:67], a[96:99], v[192:195], v[64:67]
  v_mfma_f32_16x16x32_bf16 v[68:71], a[100:103], v[192:195], v[68:71]
  v_mfma_f32_16x16x32_bf16 v[72:75], a[104:107], v[192:195], v[72:75]
  v_mfma_f32_16x16x32_bf16 v[76:79], a[108:111], v[192:195], v[76:79]
  ds_read_b64_tr_b16 v[192:193], v240 offset:16384
  ds_read_b64_tr_b16 v[194:195], v240 offset:16640
  s_waitcnt lgkmcnt(14)
  v_mfma_f32_16x16x32_bf16 v[80:83], a[96:99], v[196:199], v[80:83]
  buffer_store_dwordx4 v[228:231], v128, s[64:67], s85 offen offset:0 sc1
  v_mfma_f32_16x16x32_bf16 v[84:87], a[100:103], v[196:199], v[84:87]
  v_mfma_f32_16x16x32_bf16 v[88:91], a[104:107], v[196:199], v[88:91]
  v_mfma_f32_16x16x32_bf16 v[92:95], a[108:111], v[196:199], v[92:95]
  ds_read_b64_tr_b16 v[196:197], v241 offset:16384
  ds_read_b64_tr_b16 v[198:199], v241 offset:16640
  s_waitcnt lgkmcnt(14)
  v_mfma_f32_16x16x32_bf16 v[96:99], a[96:99], v[200:203], v[96:99]
  v_cvt_pk_bf16_f32 v232, v48, v49
  v_mfma_f32_16x16x32_bf16 v[100:103], a[100:103], v[200:203], v[100:103]
  v_mfma_f32_16x16x32_bf16 v[104:107], a[104:107], v[200:203], v[104:107]
  v_mfma_f32_16x16x32_bf16 v[108:111], a[108:111], v[200:203], v[108:111]
  ds_read_b64_tr_b16 v[200:201], v240 offset:20480
  ds_read_b64_tr_b16 v[202:203], v240 offset:20736
  s_waitcnt lgkmcnt(14)
  v_mfma_f32_16x16x32_bf16 v[112:115], a[96:99], v[204:207], v[112:115]
  v_cvt_pk_bf16_f32 v233, v50, v51
  v_mfma_f32_16x16x32_bf16 v[116:119], a[100:103], v[204:207], v[116:119]
  v_mfma_f32_16x16x32_bf16 v[120:123], a[104:107], v[204:207], v[120:123]
  v_mfma_f32_16x16x32_bf16 v[124:127], a[108:111], v[204:207], v[124:127]
  ds_read_b64_tr_b16 v[204:205], v241 offset:20480
  ds_read_b64_tr_b16 v[206:207], v241 offset:20736
  s_waitcnt lgkmcnt(14)
  v_mfma_f32_16x16x32_bf16 v[64:67], a[112:115], v[208:211], v[64:67]
  v_mfma_f32_16x16x32_bf16 v[68:71], a[116:119], v[208:211], v[68:71]
  v_mfma_f32_16x16x32_bf16 v[72:75], a[120:123], v[208:211], v[72:75]
  v_cvt_pk_bf16_f32 v234, v52, v53
  v_mfma_f32_16x16x32_bf16 v[76:79], a[124:127], v[208:211], v[76:79]
  ds_read_b64_tr_b16 v[208:209], v240 offset:18432
  ds_read_b64_tr_b16 v[210:211], v240 offset:18688
  s_waitcnt lgkmcnt(14)
  v_mfma_f32_16x16x32_bf16 v[80:83], a[112:115], v[212:215], v[80:83]
  v_mfma_f32_16x16x32_bf16 v[84:87], a[116:119], v[212:215], v[84:87]
  v_mfma_f32_16x16x32_bf16 v[88:91], a[120:123], v[212:215], v[88:91]
  v_mfma_f32_16x16x32_bf16 v[92:95], a[124:127], v[212:215], v[92:95]
  ds_read_b64_tr_b16 v[212:213], v241 offset:18432
  ds_read_b64_tr_b16 v[214:215], v241 offset:18688
  s_waitcnt lgkmcnt(14)
  v_mfma_f32_16x16x32_bf16 v[96:99], a[112:115], v[216:219], v[96:99]
  v_cvt_pk_bf16_f32 v235, v54, v55
  v_mfma_f32_16x16x32_bf16 v[100:103], a[116:119], v[216:219], v[100:103]
  v_mfma_f32_16x16x32_bf16 v[104:107], a[120:123], v[216:219], v[104:107]
  v_mfma_f32_16x16x32_bf16 v[108:111], a[124:127], v[216:219], v[108:111]
  ds_read_b64_tr_b16 v[216:217], v240 offset:22528
  ds_read_b64_tr_b16 v[218:219], v240 offset:22784
  s_waitcnt lgkmcnt(14)
  v_mfma_f32_16x16x32_bf16 v[112:115], a[112:115], v[220:223], v[112:115]
  buffer_store_dwordx4 v[232:235], v128, s[64:67], s85 offen offset:1024 sc1
  v_mfma_f32_16x16x32_bf16 v[116:119], a[116:119], v[220:223], v[116:119]
  v_mfma_f32_16x16x32_bf16 v[120:123], a[120:123], v[220:223], v[120:123]
  v_mfma_f32_16x16x32_bf16 v[124:127], a[124:127], v[220:223], v[124:127]
  ds_read_b64_tr_b16 v[220:221], v241 offset:22528
  ds_read_b64_tr_b16 v[222:223], v241 offset:22784
  s_waitcnt vmcnt(14)
  s_barrier
  s_waitcnt lgkmcnt(14)
  v_mfma_f32_16x16x32_bf16 v[64:67], a[128:131], v[192:195], v[64:67]
  v_mfma_f32_16x16x32_bf16 v[68:71], a[132:135], v[192:195], v[68:71]
  v_mfma_f32_16x16x32_bf16 v[72:75], a[136:139], v[192:195], v[72:75]
  s_lshr_b32 s6, s3, 1
  s_add_u32 s6, s6, s14
  v_mfma_f32_16x16x32_bf16 v[76:79], a[140:143], v[192:195], v[76:79]
  ds_read_b64_tr_b16 v[192:193], v240 offset:24576
  ds_read_b64_tr_b16 v[194:195], v240 offset:24832
  s_waitcnt lgkmcnt(14)
  v_mfma_f32_16x16x32_bf16 v[80:83], a[128:131], v[196:199], v[80:83]
  s_add_u32 s6, s6, 4
  s_and_b32 s6, s6, 7
  v_mfma_f32_16x16x32_bf16 v[84:87], a[132:135], v[196:199], v[84:87]
  s_lshl_b32 s6, s6, 19
  s_add_u32 m0, s9, 0
  v_mfma_f32_16x16x32_bf16 v[88:91], a[136:139], v[196:199], v[88:91]
  s_add_u32 s6, s6, s12
  buffer_load_dwordx4 v244, s[56:59], s6 offen offset:0 lds
  v_mfma_f32_16x16x32_bf16 v[92:95], a[140:143], v[196:199], v[92:95]
  ds_read_b64_tr_b16 v[196:197], v241 offset:24576
  ds_read_b64_tr_b16 v[198:199], v241 offset:24832
  s_waitcnt lgkmcnt(14)
  v_mfma_f32_16x16x32_bf16 v[96:99], a[128:131], v[200:203], v[96:99]
  buffer_load_dwordx4 v245, s[56:59], s6 offen offset:1024 lds
  buffer_load_dwordx4 v246, s[56:59], s6 offen offset:2048 lds
  v_mfma_f32_16x16x32_bf16 v[100:103], a[132:135], v[200:203], v[100:103]
  buffer_load_dwordx4 v247, s[56:59], s6 offen offset:3072 lds
  v_cvt_pk_bf16_f32 v224, v40, v41
  v_mfma_f32_16x16x32_bf16 v[104:107], a[136:139], v[200:203], v[104:107]
  v_cvt_pk_bf16_f32 v225, v42, v43
  v_mfma_f32_16x16x32_bf16 v[108:111], a[140:143], v[200:203], v[108:111]
  ds_read_b64_tr_b16 v[200:201], v240 offset:28672
  ds_read_b64_tr_b16 v[202:203], v240 offset:28928
  s_waitcnt lgkmcnt(14)
  v_mfma_f32_16x16x32_bf16 v[112:115], a[128:131], v[204:207], v[112:115]
  v_mfma_f32_16x16x32_bf16 v[116:119], a[132:135], v[204:207], v[116:119]
  v_mfma_f32_16x16x32_bf16 v[120:123], a[136:139], v[204:207], v[120:123]
  v_mfma_f32_16x16x32_bf16 v[124:127], a[140:143], v[204:207], v[124:127]
  ds_read_b64_tr_b16 v[204:205], v241 offset:28672
  ds_read_b64_tr_b16 v[206:207], v241 offset:28928
  s_waitcnt lgkmcnt(14)
  v_mfma_f32_16x16x32_bf16 v[64:67], a[144:147], v[208:211], v[64:67]
  v_cvt_pk_bf16_f32 v226, v44, v45
  v_mfma_f32_16x16x32_bf16 v[68:71], a[148:151], v[208:211], v[68:71]
  v_mfma_f32_16x16x32_bf16 v[72:75], a[152:155], v[208:211], v[72:75]
  v_mfma_f32_16x16x32_bf16 v[76:79], a[156:159], v[208:211], v[76:79]
  ds_read_b64_tr_b16 v[208:209], v240 offset:26624
  ds_read_b64_tr_b16 v[210:211], v240 offset:26880
  s_waitcnt lgkmcnt(14)
  v_mfma_f32_16x16x32_bf16 v[80:83], a[144:147], v[212:215], v[80:83]
  v_mfma_f32_16x16x32_bf16 v[84:87], a[148:151], v[212:215], v[84:87]
  v_mfma_f32_16x16x32_bf16 v[88:91], a[152:155], v[212:215], v[88:91]
  v_cvt_pk_bf16_f32 v227, v46, v47
  v_mfma_f32_16x16x32_bf16 v[92:95], a[156:159], v[212:215], v[92:95]
  ds_read_b64_tr_b16 v[212:213], v241 offset:26624
  ds_read_b64_tr_b16 v[214:215], v241 offset:26880
  s_waitcnt lgkmcnt(14)
  v_mfma_f32_16x16x32_bf16 v[96:99], a[144:147], v[216:219], v[96:99]
  v_mfma_f32_16x16x32_bf16 v[100:103], a[148:151], v[216:219], v[100:103]
  v_mfma_f32_16x16x32_bf16 v[104:107], a[152:155], v[216:219], v[104:107]
  v_mfma_f32_16x16x32_bf16 v[108:111], a[156:159], v[216:219], v[108:111]
  ds_read_b64_tr_b16 v[216:217], v240 offset:30720
  ds_read_b64_tr_b16 v[218:219], v240 offset:30976
  s_waitcnt lgkmcnt(14)
  v_mfma_f32_16x16x32_bf16 v[112:115], a[144:147], v[220:223], v[112:115]
  v_mfma_f32_16x16x32_bf16 v[116:119], a[148:151], v[220:223], v[116:119]
  buffer_store_dwordx4 v[224:227], v130, s[64:67], s85 offen offset:0 sc1
  v_mfma_f32_16x16x32_bf16 v[120:123], a[152:155], v[220:223], v[120:123]
  v_mfma_f32_16x16x32_bf16 v[124:127], a[156:159], v[220:223], v[124:127]
  ds_read_b64_tr_b16 v[220:221], v241 offset:30720
  ds_read_b64_tr_b16 v[222:223], v241 offset:30976
  s_waitcnt lgkmcnt(14)
  v_mfma_f32_16x16x32_bf16 v[64:67], a[160:163], v[192:195], v[64:67]
  v_mfma_f32_16x16x32_bf16 v[68:71], a[164:167], v[192:195], v[68:71]
  v_mfma_f32_16x16x32_bf16 v[72:75], a[168:171], v[192:195], v[72:75]
  v_mfma_f32_16x16x32_bf16 v[76:79], a[172:175], v[192:195], v[76:79]
  ds_read_b64_tr_b16 v[192:193], v240 offset:32768
  ds_read_b64_tr_b16 v[194:195], v240 offset:33024
  s_waitcnt lgkmcnt(14)
  v_mfma_f32_16x16x32_bf16 v[80:83], a[160:163], v[196:199], v[80:83]
  v_mfma_f32_16x16x32_bf16 v[84:87], a[164:167], v[196:199], v[84:87]
  v_mfma_f32_16x16x32_bf16 v[88:91], a[168:171], v[196:199], v[88:91]
  v_cvt_pk_bf16_f32 v228, v56, v57
  v_mfma_f32_16x16x32_bf16 v[92:95], a[172:175], v[196:199], v[92:95]
  ds_read_b64_tr_b16 v[196:197], v241 offset:32768
  ds_read_b64_tr_b16 v[198:199], v241 offset:33024
  s_waitcnt lgkmcnt(14)
  v_mfma_f32_16x16x32_bf16 v[96:99], a[160:163], v[200:203], v[96:99]
  v_mfma_f32_16x16x32_bf16 v[100:103], a[164:167], v[200:203], v[100:103]
  v_mfma_f32_16x16x32_bf16 v[104:107], a[168:171], v[200:203], v[104:107]
  v_mfma_f32_16x16x32_bf16 v[108:111], a[172:175], v[200:203], v[108:111]
  ds_read_b64_tr_b16 v[200:201], v240 offset:36864
  ds_read_b64_tr_b16 v[202:203], v240 offset:37120
  s_waitcnt lgkmcnt(14)
  v_mfma_f32_16x16x32_bf16 v[112:115], a[160:163], v[204:207], v[112:115]
  v_mfma_f32_16x16x32_bf16 v[116:119], a[164:167], v[204:207], v[116:119]
  v_mfma_f32_16x16x32_bf16 v[120:123], a[168:171], v[204:207], v[120:123]
  v_mfma_f32_16x16x32_bf16 v[124:127], a[172:175], v[204:207], v[124:127]
  ds_read_b64_tr_b16 v[204:205], v241 offset:36864
  ds_read_b64_tr_b16 v[206:207], v241 offset:37120
  s_waitcnt lgkmcnt(14)
  v_mfma_f32_16x16x32_bf16 v[64:67], a[176:179], v[208:211], v[64:67]
  v_cvt_pk_bf16_f32 v229, v58, v59
  v_mfma_f32_16x16x32_bf16 v[68:71], a[180:183], v[208:211], v[68:71]
  v_mfma_f32_16x16x32_bf16 v[72:75], a[184:187], v[208:211], v[72:75]
  v_mfma_f32_16x16x32_bf16 v[76:79], a[188:191], v[208:211], v[76:79]
  ds_read_b64_tr_b16 v[208:209], v240 offset:34816
  ds_read_b64_tr_b16 v[210:211], v240 offset:35072
  s_waitcnt lgkmcnt(14)
  v_mfma_f32_16x16x32_bf16 v[80:83], a[176:179], v[212:215], v[80:83]
  v_mfma_f32_16x16x32_bf16 v[84:87], a[180:183], v[212:215], v[84:87]
  v_mfma_f32_16x16x32_bf16 v[88:91], a[184:187], v[212:215], v[88:91]
  v_mfma_f32_16x16x32_bf16 v[92:95], a[188:191], v[212:215], v[92:95]
  ds_read_b64_tr_b16 v[212:213], v241 offset:34816
  ds_read_b64_tr_b16 v[214:215], v241 offset:35072
  s_waitcnt lgkmcnt(14)
  v_mfma_f32_16x16x32_bf16 v[96:99], a[176:179], v[216:219], v[96:99]
  v_mfma_f32_16x16x32_bf16 v[100:103], a[180:183], v[216:219], v[100:103]
  v_mfma_f32_16x16x32_bf16 v[104:107], a[184:187], v[216:219], v[104:107]
  v_cvt_pk_bf16_f32 v230, v60, v61
  v_mfma_f32_16x16x32_bf16 v[108:111], a[188:191], v[216:219], v[108:111]
  ds_read_b64_tr_b16 v[216:217], v240 offset:38912
  ds_read_b64_tr_b16 v[218:219], v240 offset:39168
  s_waitcnt lgkmcnt(14)
  v_mfma_f32_16x16x32_bf16 v[112:115], a[176:179], v[220:223], v[112:115]
  v_mfma_f32_16x16x32_bf16 v[116:119], a[180:183], v[220:223], v[116:119]
  v_mfma_f32_16x16x32_bf16 v[120:123], a[184:187], v[220:223], v[120:123]
  v_mfma_f32_16x16x32_bf16 v[124:127], a[188:191], v[220:223], v[124:127]
  ds_read_b64_tr_b16 v[220:221], v241 offset:38912
  ds_read_b64_tr_b16 v[222:223], v241 offset:39168
  s_waitcnt vmcnt(15)
  s_barrier
  s_waitcnt lgkmcnt(14)
  v_mfma_f32_16x16x32_bf16 v[64:67], a[192:195], v[192:195], v[64:67]
  v_mfma_f32_16x16x32_bf16 v[68:71], a[196:199], v[192:195], v[68:71]
  v_mfma_f32_16x16x32_bf16 v[72:75], a[200:203], v[192:195], v[72:75]
  s_lshr_b32 s6, s3, 1
  s_add_u32 s6, s6, s14
  v_mfma_f32_16x16x32_bf16 v[76:79], a[204:207], v[192:195], v[76:79]
  ds_read_b64_tr_b16 v[192:193], v240 offset:40960
  ds_read_b64_tr_b16 v[194:195], v240 offset:41216
  s_waitcnt lgkmcnt(14)
  v_mfma_f32_16x16x32_bf16 v[80:83], a[192:195], v[196:199], v[80:83]
  s_add_u32 s6, s6, 6
  s_and_b32 s6, s6, 7
  v_mfma_f32_16x16x32_bf16 v[84:87], a[196:199], v[196:199], v[84:87]
  s_lshl_b32 s6, s6, 19
  s_add_u32 m0, s9, 16384
  v_mfma_f32_16x16x32_bf16 v[88:91], a[200:203], v[196:199], v[88:91]
  s_add_u32 s6, s6, s12
  buffer_load_dwordx4 v244, s[56:59], s6 offen offset:0 lds
  v_mfma_f32_16x16x32_bf16 v[92:95], a[204:207], v[196:199], v[92:95]
  ds_read_b64_tr_b16 v[196:197], v241 offset:40960
  ds_read_b64_tr_b16 v[198:199], v241 offset:41216
  s_waitcnt lgkmcnt(14)
  v_mfma_f32_16x16x32_bf16 v[96:99], a[192:195], v[200:203], v[96:99]
  buffer_load_dwordx4 v245, s[56:59], s6 offen offset:1024 lds
  buffer_load_dwordx4 v246, s[56:59], s6 offen offset:2048 lds
  v_mfma_f32_16x16x32_bf16 v[100:103], a[196:199], v[200:203], v[100:103]
  buffer_load_dwordx4 v247, s[56:59], s6 offen offset:3072 lds
  v_cvt_pk_bf16_f32 v231, v62, v63
  v_mfma_f32_16x16x32_bf16 v[104:107], a[200:203], v[200:203], v[104:107]
  v_mfma_f32_16x16x32_bf16 v[108:111], a[204:207], v[200:203], v[108:111]
  ds_read_b64_tr_b16 v[200:201], v240 offset:45056
  ds_read_b64_tr_b16 v[202:203], v240 offset:45312
  s_waitcnt lgkmcnt(14)
  v_mfma_f32_16x16x32_bf16 v[112:115], a[192:195], v[204:207], v[112:115]
  v_mfma_f32_16x16x32_bf16 v[116:119], a[196:199], v[204:207], v[116:119]
  v_mfma_f32_16x16x32_bf16 v[120:123], a[200:203], v[204:207], v[120:123]
  v_mfma_f32_16x16x32_bf16 v[124:127], a[204:207], v[204:207], v[124:127]
  ds_read_b64_tr_b16 v[204:205], v241 offset:45056
  ds_read_b64_tr_b16 v[206:207], v241 offset:45312
  s_waitcnt lgkmcnt(14)
  v_mfma_f32_16x16x32_bf16 v[64:67], a[208:211], v[208:211], v[64:67]
  v_mfma_f32_16x16x32_bf16 v[68:71], a[212:215], v[208:211], v[68:71]
  v_mfma_f32_16x16x32_bf16 v[72:75], a[216:219], v[208:211], v[72:75]
  v_mfma_f32_16x16x32_bf16 v[76:79], a[220:223], v[208:211], v[76:79]
  ds_read_b64_tr_b16 v[208:209], v240 offset:43008
  ds_read_b64_tr_b16 v[210:211], v240 offset:43264
  s_waitcnt lgkmcnt(14)
  v_mfma_f32_16x16x32_bf16 v[80:83], a[208:211], v[212:215], v[80:83]
  v_mfma_f32_16x16x32_bf16 v[84:87], a[212:215], v[212:215], v[84:87]
  v_mfma_f32_16x16x32_bf16 v[88:91], a[216:219], v[212:215], v[88:91]
  v_mfma_f32_16x16x32_bf16 v[92:95], a[220:223], v[212:215], v[92:95]
  ds_read_b64_tr_b16 v[212:213], v241 offset:43008
  ds_read_b64_tr_b16 v[214:215], v241 offset:43264
  s_waitcnt lgkmcnt(14)
  v_mfma_f32_16x16x32_bf16 v[96:99], a[208:211], v[216:219], v[96:99]
  v_mfma_f32_16x16x32_bf16 v[100:103], a[212:215], v[216:219], v[100:103]
  buffer_store_dwordx4 v[228:231], v130, s[64:67], s85 offen offset:1024 sc1
  v_mfma_f32_16x16x32_bf16 v[104:107], a[216:219], v[216:219], v[104:107]
  v_mfma_f32_16x16x32_bf16 v[108:111], a[220:223], v[216:219], v[108:111]
  ds_read_b64_tr_b16 v[216:217], v240 offset:47104
  ds_read_b64_tr_b16 v[218:219], v240 offset:47360
  s_waitcnt lgkmcnt(14)
  v_mfma_f32_16x16x32_bf16 v[112:115], a[208:211], v[220:223], v[112:115]
  v_mfma_f32_16x16x32_bf16 v[116:119], a[212:215], v[220:223], v[116:119]
  v_mfma_f32_16x16x32_bf16 v[120:123], a[216:219], v[220:223], v[120:123]
  v_mfma_f32_16x16x32_bf16 v[124:127], a[220:223], v[220:223], v[124:127]
  ds_read_b64_tr_b16 v[220:221], v241 offset:47104
  ds_read_b64_tr_b16 v[222:223], v241 offset:47360
  s_waitcnt lgkmcnt(14)
  v_mfma_f32_16x16x32_bf16 v[64:67], a[224:227], v[192:195], v[64:67]
  v_mfma_f32_16x16x32_bf16 v[68:71], a[228:231], v[192:195], v[68:71]
  v_mfma_f32_16x16x32_bf16 v[72:75], a[232:235], v[192:195], v[72:75]
  v_mfma_f32_16x16x32_bf16 v[76:79], a[236:239], v[192:195], v[76:79]
  ds_read_b64_tr_b16 v[192:193], v240 offset:49152
  ds_read_b64_tr_b16 v[194:195], v240 offset:49408
  s_waitcnt lgkmcnt(14)
  v_mfma_f32_16x16x32_bf16 v[80:83], a[224:227], v[196:199], v[80:83]
  v_mfma_f32_16x16x32_bf16 v[84:87], a[228:231], v[196:199], v[84:87]
  v_mfma_f32_16x16x32_bf16 v[88:91], a[232:235], v[196:199], v[88:91]
  v_mfma_f32_16x16x32_bf16 v[92:95], a[236:239], v[196:199], v[92:95]
  ds_read_b64_tr_b16 v[196:197], v241 offset:49152
  ds_read_b64_tr_b16 v[198:199], v241 offset:49408
  s_waitcnt lgkmcnt(14)
  v_mfma_f32_16x16x32_bf16 v[96:99], a[224:227], v[200:203], v[96:99]
  v_mfma_f32_16x16x32_bf16 v[100:103], a[228:231], v[200:203], v[100:103]
  v_mfma_f32_16x16x32_bf16 v[104:107], a[232:235], v[200:203], v[104:107]
  v_mfma_f32_16x16x32_bf16 v[108:111], a[236:239], v[200:203], v[108:111]
  ds_read_b64_tr_b16 v[200:201], v240 offset:53248
  ds_read_b64_tr_b16 v[202:203], v240 offset:53504
  s_waitcnt lgkmcnt(14)
  v_mfma_f32_16x16x32_bf16 v[112:115], a[224:227], v[204:207], v[112:115]
  v_mfma_f32_16x16x32_bf16 v[116:119], a[228:231], v[204:207], v[116:119]
  v_mfma_f32_16x16x32_bf16 v[120:123], a[232:235], v[204:207], v[120:123]
  v_mfma_f32_16x16x32_bf16 v[124:127], a[236:239], v[204:207], v[124:127]
  ds_read_b64_tr_b16 v[204:205], v241 offset:53248
  ds_read_b64_tr_b16 v[206:207], v241 offset:53504
  s_waitcnt lgkmcnt(14)
  v_mfma_f32_16x16x32_bf16 v[64:67], a[240:243], v[208:211], v[64:67]
  v_mfma_f32_16x16x32_bf16 v[68:71], a[244:247], v[208:211], v[68:71]
  v_mfma_f32_16x16x32_bf16 v[72:75], a[248:251], v[208:211], v[72:75]
  v_mfma_f32_16x16x32_bf16 v[76:79], a[252:255], v[208:211], v[76:79]
  ds_read_b64_tr_b16 v[208:209], v240 offset:51200
  ds_read_b64_tr_b16 v[210:211], v240 offset:51456
  s_waitcnt lgkmcnt(14)
  v_mfma_f32_16x16x32_bf16 v[80:83], a[240:243], v[212:215], v[80:83]
  v_mfma_f32_16x16x32_bf16 v[84:87], a[244:247], v[212:215], v[84:87]
  v_mfma_f32_16x16x32_bf16 v[88:91], a[248:251], v[212:215], v[88:91]
  v_mfma_f32_16x16x32_bf16 v[92:95], a[252:255], v[212:215], v[92:95]
  ds_read_b64_tr_b16 v[212:213], v241 offset:51200
  ds_read_b64_tr_b16 v[214:215], v241 offset:51456
  s_waitcnt lgkmcnt(14)
  v_mfma_f32_16x16x32_bf16 v[96:99], a[240:243], v[216:219], v[96:99]
  v_mfma_f32_16x16x32_bf16 v[100:103], a[244:247], v[216:219], v[100:103]
  v_mfma_f32_16x16x32_bf16 v[104:107], a[248:251], v[216:219], v[104:107]
  v_mfma_f32_16x16x32_bf16 v[108:111], a[252:255], v[216:219], v[108:111]
  ds_read_b64_tr_b16 v[216:217], v240 offset:55296
  ds_read_b64_tr_b16 v[218:219], v240 offset:55552
  s_waitcnt lgkmcnt(14)
  v_mfma_f32_16x16x32_bf16 v[112:115], a[240:243], v[220:223], v[112:115]
  v_mfma_f32_16x16x32_bf16 v[116:119], a[244:247], v[220:223], v[116:119]
  v_mfma_f32_16x16x32_bf16 v[120:123], a[248:251], v[220:223], v[120:123]
  v_mfma_f32_16x16x32_bf16 v[124:127], a[252:255], v[220:223], v[124:127]
  ds_read_b64_tr_b16 v[220:221], v241 offset:55296
  ds_read_b64_tr_b16 v[222:223], v241 offset:55552
  s_waitcnt vmcnt(13)
  s_barrier
  s_waitcnt lgkmcnt(14)
  v_mfma_f32_16x16x32_bf16 v[0:3], a[0:3], v[192:195], 0
  v_mfma_f32_16x16x32_bf16 v[4:7], a[4:7], v[192:195], 0
  v_mfma_f32_16x16x32_bf16 v[8:11], a[8:11], v[192:195], 0
  s_lshr_b32 s6, s3, 1
  s_add_u32 s6, s6, s14
  v_mfma_f32_16x16x32_bf16 v[12:15], a[12:15], v[192:195], 0
  ds_read_b64_tr_b16 v[192:193], v240 offset:57344
  ds_read_b64_tr_b16 v[194:195], v240 offset:57600
  s_waitcnt lgkmcnt(14)
  v_mfma_f32_16x16x32_bf16 v[16:19], a[0:3], v[196:199], 0
  s_add_u32 s6, s6, 0
  s_and_b32 s6, s6, 7
  v_mfma_f32_16x16x32_bf16 v[20:23], a[4:7], v[196:199], 0
  s_lshl_b32 s6, s6, 19
  s_add_u32 m0, s9, 32768
  v_mfma_f32_16x16x32_bf16 v[24:27], a[8:11], v[196:199], 0
  s_add_u32 s6, s6, s13
  buffer_load_dwordx4 v244, s[56:59], s6 offen offset:0 lds
  v_mfma_f32_16x16x32_bf16 v[28:31], a[12:15], v[196:199], 0
  ds_read_b64_tr_b16 v[196:197], v241 offset:57344
  ds_read_b64_tr_b16 v[198:199], v241 offset:57600
  s_waitcnt lgkmcnt(14)
  v_mfma_f32_16x16x32_bf16 v[32:35], a[0:3], v[200:203], 0
  buffer_load_dwordx4 v245, s[56:59], s6 offen offset:1024 lds
  buffer_load_dwordx4 v246, s[56:59], s6 offen offset:2048 lds
  v_mfma_f32_16x16x32_bf16 v[36:39], a[4:7], v[200:203], 0
  buffer_load_dwordx4 v247, s[56:59], s6 offen offset:3072 lds
  v_cvt_pk_bf16_f32 v232, v64, v65
  v_mfma_f32_16x16x32_bf16 v[40:43], a[8:11], v[200:203], 0
  v_mfma_f32_16x16x32_bf16 v[44:47], a[12:15], v[200:203], 0
  ds_read_b64_tr_b16 v[200:201], v240 offset:61440
  ds_read_b64_tr_b16 v[202:203], v240 offset:61696
  s_waitcnt lgkmcnt(14)
  v_mfma_f32_16x16x32_bf16 v[48:51], a[0:3], v[204:207], 0
  v_cvt_pk_bf16_f32 v233, v66, v67
  v_mfma_f32_16x16x32_bf16 v[52:55], a[4:7], v[204:207], 0
  v_mfma_f32_16x16x32_bf16 v[56:59], a[8:11], v[204:207], 0
  v_cvt_pk_bf16_f32 v234, v68, v69
  v_mfma_f32_16x16x32_bf16 v[60:63], a[12:15], v[204:207], 0
  ds_read_b64_tr_b16 v[204:205], v241 offset:61440
  ds_read_b64_tr_b16 v[206:207], v241 offset:61696
  s_waitcnt lgkmcnt(14)
  v_mfma_f32_16x16x32_bf16 v[0:3], a[16:19], v[208:211], v[0:3]
  v_mfma_f32_16x16x32_bf16 v[4:7], a[20:23], v[208:211], v[4:7]
  v_mfma_f32_16x16x32_bf16 v[8:11], a[24:27], v[208:211], v[8:11]
  v_cvt_pk_bf16_f32 v235, v70, v71
  v_mfma_f32_16x16x32_bf16 v[12:15], a[28:31], v[208:211], v[12:15]
  ds_read_b64_tr_b16 v[208:209], v240 offset:59392
  ds_read_b64_tr_b16 v[210:211], v240 offset:59648
  s_waitcnt lgkmcnt(14)
  v_mfma_f32_16x16x32_bf16 v[16:19], a[16:19], v[212:215], v[16:19]
  v_mfma_f32_16x16x32_bf16 v[20:23], a[20:23], v[212:215], v[20:23]
  buffer_store_dwordx4 v[232:235], v128, s[64:67], s86 offen offset:0 sc1
  v_mfma_f32_16x16x32_bf16 v[24:27], a[24:27], v[212:215], v[24:27]
  v_mfma_f32_16x16x32_bf16 v[28:31], a[28:31], v[212:215], v[28:31]
  ds_read_b64_tr_b16 v[212:213], v241 offset:59392
  ds_read_b64_tr_b16 v[214:215], v241 offset:59648
  s_waitcnt lgkmcnt(14)
  v_mfma_f32_16x16x32_bf16 v[32:35], a[16:19], v[216:219], v[32:35]
  v_cvt_pk_bf16_f32 v224, v80, v81
  v_mfma_f32_16x16x32_bf16 v[36:39], a[20:23], v[216:219], v[36:39]
  v_mfma_f32_16x16x32_bf16 v[40:43], a[24:27], v[216:219], v[40:43]
  v_mfma_f32_16x16x32_bf16 v[44:47], a[28:31], v[216:219], v[44:47]
  ds_read_b64_tr_b16 v[216:217], v240 offset:63488
  ds_read_b64_tr_b16 v[218:219], v240 offset:63744
  s_waitcnt lgkmcnt(14)
  v_mfma_f32_16x16x32_bf16 v[48:51], a[16:19], v[220:223], v[48:51]
  v_cvt_pk_bf16_f32 v225, v82, v83
  v_mfma_f32_16x16x32_bf16 v[52:55], a[20:23], v[220:223], v[52:55]
  v_mfma_f32_16x16x32_bf16 v[56:59], a[24:27], v[220:223], v[56:59]
  v_cvt_pk_bf16_f32 v226, v84, v85
  v_mfma_f32_16x16x32_bf16 v[60:63], a[28:31], v[220:223], v[60:63]
  ds_read_b64_tr_b16 v[220:221], v241 offset:63488
  ds_read_b64_tr_b16 v[222:223], v241 offset:63744
  s_waitcnt lgkmcnt(14)
  v_mfma_f32_16x16x32_bf16 v[0:3], a[32:35], v[192:195], v[0:3]
  v_mfma_f32_16x16x32_bf16 v[4:7], a[36:39], v[192:195], v[4:7]
  v_mfma_f32_16x16x32_bf16 v[8:11], a[40:43], v[192:195], v[8:11]
  v_cvt_pk_bf16_f32 v227, v86, v87
  v_mfma_f32_16x16x32_bf16 v[12:15], a[44:47], v[192:195], v[12:15]
  ds_read_b64_tr_b16 v[192:193], v242 offset:0
  ds_read_b64_tr_b16 v[194:195], v242 offset:256
  s_waitcnt lgkmcnt(14)
  v_mfma_f32_16x16x32_bf16 v[16:19], a[32:35], v[196:199], v[16:19]
  v_mfma_f32_16x16x32_bf16 v[20:23], a[36:39], v[196:199], v[20:23]
  buffer_store_dwordx4 v[224:227], v128, s[64:67], s86 offen offset:1024 sc1
  v_mfma_f32_16x16x32_bf16 v[24:27], a[40:43], v[196:199], v[24:27]
  v_mfma_f32_16x16x32_bf16 v[28:31], a[44:47], v[196:199], v[28:31]
  ds_read_b64_tr_b16 v[196:197], v243 offset:0
  ds_read_b64_tr_b16 v[198:199], v243 offset:256
  s_waitcnt lgkmcnt(14)
  v_mfma_f32_16x16x32_bf16 v[32:35], a[32:35], v[200:203], v[32:35]
  v_mfma_f32_16x16x32_bf16 v[36:39], a[36:39], v[200:203], v[36:39]
  v_cvt_pk_bf16_f32 v228, v72, v73
  v_mfma_f32_16x16x32_bf16 v[40:43], a[40:43], v[200:203], v[40:43]
  v_mfma_f32_16x16x32_bf16 v[44:47], a[44:47], v[200:203], v[44:47]
  ds_read_b64_tr_b16 v[200:201], v242 offset:4096
  ds_read_b64_tr_b16 v[202:203], v242 offset:4352
  s_waitcnt lgkmcnt(14)
  v_mfma_f32_16x16x32_bf16 v[48:51], a[32:35], v[204:207], v[48:51]
  v_cvt_pk_bf16_f32 v229, v74, v75
  v_mfma_f32_16x16x32_bf16 v[52:55], a[36:39], v[204:207], v[52:55]
  v_mfma_f32_16x16x32_bf16 v[56:59], a[40:43], v[204:207], v[56:59]
  v_mfma_f32_16x16x32_bf16 v[60:63], a[44:47], v[204:207], v[60:63]
  ds_read_b64_tr_b16 v[204:205], v243 offset:4096
  ds_read_b64_tr_b16 v[206:207], v243 offset:4352
  s_waitcnt lgkmcnt(14)
  v_mfma_f32_16x16x32_bf16 v[0:3], a[48:51], v[208:211], v[0:3]
  v_cvt_pk_bf16_f32 v230, v76, v77
  v_mfma_f32_16x16x32_bf16 v[4:7], a[52:55], v[208:211], v[4:7]
  v_mfma_f32_16x16x32_bf16 v[8:11], a[56:59], v[208:211], v[8:11]
  v_mfma_f32_16x16x32_bf16 v[12:15], a[60:63], v[208:211], v[12:15]
  ds_read_b64_tr_b16 v[208:209], v242 offset:2048
  ds_read_b64_tr_b16 v[210:211], v242 offset:2304
  s_waitcnt lgkmcnt(14)
  v_mfma_f32_16x16x32_bf16 v[16:19], a[48:51], v[212:215], v[16:19]
  v_cvt_pk_bf16_f32 v231, v78, v79
  v_mfma_f32_16x16x32_bf16 v[20:23], a[52:55], v[212:215], v[20:23]
  v_mfma_f32_16x16x32_bf16 v[24:27], a[56:59], v[212:215], v[24:27]
  v_mfma_f32_16x16x32_bf16 v[28:31], a[60:63], v[212:215], v[28:31]
  ds_read_b64_tr_b16 v[212:213], v243 offset:2048
  ds_read_b64_tr_b16 v[214:215], v243 offset:2304
  s_waitcnt lgkmcnt(14)
  v_mfma_f32_16x16x32_bf16 v[32:35], a[48:51], v[216:219], v[32:35]
  buffer_store_dwordx4 v[228:231], v130, s[64:67], s86 offen offset:0 sc1
  v_mfma_f32_16x16x32_bf16 v[36:39], a[52:55], v[216:219], v[36:39]
  v_mfma_f32_16x16x32_bf16 v[40:43], a[56:59], v[216:219], v[40:43]
  v_mfma_f32_16x16x32_bf16 v[44:47], a[60:63], v[216:219], v[44:47]
  ds_read_b64_tr_b16 v[216:217], v242 offset:6144
  ds_read_b64_tr_b16 v[218:219], v242 offset:6400
  s_waitcnt lgkmcnt(14)
  v_mfma_f32_16x16x32_bf16 v[48:51], a[48:51], v[220:223], v[48:51]
  v_cvt_pk_bf16_f32 v232, v88, v89
  v_mfma_f32_16x16x32_bf16 v[52:55], a[52:55], v[220:223], v[52:55]
  v_mfma_f32_16x16x32_bf16 v[56:59], a[56:59], v[220:223], v[56:59]
  v_cvt_pk_bf16_f32 v233, v90, v91
  v_mfma_f32_16x16x32_bf16 v[60:63], a[60:63], v[220:223], v[60:63]
  ds_read_b64_tr_b16 v[220:221], v243 offset:6144
  ds_read_b64_tr_b16 v[222:223], v243 offset:6400
  s_waitcnt vmcnt(13)
  s_barrier
  s_waitcnt lgkmcnt(14)
  v_mfma_f32_16x16x32_bf16 v[0:3], a[64:67], v[192:195], v[0:3]
  v_mfma_f32_16x16x32_bf16 v[4:7], a[68:71], v[192:195], v[4:7]
  v_mfma_f32_16x16x32_bf16 v[8:11], a[72:75], v[192:195], v[8:11]
  s_lshr_b32 s6, s3, 1
  s_add_u32 s6, s6, s14
  v_mfma_f32_16x16x32_bf16 v[12:15], a[76:79], v[192:195], v[12:15]
  ds_read_b64_tr_b16 v[192:193], v242 offset:8192
  ds_read_b64_tr_b16 v[194:195], v242 offset:8448
  s_waitcnt lgkmcnt(14)
  v_mfma_f32_16x16x32_bf16 v[16:19], a[64:67], v[196:199], v[16:19]
  s_add_u32 s6, s6, 2
  s_and_b32 s6, s6, 7
  v_mfma_f32_16x16x32_bf16 v[20:23], a[68:71], v[196:199], v[20:23]
  s_lshl_b32 s6, s6, 19
  s_add_u32 m0, s9, 49152
  v_mfma_f32_16x16x32_bf16 v[24:27], a[72:75], v[196:199], v[24:27]
  s_add_u32 s6, s6, s13
  buffer_load_dwordx4 v244, s[56:59], s6 offen offset:0 lds
  v_mfma_f32_16x16x32_bf16 v[28:31], a[76:79], v[196:199], v[28:31]
  ds_read_b64_tr_b16 v[196:197], v243 offset:8192
  ds_read_b64_tr_b16 v[198:199], v243 offset:8448
  s_waitcnt lgkmcnt(14)
  v_mfma_f32_16x16x32_bf16 v[32:35], a[64:67], v[200:203], v[32:35]
  buffer_load_dwordx4 v245, s[56:59], s6 offen offset:1024 lds
  buffer_load_dwordx4 v246, s[56:59], s6 offen offset:2048 lds
  v_mfma_f32_16x16x32_bf16 v[36:39], a[68:71], v[200:203], v[36:39]
  buffer_load_dwordx4 v247, s[56:59], s6 offen offset:3072 lds
  v_cvt_pk_bf16_f32 v234, v92, v93
  v_mfma_f32_16x16x32_bf16 v[40:43], a[72:75], v[200:203], v[40:43]
  v_cvt_pk_bf16_f32 v235, v94, v95
  v_mfma_f32_16x16x32_bf16 v[44:47], a[76:79], v[200:203], v[44:47]
  ds_read_b64_tr_b16 v[200:201], v242 offset:12288
  ds_read_b64_tr_b16 v[202:203], v242 offset:12544
  s_waitcnt lgkmcnt(14)
  v_mfma_f32_16x16x32_bf16 v[48:51], a[64:67], v[204:207], v[48:51]
  buffer_store_dwordx4 v[232:235], v130, s[64:67], s86 offen offset:1024 sc1
  v_mfma_f32_16x16x32_bf16 v[52:55], a[68:71], v[204:207], v[52:55]
  v_mfma_f32_16x16x32_bf16 v[56:59], a[72:75], v[204:207], v[56:59]
  v_mfma_f32_16x16x32_bf16 v[60:63], a[76:79], v[204:207], v[60:63]
  ds_read_b64_tr_b16 v[204:205], v243 offset:12288
  ds_read_b64_tr_b16 v[206:207], v243 offset:12544
  s_waitcnt lgkmcnt(14)
  v_mfma_f32_16x16x32_bf16 v[0:3], a[80:83], v[208:211], v[0:3]
  v_mfma_f32_16x16x32_bf16 v[4:7], a[84:87], v[208:211], v[4:7]
  v_cvt_pk_bf16_f32 v224, v96, v97
  v_mfma_f32_16x16x32_bf16 v[8:11], a[88:91], v[208:211], v[8:11]
  v_mfma_f32_16x16x32_bf16 v[12:15], a[92:95], v[208:211], v[12:15]
  ds_read_b64_tr_b16 v[208:209], v242 offset:10240
  ds_read_b64_tr_b16 v[210:211], v242 offset:10496
  s_waitcnt lgkmcnt(14)
  v_mfma_f32_16x16x32_bf16 v[16:19], a[80:83], v[212:215], v[16:19]
  v_mfma_f32_16x16x32_bf16 v[20:23], a[84:87], v[212:215], v[20:23]
  v_cvt_pk_bf16_f32 v225, v98, v99
  v_mfma_f32_16x16x32_bf16 v[24:27], a[88:91], v[212:215], v[24:27]
  v_mfma_f32_16x16x32_bf16 v[28:31], a[92:95], v[212:215], v[28:31]
  ds_read_b64_tr_b16 v[212:213], v243 offset:10240
  ds_read_b64_tr_b16 v[214:215], v243 offset:10496
  s_waitcnt lgkmcnt(14)
  v_mfma_f32_16x16x32_bf16 v[32:35], a[80:83], v[216:219], v[32:35]
  v_mfma_f32_16x16x32_bf16 v[36:39], a[84:87], v[216:219], v[36:39]
  v_cvt_pk_bf16_f32 v226, v100, v101
  v_mfma_f32_16x16x32_bf16 v[40:43], a[88:91], v[216:219], v[40:43]
  v_mfma_f32_16x16x32_bf16 v[44:47], a[92:95], v[216:219], v[44:47]
  ds_read_b64_tr_b16 v[216:217], v242 offset:14336
  ds_read_b64_tr_b16 v[218:219], v242 offset:14592
  s_waitcnt lgkmcnt(14)
  v_mfma_f32_16x16x32_bf16 v[48:51], a[80:83], v[220:223], v[48:51]
  v_mfma_f32_16x16x32_bf16 v[52:55], a[84:87], v[220:223], v[52:55]
  v_mfma_f32_16x16x32_bf16 v[56:59], a[88:91], v[220:223], v[56:59]
  v_cvt_pk_bf16_f32 v227, v102, v103
  v_mfma_f32_16x16x32_bf16 v[60:63], a[92:95], v[220:223], v[60:63]
  ds_read_b64_tr_b16 v[220:221], v243 offset:14336
  ds_read_b64_tr_b16 v[222:223], v243 offset:14592
  s_waitcnt lgkmcnt(14)
  v_mfma_f32_16x16x32_bf16 v[0:3], a[96:99], v[192:195], v[0:3]
  v_mfma_f32_16x16x32_bf16 v[4:7], a[100:103], v[192:195], v[4:7]
  v_mfma_f32_16x16x32_bf16 v[8:11], a[104:107], v[192:195], v[8:11]
  v_mfma_f32_16x16x32_bf16 v[12:15], a[108:111], v[192:195], v[12:15]
  ds_read_b64_tr_b16 v[192:193], v240 offset:0
  ds_read_b64_tr_b16 v[194:195], v240 offset:256
  s_waitcnt lgkmcnt(14)
  v_mfma_f32_16x16x32_bf16 v[16:19], a[96:99], v[196:199], v[16:19]
  buffer_store_dwordx4 v[224:227], v128, s[64:67], s87 offen offset:0 sc1
  v_mfma_f32_16x16x32_bf16 v[20:23], a[100:103], v[196:199], v[20:23]
  v_mfma_f32_16x16x32_bf16 v[24:27], a[104:107], v[196:199], v[24:27]
  v_mfma_f32_16x16x32_bf16 v[28:31], a[108:111], v[196:199], v[28:31]
  ds_read_b64_tr_b16 v[196:197], v241 offset:0
  ds_read_b64_tr_b16 v[198:199], v241 offset:256
  s_waitcnt lgkmcnt(14)
  v_mfma_f32_16x16x32_bf16 v[32:35], a[96:99], v[200:203], v[32:35]
  v_cvt_pk_bf16_f32 v228, v112, v113
  v_mfma_f32_16x16x32_bf16 v[36:39], a[100:103], v[200:203], v[36:39]
  v_mfma_f32_16x16x32_bf16 v[40:43], a[104:107], v[200:203], v[40:43]
  v_mfma_f32_16x16x32_bf16 v[44:47], a[108:111], v[200:203], v[44:47]
  ds_read_b64_tr_b16 v[200:201], v240 offset:4096
  ds_read_b64_tr_b16 v[202:203], v240 offset:4352
  s_waitcnt lgkmcnt(14)
  v_mfma_f32_16x16x32_bf16 v[48:51], a[96:99], v[204:207], v[48:51]
  v_cvt_pk_bf16_f32 v229, v114, v115
  v_mfma_f32_16x16x32_bf16 v[52:55], a[100:103], v[204:207], v[52:55]
  v_mfma_f32_16x16x32_bf16 v[56:59], a[104:107], v[204:207], v[56:59]
  v_mfma_f32_16x16x32_bf16 v[60:63], a[108:111], v[204:207], v[60:63]
  ds_read_b64_tr_b16 v[204:205], v241 offset:4096
  ds_read_b64_tr_b16 v[206:207], v241 offset:4352
  s_waitcnt lgkmcnt(14)
  v_mfma_f32_16x16x32_bf16 v[0:3], a[112:115], v[208:211], v[0:3]
  v_mfma_f32_16x16x32_bf16 v[4:7], a[116:119], v[208:211], v[4:7]
  v_mfma_f32_16x16x32_bf16 v[8:11], a[120:123], v[208:211], v[8:11]
  v_cvt_pk_bf16_f32 v230, v116, v117
  v_mfma_f32_16x16x32_bf16 v[12:15], a[124:127], v[208:211], v[12:15]
  ds_read_b64_tr_b16 v[208:209], v240 offset:2048
  ds_read_b64_tr_b16 v[210:211], v240 offset:2304
  s_waitcnt lgkmcnt(14)
  v_mfma_f32_16x16x32_bf16 v[16:19], a[112:115], v[212:215], v[16:19]
  v_mfma_f32_16x16x32_bf16 v[20:23], a[116:119], v[212:215], v[20:23]
  v_mfma_f32_16x16x32_bf16 v[24:27], a[120:123], v[212:215], v[24:27]
  v_mfma_f32_16x16x32_bf16 v[28:31], a[124:127], v[212:215], v[28:31]
  ds_read_b64_tr_b16 v[212:213], v241 offset:2048
  ds_read_b64_tr_b16 v[214:215], v241 offset:2304
  s_waitcnt lgkmcnt(14)
  v_mfma_f32_16x16x32_bf16 v[32:35], a[112:115], v[216:219], v[32:35]
  v_cvt_pk_bf16_f32 v231, v118, v119
  v_mfma_f32_16x16x32_bf16 v[36:39], a[116:119], v[216:219], v[36:39]
  v_mfma_f32_16x16x32_bf16 v[40:43], a[120:123], v[216:219], v[40:43]
  v_mfma_f32_16x16x32_bf16 v[44:47], a[124:127], v[216:219], v[44:47]
  ds_read_b64_tr_b16 v[216:217], v240 offset:6144
  ds_read_b64_tr_b16 v[218:219], v240 offset:6400
  s_waitcnt lgkmcnt(14)
  v_mfma_f32_16x16x32_bf16 v[48:51], a[112:115], v[220:223], v[48:51]
  buffer_store_dwordx4 v[228:231], v128, s[64:67], s87 offen offset:1024 sc1
  v_mfma_f32_16x16x32_bf16 v[52:55], a[116:119], v[220:223], v[52:55]
  v_mfma_f32_16x16x32_bf16 v[56:59], a[120:123], v[220:223], v[56:59]
  v_mfma_f32_16x16x32_bf16 v[60:63], a[124:127], v[220:223], v[60:63]
  ds_read_b64_tr_b16 v[220:221], v241 offset:6144
  ds_read_b64_tr_b16 v[222:223], v241 offset:6400
  s_waitcnt vmcnt(15)
  s_barrier
  s_waitcnt lgkmcnt(14)
  v_mfma_f32_16x16x32_bf16 v[0:3], a[128:131], v[192:195], v[0:3]
  v_mfma_f32_16x16x32_bf16 v[4:7], a[132:135], v[192:195], v[4:7]
  v_mfma_f32_16x16x32_bf16 v[8:11], a[136:139], v[192:195], v[8:11]
  s_lshr_b32 s6, s3, 1
  s_add_u32 s6, s6, s14
  v_mfma_f32_16x16x32_bf16 v[12:15], a[140:143], v[192:195], v[12:15]
  ds_read_b64_tr_b16 v[192:193], v240 offset:8192
  ds_read_b64_tr_b16 v[194:195], v240 offset:8448
  s_waitcnt lgkmcnt(14)
  v_mfma_f32_16x16x32_bf16 v[16:19], a[128:131], v[196:199], v[16:19]
  s_add_u32 s6, s6, 4
  s_and_b32 s6, s6, 7
  v_mfma_f32_16x16x32_bf16 v[20:23], a[132:135], v[196:199], v[20:23]
  s_lshl_b32 s6, s6, 19
  s_add_u32 m0, s9, 65536
  v_mfma_f32_16x16x32_bf16 v[24:27], a[136:139], v[196:199], v[24:27]
  s_add_u32 s6, s6, s13
  buffer_load_dwordx4 v244, s[56:59], s6 offen offset:0 lds
  v_mfma_f32_16x16x32_bf16 v[28:31], a[140:143], v[196:199], v[28:31]
  ds_read_b64_tr_b16 v[196:197], v241 offset:8192
  ds_read_b64_tr_b16 v[198:199], v241 offset:8448
  s_waitcnt lgkmcnt(14)
  v_mfma_f32_16x16x32_bf16 v[32:35], a[128:131], v[200:203], v[32:35]
  buffer_load_dwordx4 v245, s[56:59], s6 offen offset:1024 lds
  buffer_load_dwordx4 v246, s[56:59], s6 offen offset:2048 lds
  v_mfma_f32_16x16x32_bf16 v[36:39], a[132:135], v[200:203], v[36:39]
  buffer_load_dwordx4 v247, s[56:59], s6 offen offset:3072 lds
  v_cvt_pk_bf16_f32 v232, v104, v105
  v_mfma_f32_16x16x32_bf16 v[40:43], a[136:139], v[200:203], v[40:43]
  v_cvt_pk_bf16_f32 v233, v106, v107
  v_mfma_f32_16x16x32_bf16 v[44:47], a[140:143], v[200:203], v[44:47]
  ds_read_b64_tr_b16 v[200:201], v240 offset:12288
  ds_read_b64_tr_b16 v[202:203], v240 offset:12544
  s_waitcnt lgkmcnt(14)
  v_mfma_f32_16x16x32_bf16 v[48:51], a[128:131], v[204:207], v[48:51]
  v_mfma_f32_16x16x32_bf16 v[52:55], a[132:135], v[204:207], v[52:55]
  v_mfma_f32_16x16x32_bf16 v[56:59], a[136:139], v[204:207], v[56:59]
  v_mfma_f32_16x16x32_bf16 v[60:63], a[140:143], v[204:207], v[60:63]
  ds_read_b64_tr_b16 v[204:205], v241 offset:12288
  ds_read_b64_tr_b16 v[206:207], v241 offset:12544
  s_waitcnt lgkmcnt(14)
  v_mfma_f32_16x16x32_bf16 v[0:3], a[144:147], v[208:211], v[0:3]
  v_cvt_pk_bf16_f32 v234, v108, v109
  v_mfma_f32_16x16x32_bf16 v[4:7], a[148:151], v[208:211], v[4:7]
  v_mfma_f32_16x16x32_bf16 v[8:11], a[152:155], v[208:211], v[8:11]
  v_mfma_f32_16x16x32_bf16 v[12:15], a[156:159], v[208:211], v[12:15]
  ds_read_b64_tr_b16 v[208:209], v240 offset:10240
  ds_read_b64_tr_b16 v[210:211], v240 offset:10496
  s_waitcnt lgkmcnt(14)
  v_mfma_f32_16x16x32_bf16 v[16:19], a[144:147], v[212:215], v[16:19]
  v_mfma_f32_16x16x32_bf16 v[20:23], a[148:151], v[212:215], v[20:23]
  v_mfma_f32_16x16x32_bf16 v[24:27], a[152:155], v[212:215], v[24:27]
  v_cvt_pk_bf16_f32 v235, v110, v111
  v_mfma_f32_16x16x32_bf16 v[28:31], a[156:159], v[212:215], v[28:31]
  ds_read_b64_tr_b16 v[212:213], v241 offset:10240
  ds_read_b64_tr_b16 v[214:215], v241 offset:10496
  s_waitcnt lgkmcnt(14)
  v_mfma_f32_16x16x32_bf16 v[32:35], a[144:147], v[216:219], v[32:35]
  v_mfma_f32_16x16x32_bf16 v[36:39], a[148:151], v[216:219], v[36:39]
  v_mfma_f32_16x16x32_bf16 v[40:43], a[152:155], v[216:219], v[40:43]
  v_mfma_f32_16x16x32_bf16 v[44:47], a[156:159], v[216:219], v[44:47]
  ds_read_b64_tr_b16 v[216:217], v240 offset:14336
  ds_read_b64_tr_b16 v[218:219], v240 offset:14592
  s_waitcnt lgkmcnt(14)
  v_mfma_f32_16x16x32_bf16 v[48:51], a[144:147], v[220:223], v[48:51]
  v_mfma_f32_16x16x32_bf16 v[52:55], a[148:151], v[220:223], v[52:55]
  buffer_store_dwordx4 v[232:235], v130, s[64:67], s87 offen offset:0 sc1
  v_mfma_f32_16x16x32_bf16 v[56:59], a[152:155], v[220:223], v[56:59]
  v_mfma_f32_16x16x32_bf16 v[60:63], a[156:159], v[220:223], v[60:63]
  ds_read_b64_tr_b16 v[220:221], v241 offset:14336
  ds_read_b64_tr_b16 v[222:223], v241 offset:14592
  s_waitcnt lgkmcnt(14)
  v_mfma_f32_16x16x32_bf16 v[0:3], a[160:163], v[192:195], v[0:3]
  v_mfma_f32_16x16x32_bf16 v[4:7], a[164:167], v[192:195], v[4:7]
  v_mfma_f32_16x16x32_bf16 v[8:11], a[168:171], v[192:195], v[8:11]
  v_mfma_f32_16x16x32_bf16 v[12:15], a[172:175], v[192:195], v[12:15]
  ds_read_b64_tr_b16 v[192:193], v240 offset:16384
  ds_read_b64_tr_b16 v[194:195], v240 offset:16640
  s_waitcnt lgkmcnt(14)
  v_mfma_f32_16x16x32_bf16 v[16:19], a[160:163], v[196:199], v[16:19]
  v_mfma_f32_16x16x32_bf16 v[20:23], a[164:167], v[196:199], v[20:23]
  v_mfma_f32_16x16x32_bf16 v[24:27], a[168:171], v[196:199], v[24:27]
  v_cvt_pk_bf16_f32 v224, v120, v121
  v_mfma_f32_16x16x32_bf16 v[28:31], a[172:175], v[196:199], v[28:31]
  ds_read_b64_tr_b16 v[196:197], v241 offset:16384
  ds_read_b64_tr_b16 v[198:199], v241 offset:16640
  s_waitcnt lgkmcnt(14)
  v_mfma_f32_16x16x32_bf16 v[32:35], a[160:163], v[200:203], v[32:35]
  v_mfma_f32_16x16x32_bf16 v[36:39], a[164:167], v[200:203], v[36:39]
  v_mfma_f32_16x16x32_bf16 v[40:43], a[168:171], v[200:203], v[40:43]
  v_mfma_f32_16x16x32_bf16 v[44:47], a[172:175], v[200:203], v[44:47]
  ds_read_b64_tr_b16 v[200:201], v240 offset:20480
  ds_read_b64_tr_b16 v[202:203], v240 offset:20736
  s_waitcnt lgkmcnt(14)
  v_mfma_f32_16x16x32_bf16 v[48:51], a[160:163], v[204:207], v[48:51]
  v_mfma_f32_16x16x32_bf16 v[52:55], a[164:167], v[204:207], v[52:55]
  v_mfma_f32_16x16x32_bf16 v[56:59], a[168:171], v[204:207], v[56:59]
  v_mfma_f32_16x16x32_bf16 v[60:63], a[172:175], v[204:207], v[60:63]
  ds_read_b64_tr_b16 v[204:205], v241 offset:20480
  ds_read_b64_tr_b16 v[206:207], v241 offset:20736
  s_waitcnt lgkmcnt(14)
  v_mfma_f32_16x16x32_bf16 v[0:3], a[176:179], v[208:211], v[0:3]
  v_cvt_pk_bf16_f32 v225, v122, v123
  v_mfma_f32_16x16x32_bf16 v[4:7], a[180:183], v[208:211], v[4:7]
  v_mfma_f32_16x16x32_bf16 v[8:11], a[184:187], v[208:211], v[8:11]
  v_mfma_f32_16x16x32_bf16 v[12:15], a[188:191], v[208:211], v[12:15]
  ds_read_b64_tr_b16 v[208:209], v240 offset:18432
  ds_read_b64_tr_b16 v[210:211], v240 offset:18688
  s_waitcnt lgkmcnt(14)
  v_mfma_f32_16x16x32_bf16 v[16:19], a[176:179], v[212:215], v[16:19]
  v_mfma_f32_16x16x32_bf16 v[20:23], a[180:183], v[212:215], v[20:23]
  v_mfma_f32_16x16x32_bf16 v[24:27], a[184:187], v[212:215], v[24:27]
  v_mfma_f32_16x16x32_bf16 v[28:31], a[188:191], v[212:215], v[28:31]
  ds_read_b64_tr_b16 v[212:213], v241 offset:18432
  ds_read_b64_tr_b16 v[214:215], v241 offset:18688
  s_waitcnt lgkmcnt(14)
  v_mfma_f32_16x16x32_bf16 v[32:35], a[176:179], v[216:219], v[32:35]
  v_mfma_f32_16x16x32_bf16 v[36:39], a[180:183], v[216:219], v[36:39]
  v_mfma_f32_16x16x32_bf16 v[40:43], a[184:187], v[216:219], v[40:43]
  v_cvt_pk_bf16_f32 v226, v124, v125
  v_mfma_f32_16x16x32_bf16 v[44:47], a[188:191], v[216:219], v[44:47]
  ds_read_b64_tr_b16 v[216:217], v240 offset:22528
  ds_read_b64_tr_b16 v[218:219], v240 offset:22784
  s_waitcnt lgkmcnt(14)
  v_mfma_f32_16x16x32_bf16 v[48:51], a[176:179], v[220:223], v[48:51]
  v_mfma_f32_16x16x32_bf16 v[52:55], a[180:183], v[220:223], v[52:55]
  v_mfma_f32_16x16x32_bf16 v[56:59], a[184:187], v[220:223], v[56:59]
  v_mfma_f32_16x16x32_bf16 v[60:63], a[188:191], v[220:223], v[60:63]
  ds_read_b64_tr_b16 v[220:221], v241 offset:22528
  ds_read_b64_tr_b16 v[222:223], v241 offset:22784
  s_waitcnt vmcnt(15)
  s_barrier
  s_waitcnt lgkmcnt(14)
  v_mfma_f32_16x16x32_bf16 v[0:3], a[192:195], v[192:195], v[0:3]
  v_mfma_f32_16x16x32_bf16 v[4:7], a[196:199], v[192:195], v[4:7]
  v_mfma_f32_16x16x32_bf16 v[8:11], a[200:203], v[192:195], v[8:11]
  s_lshr_b32 s6, s3, 1
  s_add_u32 s6, s6, s14
  v_mfma_f32_16x16x32_bf16 v[12:15], a[204:207], v[192:195], v[12:15]
  ds_read_b64_tr_b16 v[192:193], v240 offset:24576
  ds_read_b64_tr_b16 v[194:195], v240 offset:24832
  s_waitcnt lgkmcnt(14)
  v_mfma_f32_16x16x32_bf16 v[16:19], a[192:195], v[196:199], v[16:19]
  s_add_u32 s6, s6, 6
  s_and_b32 s6, s6, 7
  v_mfma_f32_16x16x32_bf16 v[20:23], a[196:199], v[196:199], v[20:23]
  s_lshl_b32 s6, s6, 19
  s_add_u32 m0, s9, 0
  v_mfma_f32_16x16x32_bf16 v[24:27], a[200:203], v[196:199], v[24:27]
  s_add_u32 s6, s6, s13
  buffer_load_dwordx4 v244, s[56:59], s6 offen offset:0 lds
  v_mfma_f32_16x16x32_bf16 v[28:31], a[204:207], v[196:199], v[28:31]
  ds_read_b64_tr_b16 v[196:197], v241 offset:24576
  ds_read_b64_tr_b16 v[198:199], v241 offset:24832
  s_waitcnt lgkmcnt(14)
  v_mfma_f32_16x16x32_bf16 v[32:35], a[192:195], v[200:203], v[32:35]
  buffer_load_dwordx4 v245, s[56:59], s6 offen offset:1024 lds
  buffer_load_dwordx4 v246, s[56:59], s6 offen offset:2048 lds
  v_mfma_f32_16x16x32_bf16 v[36:39], a[196:199], v[200:203], v[36:39]
  buffer_load_dwordx4 v247, s[56:59], s6 offen offset:3072 lds
  v_cvt_pk_bf16_f32 v227, v126, v127
  v_mfma_f32_16x16x32_bf16 v[40:43], a[200:203], v[200:203], v[40:43]
  v_mfma_f32_16x16x32_bf16 v[44:47], a[204:207], v[200:203], v[44:47]
  ds_read_b64_tr_b16 v[200:201], v240 offset:28672
  ds_read_b64_tr_b16 v[202:203], v240 offset:28928
  s_waitcnt lgkmcnt(14)
  v_mfma_f32_16x16x32_bf16 v[48:51], a[192:195], v[204:207], v[48:51]
  v_mfma_f32_16x16x32_bf16 v[52:55], a[196:199], v[204:207], v[52:55]
  v_mfma_f32_16x16x32_bf16 v[56:59], a[200:203], v[204:207], v[56:59]
  v_mfma_f32_16x16x32_bf16 v[60:63], a[204:207], v[204:207], v[60:63]
  ds_read_b64_tr_b16 v[204:205], v241 offset:28672
  ds_read_b64_tr_b16 v[206:207], v241 offset:28928
  s_waitcnt lgkmcnt(14)
  v_mfma_f32_16x16x32_bf16 v[0:3], a[208:211], v[208:211], v[0:3]
  v_mfma_f32_16x16x32_bf16 v[4:7], a[212:215], v[208:211], v[4:7]
  v_mfma_f32_16x16x32_bf16 v[8:11], a[216:219], v[208:211], v[8:11]
  v_mfma_f32_16x16x32_bf16 v[12:15], a[220:223], v[208:211], v[12:15]
  ds_read_b64_tr_b16 v[208:209], v240 offset:26624
  ds_read_b64_tr_b16 v[210:211], v240 offset:26880
  s_waitcnt lgkmcnt(14)
  v_mfma_f32_16x16x32_bf16 v[16:19], a[208:211], v[212:215], v[16:19]
  v_mfma_f32_16x16x32_bf16 v[20:23], a[212:215], v[212:215], v[20:23]
  v_mfma_f32_16x16x32_bf16 v[24:27], a[216:219], v[212:215], v[24:27]
  v_mfma_f32_16x16x32_bf16 v[28:31], a[220:223], v[212:215], v[28:31]
  ds_read_b64_tr_b16 v[212:213], v241 offset:26624
  ds_read_b64_tr_b16 v[214:215], v241 offset:26880
  s_waitcnt lgkmcnt(14)
  v_mfma_f32_16x16x32_bf16 v[32:35], a[208:211], v[216:219], v[32:35]
  v_mfma_f32_16x16x32_bf16 v[36:39], a[212:215], v[216:219], v[36:39]
  buffer_store_dwordx4 v[224:227], v130, s[64:67], s87 offen offset:1024 sc1
  v_mfma_f32_16x16x32_bf16 v[40:43], a[216:219], v[216:219], v[40:43]
  v_mfma_f32_16x16x32_bf16 v[44:47], a[220:223], v[216:219], v[44:47]
  ds_read_b64_tr_b16 v[216:217], v240 offset:30720
  ds_read_b64_tr_b16 v[218:219], v240 offset:30976
  s_waitcnt lgkmcnt(14)
  v_mfma_f32_16x16x32_bf16 v[48:51], a[208:211], v[220:223], v[48:51]
  v_mfma_f32_16x16x32_bf16 v[52:55], a[212:215], v[220:223], v[52:55]
  v_mfma_f32_16x16x32_bf16 v[56:59], a[216:219], v[220:223], v[56:59]
  v_mfma_f32_16x16x32_bf16 v[60:63], a[220:223], v[220:223], v[60:63]
  ds_read_b64_tr_b16 v[220:221], v241 offset:30720
  ds_read_b64_tr_b16 v[222:223], v241 offset:30976
  s_waitcnt lgkmcnt(14)
  v_mfma_f32_16x16x32_bf16 v[0:3], a[224:227], v[192:195], v[0:3]
  v_mfma_f32_16x16x32_bf16 v[4:7], a[228:231], v[192:195], v[4:7]
  v_mfma_f32_16x16x32_bf16 v[8:11], a[232:235], v[192:195], v[8:11]
  v_mfma_f32_16x16x32_bf16 v[12:15], a[236:239], v[192:195], v[12:15]
  ds_read_b64_tr_b16 v[192:193], v240 offset:32768
  ds_read_b64_tr_b16 v[194:195], v240 offset:33024
  s_waitcnt lgkmcnt(14)
  v_mfma_f32_16x16x32_bf16 v[16:19], a[224:227], v[196:199], v[16:19]
  v_mfma_f32_16x16x32_bf16 v[20:23], a[228:231], v[196:199], v[20:23]
  v_mfma_f32_16x16x32_bf16 v[24:27], a[232:235], v[196:199], v[24:27]
  v_mfma_f32_16x16x32_bf16 v[28:31], a[236:239], v[196:199], v[28:31]
  ds_read_b64_tr_b16 v[196:197], v241 offset:32768
  ds_read_b64_tr_b16 v[198:199], v241 offset:33024
  s_waitcnt lgkmcnt(14)
  v_mfma_f32_16x16x32_bf16 v[32:35], a[224:227], v[200:203], v[32:35]
  v_mfma_f32_16x16x32_bf16 v[36:39], a[228:231], v[200:203], v[36:39]
  v_mfma_f32_16x16x32_bf16 v[40:43], a[232:235], v[200:203], v[40:43]
  v_mfma_f32_16x16x32_bf16 v[44:47], a[236:239], v[200:203], v[44:47]
  ds_read_b64_tr_b16 v[200:201], v240 offset:36864
  ds_read_b64_tr_b16 v[202:203], v240 offset:37120
  s_waitcnt lgkmcnt(14)
  v_mfma_f32_16x16x32_bf16 v[48:51], a[224:227], v[204:207], v[48:51]
  v_mfma_f32_16x16x32_bf16 v[52:55], a[228:231], v[204:207], v[52:55]
  v_mfma_f32_16x16x32_bf16 v[56:59], a[232:235], v[204:207], v[56:59]
  v_mfma_f32_16x16x32_bf16 v[60:63], a[236:239], v[204:207], v[60:63]
  ds_read_b64_tr_b16 v[204:205], v241 offset:36864
  ds_read_b64_tr_b16 v[206:207], v241 offset:37120
  s_waitcnt lgkmcnt(14)
  v_mfma_f32_16x16x32_bf16 v[0:3], a[240:243], v[208:211], v[0:3]
  v_mfma_f32_16x16x32_bf16 v[4:7], a[244:247], v[208:211], v[4:7]
  v_mfma_f32_16x16x32_bf16 v[8:11], a[248:251], v[208:211], v[8:11]
  v_mfma_f32_16x16x32_bf16 v[12:15], a[252:255], v[208:211], v[12:15]
  ds_read_b64_tr_b16 v[208:209], v240 offset:34816
  ds_read_b64_tr_b16 v[210:211], v240 offset:35072
  s_waitcnt lgkmcnt(14)
  v_mfma_f32_16x16x32_bf16 v[16:19], a[240:243], v[212:215], v[16:19]
  v_mfma_f32_16x16x32_bf16 v[20:23], a[244:247], v[212:215], v[20:23]
  v_mfma_f32_16x16x32_bf16 v[24:27], a[248:251], v[212:215], v[24:27]
  v_mfma_f32_16x16x32_bf16 v[28:31], a[252:255], v[212:215], v[28:31]
  ds_read_b64_tr_b16 v[212:213], v241 offset:34816
  ds_read_b64_tr_b16 v[214:215], v241 offset:35072
  s_waitcnt lgkmcnt(14)
  v_mfma_f32_16x16x32_bf16 v[32:35], a[240:243], v[216:219], v[32:35]
  v_mfma_f32_16x16x32_bf16 v[36:39], a[244:247], v[216:219], v[36:39]
  v_mfma_f32_16x16x32_bf16 v[40:43], a[248:251], v[216:219], v[40:43]
  v_mfma_f32_16x16x32_bf16 v[44:47], a[252:255], v[216:219], v[44:47]
  ds_read_b64_tr_b16 v[216:217], v240 offset:38912
  ds_read_b64_tr_b16 v[218:219], v240 offset:39168
  s_waitcnt lgkmcnt(14)
  v_mfma_f32_16x16x32_bf16 v[48:51], a[240:243], v[220:223], v[48:51]
  v_mfma_f32_16x16x32_bf16 v[52:55], a[244:247], v[220:223], v[52:55]
  v_mfma_f32_16x16x32_bf16 v[56:59], a[248:251], v[220:223], v[56:59]
  v_mfma_f32_16x16x32_bf16 v[60:63], a[252:255], v[220:223], v[60:63]
  ds_read_b64_tr_b16 v[220:221], v241 offset:38912
  ds_read_b64_tr_b16 v[222:223], v241 offset:39168
  s_waitcnt vmcnt(13)
  s_barrier
  s_waitcnt lgkmcnt(14)
  v_mfma_f32_16x16x32_bf16 v[64:67], a[0:3], v[192:195], 0
  v_mfma_f32_16x16x32_bf16 v[68:71], a[4:7], v[192:195], 0
  v_mfma_f32_16x16x32_bf16 v[72:75], a[8:11], v[192:195], 0
  s_lshr_b32 s6, s3, 1
  s_add_u32 s6, s6, s14
  v_mfma_f32_16x16x32_bf16 v[76:79], a[12:15], v[192:195], 0
  ds_read_b64_tr_b16 v[192:193], v240 offset:40960
  ds_read_b64_tr_b16 v[194:195], v240 offset:41216
  s_waitcnt lgkmcnt(14)
  v_mfma_f32_16x16x32_bf16 v[80:83], a[0:3], v[196:199], 0
  s_add_u32 s6, s6, 0
  s_and_b32 s6, s6, 7
  v_mfma_f32_16x16x32_bf16 v[84:87], a[4:7], v[196:199], 0
  s_lshl_b32 s6, s6, 19
  s_add_u32 m0, s9, 16384
  v_mfma_f32_16x16x32_bf16 v[88:91], a[8:11], v[196:199], 0
  s_add_u32 s6, s6, s97
  buffer_load_dwordx4 v244, s[56:59], s6 offen offset:0 lds
  v_mfma_f32_16x16x32_bf16 v[92:95], a[12:15], v[196:199], 0
  ds_read_b64_tr_b16 v[196:197], v241 offset:40960
  ds_read_b64_tr_b16 v[198:199], v241 offset:41216
  s_waitcnt lgkmcnt(14)
  v_mfma_f32_16x16x32_bf16 v[96:99], a[0:3], v[200:203], 0
  buffer_load_dwordx4 v245, s[56:59], s6 offen offset:1024 lds
  buffer_load_dwordx4 v246, s[56:59], s6 offen offset:2048 lds
  v_mfma_f32_16x16x32_bf16 v[100:103], a[4:7], v[200:203], 0
  buffer_load_dwordx4 v247, s[56:59], s6 offen offset:3072 lds
  v_cvt_pk_bf16_f32 v228, v0, v1
  v_mfma_f32_16x16x32_bf16 v[104:107], a[8:11], v[200:203], 0
  v_mfma_f32_16x16x32_bf16 v[108:111], a[12:15], v[200:203], 0
  ds_read_b64_tr_b16 v[200:201], v240 offset:45056
  ds_read_b64_tr_b16 v[202:203], v240 offset:45312
  s_waitcnt lgkmcnt(14)
  v_mfma_f32_16x16x32_bf16 v[112:115], a[0:3], v[204:207], 0
  v_cvt_pk_bf16_f32 v229, v2, v3
  v_mfma_f32_16x16x32_bf16 v[116:119], a[4:7], v[204:207], 0
  v_mfma_f32_16x16x32_bf16 v[120:123], a[8:11], v[204:207], 0
  v_cvt_pk_bf16_f32 v230, v4, v5
  v_mfma_f32_16x16x32_bf16 v[124:127], a[12:15], v[204:207], 0
  ds_read_b64_tr_b16 v[204:205], v241 offset:45056
  ds_read_b64_tr_b16 v[206:207], v241 offset:45312
  s_waitcnt lgkmcnt(14)
  v_mfma_f32_16x16x32_bf16 v[64:67], a[16:19], v[208:211], v[64:67]
  v_mfma_f32_16x16x32_bf16 v[68:71], a[20:23], v[208:211], v[68:71]
  v_mfma_f32_16x16x32_bf16 v[72:75], a[24:27], v[208:211], v[72:75]
  v_cvt_pk_bf16_f32 v231, v6, v7
  v_mfma_f32_16x16x32_bf16 v[76:79], a[28:31], v[208:211], v[76:79]
  ds_read_b64_tr_b16 v[208:209], v240 offset:43008
  ds_read_b64_tr_b16 v[210:211], v240 offset:43264
  s_waitcnt lgkmcnt(14)
  v_mfma_f32_16x16x32_bf16 v[80:83], a[16:19], v[212:215], v[80:83]
  v_mfma_f32_16x16x32_bf16 v[84:87], a[20:23], v[212:215], v[84:87]
  buffer_store_dwordx4 v[228:231], v128, s[64:67], s88 offen offset:0 sc1
  v_mfma_f32_16x16x32_bf16 v[88:91], a[24:27], v[212:215], v[88:91]
  v_mfma_f32_16x16x32_bf16 v[92:95], a[28:31], v[212:215], v[92:95]
  ds_read_b64_tr_b16 v[212:213], v241 offset:43008
  ds_read_b64_tr_b16 v[214:215], v241 offset:43264
  s_waitcnt lgkmcnt(14)
  v_mfma_f32_16x16x32_bf16 v[96:99], a[16:19], v[216:219], v[96:99]
  v_cvt_pk_bf16_f32 v232, v16, v17
  v_mfma_f32_16x16x32_bf16 v[100:103], a[20:23], v[216:219], v[100:103]
  v_mfma_f32_16x16x32_bf16 v[104:107], a[24:27], v[216:219], v[104:107]
  v_mfma_f32_16x16x32_bf16 v[108:111], a[28:31], v[216:219], v[108:111]
  ds_read_b64_tr_b16 v[216:217], v240 offset:47104
  ds_read_b64_tr_b16 v[218:219], v240 offset:47360
  s_waitcnt lgkmcnt(14)
  v_mfma_f32_16x16x32_bf16 v[112:115], a[16:19], v[220:223], v[112:115]
  v_cvt_pk_bf16_f32 v233, v18, v19
  v_mfma_f32_16x16x32_bf16 v[116:119], a[20:23], v[220:223], v[116:119]
  v_mfma_f32_16x16x32_bf16 v[120:123], a[24:27], v[220:223], v[120:123]
  v_cvt_pk_bf16_f32 v234, v20, v21
  v_mfma_f32_16x16x32_bf16 v[124:127], a[28:31], v[220:223], v[124:127]
  ds_read_b64_tr_b16 v[220:221], v241 offset:47104
  ds_read_b64_tr_b16 v[222:223], v241 offset:47360
  s_waitcnt lgkmcnt(14)
  v_mfma_f32_16x16x32_bf16 v[64:67], a[32:35], v[192:195], v[64:67]
  v_mfma_f32_16x16x32_bf16 v[68:71], a[36:39], v[192:195], v[68:71]
  v_mfma_f32_16x16x32_bf16 v[72:75], a[40:43], v[192:195], v[72:75]
  v_cvt_pk_bf16_f32 v235, v22, v23
  v_mfma_f32_16x16x32_bf16 v[76:79], a[44:47], v[192:195], v[76:79]
  ds_read_b64_tr_b16 v[192:193], v240 offset:49152
  ds_read_b64_tr_b16 v[194:195], v240 offset:49408
  s_waitcnt lgkmcnt(14)
  v_mfma_f32_16x16x32_bf16 v[80:83], a[32:35], v[196:199], v[80:83]
  v_mfma_f32_16x16x32_bf16 v[84:87], a[36:39], v[196:199], v[84:87]
  buffer_store_dwordx4 v[232:235], v128, s[64:67], s88 offen offset:1024 sc1
  v_mfma_f32_16x16x32_bf16 v[88:91], a[40:43], v[196:199], v[88:91]
  v_mfma_f32_16x16x32_bf16 v[92:95], a[44:47], v[196:199], v[92:95]
  ds_read_b64_tr_b16 v[196:197], v241 offset:49152
  ds_read_b64_tr_b16 v[198:199], v241 offset:49408
  s_waitcnt lgkmcnt(14)
  v_mfma_f32_16x16x32_bf16 v[96:99], a[32:35], v[200:203], v[96:99]
  v_mfma_f32_16x16x32_bf16 v[100:103], a[36:39], v[200:203], v[100:103]
  v_cvt_pk_bf16_f32 v224, v8, v9
  v_mfma_f32_16x16x32_bf16 v[104:107], a[40:43], v[200:203], v[104:107]
  v_mfma_f32_16x16x32_bf16 v[108:111], a[44:47], v[200:203], v[108:111]
  ds_read_b64_tr_b16 v[200:201], v240 offset:53248
  ds_read_b64_tr_b16 v[202:203], v240 offset:53504
  s_waitcnt lgkmcnt(14)
  v_mfma_f32_16x16x32_bf16 v[112:115], a[32:35], v[204:207], v[112:115]
  v_cvt_pk_bf16_f32 v225, v10, v11
  v_mfma_f32_16x16x32_bf16 v[116:119], a[36:39], v[204:207], v[116:119]
  v_mfma_f32_16x16x32_bf16 v[120:123], a[40:43], v[204:207], v[120:123]
  v_mfma_f32_16x16x32_bf16 v[124:127], a[44:47], v[204:207], v[124:127]
  ds_read_b64_tr_b16 v[204:205], v241 offset:53248
  ds_read_b64_tr_b16 v[206:207], v241 offset:53504
  s_waitcnt lgkmcnt(14)
  v_mfma_f32_16x16x32_bf16 v[64:67], a[48:51], v[208:211], v[64:67]
  v_cvt_pk_bf16_f32 v226, v12, v13
  v_mfma_f32_16x16x32_bf16 v[68:71], a[52:55], v[208:211], v[68:71]
  v_mfma_f32_16x16x32_bf16 v[72:75], a[56:59], v[208:211], v[72:75]
  v_mfma_f32_16x16x32_bf16 v[76:79], a[60:63], v[208:211], v[76:79]
  ds_read_b64_tr_b16 v[208:209], v240 offset:51200
  ds_read_b64_tr_b16 v[210:211], v240 offset:51456
  s_waitcnt lgkmcnt(14)
  v_mfma_f32_16x16x32_bf16 v[80:83], a[48:51], v[212:215], v[80:83]
  v_cvt_pk_bf16_f32 v227, v14, v15
  v_mfma_f32_16x16x32_bf16 v[84:87], a[52:55], v[212:215], v[84:87]
  v_mfma_f32_16x16x32_bf16 v[88:91], a[56:59], v[212:215], v[88:91]
  v_mfma_f32_16x16x32_bf16 v[92:95], a[60:63], v[212:215], v[92:95]
  ds_read_b64_tr_b16 v[212:213], v241 offset:51200
  ds_read_b64_tr_b16 v[214:215], v241 offset:51456
  s_waitcnt lgkmcnt(14)
  v_mfma_f32_16x16x32_bf16 v[96:99], a[48:51], v[216:219], v[96:99]
  buffer_store_dwordx4 v[224:227], v130, s[64:67], s88 offen offset:0 sc1
  v_mfma_f32_16x16x32_bf16 v[100:103], a[52:55], v[216:219], v[100:103]
  v_mfma_f32_16x16x32_bf16 v[104:107], a[56:59], v[216:219], v[104:107]
  v_mfma_f32_16x16x32_bf16 v[108:111], a[60:63], v[216:219], v[108:111]
  ds_read_b64_tr_b16 v[216:217], v240 offset:55296
  ds_read_b64_tr_b16 v[218:219], v240 offset:55552
  s_waitcnt lgkmcnt(14)
  v_mfma_f32_16x16x32_bf16 v[112:115], a[48:51], v[220:223], v[112:115]
  v_cvt_pk_bf16_f32 v228, v24, v25
  v_mfma_f32_16x16x32_bf16 v[116:119], a[52:55], v[220:223], v[116:119]
  v_mfma_f32_16x16x32_bf16 v[120:123], a[56:59], v[220:223], v[120:123]
  v_cvt_pk_bf16_f32 v229, v26, v27
  v_mfma_f32_16x16x32_bf16 v[124:127], a[60:63], v[220:223], v[124:127]
  ds_read_b64_tr_b16 v[220:221], v241 offset:55296
  ds_read_b64_tr_b16 v[222:223], v241 offset:55552
  s_waitcnt vmcnt(13)
  s_barrier
  s_waitcnt lgkmcnt(14)
  v_mfma_f32_16x16x32_bf16 v[64:67], a[64:67], v[192:195], v[64:67]
  v_mfma_f32_16x16x32_bf16 v[68:71], a[68:71], v[192:195], v[68:71]
  v_mfma_f32_16x16x32_bf16 v[72:75], a[72:75], v[192:195], v[72:75]
  s_lshr_b32 s6, s3, 1
  s_add_u32 s6, s6, s14
  v_mfma_f32_16x16x32_bf16 v[76:79], a[76:79], v[192:195], v[76:79]
  ds_read_b64_tr_b16 v[192:193], v240 offset:57344
  ds_read_b64_tr_b16 v[194:195], v240 offset:57600
  s_waitcnt lgkmcnt(14)
  v_mfma_f32_16x16x32_bf16 v[80:83], a[64:67], v[196:199], v[80:83]
  s_add_u32 s6, s6, 2
  s_and_b32 s6, s6, 7
  v_mfma_f32_16x16x32_bf16 v[84:87], a[68:71], v[196:199], v[84:87]
  s_lshl_b32 s6, s6, 19
  s_add_u32 m0, s9, 32768
  v_mfma_f32_16x16x32_bf16 v[88:91], a[72:75], v[196:199], v[88:91]
  s_add_u32 s6, s6, s97
  buffer_load_dwordx4 v244, s[56:59], s6 offen offset:0 lds
  v_mfma_f32_16x16x32_bf16 v[92:95], a[76:79], v[196:199], v[92:95]
  ds_read_b64_tr_b16 v[196:197], v241 offset:57344
  ds_read_b64_tr_b16 v[198:199], v241 offset:57600
  s_waitcnt lgkmcnt(14)
  v_mfma_f32_16x16x32_bf16 v[96:99], a[64:67], v[200:203], v[96:99]
  buffer_load_dwordx4 v245, s[56:59], s6 offen offset:1024 lds
  buffer_load_dwordx4 v246, s[56:59], s6 offen offset:2048 lds
  v_mfma_f32_16x16x32_bf16 v[100:103], a[68:71], v[200:203], v[100:103]
  buffer_load_dwordx4 v247, s[56:59], s6 offen offset:3072 lds
  v_cvt_pk_bf16_f32 v230, v28, v29
  v_mfma_f32_16x16x32_bf16 v[104:107], a[72:75], v[200:203], v[104:107]
  v_cvt_pk_bf16_f32 v231, v30, v31
  v_mfma_f32_16x16x32_bf16 v[108:111], a[76:79], v[200:203], v[108:111]
  ds_read_b64_tr_b16 v[200:201], v240 offset:61440
  ds_read_b64_tr_b16 v[202:203], v240 offset:61696
  s_waitcnt lgkmcnt(14)
  v_mfma_f32_16x16x32_bf16 v[112:115], a[64:67], v[204:207], v[112:115]
  buffer_store_dwordx4 v[228:231], v130, s[64:67], s88 offen offset:1024 sc1
  v_mfma_f32_16x16x32_bf16 v[116:119], a[68:71], v[204:207], v[116:119]
  v_mfma_f32_16x16x32_bf16 v[120:123], a[72:75], v[204:207], v[120:123]
  v_mfma_f32_16x16x32_bf16 v[124:127], a[76:79], v[204:207], v[124:127]
  ds_read_b64_tr_b16 v[204:205], v241 offset:61440
  ds_read_b64_tr_b16 v[206:207], v241 offset:61696
  s_waitcnt lgkmcnt(14)
  v_mfma_f32_16x16x32_bf16 v[64:67], a[80:83], v[208:211], v[64:67]
  v_mfma_f32_16x16x32_bf16 v[68:71], a[84:87], v[208:211], v[68:71]
  v_cvt_pk_bf16_f32 v232, v32, v33
  v_mfma_f32_16x16x32_bf16 v[72:75], a[88:91], v[208:211], v[72:75]
  v_mfma_f32_16x16x32_bf16 v[76:79], a[92:95], v[208:211], v[76:79]
  ds_read_b64_tr_b16 v[208:209], v240 offset:59392
  ds_read_b64_tr_b16 v[210:211], v240 offset:59648
  s_waitcnt lgkmcnt(14)
  v_mfma_f32_16x16x32_bf16 v[80:83], a[80:83], v[212:215], v[80:83]
  v_mfma_f32_16x16x32_bf16 v[84:87], a[84:87], v[212:215], v[84:87]
  v_cvt_pk_bf16_f32 v233, v34, v35
  v_mfma_f32_16x16x32_bf16 v[88:91], a[88:91], v[212:215], v[88:91]
  v_mfma_f32_16x16x32_bf16 v[92:95], a[92:95], v[212:215], v[92:95]
  ds_read_b64_tr_b16 v[212:213], v241 offset:59392
  ds_read_b64_tr_b16 v[214:215], v241 offset:59648
  s_waitcnt lgkmcnt(14)
  v_mfma_f32_16x16x32_bf16 v[96:99], a[80:83], v[216:219], v[96:99]
  v_mfma_f32_16x16x32_bf16 v[100:103], a[84:87], v[216:219], v[100:103]
  v_cvt_pk_bf16_f32 v234, v36, v37
  v_mfma_f32_16x16x32_bf16 v[104:107], a[88:91], v[216:219], v[104:107]
  v_mfma_f32_16x16x32_bf16 v[108:111], a[92:95], v[216:219], v[108:111]
  ds_read_b64_tr_b16 v[216:217], v240 offset:63488
  ds_read_b64_tr_b16 v[218:219], v240 offset:63744
  s_waitcnt lgkmcnt(14)
  v_mfma_f32_16x16x32_bf16 v[112:115], a[80:83], v[220:223], v[112:115]
  v_mfma_f32_16x16x32_bf16 v[116:119], a[84:87], v[220:223], v[116:119]
  v_mfma_f32_16x16x32_bf16 v[120:123], a[88:91], v[220:223], v[120:123]
  v_cvt_pk_bf16_f32 v235, v38, v39
  v_mfma_f32_16x16x32_bf16 v[124:127], a[92:95], v[220:223], v[124:127]
  ds_read_b64_tr_b16 v[220:221], v241 offset:63488
  ds_read_b64_tr_b16 v[222:223], v241 offset:63744
  s_waitcnt lgkmcnt(14)
  v_mfma_f32_16x16x32_bf16 v[64:67], a[96:99], v[192:195], v[64:67]
  v_mfma_f32_16x16x32_bf16 v[68:71], a[100:103], v[192:195], v[68:71]
  v_mfma_f32_16x16x32_bf16 v[72:75], a[104:107], v[192:195], v[72:75]
  v_mfma_f32_16x16x32_bf16 v[76:79], a[108:111], v[192:195], v[76:79]
  ds_read_b64_tr_b16 v[192:193], v242 offset:0
  ds_read_b64_tr_b16 v[194:195], v242 offset:256
  s_waitcnt lgkmcnt(14)
  v_mfma_f32_16x16x32_bf16 v[80:83], a[96:99], v[196:199], v[80:83]
  buffer_store_dwordx4 v[232:235], v128, s[64:67], s89 offen offset:0 sc1
  v_mfma_f32_16x16x32_bf16 v[84:87], a[100:103], v[196:199], v[84:87]
  v_mfma_f32_16x16x32_bf16 v[88:91], a[104:107], v[196:199], v[88:91]
  v_mfma_f32_16x16x32_bf16 v[92:95], a[108:111], v[196:199], v[92:95]
  ds_read_b64_tr_b16 v[196:197], v243 offset:0
  ds_read_b64_tr_b16 v[198:199], v243 offset:256
  s_waitcnt lgkmcnt(14)
  v_mfma_f32_16x16x32_bf16 v[96:99], a[96:99], v[200:203], v[96:99]
  v_cvt_pk_bf16_f32 v224, v48, v49
  v_mfma_f32_16x16x32_bf16 v[100:103], a[100:103], v[200:203], v[100:103]
  v_mfma_f32_16x16x32_bf16 v[104:107], a[104:107], v[200:203], v[104:107]
  v_mfma_f32_16x16x32_bf16 v[108:111], a[108:111], v[200:203], v[108:111]
  ds_read_b64_tr_b16 v[200:201], v242 offset:4096
  ds_read_b64_tr_b16 v[202:203], v242 offset:4352
  s_waitcnt lgkmcnt(14)
  v_mfma_f32_16x16x32_bf16 v[112:115], a[96:99], v[204:207], v[112:115]
  v_cvt_pk_bf16_f32 v225, v50, v51
  v_mfma_f32_16x16x32_bf16 v[116:119], a[100:103], v[204:207], v[116:119]
  v_mfma_f32_16x16x32_bf16 v[120:123], a[104:107], v[204:207], v[120:123]
  v_mfma_f32_16x16x32_bf16 v[124:127], a[108:111], v[204:207], v[124:127]
  ds_read_b64_tr_b16 v[204:205], v243 offset:4096
  ds_read_b64_tr_b16 v[206:207], v243 offset:4352
  s_waitcnt lgkmcnt(14)
  v_mfma_f32_16x16x32_bf16 v[64:67], a[112:115], v[208:211], v[64:67]
  v_mfma_f32_16x16x32_bf16 v[68:71], a[116:119], v[208:211], v[68:71]
  v_mfma_f32_16x16x32_bf16 v[72:75], a[120:123], v[208:211], v[72:75]
  v_cvt_pk_bf16_f32 v226, v52, v53
  v_mfma_f32_16x16x32_bf16 v[76:79], a[124:127], v[208:211], v[76:79]
  ds_read_b64_tr_b16 v[208:209], v242 offset:2048
  ds_read_b64_tr_b16 v[210:211], v242 offset:2304
  s_waitcnt lgkmcnt(14)
  v_mfma_f32_16x16x32_bf16 v[80:83], a[112:115], v[212:215], v[80:83]
  v_mfma_f32_16x16x32_bf16 v[84:87], a[116:119], v[212:215], v[84:87]
  v_mfma_f32_16x16x32_bf16 v[88:91], a[120:123], v[212:215], v[88:91]
  v_mfma_f32_16x16x32_bf16 v[92:95], a[124:127], v[212:215], v[92:95]
  ds_read_b64_tr_b16 v[212:213], v243 offset:2048
  ds_read_b64_tr_b16 v[214:215], v243 offset:2304
  s_waitcnt lgkmcnt(14)
  v_mfma_f32_16x16x32_bf16 v[96:99], a[112:115], v[216:219], v[96:99]
  v_cvt_pk_bf16_f32 v227, v54, v55
  v_mfma_f32_16x16x32_bf16 v[100:103], a[116:119], v[216:219], v[100:103]
  v_mfma_f32_16x16x32_bf16 v[104:107], a[120:123], v[216:219], v[104:107]
  v_mfma_f32_16x16x32_bf16 v[108:111], a[124:127], v[216:219], v[108:111]
  ds_read_b64_tr_b16 v[216:217], v242 offset:6144
  ds_read_b64_tr_b16 v[218:219], v242 offset:6400
  s_waitcnt lgkmcnt(14)
  v_mfma_f32_16x16x32_bf16 v[112:115], a[112:115], v[220:223], v[112:115]
  buffer_store_dwordx4 v[224:227], v128, s[64:67], s89 offen offset:1024 sc1
  v_mfma_f32_16x16x32_bf16 v[116:119], a[116:119], v[220:223], v[116:119]
  v_mfma_f32_16x16x32_bf16 v[120:123], a[120:123], v[220:223], v[120:123]
  v_mfma_f32_16x16x32_bf16 v[124:127], a[124:127], v[220:223], v[124:127]
  ds_read_b64_tr_b16 v[220:221], v243 offset:6144
  ds_read_b64_tr_b16 v[222:223], v243 offset:6400
  s_waitcnt vmcnt(15)
  s_barrier
  s_waitcnt lgkmcnt(14)
  v_mfma_f32_16x16x32_bf16 v[64:67], a[128:131], v[192:195], v[64:67]
  v_mfma_f32_16x16x32_bf16 v[68:71], a[132:135], v[192:195], v[68:71]
  v_mfma_f32_16x16x32_bf16 v[72:75], a[136:139], v[192:195], v[72:75]
  s_lshr_b32 s6, s3, 1
  s_add_u32 s6, s6, s14
  v_mfma_f32_16x16x32_bf16 v[76:79], a[140:143], v[192:195], v[76:79]
  ds_read_b64_tr_b16 v[192:193], v242 offset:8192
  ds_read_b64_tr_b16 v[194:195], v242 offset:8448
  s_waitcnt lgkmcnt(14)
  v_mfma_f32_16x16x32_bf16 v[80:83], a[128:131], v[196:199], v[80:83]
  s_add_u32 s6, s6, 4
  s_and_b32 s6, s6, 7
  v_mfma_f32_16x16x32_bf16 v[84:87], a[132:135], v[196:199], v[84:87]
  s_lshl_b32 s6, s6, 19
  s_add_u32 m0, s9, 49152
  v_mfma_f32_16x16x32_bf16 v[88:91], a[136:139], v[196:199], v[88:91]
  s_add_u32 s6, s6, s97
  buffer_load_dwordx4 v244, s[56:59], s6 offen offset:0 lds
  v_mfma_f32_16x16x32_bf16 v[92:95], a[140:143], v[196:199], v[92:95]
  ds_read_b64_tr_b16 v[196:197], v243 offset:8192
  ds_read_b64_tr_b16 v[198:199], v243 offset:8448
  s_waitcnt lgkmcnt(14)
  v_mfma_f32_16x16x32_bf16 v[96:99], a[128:131], v[200:203], v[96:99]
  buffer_load_dwordx4 v245, s[56:59], s6 offen offset:1024 lds
  buffer_load_dwordx4 v246, s[56:59], s6 offen offset:2048 lds
  v_mfma_f32_16x16x32_bf16 v[100:103], a[132:135], v[200:203], v[100:103]
  buffer_load_dwordx4 v247, s[56:59], s6 offen offset:3072 lds
  v_cvt_pk_bf16_f32 v228, v40, v41
  v_mfma_f32_16x16x32_bf16 v[104:107], a[136:139], v[200:203], v[104:107]
  v_cvt_pk_bf16_f32 v229, v42, v43
  v_mfma_f32_16x16x32_bf16 v[108:111], a[140:143], v[200:203], v[108:111]
  ds_read_b64_tr_b16 v[200:201], v242 offset:12288
  ds_read_b64_tr_b16 v[202:203], v242 offset:12544
  s_waitcnt lgkmcnt(14)
  v_mfma_f32_16x16x32_bf16 v[112:115], a[128:131], v[204:207], v[112:115]
  v_mfma_f32_16x16x32_bf16 v[116:119], a[132:135], v[204:207], v[116:119]
  v_mfma_f32_16x16x32_bf16 v[120:123], a[136:139], v[204:207], v[120:123]
  v_mfma_f32_16x16x32_bf16 v[124:127], a[140:143], v[204:207], v[124:127]
  ds_read_b64_tr_b16 v[204:205], v243 offset:12288
  ds_read_b64_tr_b16 v[206:207], v243 offset:12544
  s_waitcnt lgkmcnt(14)
  v_mfma_f32_16x16x32_bf16 v[64:67], a[144:147], v[208:211], v[64:67]
  v_cvt_pk_bf16_f32 v230, v44, v45
  v_mfma_f32_16x16x32_bf16 v[68:71], a[148:151], v[208:211], v[68:71]
  v_mfma_f32_16x16x32_bf16 v[72:75], a[152:155], v[208:211], v[72:75]
  v_mfma_f32_16x16x32_bf16 v[76:79], a[156:159], v[208:211], v[76:79]
  ds_read_b64_tr_b16 v[208:209], v242 offset:10240
  ds_read_b64_tr_b16 v[210:211], v242 offset:10496
  s_waitcnt lgkmcnt(14)
  v_mfma_f32_16x16x32_bf16 v[80:83], a[144:147], v[212:215], v[80:83]
  v_mfma_f32_16x16x32_bf16 v[84:87], a[148:151], v[212:215], v[84:87]
  v_mfma_f32_16x16x32_bf16 v[88:91], a[152:155], v[212:215], v[88:91]
  v_cvt_pk_bf16_f32 v231, v46, v47
  v_mfma_f32_16x16x32_bf16 v[92:95], a[156:159], v[212:215], v[92:95]
  ds_read_b64_tr_b16 v[212:213], v243 offset:10240
  ds_read_b64_tr_b16 v[214:215], v243 offset:10496
  s_waitcnt lgkmcnt(14)
  v_mfma_f32_16x16x32_bf16 v[96:99], a[144:147], v[216:219], v[96:99]
  v_mfma_f32_16x16x32_bf16 v[100:103], a[148:151], v[216:219], v[100:103]
  v_mfma_f32_16x16x32_bf16 v[104:107], a[152:155], v[216:219], v[104:107]
  v_mfma_f32_16x16x32_bf16 v[108:111], a[156:159], v[216:219], v[108:111]
  ds_read_b64_tr_b16 v[216:217], v242 offset:14336
  ds_read_b64_tr_b16 v[218:219], v242 offset:14592
  s_waitcnt lgkmcnt(14)
  v_mfma_f32_16x16x32_bf16 v[112:115], a[144:147], v[220:223], v[112:115]
  v_mfma_f32_16x16x32_bf16 v[116:119], a[148:151], v[220:223], v[116:119]
  buffer_store_dwordx4 v[228:231], v130, s[64:67], s89 offen offset:0 sc1
  v_mfma_f32_16x16x32_bf16 v[120:123], a[152:155], v[220:223], v[120:123]
  v_mfma_f32_16x16x32_bf16 v[124:127], a[156:159], v[220:223], v[124:127]
  ds_read_b64_tr_b16 v[220:221], v243 offset:14336
  ds_read_b64_tr_b16 v[222:223], v243 offset:14592
  s_waitcnt lgkmcnt(14)
  v_mfma_f32_16x16x32_bf16 v[64:67], a[160:163], v[192:195], v[64:67]
  v_mfma_f32_16x16x32_bf16 v[68:71], a[164:167], v[192:195], v[68:71]
  v_mfma_f32_16x16x32_bf16 v[72:75], a[168:171], v[192:195], v[72:75]
  v_mfma_f32_16x16x32_bf16 v[76:79], a[172:175], v[192:195], v[76:79]
  ds_read_b64_tr_b16 v[192:193], v240 offset:0
  ds_read_b64_tr_b16 v[194:195], v240 offset:256
  s_waitcnt lgkmcnt(14)
  v_mfma_f32_16x16x32_bf16 v[80:83], a[160:163], v[196:199], v[80:83]
  v_mfma_f32_16x16x32_bf16 v[84:87], a[164:167], v[196:199], v[84:87]
  v_mfma_f32_16x16x32_bf16 v[88:91], a[168:171], v[196:199], v[88:91]
  v_cvt_pk_bf16_f32 v232, v56, v57
  v_mfma_f32_16x16x32_bf16 v[92:95], a[172:175], v[196:199], v[92:95]
  ds_read_b64_tr_b16 v[196:197], v241 offset:0
  ds_read_b64_tr_b16 v[198:199], v241 offset:256
  s_waitcnt lgkmcnt(14)
  v_mfma_f32_16x16x32_bf16 v[96:99], a[160:163], v[200:203], v[96:99]
  v_mfma_f32_16x16x32_bf16 v[100:103], a[164:167], v[200:203], v[100:103]
  v_mfma_f32_16x16x32_bf16 v[104:107], a[168:171], v[200:203], v[104:107]
  v_mfma_f32_16x16x32_bf16 v[108:111], a[172:175], v[200:203], v[108:111]
  ds_read_b64_tr_b16 v[200:201], v240 offset:4096
  ds_read_b64_tr_b16 v[202:203], v240 offset:4352
  s_waitcnt lgkmcnt(14)
  v_mfma_f32_16x16x32_bf16 v[112:115], a[160:163], v[204:207], v[112:115]
  v_mfma_f32_16x16x32_bf16 v[116:119], a[164:167], v[204:207], v[116:119]
  v_mfma_f32_16x16x32_bf16 v[120:123], a[168:171], v[204:207], v[120:123]
  v_mfma_f32_16x16x32_bf16 v[124:127], a[172:175], v[204:207], v[124:127]
  ds_read_b64_tr_b16 v[204:205], v241 offset:4096
  ds_read_b64_tr_b16 v[206:207], v241 offset:4352
  s_waitcnt lgkmcnt(14)
  v_mfma_f32_16x16x32_bf16 v[64:67], a[176:179], v[208:211], v[64:67]
  v_cvt_pk_bf16_f32 v233, v58, v59
  v_mfma_f32_16x16x32_bf16 v[68:71], a[180:183], v[208:211], v[68:71]
  v_mfma_f32_16x16x32_bf16 v[72:75], a[184:187], v[208:211], v[72:75]
  v_mfma_f32_16x16x32_bf16 v[76:79], a[188:191], v[208:211], v[76:79]
  ds_read_b64_tr_b16 v[208:209], v240 offset:2048
  ds_read_b64_tr_b16 v[210:211], v240 offset:2304
  s_waitcnt lgkmcnt(14)
  v_mfma_f32_16x16x32_bf16 v[80:83], a[176:179], v[212:215], v[80:83]
  v_mfma_f32_16x16x32_bf16 v[84:87], a[180:183], v[212:215], v[84:87]
  v_mfma_f32_16x16x32_bf16 v[88:91], a[184:187], v[212:215], v[88:91]
  v_mfma_f32_16x16x32_bf16 v[92:95], a[188:191], v[212:215], v[92:95]
  ds_read_b64_tr_b16 v[212:213], v241 offset:2048
  ds_read_b64_tr_b16 v[214:215], v241 offset:2304
  s_waitcnt lgkmcnt(14)
  v_mfma_f32_16x16x32_bf16 v[96:99], a[176:179], v[216:219], v[96:99]
  v_mfma_f32_16x16x32_bf16 v[100:103], a[180:183], v[216:219], v[100:103]
  v_mfma_f32_16x16x32_bf16 v[104:107], a[184:187], v[216:219], v[104:107]
  v_cvt_pk_bf16_f32 v234, v60, v61
  v_mfma_f32_16x16x32_bf16 v[108:111], a[188:191], v[216:219], v[108:111]
  ds_read_b64_tr_b16 v[216:217], v240 offset:6144
  ds_read_b64_tr_b16 v[218:219], v240 offset:6400
  s_waitcnt lgkmcnt(14)
  v_mfma_f32_16x16x32_bf16 v[112:115], a[176:179], v[220:223], v[112:115]
  v_mfma_f32_16x16x32_bf16 v[116:119], a[180:183], v[220:223], v[116:119]
  v_mfma_f32_16x16x32_bf16 v[120:123], a[184:187], v[220:223], v[120:123]
  v_mfma_f32_16x16x32_bf16 v[124:127], a[188:191], v[220:223], v[124:127]
  ds_read_b64_tr_b16 v[220:221], v241 offset:6144
  ds_read_b64_tr_b16 v[222:223], v241 offset:6400
  s_waitcnt vmcnt(15)
  s_barrier
  s_waitcnt lgkmcnt(14)
  v_mfma_f32_16x16x32_bf16 v[64:67], a[192:195], v[192:195], v[64:67]
  v_mfma_f32_16x16x32_bf16 v[68:71], a[196:199], v[192:195], v[68:71]
  v_mfma_f32_16x16x32_bf16 v[72:75], a[200:203], v[192:195], v[72:75]
  s_lshr_b32 s6, s3, 1
  s_add_u32 s6, s6, s14
  v_mfma_f32_16x16x32_bf16 v[76:79], a[204:207], v[192:195], v[76:79]
  ds_read_b64_tr_b16 v[192:193], v240 offset:8192
  ds_read_b64_tr_b16 v[194:195], v240 offset:8448
  s_waitcnt lgkmcnt(14)
  v_mfma_f32_16x16x32_bf16 v[80:83], a[192:195], v[196:199], v[80:83]
  s_add_u32 s6, s6, 6
  s_and_b32 s6, s6, 7
  v_mfma_f32_16x16x32_bf16 v[84:87], a[196:199], v[196:199], v[84:87]
  s_lshl_b32 s6, s6, 19
  s_add_u32 m0, s9, 65536
  v_mfma_f32_16x16x32_bf16 v[88:91], a[200:203], v[196:199], v[88:91]
  s_add_u32 s6, s6, s97
  buffer_load_dwordx4 v244, s[56:59], s6 offen offset:0 lds
  v_mfma_f32_16x16x32_bf16 v[92:95], a[204:207], v[196:199], v[92:95]
  ds_read_b64_tr_b16 v[196:197], v241 offset:8192
  ds_read_b64_tr_b16 v[198:199], v241 offset:8448
  s_waitcnt lgkmcnt(14)
  v_mfma_f32_16x16x32_bf16 v[96:99], a[192:195], v[200:203], v[96:99]
  buffer_load_dwordx4 v245, s[56:59], s6 offen offset:1024 lds
  buffer_load_dwordx4 v246, s[56:59], s6 offen offset:2048 lds
  v_mfma_f32_16x16x32_bf16 v[100:103], a[196:199], v[200:203], v[100:103]
  buffer_load_dwordx4 v247, s[56:59], s6 offen offset:3072 lds
  v_cvt_pk_bf16_f32 v235, v62, v63
  v_mfma_f32_16x16x32_bf16 v[104:107], a[200:203], v[200:203], v[104:107]
  v_mfma_f32_16x16x32_bf16 v[108:111], a[204:207], v[200:203], v[108:111]
  ds_read_b64_tr_b16 v[200:201], v240 offset:12288
  ds_read_b64_tr_b16 v[202:203], v240 offset:12544
  s_waitcnt lgkmcnt(14)
  v_mfma_f32_16x16x32_bf16 v[112:115], a[192:195], v[204:207], v[112:115]
  v_mfma_f32_16x16x32_bf16 v[116:119], a[196:199], v[204:207], v[116:119]
  v_mfma_f32_16x16x32_bf16 v[120:123], a[200:203], v[204:207], v[120:123]
  v_mfma_f32_16x16x32_bf16 v[124:127], a[204:207], v[204:207], v[124:127]
  ds_read_b64_tr_b16 v[204:205], v241 offset:12288
  ds_read_b64_tr_b16 v[206:207], v241 offset:12544
  s_waitcnt lgkmcnt(14)
  v_mfma_f32_16x16x32_bf16 v[64:67], a[208:211], v[208:211], v[64:67]
  v_mfma_f32_16x16x32_bf16 v[68:71], a[212:215], v[208:211], v[68:71]
  v_mfma_f32_16x16x32_bf16 v[72:75], a[216:219], v[208:211], v[72:75]
  v_mfma_f32_16x16x32_bf16 v[76:79], a[220:223], v[208:211], v[76:79]
  ds_read_b64_tr_b16 v[208:209], v240 offset:10240
  ds_read_b64_tr_b16 v[210:211], v240 offset:10496
  s_waitcnt lgkmcnt(14)
  v_mfma_f32_16x16x32_bf16 v[80:83], a[208:211], v[212:215], v[80:83]
  v_mfma_f32_16x16x32_bf16 v[84:87], a[212:215], v[212:215], v[84:87]
  v_mfma_f32_16x16x32_bf16 v[88:91], a[216:219], v[212:215], v[88:91]
  v_mfma_f32_16x16x32_bf16 v[92:95], a[220:223], v[212:215], v[92:95]
  ds_read_b64_tr_b16 v[212:213], v241 offset:10240
  ds_read_b64_tr_b16 v[214:215], v241 offset:10496
  s_waitcnt lgkmcnt(14)
  v_mfma_f32_16x16x32_bf16 v[96:99], a[208:211], v[216:219], v[96:99]
  v_mfma_f32_16x16x32_bf16 v[100:103], a[212:215], v[216:219], v[100:103]
  buffer_store_dwordx4 v[232:235], v130, s[64:67], s89 offen offset:1024 sc1
  v_mfma_f32_16x16x32_bf16 v[104:107], a[216:219], v[216:219], v[104:107]
  v_mfma_f32_16x16x32_bf16 v[108:111], a[220:223], v[216:219], v[108:111]
  ds_read_b64_tr_b16 v[216:217], v240 offset:14336
  ds_read_b64_tr_b16 v[218:219], v240 offset:14592
  s_waitcnt lgkmcnt(14)
  v_mfma_f32_16x16x32_bf16 v[112:115], a[208:211], v[220:223], v[112:115]
  v_mfma_f32_16x16x32_bf16 v[116:119], a[212:215], v[220:223], v[116:119]
  v_mfma_f32_16x16x32_bf16 v[120:123], a[216:219], v[220:223], v[120:123]
  v_mfma_f32_16x16x32_bf16 v[124:127], a[220:223], v[220:223], v[124:127]
  ds_read_b64_tr_b16 v[220:221], v241 offset:14336
  ds_read_b64_tr_b16 v[222:223], v241 offset:14592
  s_waitcnt lgkmcnt(14)
  v_mfma_f32_16x16x32_bf16 v[64:67], a[224:227], v[192:195], v[64:67]
  v_mfma_f32_16x16x32_bf16 v[68:71], a[228:231], v[192:195], v[68:71]
  v_mfma_f32_16x16x32_bf16 v[72:75], a[232:235], v[192:195], v[72:75]
  v_mfma_f32_16x16x32_bf16 v[76:79], a[236:239], v[192:195], v[76:79]
  ds_read_b64_tr_b16 v[192:193], v240 offset:16384
  ds_read_b64_tr_b16 v[194:195], v240 offset:16640
  s_waitcnt lgkmcnt(14)
  v_mfma_f32_16x16x32_bf16 v[80:83], a[224:227], v[196:199], v[80:83]
  v_mfma_f32_16x16x32_bf16 v[84:87], a[228:231], v[196:199], v[84:87]
  v_mfma_f32_16x16x32_bf16 v[88:91], a[232:235], v[196:199], v[88:91]
  v_mfma_f32_16x16x32_bf16 v[92:95], a[236:239], v[196:199], v[92:95]
  ds_read_b64_tr_b16 v[196:197], v241 offset:16384
  ds_read_b64_tr_b16 v[198:199], v241 offset:16640
  s_waitcnt lgkmcnt(14)
  v_mfma_f32_16x16x32_bf16 v[96:99], a[224:227], v[200:203], v[96:99]
  v_mfma_f32_16x16x32_bf16 v[100:103], a[228:231], v[200:203], v[100:103]
  v_mfma_f32_16x16x32_bf16 v[104:107], a[232:235], v[200:203], v[104:107]
  v_mfma_f32_16x16x32_bf16 v[108:111], a[236:239], v[200:203], v[108:111]
  ds_read_b64_tr_b16 v[200:201], v240 offset:20480
  ds_read_b64_tr_b16 v[202:203], v240 offset:20736
  s_waitcnt lgkmcnt(14)
  v_mfma_f32_16x16x32_bf16 v[112:115], a[224:227], v[204:207], v[112:115]
  v_mfma_f32_16x16x32_bf16 v[116:119], a[228:231], v[204:207], v[116:119]
  v_mfma_f32_16x16x32_bf16 v[120:123], a[232:235], v[204:207], v[120:123]
  v_mfma_f32_16x16x32_bf16 v[124:127], a[236:239], v[204:207], v[124:127]
  ds_read_b64_tr_b16 v[204:205], v241 offset:20480
  ds_read_b64_tr_b16 v[206:207], v241 offset:20736
  s_waitcnt lgkmcnt(14)
  v_mfma_f32_16x16x32_bf16 v[64:67], a[240:243], v[208:211], v[64:67]
  v_mfma_f32_16x16x32_bf16 v[68:71], a[244:247], v[208:211], v[68:71]
  v_mfma_f32_16x16x32_bf16 v[72:75], a[248:251], v[208:211], v[72:75]
  v_mfma_f32_16x16x32_bf16 v[76:79], a[252:255], v[208:211], v[76:79]
  ds_read_b64_tr_b16 v[208:209], v240 offset:18432
  ds_read_b64_tr_b16 v[210:211], v240 offset:18688
  s_waitcnt lgkmcnt(14)
  v_mfma_f32_16x16x32_bf16 v[80:83], a[240:243], v[212:215], v[80:83]
  v_mfma_f32_16x16x32_bf16 v[84:87], a[244:247], v[212:215], v[84:87]
  v_mfma_f32_16x16x32_bf16 v[88:91], a[248:251], v[212:215], v[88:91]
  v_mfma_f32_16x16x32_bf16 v[92:95], a[252:255], v[212:215], v[92:95]
  ds_read_b64_tr_b16 v[212:213], v241 offset:18432
  ds_read_b64_tr_b16 v[214:215], v241 offset:18688
  s_waitcnt lgkmcnt(14)
  v_mfma_f32_16x16x32_bf16 v[96:99], a[240:243], v[216:219], v[96:99]
  v_mfma_f32_16x16x32_bf16 v[100:103], a[244:247], v[216:219], v[100:103]
  v_mfma_f32_16x16x32_bf16 v[104:107], a[248:251], v[216:219], v[104:107]
  v_mfma_f32_16x16x32_bf16 v[108:111], a[252:255], v[216:219], v[108:111]
  ds_read_b64_tr_b16 v[216:217], v240 offset:22528
  ds_read_b64_tr_b16 v[218:219], v240 offset:22784
  s_waitcnt lgkmcnt(14)
  v_mfma_f32_16x16x32_bf16 v[112:115], a[240:243], v[220:223], v[112:115]
  v_mfma_f32_16x16x32_bf16 v[116:119], a[244:247], v[220:223], v[116:119]
  v_mfma_f32_16x16x32_bf16 v[120:123], a[248:251], v[220:223], v[120:123]
  v_mfma_f32_16x16x32_bf16 v[124:127], a[252:255], v[220:223], v[124:127]
  ds_read_b64_tr_b16 v[220:221], v241 offset:22528
  ds_read_b64_tr_b16 v[222:223], v241 offset:22784
  s_waitcnt vmcnt(13)
  s_barrier
  s_waitcnt lgkmcnt(14)
  v_mfma_f32_16x16x32_bf16 v[0:3], a[0:3], v[192:195], 0
  v_mfma_f32_16x16x32_bf16 v[4:7], a[4:7], v[192:195], 0
  v_mfma_f32_16x16x32_bf16 v[8:11], a[8:11], v[192:195], 0
  v_mfma_f32_16x16x32_bf16 v[12:15], a[12:15], v[192:195], 0
  ds_read_b64_tr_b16 v[192:193], v240 offset:24576
  ds_read_b64_tr_b16 v[194:195], v240 offset:24832
  s_waitcnt lgkmcnt(14)
  v_mfma_f32_16x16x32_bf16 v[16:19], a[0:3], v[196:199], 0
  v_mfma_f32_16x16x32_bf16 v[20:23], a[4:7], v[196:199], 0
  v_mfma_f32_16x16x32_bf16 v[24:27], a[8:11], v[196:199], 0
  v_mfma_f32_16x16x32_bf16 v[28:31], a[12:15], v[196:199], 0
  ds_read_b64_tr_b16 v[196:197], v241 offset:24576
  ds_read_b64_tr_b16 v[198:199], v241 offset:24832
  s_waitcnt lgkmcnt(14)
  v_mfma_f32_16x16x32_bf16 v[32:35], a[0:3], v[200:203], 0
  s_mov_b32 s72, s16
  v_mfma_f32_16x16x32_bf16 v[36:39], a[4:7], v[200:203], 0
  s_and_b32 s73, s17, 0xffff
  v_mfma_f32_16x16x32_bf16 v[40:43], a[8:11], v[200:203], 0
  v_mfma_f32_16x16x32_bf16 v[44:47], a[12:15], v[200:203], 0
  ds_read_b64_tr_b16 v[200:201], v240 offset:28672
  ds_read_b64_tr_b16 v[202:203], v240 offset:28928
  s_waitcnt lgkmcnt(14)
  v_mfma_f32_16x16x32_bf16 v[48:51], a[0:3], v[204:207], 0
  s_mov_b32 s74, 2097152
  s_mov_b32 s75, 0x00020000
  v_mfma_f32_16x16x32_bf16 v[52:55], a[4:7], v[204:207], 0
  v_mfma_f32_16x16x32_bf16 v[56:59], a[8:11], v[204:207], 0
  s_lshl_b32 s8, s2, 2
  v_mfma_f32_16x16x32_bf16 v[60:63], a[12:15], v[204:207], 0
  ds_read_b64_tr_b16 v[204:205], v241 offset:28672
  ds_read_b64_tr_b16 v[206:207], v241 offset:28928
  s_waitcnt lgkmcnt(14)
  v_mfma_f32_16x16x32_bf16 v[0:3], a[16:19], v[208:211], v[0:3]
  s_add_u32 s8, s8, s3
  v_mfma_f32_16x16x32_bf16 v[4:7], a[20:23], v[208:211], v[4:7]
  s_mul_i32 s8, s8, 2048
  v_mfma_f32_16x16x32_bf16 v[8:11], a[24:27], v[208:211], v[8:11]
  v_mfma_f32_16x16x32_bf16 v[12:15], a[28:31], v[208:211], v[12:15]
  ds_read_b64_tr_b16 v[208:209], v240 offset:26624
  ds_read_b64_tr_b16 v[210:211], v240 offset:26880
  s_waitcnt lgkmcnt(14)
  v_mfma_f32_16x16x32_bf16 v[16:19], a[16:19], v[212:215], v[16:19]
  buffer_load_dwordx4 v[144:147], v140, s[72:75], s8 offen offset:0
  v_mfma_f32_16x16x32_bf16 v[20:23], a[20:23], v[212:215], v[20:23]
  buffer_load_dwordx4 v[144:147], v140, s[72:75], s8 offen offset:1024
  v_mfma_f32_16x16x32_bf16 v[24:27], a[24:27], v[212:215], v[24:27]
  v_mfma_f32_16x16x32_bf16 v[28:31], a[28:31], v[212:215], v[28:31]
  ds_read_b64_tr_b16 v[212:213], v241 offset:26624
  ds_read_b64_tr_b16 v[214:215], v241 offset:26880
  s_waitcnt lgkmcnt(14)
  v_mfma_f32_16x16x32_bf16 v[32:35], a[16:19], v[216:219], v[32:35]
  s_mov_b32 s72, s20
  v_mfma_f32_16x16x32_bf16 v[36:39], a[20:23], v[216:219], v[36:39]
  s_and_b32 s73, s21, 0xffff
  v_mfma_f32_16x16x32_bf16 v[40:43], a[24:27], v[216:219], v[40:43]
  s_mov_b32 s74, 4194304
  v_mfma_f32_16x16x32_bf16 v[44:47], a[28:31], v[216:219], v[44:47]
  ds_read_b64_tr_b16 v[216:217], v240 offset:30720
  ds_read_b64_tr_b16 v[218:219], v240 offset:30976
  s_waitcnt lgkmcnt(14)
  v_mfma_f32_16x16x32_bf16 v[48:51], a[16:19], v[220:223], v[48:51]
  s_mov_b32 s75, 0x00020000
  v_mfma_f32_16x16x32_bf16 v[52:55], a[20:23], v[220:223], v[52:55]
  v_mfma_f32_16x16x32_bf16 v[56:59], a[24:27], v[220:223], v[56:59]
  s_lshl_b32 s8, s2, 2
  v_mfma_f32_16x16x32_bf16 v[60:63], a[28:31], v[220:223], v[60:63]
  ds_read_b64_tr_b16 v[220:221], v241 offset:30720
  ds_read_b64_tr_b16 v[222:223], v241 offset:30976
  s_waitcnt lgkmcnt(14)
  v_mfma_f32_16x16x32_bf16 v[0:3], a[32:35], v[192:195], v[0:3]
  s_add_u32 s8, s8, s3
  v_mfma_f32_16x16x32_bf16 v[4:7], a[36:39], v[192:195], v[4:7]
  v_mfma_f32_16x16x32_bf16 v[8:11], a[40:43], v[192:195], v[8:11]
  s_mul_i32 s8, s8, 4096
  v_mfma_f32_16x16x32_bf16 v[12:15], a[44:47], v[192:195], v[12:15]
  ds_read_b64_tr_b16 v[192:193], v240 offset:32768
  ds_read_b64_tr_b16 v[194:195], v240 offset:33024
  s_waitcnt lgkmcnt(14)
  v_mfma_f32_16x16x32_bf16 v[16:19], a[32:35], v[196:199], v[16:19]
  buffer_load_dwordx4 v[144:147], v140, s[72:75], s8 offen offset:0
  v_mfma_f32_16x16x32_bf16 v[20:23], a[36:39], v[196:199], v[20:23]
  v_mfma_f32_16x16x32_bf16 v[24:27], a[40:43], v[196:199], v[24:27]
  buffer_load_dwordx4 v[144:147], v140, s[72:75], s8 offen offset:1024
  v_mfma_f32_16x16x32_bf16 v[28:31], a[44:47], v[196:199], v[28:31]
  ds_read_b64_tr_b16 v[196:197], v241 offset:32768
  ds_read_b64_tr_b16 v[198:199], v241 offset:33024
  s_waitcnt lgkmcnt(14)
  v_mfma_f32_16x16x32_bf16 v[32:35], a[32:35], v[200:203], v[32:35]
  buffer_load_dwordx4 v[144:147], v140, s[72:75], s8 offen offset:2048
  v_mfma_f32_16x16x32_bf16 v[36:39], a[36:39], v[200:203], v[36:39]
  v_mfma_f32_16x16x32_bf16 v[40:43], a[40:43], v[200:203], v[40:43]
  buffer_load_dwordx4 v[144:147], v140, s[72:75], s8 offen offset:3072
  v_mfma_f32_16x16x32_bf16 v[44:47], a[44:47], v[200:203], v[44:47]
  ds_read_b64_tr_b16 v[200:201], v240 offset:36864
  ds_read_b64_tr_b16 v[202:203], v240 offset:37120
  s_waitcnt lgkmcnt(14)
  v_mfma_f32_16x16x32_bf16 v[48:51], a[32:35], v[204:207], v[48:51]
  s_getpc_b64 s[76:77]
  K1n_V10: s_add_u32 s76, s76, k2_kernel-K1n_V10
  s_addc_u32 s77, s77, 0
  v_mfma_f32_16x16x32_bf16 v[52:55], a[36:39], v[204:207], v[52:55]
  v_mfma_f32_16x16x32_bf16 v[56:59], a[40:43], v[204:207], v[56:59]
  s_lshl_b32 s8, s2, 2
  v_mfma_f32_16x16x32_bf16 v[60:63], a[44:47], v[204:207], v[60:63]
  ds_read_b64_tr_b16 v[204:205], v241 offset:36864
  ds_read_b64_tr_b16 v[206:207], v241 offset:37120
  s_waitcnt lgkmcnt(14)
  v_mfma_f32_16x16x32_bf16 v[0:3], a[48:51], v[208:211], v[0:3]
  s_add_u32 s8, s8, s3
  v_mfma_f32_16x16x32_bf16 v[4:7], a[52:55], v[208:211], v[4:7]
  v_mfma_f32_16x16x32_bf16 v[8:11], a[56:59], v[208:211], v[8:11]
  s_lshl_b32 s8, s8, 10
  v_mfma_f32_16x16x32_bf16 v[12:15], a[60:63], v[208:211], v[12:15]
  ds_read_b64_tr_b16 v[208:209], v240 offset:34816
  ds_read_b64_tr_b16 v[210:211], v240 offset:35072
  s_waitcnt lgkmcnt(14)
  v_mfma_f32_16x16x32_bf16 v[16:19], a[48:51], v[212:215], v[16:19]
  v_mfma_f32_16x16x32_bf16 v[20:23], a[52:55], v[212:215], v[20:23]
  v_add_u32 v142, s8, v140
  v_mfma_f32_16x16x32_bf16 v[24:27], a[56:59], v[212:215], v[24:27]
  v_mfma_f32_16x16x32_bf16 v[28:31], a[60:63], v[212:215], v[28:31]
  ds_read_b64_tr_b16 v[212:213], v241 offset:34816
  ds_read_b64_tr_b16 v[214:215], v241 offset:35072
  s_waitcnt lgkmcnt(14)
  v_mfma_f32_16x16x32_bf16 v[32:35], a[48:51], v[216:219], v[32:35]
  v_min_u32 v142, K3e-k2_kernel-16, v142
  v_mfma_f32_16x16x32_bf16 v[36:39], a[52:55], v[216:219], v[36:39]
  global_load_dwordx4 v[144:147], v142, s[76:77]
  v_mfma_f32_16x16x32_bf16 v[40:43], a[56:59], v[216:219], v[40:43]
  v_mfma_f32_16x16x32_bf16 v[44:47], a[60:63], v[216:219], v[44:47]
  ds_read_b64_tr_b16 v[216:217], v240 offset:38912
  ds_read_b64_tr_b16 v[218:219], v240 offset:39168
  s_waitcnt lgkmcnt(14)
  v_mfma_f32_16x16x32_bf16 v[48:51], a[48:51], v[220:223], v[48:51]
  v_cvt_pk_bf16_f32 v224, v64, v65
  v_mfma_f32_16x16x32_bf16 v[52:55], a[52:55], v[220:223], v[52:55]
  v_mfma_f32_16x16x32_bf16 v[56:59], a[56:59], v[220:223], v[56:59]
  v_cvt_pk_bf16_f32 v225, v66, v67
  v_mfma_f32_16x16x32_bf16 v[60:63], a[60:63], v[220:223], v[60:63]
  ds_read_b64_tr_b16 v[220:221], v241 offset:38912
  ds_read_b64_tr_b16 v[222:223], v241 offset:39168
  s_waitcnt vmcnt(13)
  s_barrier
  s_waitcnt lgkmcnt(14)
  v_mfma_f32_16x16x32_bf16 v[0:3], a[64:67], v[192:195], v[0:3]
  v_cvt_pk_bf16_f32 v226, v68, v69
  v_mfma_f32_16x16x32_bf16 v[4:7], a[68:71], v[192:195], v[4:7]
  v_mfma_f32_16x16x32_bf16 v[8:11], a[72:75], v[192:195], v[8:11]
  v_mfma_f32_16x16x32_bf16 v[12:15], a[76:79], v[192:195], v[12:15]
  ds_read_b64_tr_b16 v[192:193], v240 offset:40960
  ds_read_b64_tr_b16 v[194:195], v240 offset:41216
  s_waitcnt lgkmcnt(14)
  v_mfma_f32_16x16x32_bf16 v[16:19], a[64:67], v[196:199], v[16:19]
  v_cvt_pk_bf16_f32 v227, v70, v71
  v_mfma_f32_16x16x32_bf16 v[20:23], a[68:71], v[196:199], v[20:23]
  buffer_store_dwordx4 v[224:227], v128, s[64:67], s90 offen offset:0 sc1
  v_mfma_f32_16x16x32_bf16 v[24:27], a[72:75], v[196:199], v[24:27]
  v_mfma_f32_16x16x32_bf16 v[28:31], a[76:79], v[196:199], v[28:31]
  ds_read_b64_tr_b16 v[196:197], v241 offset:40960
  ds_read_b64_tr_b16 v[198:199], v241 offset:41216
  s_waitcnt lgkmcnt(14)
  v_mfma_f32_16x16x32_bf16 v[32:35], a[64:67], v[200:203], v[32:35]
  v_cvt_pk_bf16_f32 v228, v80, v81
  v_mfma_f32_16x16x32_bf16 v[36:39], a[68:71], v[200:203], v[36:39]
  v_mfma_f32_16x16x32_bf16 v[40:43], a[72:75], v[200:203], v[40:43]
  v_cvt_pk_bf16_f32 v229, v82, v83
  v_mfma_f32_16x16x32_bf16 v[44:47], a[76:79], v[200:203], v[44:47]
  ds_read_b64_tr_b16 v[200:201], v240 offset:45056
  ds_read_b64_tr_b16 v[202:203], v240 offset:45312
  s_waitcnt lgkmcnt(14)
  v_mfma_f32_16x16x32_bf16 v[48:51], a[64:67], v[204:207], v[48:51]
  v_mfma_f32_16x16x32_bf16 v[52:55], a[68:71], v[204:207], v[52:55]
  v_cvt_pk_bf16_f32 v230, v84, v85
  v_mfma_f32_16x16x32_bf16 v[56:59], a[72:75], v[204:207], v[56:59]
  v_mfma_f32_16x16x32_bf16 v[60:63], a[76:79], v[204:207], v[60:63]
  ds_read_b64_tr_b16 v[204:205], v241 offset:45056
  ds_read_b64_tr_b16 v[206:207], v241 offset:45312
  s_waitcnt lgkmcnt(14)
  v_mfma_f32_16x16x32_bf16 v[0:3], a[80:83], v[208:211], v[0:3]
  v_cvt_pk_bf16_f32 v231, v86, v87
  v_mfma_f32_16x16x32_bf16 v[4:7], a[84:87], v[208:211], v[4:7]
  v_mfma_f32_16x16x32_bf16 v[8:11], a[88:91], v[208:211], v[8:11]
  buffer_store_dwordx4 v[228:231], v128, s[64:67], s90 offen offset:1024 sc1
  v_mfma_f32_16x16x32_bf16 v[12:15], a[92:95], v[208:211], v[12:15]
  ds_read_b64_tr_b16 v[208:209], v240 offset:43008
  ds_read_b64_tr_b16 v[210:211], v240 offset:43264
  s_waitcnt lgkmcnt(14)
  v_mfma_f32_16x16x32_bf16 v[16:19], a[80:83], v[212:215], v[16:19]
  v_mfma_f32_16x16x32_bf16 v[20:23], a[84:87], v[212:215], v[20:23]
  v_cvt_pk_bf16_f32 v232, v72, v73
  v_mfma_f32_16x16x32_bf16 v[24:27], a[88:91], v[212:215], v[24:27]
  v_mfma_f32_16x16x32_bf16 v[28:31], a[92:95], v[212:215], v[28:31]
  ds_read_b64_tr_b16 v[212:213], v241 offset:43008
  ds_read_b64_tr_b16 v[214:215], v241 offset:43264
  s_waitcnt lgkmcnt(14)
  v_mfma_f32_16x16x32_bf16 v[32:35], a[80:83], v[216:219], v[32:35]
  v_cvt_pk_bf16_f32 v233, v74, v75
  v_mfma_f32_16x16x32_bf16 v[36:39], a[84:87], v[216:219], v[36:39]
  v_mfma_f32_16x16x32_bf16 v[40:43], a[88:91], v[216:219], v[40:43]
  v_cvt_pk_bf16_f32 v234, v76, v77
  v_mfma_f32_16x16x32_bf16 v[44:47], a[92:95], v[216:219], v[44:47]
  ds_read_b64_tr_b16 v[216:217], v240 offset:47104
  ds_read_b64_tr_b16 v[218:219], v240 offset:47360
  s_waitcnt lgkmcnt(14)
  v_mfma_f32_16x16x32_bf16 v[48:51], a[80:83], v[220:223], v[48:51]
  v_mfma_f32_16x16x32_bf16 v[52:55], a[84:87], v[220:223], v[52:55]
  v_cvt_pk_bf16_f32 v235, v78, v79
  v_mfma_f32_16x16x32_bf16 v[56:59], a[88:91], v[220:223], v[56:59]
  v_mfma_f32_16x16x32_bf16 v[60:63], a[92:95], v[220:223], v[60:63]
  ds_read_b64_tr_b16 v[220:221], v241 offset:47104
  ds_read_b64_tr_b16 v[222:223], v241 offset:47360
  s_waitcnt lgkmcnt(14)
  v_mfma_f32_16x16x32_bf16 v[0:3], a[96:99], v[192:195], v[0:3]
  buffer_store_dwordx4 v[232:235], v130, s[64:67], s90 offen offset:0 sc1
  v_mfma_f32_16x16x32_bf16 v[4:7], a[100:103], v[192:195], v[4:7]
  v_mfma_f32_16x16x32_bf16 v[8:11], a[104:107], v[192:195], v[8:11]
  v_mfma_f32_16x16x32_bf16 v[12:15], a[108:111], v[192:195], v[12:15]
  ds_read_b64_tr_b16 v[192:193], v240 offset:49152
  ds_read_b64_tr_b16 v[194:195], v240 offset:49408
  s_waitcnt lgkmcnt(14)
  v_mfma_f32_16x16x32_bf16 v[16:19], a[96:99], v[196:199], v[16:19]
  v_cvt_pk_bf16_f32 v224, v88, v89
  v_mfma_f32_16x16x32_bf16 v[20:23], a[100:103], v[196:199], v[20:23]
  v_mfma_f32_16x16x32_bf16 v[24:27], a[104:107], v[196:199], v[24:27]
  v_cvt_pk_bf16_f32 v225, v90, v91
  v_mfma_f32_16x16x32_bf16 v[28:31], a[108:111], v[196:199], v[28:31]
  ds_read_b64_tr_b16 v[196:197], v241 offset:49152
  ds_read_b64_tr_b16 v[198:199], v241 offset:49408
  s_waitcnt lgkmcnt(14)
  v_mfma_f32_16x16x32_bf16 v[32:35], a[96:99], v[200:203], v[32:35]
  v_mfma_f32_16x16x32_bf16 v[36:39], a[100:103], v[200:203], v[36:39]
  v_cvt_pk_bf16_f32 v226, v92, v93
  v_mfma_f32_16x16x32_bf16 v[40:43], a[104:107], v[200:203], v[40:43]
  v_mfma_f32_16x16x32_bf16 v[44:47], a[108:111], v[200:203], v[44:47]
  ds_read_b64_tr_b16 v[200:201], v240 offset:53248
  ds_read_b64_tr_b16 v[202:203], v240 offset:53504
  s_waitcnt lgkmcnt(14)
  v_mfma_f32_16x16x32_bf16 v[48:51], a[96:99], v[204:207], v[48:51]
  v_cvt_pk_bf16_f32 v227, v94, v95
  v_mfma_f32_16x16x32_bf16 v[52:55], a[100:103], v[204:207], v[52:55]
  v_mfma_f32_16x16x32_bf16 v[56:59], a[104:107], v[204:207], v[56:59]
  v_mfma_f32_16x16x32_bf16 v[60:63], a[108:111], v[204:207], v[60:63]
  ds_read_b64_tr_b16 v[204:205], v241 offset:53248
  ds_read_b64_tr_b16 v[206:207], v241 offset:53504
  s_waitcnt lgkmcnt(14)
  v_mfma_f32_16x16x32_bf16 v[0:3], a[112:115], v[208:211], v[0:3]
  buffer_store_dwordx4 v[224:227], v130, s[64:67], s90 offen offset:1024 sc1
  v_mfma_f32_16x16x32_bf16 v[4:7], a[116:119], v[208:211], v[4:7]
  v_mfma_f32_16x16x32_bf16 v[8:11], a[120:123], v[208:211], v[8:11]
  v_mfma_f32_16x16x32_bf16 v[12:15], a[124:127], v[208:211], v[12:15]
  ds_read_b64_tr_b16 v[208:209], v240 offset:51200
  ds_read_b64_tr_b16 v[210:211], v240 offset:51456
  s_waitcnt lgkmcnt(14)
  v_mfma_f32_16x16x32_bf16 v[16:19], a[112:115], v[212:215], v[16:19]
  v_cvt_pk_bf16_f32 v228, v96, v97
  v_mfma_f32_16x16x32_bf16 v[20:23], a[116:119], v[212:215], v[20:23]
  v_mfma_f32_16x16x32_bf16 v[24:27], a[120:123], v[212:215], v[24:27]
  v_cvt_pk_bf16_f32 v229, v98, v99
  v_mfma_f32_16x16x32_bf16 v[28:31], a[124:127], v[212:215], v[28:31]
  ds_read_b64_tr_b16 v[212:213], v241 offset:51200
  ds_read_b64_tr_b16 v[214:215], v241 offset:51456
  s_waitcnt lgkmcnt(14)
  v_mfma_f32_16x16x32_bf16 v[32:35], a[112:115], v[216:219], v[32:35]
  v_mfma_f32_16x16x32_bf16 v[36:39], a[116:119], v[216:219], v[36:39]
  v_mfma_f32_16x16x32_bf16 v[40:43], a[120:123], v[216:219], v[40:43]
  v_cvt_pk_bf16_f32 v230, v100, v101
  v_mfma_f32_16x16x32_bf16 v[44:47], a[124:127], v[216:219], v[44:47]
  ds_read_b64_tr_b16 v[216:217], v240 offset:55296
  ds_read_b64_tr_b16 v[218:219], v240 offset:55552
  s_waitcnt lgkmcnt(14)
  v_mfma_f32_16x16x32_bf16 v[48:51], a[112:115], v[220:223], v[48:51]
  v_mfma_f32_16x16x32_bf16 v[52:55], a[116:119], v[220:223], v[52:55]
  v_cvt_pk_bf16_f32 v231, v102, v103
  v_mfma_f32_16x16x32_bf16 v[56:59], a[120:123], v[220:223], v[56:59]
  v_mfma_f32_16x16x32_bf16 v[60:63], a[124:127], v[220:223], v[60:63]
  ds_read_b64_tr_b16 v[220:221], v241 offset:55296
  ds_read_b64_tr_b16 v[222:223], v241 offset:55552
  s_waitcnt vmcnt(12)
  s_barrier
  s_waitcnt lgkmcnt(14)
  v_mfma_f32_16x16x32_bf16 v[0:3], a[128:131], v[192:195], v[0:3]
  v_mfma_f32_16x16x32_bf16 v[4:7], a[132:135], v[192:195], v[4:7]
  buffer_store_dwordx4 v[228:231], v128, s[64:67], s91 offen offset:0 sc1
  v_mfma_f32_16x16x32_bf16 v[8:11], a[136:139], v[192:195], v[8:11]
  v_mfma_f32_16x16x32_bf16 v[12:15], a[140:143], v[192:195], v[12:15]
  ds_read_b64_tr_b16 v[192:193], v240 offset:57344
  ds_read_b64_tr_b16 v[194:195], v240 offset:57600
  s_waitcnt lgkmcnt(14)
  v_mfma_f32_16x16x32_bf16 v[16:19], a[128:131], v[196:199], v[16:19]
  v_mfma_f32_16x16x32_bf16 v[20:23], a[132:135], v[196:199], v[20:23]
  v_cvt_pk_bf16_f32 v232, v112, v113
  v_mfma_f32_16x16x32_bf16 v[24:27], a[136:139], v[196:199], v[24:27]
  v_mfma_f32_16x16x32_bf16 v[28:31], a[140:143], v[196:199], v[28:31]
  ds_read_b64_tr_b16 v[196:197], v241 offset:57344
  ds_read_b64_tr_b16 v[198:199], v241 offset:57600
  s_waitcnt lgkmcnt(14)
  v_mfma_f32_16x16x32_bf16 v[32:35], a[128:131], v[200:203], v[32:35]
  v_mfma_f32_16x16x32_bf16 v[36:39], a[132:135], v[200:203], v[36:39]
  v_cvt_pk_bf16_f32 v233, v114, v115
  v_mfma_f32_16x16x32_bf16 v[40:43], a[136:139], v[200:203], v[40:43]
  v_mfma_f32_16x16x32_bf16 v[44:47], a[140:143], v[200:203], v[44:47]
  ds_read_b64_tr_b16 v[200:201], v240 offset:61440
  ds_read_b64_tr_b16 v[202:203], v240 offset:61696
  s_waitcnt lgkmcnt(14)
  v_mfma_f32_16x16x32_bf16 v[48:51], a[128:131], v[204:207], v[48:51]
  v_mfma_f32_16x16x32_bf16 v[52:55], a[132:135], v[204:207], v[52:55]
  v_cvt_pk_bf16_f32 v234, v116, v117
  v_mfma_f32_16x16x32_bf16 v[56:59], a[136:139], v[204:207], v[56:59]
  v_mfma_f32_16x16x32_bf16 v[60:63], a[140:143], v[204:207], v[60:63]
  ds_read_b64_tr_b16 v[204:205], v241 offset:61440
  ds_read_b64_tr_b16 v[206:207], v241 offset:61696
  s_waitcnt lgkmcnt(14)
  v_mfma_f32_16x16x32_bf16 v[0:3], a[144:147], v[208:211], v[0:3]
  v_mfma_f32_16x16x32_bf16 v[4:7], a[148:151], v[208:211], v[4:7]
  v_cvt_pk_bf16_f32 v235, v118, v119
  v_mfma_f32_16x16x32_bf16 v[8:11], a[152:155], v[208:211], v[8:11]
  v_mfma_f32_16x16x32_bf16 v[12:15], a[156:159], v[208:211], v[12:15]
  ds_read_b64_tr_b16 v[208:209], v240 offset:59392
  ds_read_b64_tr_b16 v[210:211], v240 offset:59648
  s_waitcnt lgkmcnt(14)
  v_mfma_f32_16x16x32_bf16 v[16:19], a[144:147], v[212:215], v[16:19]
  v_mfma_f32_16x16x32_bf16 v[20:23], a[148:151], v[212:215], v[20:23]
  v_mfma_f32_16x16x32_bf16 v[24:27], a[152:155], v[212:215], v[24:27]
  buffer_store_dwordx4 v[232:235], v128, s[64:67], s91 offen offset:1024 sc1
  v_mfma_f32_16x16x32_bf16 v[28:31], a[156:159], v[212:215], v[28:31]
  ds_read_b64_tr_b16 v[212:213], v241 offset:59392
  ds_read_b64_tr_b16 v[214:215], v241 offset:59648
  s_waitcnt lgkmcnt(14)
  v_mfma_f32_16x16x32_bf16 v[32:35], a[144:147], v[216:219], v[32:35]
  v_mfma_f32_16x16x32_bf16 v[36:39], a[148:151], v[216:219], v[36:39]
  v_mfma_f32_16x16x32_bf16 v[40:43], a[152:155], v[216:219], v[40:43]
  v_cvt_pk_bf16_f32 v224, v104, v105
  v_mfma_f32_16x16x32_bf16 v[44:47], a[156:159], v[216:219], v[44:47]
  ds_read_b64_tr_b16 v[216:217], v240 offset:63488
  ds_read_b64_tr_b16 v[218:219], v240 offset:63744
  s_waitcnt lgkmcnt(14)
  v_mfma_f32_16x16x32_bf16 v[48:51], a[144:147], v[220:223], v[48:51]
  v_mfma_f32_16x16x32_bf16 v[52:55], a[148:151], v[220:223], v[52:55]
  v_mfma_f32_16x16x32_bf16 v[56:59], a[152:155], v[220:223], v[56:59]
  v_mfma_f32_16x16x32_bf16 v[60:63], a[156:159], v[220:223], v[60:63]
  ds_read_b64_tr_b16 v[220:221], v241 offset:63488
  ds_read_b64_tr_b16 v[222:223], v241 offset:63744
  s_waitcnt lgkmcnt(14)
  v_mfma_f32_16x16x32_bf16 v[0:3], a[160:163], v[192:195], v[0:3]
  v_cvt_pk_bf16_f32 v225, v106, v107
  v_mfma_f32_16x16x32_bf16 v[4:7], a[164:167], v[192:195], v[4:7]
  v_mfma_f32_16x16x32_bf16 v[8:11], a[168:171], v[192:195], v[8:11]
  v_mfma_f32_16x16x32_bf16 v[12:15], a[172:175], v[192:195], v[12:15]
  ds_read_b64_tr_b16 v[192:193], v242 offset:0
  ds_read_b64_tr_b16 v[194:195], v242 offset:256
  s_waitcnt lgkmcnt(14)
  v_mfma_f32_16x16x32_bf16 v[16:19], a[160:163], v[196:199], v[16:19]
  v_mfma_f32_16x16x32_bf16 v[20:23], a[164:167], v[196:199], v[20:23]
  v_cvt_pk_bf16_f32 v226, v108, v109
  v_mfma_f32_16x16x32_bf16 v[24:27], a[168:171], v[196:199], v[24:27]
  v_mfma_f32_16x16x32_bf16 v[28:31], a[172:175], v[196:199], v[28:31]
  ds_read_b64_tr_b16 v[196:197], v243 offset:0
  ds_read_b64_tr_b16 v[198:199], v243 offset:256
  s_waitcnt lgkmcnt(14)
  v_mfma_f32_16x16x32_bf16 v[32:35], a[160:163], v[200:203], v[32:35]
  v_mfma_f32_16x16x32_bf16 v[36:39], a[164:167], v[200:203], v[36:39]
  v_mfma_f32_16x16x32_bf16 v[40:43], a[168:171], v[200:203], v[40:43]
  v_cvt_pk_bf16_f32 v227, v110, v111
  v_mfma_f32_16x16x32_bf16 v[44:47], a[172:175], v[200:203], v[44:47]
  ds_read_b64_tr_b16 v[200:201], v242 offset:4096
  ds_read_b64_tr_b16 v[202:203], v242 offset:4352
  s_waitcnt lgkmcnt(14)
  v_mfma_f32_16x16x32_bf16 v[48:51], a[160:163], v[204:207], v[48:51]
  v_mfma_f32_16x16x32_bf16 v[52:55], a[164:167], v[204:207], v[52:55]
  v_mfma_f32_16x16x32_bf16 v[56:59], a[168:171], v[204:207], v[56:59]
  v_mfma_f32_16x16x32_bf16 v[60:63], a[172:175], v[204:207], v[60:63]
  ds_read_b64_tr_b16 v[204:205], v243 offset:4096
  ds_read_b64_tr_b16 v[206:207], v243 offset:4352
  s_waitcnt lgkmcnt(14)
  v_mfma_f32_16x16x32_bf16 v[0:3], a[176:179], v[208:211], v[0:3]
  buffer_store_dwordx4 v[224:227], v130, s[64:67], s91 offen offset:0 sc1
  v_mfma_f32_16x16x32_bf16 v[4:7], a[180:183], v[208:211], v[4:7]
  v_mfma_f32_16x16x32_bf16 v[8:11], a[184:187], v[208:211], v[8:11]
  v_mfma_f32_16x16x32_bf16 v[12:15], a[188:191], v[208:211], v[12:15]
  ds_read_b64_tr_b16 v[208:209], v242 offset:2048
  ds_read_b64_tr_b16 v[210:211], v242 offset:2304
  s_waitcnt lgkmcnt(14)
  v_mfma_f32_16x16x32_bf16 v[16:19], a[176:179], v[212:215], v[16:19]
  v_mfma_f32_16x16x32_bf16 v[20:23], a[180:183], v[212:215], v[20:23]
  v_mfma_f32_16x16x32_bf16 v[24:27], a[184:187], v[212:215], v[24:27]
  v_mfma_f32_16x16x32_bf16 v[28:31], a[188:191], v[212:215], v[28:31]
  ds_read_b64_tr_b16 v[212:213], v243 offset:2048
  ds_read_b64_tr_b16 v[214:215], v243 offset:2304
  s_waitcnt lgkmcnt(14)
  v_mfma_f32_16x16x32_bf16 v[32:35], a[176:179], v[216:219], v[32:35]
  v_cvt_pk_bf16_f32 v228, v120, v121
  v_mfma_f32_16x16x32_bf16 v[36:39], a[180:183], v[216:219], v[36:39]
  v_mfma_f32_16x16x32_bf16 v[40:43], a[184:187], v[216:219], v[40:43]
  v_mfma_f32_16x16x32_bf16 v[44:47], a[188:191], v[216:219], v[44:47]
  ds_read_b64_tr_b16 v[216:217], v242 offset:6144
  ds_read_b64_tr_b16 v[218:219], v242 offset:6400
  s_waitcnt lgkmcnt(14)
  v_mfma_f32_16x16x32_bf16 v[48:51], a[176:179], v[220:223], v[48:51]
  v_mfma_f32_16x16x32_bf16 v[52:55], a[180:183], v[220:223], v[52:55]
  v_mfma_f32_16x16x32_bf16 v[56:59], a[184:187], v[220:223], v[56:59]
  v_cvt_pk_bf16_f32 v229, v122, v123
  v_mfma_f32_16x16x32_bf16 v[60:63], a[188:191], v[220:223], v[60:63]
  ds_read_b64_tr_b16 v[220:221], v243 offset:6144
  ds_read_b64_tr_b16 v[222:223], v243 offset:6400
  s_barrier
  s_waitcnt lgkmcnt(14)
  v_mfma_f32_16x16x32_bf16 v[0:3], a[192:195], v[192:195], v[0:3]
  v_mfma_f32_16x16x32_bf16 v[4:7], a[196:199], v[192:195], v[4:7]
  v_mfma_f32_16x16x32_bf16 v[8:11], a[200:203], v[192:195], v[8:11]
  v_mfma_f32_16x16x32_bf16 v[12:15], a[204:207], v[192:195], v[12:15]
  ds_read_b64_tr_b16 v[192:193], v242 offset:8192
  ds_read_b64_tr_b16 v[194:195], v242 offset:8448
  s_waitcnt lgkmcnt(14)
  v_mfma_f32_16x16x32_bf16 v[16:19], a[192:195], v[196:199], v[16:19]
  v_mfma_f32_16x16x32_bf16 v[20:23], a[196:199], v[196:199], v[20:23]
  v_mfma_f32_16x16x32_bf16 v[24:27], a[200:203], v[196:199], v[24:27]
  v_mfma_f32_16x16x32_bf16 v[28:31], a[204:207], v[196:199], v[28:31]
  ds_read_b64_tr_b16 v[196:197], v243 offset:8192
  ds_read_b64_tr_b16 v[198:199], v243 offset:8448
  s_waitcnt lgkmcnt(14)
  v_mfma_f32_16x16x32_bf16 v[32:35], a[192:195], v[200:203], v[32:35]
  v_cvt_pk_bf16_f32 v230, v124, v125
  v_mfma_f32_16x16x32_bf16 v[36:39], a[196:199], v[200:203], v[36:39]
  v_mfma_f32_16x16x32_bf16 v[40:43], a[200:203], v[200:203], v[40:43]
  v_mfma_f32_16x16x32_bf16 v[44:47], a[204:207], v[200:203], v[44:47]
  ds_read_b64_tr_b16 v[200:201], v242 offset:12288
  ds_read_b64_tr_b16 v[202:203], v242 offset:12544
  s_waitcnt lgkmcnt(14)
  v_mfma_f32_16x16x32_bf16 v[48:51], a[192:195], v[204:207], v[48:51]
  v_mfma_f32_16x16x32_bf16 v[52:55], a[196:199], v[204:207], v[52:55]
  v_mfma_f32_16x16x32_bf16 v[56:59], a[200:203], v[204:207], v[56:59]
  v_mfma_f32_16x16x32_bf16 v[60:63], a[204:207], v[204:207], v[60:63]
  ds_read_b64_tr_b16 v[204:205], v243 offset:12288
  ds_read_b64_tr_b16 v[206:207], v243 offset:12544
  s_waitcnt lgkmcnt(14)
  v_mfma_f32_16x16x32_bf16 v[0:3], a[208:211], v[208:211], v[0:3]
  v_mfma_f32_16x16x32_bf16 v[4:7], a[212:215], v[208:211], v[4:7]
  v_cvt_pk_bf16_f32 v231, v126, v127
  v_mfma_f32_16x16x32_bf16 v[8:11], a[216:219], v[208:211], v[8:11]
  v_mfma_f32_16x16x32_bf16 v[12:15], a[220:223], v[208:211], v[12:15]
  ds_read_b64_tr_b16 v[208:209], v242 offset:10240
  ds_read_b64_tr_b16 v[210:211], v242 offset:10496
  s_waitcnt lgkmcnt(14)
  v_mfma_f32_16x16x32_bf16 v[16:19], a[208:211], v[212:215], v[16:19]
  v_mfma_f32_16x16x32_bf16 v[20:23], a[212:215], v[212:215], v[20:23]
  v_mfma_f32_16x16x32_bf16 v[24:27], a[216:219], v[212:215], v[24:27]
  v_mfma_f32_16x16x32_bf16 v[28:31], a[220:223], v[212:215], v[28:31]
  ds_read_b64_tr_b16 v[212:213], v243 offset:10240
  ds_read_b64_tr_b16 v[214:215], v243 offset:10496
  s_waitcnt lgkmcnt(14)
  v_mfma_f32_16x16x32_bf16 v[32:35], a[208:211], v[216:219], v[32:35]
  v_mfma_f32_16x16x32_bf16 v[36:39], a[212:215], v[216:219], v[36:39]
  v_mfma_f32_16x16x32_bf16 v[40:43], a[216:219], v[216:219], v[40:43]
  v_mfma_f32_16x16x32_bf16 v[44:47], a[220:223], v[216:219], v[44:47]
  ds_read_b64_tr_b16 v[216:217], v242 offset:14336
  ds_read_b64_tr_b16 v[218:219], v242 offset:14592
  s_waitcnt lgkmcnt(14)
  v_mfma_f32_16x16x32_bf16 v[48:51], a[208:211], v[220:223], v[48:51]
  v_mfma_f32_16x16x32_bf16 v[52:55], a[212:215], v[220:223], v[52:55]
  v_mfma_f32_16x16x32_bf16 v[56:59], a[216:219], v[220:223], v[56:59]
  v_mfma_f32_16x16x32_bf16 v[60:63], a[220:223], v[220:223], v[60:63]
  ds_read_b64_tr_b16 v[220:221], v243 offset:14336
  ds_read_b64_tr_b16 v[222:223], v243 offset:14592
  s_waitcnt lgkmcnt(14)
  v_mfma_f32_16x16x32_bf16 v[0:3], a[224:227], v[192:195], v[0:3]
  buffer_store_dwordx4 v[228:231], v130, s[64:67], s91 offen offset:1024 sc1
  v_mfma_f32_16x16x32_bf16 v[4:7], a[228:231], v[192:195], v[4:7]
  v_mfma_f32_16x16x32_bf16 v[8:11], a[232:235], v[192:195], v[8:11]
  v_mfma_f32_16x16x32_bf16 v[12:15], a[236:239], v[192:195], v[12:15]
  s_waitcnt lgkmcnt(12)
  v_mfma_f32_16x16x32_bf16 v[16:19], a[224:227], v[196:199], v[16:19]
  v_mfma_f32_16x16x32_bf16 v[20:23], a[228:231], v[196:199], v[20:23]
  v_mfma_f32_16x16x32_bf16 v[24:27], a[232:235], v[196:199], v[24:27]
  v_mfma_f32_16x16x32_bf16 v[28:31], a[236:239], v[196:199], v[28:31]
  s_waitcnt lgkmcnt(10)
  v_mfma_f32_16x16x32_bf16 v[32:35], a[224:227], v[200:203], v[32:35]
  v_mfma_f32_16x16x32_bf16 v[36:39], a[228:231], v[200:203], v[36:39]
  v_mfma_f32_16x16x32_bf16 v[40:43], a[232:235], v[200:203], v[40:43]
  v_mfma_f32_16x16x32_bf16 v[44:47], a[236:239], v[200:203], v[44:47]
  s_waitcnt lgkmcnt(8)
  v_mfma_f32_16x16x32_bf16 v[48:51], a[224:227], v[204:207], v[48:51]
  v_mfma_f32_16x16x32_bf16 v[52:55], a[228:231], v[204:207], v[52:55]
  v_mfma_f32_16x16x32_bf16 v[56:59], a[232:235], v[204:207], v[56:59]
  v_mfma_f32_16x16x32_bf16 v[60:63], a[236:239], v[204:207], v[60:63]
  s_waitcnt lgkmcnt(6)
  v_mfma_f32_16x16x32_bf16 v[0:3], a[240:243], v[208:211], v[0:3]
  v_mfma_f32_16x16x32_bf16 v[4:7], a[244:247], v[208:211], v[4:7]
  v_mfma_f32_16x16x32_bf16 v[8:11], a[248:251], v[208:211], v[8:11]
  v_mfma_f32_16x16x32_bf16 v[12:15], a[252:255], v[208:211], v[12:15]
  s_waitcnt lgkmcnt(4)
  v_mfma_f32_16x16x32_bf16 v[16:19], a[240:243], v[212:215], v[16:19]
  v_mfma_f32_16x16x32_bf16 v[20:23], a[244:247], v[212:215], v[20:23]
  v_mfma_f32_16x16x32_bf16 v[24:27], a[248:251], v[212:215], v[24:27]
  v_mfma_f32_16x16x32_bf16 v[28:31], a[252:255], v[212:215], v[28:31]
  s_waitcnt lgkmcnt(2)
  v_mfma_f32_16x16x32_bf16 v[32:35], a[240:243], v[216:219], v[32:35]
  v_mfma_f32_16x16x32_bf16 v[36:39], a[244:247], v[216:219], v[36:39]
  v_mfma_f32_16x16x32_bf16 v[40:43], a[248:251], v[216:219], v[40:43]
  v_mfma_f32_16x16x32_bf16 v[44:47], a[252:255], v[216:219], v[44:47]
  s_waitcnt lgkmcnt(0)
  v_mfma_f32_16x16x32_bf16 v[48:51], a[240:243], v[220:223], v[48:51]
  v_mfma_f32_16x16x32_bf16 v[52:55], a[244:247], v[220:223], v[52:55]
  v_mfma_f32_16x16x32_bf16 v[56:59], a[248:251], v[220:223], v[56:59]
  v_mfma_f32_16x16x32_bf16 v[60:63], a[252:255], v[220:223], v[60:63]
  s_nop 15
  v_cvt_pk_bf16_f32 v232, v0, v1
  v_cvt_pk_bf16_f32 v233, v2, v3
  v_cvt_pk_bf16_f32 v234, v4, v5
  v_cvt_pk_bf16_f32 v235, v6, v7
  buffer_store_dwordx4 v[232:235], v128, s[64:67], s92 offen offset:0 sc1
  v_cvt_pk_bf16_f32 v224, v16, v17
  v_cvt_pk_bf16_f32 v225, v18, v19
  v_cvt_pk_bf16_f32 v226, v20, v21
  v_cvt_pk_bf16_f32 v227, v22, v23
  buffer_store_dwordx4 v[224:227], v128, s[64:67], s92 offen offset:1024 sc1
  v_cvt_pk_bf16_f32 v228, v8, v9
  v_cvt_pk_bf16_f32 v229, v10, v11
  v_cvt_pk_bf16_f32 v230, v12, v13
  v_cvt_pk_bf16_f32 v231, v14, v15
  buffer_store_dwordx4 v[228:231], v130, s[64:67], s92 offen offset:0 sc1
  v_cvt_pk_bf16_f32 v232, v24, v25
  v_cvt_pk_bf16_f32 v233, v26, v27
  v_cvt_pk_bf16_f32 v234, v28, v29
  v_cvt_pk_bf16_f32 v235, v30, v31
  buffer_store_dwordx4 v[232:235], v130, s[64:67], s92 offen offset:1024 sc1
  v_cvt_pk_bf16_f32 v224, v32, v33
  v_cvt_pk_bf16_f32 v225, v34, v35
  v_cvt_pk_bf16_f32 v226, v36, v37
  v_cvt_pk_bf16_f32 v227, v38, v39
  buffer_store_dwordx4 v[224:227], v128, s[64:67], s93 offen offset:0 sc1
  v_cvt_pk_bf16_f32 v228, v48, v49
  v_cvt_pk_bf16_f32 v229, v50, v51
  v_cvt_pk_bf16_f32 v230, v52, v53
  v_cvt_pk_bf16_f32 v231, v54, v55
  buffer_store_dwordx4 v[228:231], v128, s[64:67], s93 offen offset:1024 sc1
  v_cvt_pk_bf16_f32 v232, v40, v41
  v_cvt_pk_bf16_f32 v233, v42, v43
  v_cvt_pk_bf16_f32 v234, v44, v45
  v_cvt_pk_bf16_f32 v235, v46, v47
  buffer_store_dwordx4 v[232:235], v130, s[64:67], s93 offen offset:0 sc1
  v_cvt_pk_bf16_f32 v224, v56, v57
  v_cvt_pk_bf16_f32 v225, v58, v59
  v_cvt_pk_bf16_f32 v226, v60, v61
  v_cvt_pk_bf16_f32 v227, v62, v63
  buffer_store_dwordx4 v[224:227], v130, s[64:67], s93 offen offset:1024 sc1
  s_endpgm
K1e_V10:
K1_S6:
  v_and_b32 v239, 63, v0
  v_lshlrev_b32 v140, 4, v239
  s_getpc_b64 s[76:77]
K1c_S6:
  s_lshl_b32 s78, s3, 10
  v_add_u32 v142, s78, v140
  v_min_u32 v143, K1e_S6-K1c_S6-16, v142
  global_load_dwordx4 v[144:147], v143, s[76:77]
  v_add_u32 v142, 4096, v142
  v_min_u32 v143, K1e_S6-K1c_S6-16, v142
  global_load_dwordx4 v[144:147], v143, s[76:77]
  v_add_u32 v142, 4096, v142
  v_min_u32 v143, K1e_S6-K1c_S6-16, v142
  global_load_dwordx4 v[144:147], v143, s[76:77]
  v_add_u32 v142, 4096, v142
  v_min_u32 v143, K1e_S6-K1c_S6-16, v142
  global_load_dwordx4 v[144:147], v143, s[76:77]
  v_add_u32 v142, 4096, v142
  v_min_u32 v143, K1e_S6-K1c_S6-16, v142
  global_load_dwordx4 v[144:147], v143, s[76:77]
  v_lshrrev_b32 v224, 3, v239
  v_and_b32 v225, 7, v239
  v_add_u32 v226, 0, v224
  v_bfe_u32 v227, v226, 1, 3
  v_xor_b32 v227, v227, v225
  v_lshlrev_b32 v227, 4, v227
  v_lshl_add_u32 v227, v226, 10, v227
  v_subrev_u32 v248, 0, v227
  v_add_u32 v226, 8, v224
  v_bfe_u32 v227, v226, 1, 3
  v_xor_b32 v227, v227, v225
  v_lshlrev_b32 v227, 4, v227
  v_lshl_add_u32 v227, v226, 10, v227
  v_subrev_u32 v249, 1024, v227
  s_lshl_b32 s6, s4, 18
  s_lshl_b32 s7, s3, 16
  s_add_u32 s100, s6, s7
  s_mul_i32 s101, s3, 16384
  s_add_u32 s101, s101, 81920
  v_and_b32 v234, 15, v239
  v_lshlrev_b32 v224, 7, v234
  v_bfe_u32 v225, v239, 1, 3
  v_lshrrev_b32 v226, 4, v239
  v_xor_b32 v225, v225, v226
  v_lshl_add_u32 v228, v225, 4, v224
  v_add_u32 v250, s101, v228
  v_xor_b32 v251, 64, v250
  v_mov_b32 v240, v228
  s_mov_b32 s56, s22
  s_and_b32 s57, s23, 0xffff
  s_mov_b32 s58, 4194304
  s_mov_b32 s59, 0x00020000
  s_lshl_b32 s9, s3, 12
  s_mov_b32 s52, s28
  s_and_b32 s53, s29, 0xffff
  s_mov_b32 s54, 2097152
  s_mov_b32 s55, 0x00020000
  s_mov_b32 s60, s34
  s_and_b32 s61, s35, 0xffff
  s_mov_b32 s62, 524288
  s_mov_b32 s63, 0x00020000
  s_mov_b32 s44, s36
  s_and_b32 s45, s37, 0xffff
  s_mov_b32 s46, 524288
  s_mov_b32 s47, 0x00020000
  s_sub_u32 s95, s5, 26
  s_mul_i32 s95, s95, 6
  s_min_u32 s95, s95, 26
  s_and_b32 s7, s3, 1
  s_add_u32 s7, s7, s95
  s_lshl_b32 s10, s7, 14
  s_and_b32 s7, s3, 1
  s_add_u32 s7, s7, s95
  s_add_u32 s7, s7, 2
  s_lshl_b32 s11, s7, 14
  s_and_b32 s7, s3, 1
  s_add_u32 s7, s7, s95
  s_add_u32 s7, s7, 4
  s_lshl_b32 s12, s7, 14
  s_mov_b32 s72, s30
  s_and_b32 s73, s31, 0xffff
  s_mov_b32 s74, 1024
  s_mov_b32 s75, 0x00020000
  s_mov_b32 s76, s32
  s_and_b32 s77, s33, 0xffff
  s_mov_b32 s78, 1024
  s_mov_b32 s79, 0x00020000
  s_mov_b32 s80, s42
  s_and_b32 s81, s43, 0xffff
  s_mov_b32 s82, 1024
  s_mov_b32 s83, 0x00020000
  s_and_b32 s6, s3, 1
  s_lshl_b32 s6, s6, 6
  s_lshl_b32 s7, s95, 4
  s_add_u32 s7, s7, s6
  s_lshl_b32 s8, s7, 1
  v_lshlrev_b32 v233, 1, v239
  buffer_load_ushort v230, v233, s[72:75], s8 offen
  buffer_load_ushort v231, v233, s[76:79], s8 offen
  buffer_load_ushort v232, v233, s[80:83], s8 offen
  s_lshr_b32 s6, s3, 1
  s_add_u32 s6, s6, s14
  s_add_u32 s6, s6, 0
  s_and_b32 s6, s6, 7
  s_lshl_b32 s6, s6, 7
  s_add_u32 m0, s9, 0
  s_add_u32 s6, s6, s10
  buffer_load_dwordx4 v248, s[60:63], s6 offen offset:0 lds
  buffer_load_dwordx4 v249, s[60:63], s6 offen offset:1024 lds
  s_add_u32 m0, s9, 2048
  s_nop 0
  buffer_load_dwordx4 v248, s[44:47], s6 offen offset:0 lds
  buffer_load_dwordx4 v249, s[44:47], s6 offen offset:1024 lds
  s_add_u32 s15, s14, 0
  s_and_b32 s15, s15, 7
  s_lshl_b32 s15, s15, 7
  s_add_u32 s15, s15, s100
  s_add_u32 m0, s101, 0
  s_nop 0
  buffer_load_dwordx4 v248, s[52:55], s15 offen offset:0 lds
  buffer_load_dwordx4 v249, s[52:55], s15 offen offset:1024 lds
  s_add_u32 m0, s101, 2048
  s_add_u32 s15, s15, 16384
  buffer_load_dwordx4 v248, s[52:55], s15 offen offset:0 lds
  buffer_load_dwordx4 v249, s[52:55], s15 offen offset:1024 lds
  s_add_u32 m0, s101, 4096
  s_add_u32 s15, s15, 16384
  buffer_load_dwordx4 v248, s[52:55], s15 offen offset:0 lds
  buffer_load_dwordx4 v249, s[52:55], s15 offen offset:1024 lds
  s_add_u32 m0, s101, 6144
  s_add_u32 s15, s15, 16384
  buffer_load_dwordx4 v248, s[52:55], s15 offen offset:0 lds
  buffer_load_dwordx4 v249, s[52:55], s15 offen offset:1024 lds
  s_add_u32 s15, s14, 1
  s_and_b32 s15, s15, 7
  s_lshl_b32 s15, s15, 7
  s_add_u32 s15, s15, s100
  s_add_u32 m0, s101, 8192
  s_nop 0
  buffer_load_dwordx4 v248, s[52:55], s15 offen offset:0 lds
  buffer_load_dwordx4 v249, s[52:55], s15 offen offset:1024 lds
  s_add_u32 m0, s101, 10240
  s_add_u32 s15, s15, 16384
  buffer_load_dwordx4 v248, s[52:55], s15 offen offset:0 lds
  buffer_load_dwordx4 v249, s[52:55], s15 offen offset:1024 lds
  s_add_u32 m0, s101, 12288
  s_add_u32 s15, s15, 16384
  buffer_load_dwordx4 v248, s[52:55], s15 offen offset:0 lds
  buffer_load_dwordx4 v249, s[52:55], s15 offen offset:1024 lds
  s_add_u32 m0, s101, 14336
  s_add_u32 s15, s15, 16384
  buffer_load_dwordx4 v248, s[52:55], s15 offen offset:0 lds
  buffer_load_dwordx4 v249, s[52:55], s15 offen offset:1024 lds
  s_lshr_b32 s6, s3, 1
  s_add_u32 s6, s6, s14
  s_add_u32 s6, s6, 2
  s_and_b32 s6, s6, 7
  s_lshl_b32 s6, s6, 7
  s_add_u32 m0, s9, 16384
  s_add_u32 s6, s6, s10
  buffer_load_dwordx4 v248, s[60:63], s6 offen offset:0 lds
  buffer_load_dwordx4 v249, s[60:63], s6 offen offset:1024 lds
  s_add_u32 m0, s9, 18432
  s_nop 0
  buffer_load_dwordx4 v248, s[44:47], s6 offen offset:0 lds
  buffer_load_dwordx4 v249, s[44:47], s6 offen offset:1024 lds
  s_mov_b32 s64, s50
  s_and_b32 s65, s51, 0xffff
  s_mov_b32 s66, 67108864
  s_mov_b32 s67, 0x00020000
  v_and_b32 v234, 15, v239
  v_xor_b32 v241, 64, v240
  v_add_u32 v242, 2048, v240
  v_add_u32 v243, 2048, v241
  v_add_u32 v244, 0x10000, v240
  v_add_u32 v245, 0x10000, v241
  v_add_u32 v246, 0x10000, v242
  v_add_u32 v247, 0x10000, v243
  s_lshl_b32 s6, s4, 3
  s_lshl_b32 s7, s3, 1
  s_add_u32 s6, s6, s7
  s_lshl_b32 s7, s6, 17
  v_lshlrev_b32 v236, 4, v234
  v_bfe_u32 v225, v239, 4, 1
  v_lshl_add_u32 v236, v225, 9, v236
  v_lshrrev_b32 v225, 5, v239
  v_lshl_add_u32 v236, v225, 10, v236
  v_add_u32 v236, s7, v236
  s_lshl_b32 s7, s6, 12
  v_lshlrev_b32 v237, 3, v234
  v_add_u32 v237, s7, v237
  v_lshlrev_b32 v238, 3, v234
  v_add_u32 v238, 147456, v238
  s_and_b32 s6, s3, 1
  s_lshl_b32 s6, s6, 6
  s_lshl_b32 s7, s95, 4
  s_add_u32 s7, s7, s6
  s_lshl_b32 s8, s7, 3
  s_add_u32 s8, s8, 59768832
  v_lshlrev_b32 v235, 3, v239
  v_add_u32 v138, s7, v239
  v_cmp_gt_u32 vcc, 512, v138
  v_mov_b32 v138, 0x7f000000
  s_nop 0
  v_cndmask_b32 v138, v138, v235, vcc
  s_lshl_b32 s6, s6, 3
  s_add_u32 s6, s6, 147456
  v_add_u32 v234, s6, v235
  s_waitcnt vmcnt(24)
  v_lshlrev_b32 v230, 16, v230
  v_lshlrev_b32 v231, 16, v231
  v_lshlrev_b32 v232, 16, v232
  v_mul_f32 v232, 0x3fb8aa3b, v232
  v_exp_f32 v232, v232
  s_nop 0
  v_cvt_pk_bf16_f32 v232, v232, v232
  v_lshlrev_b32 v233, 16, v232
  v_mul_f32 v232, v233, v230
  v_mul_f32 v233, v233, v231
  v_mul_f32 v232, 0x3fb8aa3b, v232
  v_mul_f32 v233, 0x3e22f983, v233
  s_cmp_ge_u32 s3, 2
  s_cbranch_scc1 K1tb_1
  v_mul_f32 v228, 0x3f800000, v232
  v_mul_f32 v225, 0x3f800000, v233
  v_exp_f32 v228, v228
  v_fract_f32 v225, v225
  v_cos_f32 v224, v225
  v_sin_f32 v225, v225
  s_nop 0
  v_mul_f32 v224, v224, v228
  v_mul_f32 v225, v225, v228
  ds_write_b64 v234, v[224:225]
  s_add_u32 s7, s8, 0
  buffer_store_dwordx2 v[224:225], v138, s[64:67], s7 offen
  v_mul_f32 v228, v230, v230
  v_fmac_f32 v228, v231, v231
  v_rcp_f32 v228, v228
  v_add_f32 v229, -1.0, v224
  v_add_f32 v228, v228, v228
  v_mul_f32 v226, v229, v230
  v_fmac_f32 v226, v225, v231
  v_mul_f32 v227, v225, v230
  v_fma_f32 v227, -v229, v231, v227
  v_mul_f32 v226, v226, v228
  v_mul_f32 v227, v227, v228
  s_add_u32 s7, s8, 24576
  buffer_store_dwordx2 v[226:227], v138, s[64:67], s7 offen
  v_mul_f32 v228, 0x41800000, v232
  v_mul_f32 v225, 0x41800000, v233
  v_exp_f32 v228, v228
  v_fract_f32 v225, v225
  v_cos_f32 v224, v225
  v_sin_f32 v225, v225
  s_nop 0
  v_mul_f32 v224, v224, v228
  v_mul_f32 v225, v225, v228
  ds_write_b64 v234, v[224:225] offset:1024
  v_mul_f32 v228, 0x41400000, v232
  v_mul_f32 v227, 0x41400000, v233
  v_exp_f32 v228, v228
  v_fract_f32 v227, v227
  v_cos_f32 v226, v227
  v_sin_f32 v227, v227
  s_nop 0
  v_mul_f32 v226, v226, v228
  v_mul_f32 v227, v227, v228
  ds_write_b64 v234, v[226:227] offset:2048
  v_mul_f32 v228, 0x41000000, v232
  v_mul_f32 v225, 0x41000000, v233
  v_exp_f32 v228, v228
  v_fract_f32 v225, v225
  v_cos_f32 v224, v225
  v_sin_f32 v225, v225
  s_nop 0
  v_mul_f32 v224, v224, v228
  v_mul_f32 v225, v225, v228
  ds_write_b64 v234, v[224:225] offset:3072
  s_add_u32 s7, s8, 4096
  buffer_store_dwordx2 v[224:225], v138, s[64:67], s7 offen
  v_mul_f32 v228, 0x40800000, v232
  v_mul_f32 v227, 0x40800000, v233
  v_exp_f32 v228, v228
  v_fract_f32 v227, v227
  v_cos_f32 v226, v227
  v_sin_f32 v227, v227
  s_nop 0
  v_mul_f32 v226, v226, v228
  v_mul_f32 v227, v227, v228
  ds_write_b64 v234, v[226:227] offset:4096
  v_mov_b32 v228, 1.0
  v_mov_b32 v229, 0
  ds_write_b64 v234, v[228:229] offset:5120
  s_add_u32 s7, s8, 4096
  buffer_store_dwordx2 v[224:225], v138, s[64:67], s7 offen
  s_waitcnt lgkmcnt(0)
  s_branch K1te_2
K1tb_1:
  v_mul_f32 v228, 0x42000000, v232
  v_mul_f32 v225, 0x42000000, v233
  v_exp_f32 v228, v228
  v_fract_f32 v225, v225
  v_cos_f32 v224, v225
  v_sin_f32 v225, v225
  s_nop 0
  v_mul_f32 v224, v224, v228
  v_mul_f32 v225, v225, v228
  s_add_u32 s7, s8, 8192
  buffer_store_dwordx2 v[224:225], v138, s[64:67], s7 offen
  v_mul_f32 v228, 0x44000000, v232
  v_mul_f32 v227, 0x44000000, v233
  v_exp_f32 v228, v228
  v_fract_f32 v227, v227
  v_cos_f32 v226, v227
  v_sin_f32 v227, v227
  s_nop 0
  v_mul_f32 v226, v226, v228
  v_mul_f32 v227, v227, v228
  s_add_u32 s7, s8, 12288
  buffer_store_dwordx2 v[226:227], v138, s[64:67], s7 offen
  v_mul_f32 v228, 0x44800000, v232
  v_mul_f32 v225, 0x44800000, v233
  v_exp_f32 v228, v228
  v_fract_f32 v225, v225
  v_cos_f32 v224, v225
  v_sin_f32 v225, v225
  s_nop 0
  v_mul_f32 v224, v224, v228
  v_mul_f32 v225, v225, v228
  s_add_u32 s7, s8, 16384
  buffer_store_dwordx2 v[224:225], v138, s[64:67], s7 offen
  v_mul_f32 v228, 0x44c00000, v232
  v_mul_f32 v227, 0x44c00000, v233
  v_exp_f32 v228, v228
  v_fract_f32 v227, v227
  v_cos_f32 v226, v227
  v_sin_f32 v227, v227
  s_nop 0
  v_mul_f32 v226, v226, v228
  v_mul_f32 v227, v227, v228
  s_add_u32 s7, s8, 20480
  buffer_store_dwordx2 v[226:227], v138, s[64:67], s7 offen
K1te_2:
  v_lshrrev_b32 v239, 4, v239
  v_lshl_add_u32 v239, v239, 10, v238
  v_mbcnt_lo_u32_b32 v140, -1, 0
  v_mbcnt_hi_u32_b32 v140, -1, v140
  v_lshlrev_b32 v140, 4, v140
  s_waitcnt vmcnt(16)
  ds_read_b128 a[0:3], v250 offset:0
  ds_read_b128 a[4:7], v250 offset:2048
  ds_read_b128 a[8:11], v250 offset:4096
  ds_read_b128 a[12:15], v250 offset:6144
  ds_read_b128 a[16:19], v251 offset:0
  ds_read_b128 a[20:23], v251 offset:2048
  ds_read_b128 a[24:27], v251 offset:4096
  ds_read_b128 a[28:31], v251 offset:6144
  s_barrier
  s_waitcnt lgkmcnt(0)
  s_add_u32 s15, s14, 2
  s_and_b32 s15, s15, 7
  s_lshl_b32 s15, s15, 7
  s_add_u32 s15, s15, s100
  s_add_u32 m0, s101, 0
  s_nop 0
  buffer_load_dwordx4 v248, s[52:55], s15 offen offset:0 lds
  buffer_load_dwordx4 v249, s[52:55], s15 offen offset:1024 lds
  s_add_u32 m0, s101, 2048
  s_add_u32 s15, s15, 16384
  buffer_load_dwordx4 v248, s[52:55], s15 offen offset:0 lds
  buffer_load_dwordx4 v249, s[52:55], s15 offen offset:1024 lds
  s_add_u32 m0, s101, 4096
  s_add_u32 s15, s15, 16384
  buffer_load_dwordx4 v248, s[52:55], s15 offen offset:0 lds
  buffer_load_dwordx4 v249, s[52:55], s15 offen offset:1024 lds
  s_add_u32 m0, s101, 6144
  s_add_u32 s15, s15, 16384
  buffer_load_dwordx4 v248, s[52:55], s15 offen offset:0 lds
  buffer_load_dwordx4 v249, s[52:55], s15 offen offset:1024 lds
  s_waitcnt vmcnt(12)
  s_barrier
  ds_read_b128 v[192:195], v240 offset:0
  ds_read_b128 v[196:199], v242 offset:0
  ds_read_b128 v[200:203], v240 offset:4096
  ds_read_b128 v[204:207], v242 offset:4096
  ds_read_b128 v[208:211], v241 offset:0
  ds_read_b128 v[212:215], v243 offset:0
  ds_read_b128 v[216:219], v241 offset:4096
  ds_read_b128 v[220:223], v243 offset:4096
  s_waitcnt lgkmcnt(7)
  v_mfma_f32_16x16x32_bf16 v[0:3], a[0:3], v[192:195], 0
  v_mfma_f32_16x16x32_bf16 v[4:7], a[4:7], v[192:195], 0
  v_mfma_f32_16x16x32_bf16 v[8:11], a[8:11], v[192:195], 0
  s_lshr_b32 s6, s3, 1
  s_add_u32 s6, s6, s14
  v_mfma_f32_16x16x32_bf16 v[12:15], a[12:15], v[192:195], 0
  ds_read_b128 v[192:195], v240 offset:8192
  s_add_u32 s6, s6, 4
  s_waitcnt lgkmcnt(7)
  v_mfma_f32_16x16x32_bf16 v[16:19], a[0:3], v[196:199], 0
  s_and_b32 s6, s6, 7
  s_lshl_b32 s6, s6, 7
  v_mfma_f32_16x16x32_bf16 v[20:23], a[4:7], v[196:199], 0
  s_add_u32 m0, s9, 32768
  s_add_u32 s6, s6, s10
  v_mfma_f32_16x16x32_bf16 v[24:27], a[8:11], v[196:199], 0
  buffer_load_dwordx4 v248, s[60:63], s6 offen offset:0 lds
  buffer_load_dwordx4 v249, s[60:63], s6 offen offset:1024 lds
  v_mfma_f32_16x16x32_bf16 v[28:31], a[12:15], v[196:199], 0
  ds_read_b128 v[196:199], v242 offset:8192
  s_add_u32 m0, s9, 34816
  s_waitcnt lgkmcnt(7)
  v_mfma_f32_16x16x32_bf16 v[32:35], a[0:3], v[200:203], 0
  s_nop 0
  buffer_load_dwordx4 v248, s[44:47], s6 offen offset:0 lds
  v_mfma_f32_16x16x32_bf16 v[36:39], a[4:7], v[200:203], 0
  buffer_load_dwordx4 v249, s[44:47], s6 offen offset:1024 lds
  ds_read_b128 a[32:35], v250 offset:8192
  v_mfma_f32_16x16x32_bf16 v[40:43], a[8:11], v[200:203], 0
  ds_read_b128 a[36:39], v250 offset:10240
  ds_read_b128 a[40:43], v250 offset:12288
  v_mfma_f32_16x16x32_bf16 v[44:47], a[12:15], v[200:203], 0
  ds_read_b128 v[200:203], v240 offset:12288
  ds_read_b128 a[44:47], v250 offset:14336
  s_waitcnt lgkmcnt(11)
  v_mfma_f32_16x16x32_bf16 v[48:51], a[0:3], v[204:207], 0
  ds_read_b128 a[48:51], v251 offset:8192
  ds_read_b128 a[52:55], v251 offset:10240
  v_mfma_f32_16x16x32_bf16 v[52:55], a[4:7], v[204:207], 0
  ds_read_b128 a[56:59], v251 offset:12288
  ds_read_b128 a[60:63], v251 offset:14336
  v_mfma_f32_16x16x32_bf16 v[56:59], a[8:11], v[204:207], 0
  v_mfma_f32_16x16x32_bf16 v[60:63], a[12:15], v[204:207], 0
  ds_read_b128 v[204:207], v242 offset:12288
  s_waitcnt lgkmcnt(15)
  v_mfma_f32_16x16x32_bf16 v[0:3], a[16:19], v[208:211], v[0:3]
  s_waitcnt lgkmcnt(1)
  s_add_u32 s15, s14, 3
  s_and_b32 s15, s15, 7
  v_mfma_f32_16x16x32_bf16 v[4:7], a[20:23], v[208:211], v[4:7]
  s_lshl_b32 s15, s15, 7
  s_add_u32 s15, s15, s100
  v_mfma_f32_16x16x32_bf16 v[8:11], a[24:27], v[208:211], v[8:11]
  s_add_u32 m0, s101, 8192
  s_nop 0
  v_mfma_f32_16x16x32_bf16 v[12:15], a[28:31], v[208:211], v[12:15]
  ds_read_b128 v[208:211], v241 offset:8192
  buffer_load_dwordx4 v248, s[52:55], s15 offen offset:0 lds
  v_mfma_f32_16x16x32_bf16 v[16:19], a[16:19], v[212:215], v[16:19]
  buffer_load_dwordx4 v249, s[52:55], s15 offen offset:1024 lds
  s_add_u32 m0, s101, 10240
  v_mfma_f32_16x16x32_bf16 v[20:23], a[20:23], v[212:215], v[20:23]
  s_add_u32 s15, s15, 16384
  buffer_load_dwordx4 v248, s[52:55], s15 offen offset:0 lds
  v_mfma_f32_16x16x32_bf16 v[24:27], a[24:27], v[212:215], v[24:27]
  buffer_load_dwordx4 v249, s[52:55], s15 offen offset:1024 lds
  s_add_u32 m0, s101, 12288
  v_mfma_f32_16x16x32_bf16 v[28:31], a[28:31], v[212:215], v[28:31]
  ds_read_b128 v[212:215], v243 offset:8192
  s_add_u32 s15, s15, 16384
  v_mfma_f32_16x16x32_bf16 v[32:35], a[16:19], v[216:219], v[32:35]
  buffer_load_dwordx4 v248, s[52:55], s15 offen offset:0 lds
  buffer_load_dwordx4 v249, s[52:55], s15 offen offset:1024 lds
  v_mfma_f32_16x16x32_bf16 v[36:39], a[20:23], v[216:219], v[36:39]
  s_add_u32 m0, s101, 14336
  s_add_u32 s15, s15, 16384
  v_mfma_f32_16x16x32_bf16 v[40:43], a[24:27], v[216:219], v[40:43]
  buffer_load_dwordx4 v248, s[52:55], s15 offen offset:0 lds
  buffer_load_dwordx4 v249, s[52:55], s15 offen offset:1024 lds
  v_mfma_f32_16x16x32_bf16 v[44:47], a[28:31], v[216:219], v[44:47]
  ds_read_b128 v[216:219], v241 offset:12288
  v_mfma_f32_16x16x32_bf16 v[48:51], a[16:19], v[220:223], v[48:51]
  v_mfma_f32_16x16x32_bf16 v[52:55], a[20:23], v[220:223], v[52:55]
  v_mfma_f32_16x16x32_bf16 v[56:59], a[24:27], v[220:223], v[56:59]
  v_mfma_f32_16x16x32_bf16 v[60:63], a[28:31], v[220:223], v[60:63]
  ds_read_b128 v[220:223], v243 offset:12288
  v_mfma_f32_16x16x32_bf16 v[0:3], a[32:35], v[192:195], v[0:3]
  v_mfma_f32_16x16x32_bf16 v[4:7], a[36:39], v[192:195], v[4:7]
  v_mfma_f32_16x16x32_bf16 v[8:11], a[40:43], v[192:195], v[8:11]
  s_lshr_b32 s6, s3, 1
  s_add_u32 s6, s6, s14
  v_mfma_f32_16x16x32_bf16 v[12:15], a[44:47], v[192:195], v[12:15]
  ds_read_b128 v[192:195], v240 offset:16384
  s_add_u32 s6, s6, 6
  v_mfma_f32_16x16x32_bf16 v[16:19], a[32:35], v[196:199], v[16:19]
  s_and_b32 s6, s6, 7
  s_lshl_b32 s6, s6, 7
  v_mfma_f32_16x16x32_bf16 v[20:23], a[36:39], v[196:199], v[20:23]
  s_add_u32 m0, s9, 49152
  s_add_u32 s6, s6, s10
  v_mfma_f32_16x16x32_bf16 v[24:27], a[40:43], v[196:199], v[24:27]
  buffer_load_dwordx4 v248, s[60:63], s6 offen offset:0 lds
  buffer_load_dwordx4 v249, s[60:63], s6 offen offset:1024 lds
  v_mfma_f32_16x16x32_bf16 v[28:31], a[44:47], v[196:199], v[28:31]
  ds_read_b128 v[196:199], v242 offset:16384
  s_add_u32 m0, s9, 51200
  v_mfma_f32_16x16x32_bf16 v[32:35], a[32:35], v[200:203], v[32:35]
  s_nop 0
  buffer_load_dwordx4 v248, s[44:47], s6 offen offset:0 lds
  v_mfma_f32_16x16x32_bf16 v[36:39], a[36:39], v[200:203], v[36:39]
  buffer_load_dwordx4 v249, s[44:47], s6 offen offset:1024 lds
  s_waitcnt vmcnt(16)
  ds_read_b128 a[64:67], v250 offset:0
  v_mfma_f32_16x16x32_bf16 v[40:43], a[40:43], v[200:203], v[40:43]
  ds_read_b128 a[68:71], v250 offset:2048
  ds_read_b128 a[72:75], v250 offset:4096
  v_mfma_f32_16x16x32_bf16 v[44:47], a[44:47], v[200:203], v[44:47]
  ds_read_b128 v[200:203], v240 offset:20480
  ds_read_b128 a[76:79], v250 offset:6144
  s_waitcnt lgkmcnt(11)
  v_mfma_f32_16x16x32_bf16 v[48:51], a[32:35], v[204:207], v[48:51]
  ds_read_b128 a[80:83], v251 offset:0
  ds_read_b128 a[84:87], v251 offset:2048
  v_mfma_f32_16x16x32_bf16 v[52:55], a[36:39], v[204:207], v[52:55]
  ds_read_b128 a[88:91], v251 offset:4096
  ds_read_b128 a[92:95], v251 offset:6144
  v_mfma_f32_16x16x32_bf16 v[56:59], a[40:43], v[204:207], v[56:59]
  v_mfma_f32_16x16x32_bf16 v[60:63], a[44:47], v[204:207], v[60:63]
  ds_read_b128 v[204:207], v242 offset:20480
  s_waitcnt lgkmcnt(15)
  v_mfma_f32_16x16x32_bf16 v[0:3], a[48:51], v[208:211], v[0:3]
  s_waitcnt lgkmcnt(1)
  s_add_u32 s15, s14, 4
  s_and_b32 s15, s15, 7
  v_mfma_f32_16x16x32_bf16 v[4:7], a[52:55], v[208:211], v[4:7]
  s_lshl_b32 s15, s15, 7
  s_add_u32 s15, s15, s100
  v_mfma_f32_16x16x32_bf16 v[8:11], a[56:59], v[208:211], v[8:11]
  s_add_u32 m0, s101, 0
  s_nop 0
  v_mfma_f32_16x16x32_bf16 v[12:15], a[60:63], v[208:211], v[12:15]
  ds_read_b128 v[208:211], v241 offset:16384
  buffer_load_dwordx4 v248, s[52:55], s15 offen offset:0 lds
  v_mfma_f32_16x16x32_bf16 v[16:19], a[48:51], v[212:215], v[16:19]
  buffer_load_dwordx4 v249, s[52:55], s15 offen offset:1024 lds
  s_add_u32 m0, s101, 2048
  v_mfma_f32_16x16x32_bf16 v[20:23], a[52:55], v[212:215], v[20:23]
  s_add_u32 s15, s15, 16384
  buffer_load_dwordx4 v248, s[52:55], s15 offen offset:0 lds
  v_mfma_f32_16x16x32_bf16 v[24:27], a[56:59], v[212:215], v[24:27]
  buffer_load_dwordx4 v249, s[52:55], s15 offen offset:1024 lds
  s_add_u32 m0, s101, 4096
  v_mfma_f32_16x16x32_bf16 v[28:31], a[60:63], v[212:215], v[28:31]
  ds_read_b128 v[212:215], v243 offset:16384
  s_add_u32 s15, s15, 16384
  v_mfma_f32_16x16x32_bf16 v[32:35], a[48:51], v[216:219], v[32:35]
  buffer_load_dwordx4 v248, s[52:55], s15 offen offset:0 lds
  buffer_load_dwordx4 v249, s[52:55], s15 offen offset:1024 lds
  v_mfma_f32_16x16x32_bf16 v[36:39], a[52:55], v[216:219], v[36:39]
  s_add_u32 m0, s101, 6144
  s_add_u32 s15, s15, 16384
  v_mfma_f32_16x16x32_bf16 v[40:43], a[56:59], v[216:219], v[40:43]
  buffer_load_dwordx4 v248, s[52:55], s15 offen offset:0 lds
  buffer_load_dwordx4 v249, s[52:55], s15 offen offset:1024 lds
  v_mfma_f32_16x16x32_bf16 v[44:47], a[60:63], v[216:219], v[44:47]
  ds_read_b128 v[216:219], v241 offset:20480
  v_mfma_f32_16x16x32_bf16 v[48:51], a[48:51], v[220:223], v[48:51]
  v_mfma_f32_16x16x32_bf16 v[52:55], a[52:55], v[220:223], v[52:55]
  v_mfma_f32_16x16x32_bf16 v[56:59], a[56:59], v[220:223], v[56:59]
  v_mfma_f32_16x16x32_bf16 v[60:63], a[60:63], v[220:223], v[60:63]
  ds_read_b128 v[220:223], v243 offset:20480
  s_waitcnt vmcnt(20)
  s_barrier
  v_mfma_f32_16x16x32_bf16 v[0:3], a[64:67], v[192:195], v[0:3]
  v_mfma_f32_16x16x32_bf16 v[4:7], a[68:71], v[192:195], v[4:7]
  v_mfma_f32_16x16x32_bf16 v[8:11], a[72:75], v[192:195], v[8:11]
  s_lshr_b32 s6, s3, 1
  s_add_u32 s6, s6, s14
  v_mfma_f32_16x16x32_bf16 v[12:15], a[76:79], v[192:195], v[12:15]
  ds_read_b128 v[192:195], v240 offset:24576
  s_add_u32 s6, s6, 0
  v_mfma_f32_16x16x32_bf16 v[16:19], a[64:67], v[196:199], v[16:19]
  s_and_b32 s6, s6, 7
  s_lshl_b32 s6, s6, 7
  v_mfma_f32_16x16x32_bf16 v[20:23], a[68:71], v[196:199], v[20:23]
  s_add_u32 m0, s9, 65536
  s_add_u32 s6, s6, s11
  v_mfma_f32_16x16x32_bf16 v[24:27], a[72:75], v[196:199], v[24:27]
  buffer_load_dwordx4 v248, s[60:63], s6 offen offset:0 lds
  buffer_load_dwordx4 v249, s[60:63], s6 offen offset:1024 lds
  v_mfma_f32_16x16x32_bf16 v[28:31], a[76:79], v[196:199], v[28:31]
  ds_read_b128 v[196:199], v242 offset:24576
  s_add_u32 m0, s9, 67584
  v_mfma_f32_16x16x32_bf16 v[32:35], a[64:67], v[200:203], v[32:35]
  s_nop 0
  buffer_load_dwordx4 v248, s[44:47], s6 offen offset:0 lds
  v_mfma_f32_16x16x32_bf16 v[36:39], a[68:71], v[200:203], v[36:39]
  buffer_load_dwordx4 v249, s[44:47], s6 offen offset:1024 lds
  s_waitcnt vmcnt(16)
  ds_read_b128 a[96:99], v250 offset:8192
  v_mfma_f32_16x16x32_bf16 v[40:43], a[72:75], v[200:203], v[40:43]
  ds_read_b128 a[100:103], v250 offset:10240
  ds_read_b128 a[104:107], v250 offset:12288
  v_mfma_f32_16x16x32_bf16 v[44:47], a[76:79], v[200:203], v[44:47]
  ds_read_b128 v[200:203], v240 offset:28672
  ds_read_b128 a[108:111], v250 offset:14336
  s_waitcnt lgkmcnt(11)
  v_mfma_f32_16x16x32_bf16 v[48:51], a[64:67], v[204:207], v[48:51]
  ds_read_b128 a[112:115], v251 offset:8192
  ds_read_b128 a[116:119], v251 offset:10240
  v_mfma_f32_16x16x32_bf16 v[52:55], a[68:71], v[204:207], v[52:55]
  ds_read_b128 a[120:123], v251 offset:12288
  ds_read_b128 a[124:127], v251 offset:14336
  v_mfma_f32_16x16x32_bf16 v[56:59], a[72:75], v[204:207], v[56:59]
  v_mfma_f32_16x16x32_bf16 v[60:63], a[76:79], v[204:207], v[60:63]
  ds_read_b128 v[204:207], v242 offset:28672
  s_waitcnt lgkmcnt(15)
  v_mfma_f32_16x16x32_bf16 v[0:3], a[80:83], v[208:211], v[0:3]
  s_waitcnt lgkmcnt(1)
  s_add_u32 s15, s14, 5
  s_and_b32 s15, s15, 7
  v_mfma_f32_16x16x32_bf16 v[4:7], a[84:87], v[208:211], v[4:7]
  s_lshl_b32 s15, s15, 7
  s_add_u32 s15, s15, s100
  v_mfma_f32_16x16x32_bf16 v[8:11], a[88:91], v[208:211], v[8:11]
  s_add_u32 m0, s101, 8192
  s_nop 0
  v_mfma_f32_16x16x32_bf16 v[12:15], a[92:95], v[208:211], v[12:15]
  ds_read_b128 v[208:211], v241 offset:24576
  buffer_load_dwordx4 v248, s[52:55], s15 offen offset:0 lds
  v_mfma_f32_16x16x32_bf16 v[16:19], a[80:83], v[212:215], v[16:19]
  buffer_load_dwordx4 v249, s[52:55], s15 offen offset:1024 lds
  s_add_u32 m0, s101, 10240
  v_mfma_f32_16x16x32_bf16 v[20:23], a[84:87], v[212:215], v[20:23]
  s_add_u32 s15, s15, 16384
  buffer_load_dwordx4 v248, s[52:55], s15 offen offset:0 lds
  v_mfma_f32_16x16x32_bf16 v[24:27], a[88:91], v[212:215], v[24:27]
  buffer_load_dwordx4 v249, s[52:55], s15 offen offset:1024 lds
  s_add_u32 m0, s101, 12288
  v_mfma_f32_16x16x32_bf16 v[28:31], a[92:95], v[212:215], v[28:31]
  ds_read_b128 v[212:215], v243 offset:24576
  s_add_u32 s15, s15, 16384
  v_mfma_f32_16x16x32_bf16 v[32:35], a[80:83], v[216:219], v[32:35]
  buffer_load_dwordx4 v248, s[52:55], s15 offen offset:0 lds
  buffer_load_dwordx4 v249, s[52:55], s15 offen offset:1024 lds
  v_mfma_f32_16x16x32_bf16 v[36:39], a[84:87], v[216:219], v[36:39]
  s_add_u32 m0, s101, 14336
  s_add_u32 s15, s15, 16384
  v_mfma_f32_16x16x32_bf16 v[40:43], a[88:91], v[216:219], v[40:43]
  buffer_load_dwordx4 v248, s[52:55], s15 offen offset:0 lds
  buffer_load_dwordx4 v249, s[52:55], s15 offen offset:1024 lds
  v_mfma_f32_16x16x32_bf16 v[44:47], a[92:95], v[216:219], v[44:47]
  ds_read_b128 v[216:219], v241 offset:28672
  v_mfma_f32_16x16x32_bf16 v[48:51], a[80:83], v[220:223], v[48:51]
  v_mfma_f32_16x16x32_bf16 v[52:55], a[84:87], v[220:223], v[52:55]
  v_mfma_f32_16x16x32_bf16 v[56:59], a[88:91], v[220:223], v[56:59]
  v_mfma_f32_16x16x32_bf16 v[60:63], a[92:95], v[220:223], v[60:63]
  ds_read_b128 v[220:223], v243 offset:28672
  v_mfma_f32_16x16x32_bf16 v[0:3], a[96:99], v[192:195], v[0:3]
  v_mfma_f32_16x16x32_bf16 v[4:7], a[100:103], v[192:195], v[4:7]
  v_mfma_f32_16x16x32_bf16 v[8:11], a[104:107], v[192:195], v[8:11]
  s_lshr_b32 s6, s3, 1
  s_add_u32 s6, s6, s14
  v_mfma_f32_16x16x32_bf16 v[12:15], a[108:111], v[192:195], v[12:15]
  ds_read_b128 v[192:195], v240 offset:32768
  s_add_u32 s6, s6, 2
  v_mfma_f32_16x16x32_bf16 v[16:19], a[96:99], v[196:199], v[16:19]
  s_and_b32 s6, s6, 7
  s_lshl_b32 s6, s6, 7
  v_mfma_f32_16x16x32_bf16 v[20:23], a[100:103], v[196:199], v[20:23]
  s_add_u32 m0, s9, 0
  s_add_u32 s6, s6, s11
  v_mfma_f32_16x16x32_bf16 v[24:27], a[104:107], v[196:199], v[24:27]
  buffer_load_dwordx4 v248, s[60:63], s6 offen offset:0 lds
  buffer_load_dwordx4 v249, s[60:63], s6 offen offset:1024 lds
  v_mfma_f32_16x16x32_bf16 v[28:31], a[108:111], v[196:199], v[28:31]
  ds_read_b128 v[196:199], v242 offset:32768
  s_add_u32 m0, s9, 2048
  v_mfma_f32_16x16x32_bf16 v[32:35], a[96:99], v[200:203], v[32:35]
  s_nop 0
  buffer_load_dwordx4 v248, s[44:47], s6 offen offset:0 lds
  v_mfma_f32_16x16x32_bf16 v[36:39], a[100:103], v[200:203], v[36:39]
  buffer_load_dwordx4 v249, s[44:47], s6 offen offset:1024 lds
  s_waitcnt vmcnt(16)
  ds_read_b128 a[128:131], v250 offset:0
  v_mfma_f32_16x16x32_bf16 v[40:43], a[104:107], v[200:203], v[40:43]
  ds_read_b128 a[132:135], v250 offset:2048
  ds_read_b128 a[136:139], v250 offset:4096
  v_mfma_f32_16x16x32_bf16 v[44:47], a[108:111], v[200:203], v[44:47]
  ds_read_b128 v[200:203], v240 offset:36864
  ds_read_b128 a[140:143], v250 offset:6144
  s_waitcnt lgkmcnt(11)
  v_mfma_f32_16x16x32_bf16 v[48:51], a[96:99], v[204:207], v[48:51]
  ds_read_b128 a[144:147], v251 offset:0
  ds_read_b128 a[148:151], v251 offset:2048
  v_mfma_f32_16x16x32_bf16 v[52:55], a[100:103], v[204:207], v[52:55]
  ds_read_b128 a[152:155], v251 offset:4096
  ds_read_b128 a[156:159], v251 offset:6144
  v_mfma_f32_16x16x32_bf16 v[56:59], a[104:107], v[204:207], v[56:59]
  v_mfma_f32_16x16x32_bf16 v[60:63], a[108:111], v[204:207], v[60:63]
  ds_read_b128 v[204:207], v242 offset:36864
  s_waitcnt lgkmcnt(15)
  v_mfma_f32_16x16x32_bf16 v[0:3], a[112:115], v[208:211], v[0:3]
  s_waitcnt lgkmcnt(1)
  s_add_u32 s15, s14, 6
  s_and_b32 s15, s15, 7
  v_mfma_f32_16x16x32_bf16 v[4:7], a[116:119], v[208:211], v[4:7]
  s_lshl_b32 s15, s15, 7
  s_add_u32 s15, s15, s100
  v_mfma_f32_16x16x32_bf16 v[8:11], a[120:123], v[208:211], v[8:11]
  s_add_u32 m0, s101, 0
  s_nop 0
  v_mfma_f32_16x16x32_bf16 v[12:15], a[124:127], v[208:211], v[12:15]
  ds_read_b128 v[208:211], v241 offset:32768
  buffer_load_dwordx4 v248, s[52:55], s15 offen offset:0 lds
  v_mfma_f32_16x16x32_bf16 v[16:19], a[112:115], v[212:215], v[16:19]
  buffer_load_dwordx4 v249, s[52:55], s15 offen offset:1024 lds
  s_add_u32 m0, s101, 2048
  v_mfma_f32_16x16x32_bf16 v[20:23], a[116:119], v[212:215], v[20:23]
  s_add_u32 s15, s15, 16384
  buffer_load_dwordx4 v248, s[52:55], s15 offen offset:0 lds
  v_mfma_f32_16x16x32_bf16 v[24:27], a[120:123], v[212:215], v[24:27]
  buffer_load_dwordx4 v249, s[52:55], s15 offen offset:1024 lds
  s_add_u32 m0, s101, 4096
  v_mfma_f32_16x16x32_bf16 v[28:31], a[124:127], v[212:215], v[28:31]
  ds_read_b128 v[212:215], v243 offset:32768
  s_add_u32 s15, s15, 16384
  v_mfma_f32_16x16x32_bf16 v[32:35], a[112:115], v[216:219], v[32:35]
  buffer_load_dwordx4 v248, s[52:55], s15 offen offset:0 lds
  buffer_load_dwordx4 v249, s[52:55], s15 offen offset:1024 lds
  v_mfma_f32_16x16x32_bf16 v[36:39], a[116:119], v[216:219], v[36:39]
  s_add_u32 m0, s101, 6144
  s_add_u32 s15, s15, 16384
  v_mfma_f32_16x16x32_bf16 v[40:43], a[120:123], v[216:219], v[40:43]
  buffer_load_dwordx4 v248, s[52:55], s15 offen offset:0 lds
  buffer_load_dwordx4 v249, s[52:55], s15 offen offset:1024 lds
  v_mfma_f32_16x16x32_bf16 v[44:47], a[124:127], v[216:219], v[44:47]
  ds_read_b128 v[216:219], v241 offset:36864
  v_mfma_f32_16x16x32_bf16 v[48:51], a[112:115], v[220:223], v[48:51]
  v_mfma_f32_16x16x32_bf16 v[52:55], a[116:119], v[220:223], v[52:55]
  v_mfma_f32_16x16x32_bf16 v[56:59], a[120:123], v[220:223], v[56:59]
  v_mfma_f32_16x16x32_bf16 v[60:63], a[124:127], v[220:223], v[60:63]
  ds_read_b128 v[220:223], v243 offset:36864
  s_barrier
  v_mfma_f32_16x16x32_bf16 v[0:3], a[128:131], v[192:195], v[0:3]
  v_mfma_f32_16x16x32_bf16 v[4:7], a[132:135], v[192:195], v[4:7]
  v_mfma_f32_16x16x32_bf16 v[8:11], a[136:139], v[192:195], v[8:11]
  s_lshr_b32 s6, s3, 1
  s_add_u32 s6, s6, s14
  v_mfma_f32_16x16x32_bf16 v[12:15], a[140:143], v[192:195], v[12:15]
  ds_read_b128 v[192:195], v240 offset:40960
  s_add_u32 s6, s6, 4
  v_mfma_f32_16x16x32_bf16 v[16:19], a[128:131], v[196:199], v[16:19]
  s_and_b32 s6, s6, 7
  s_lshl_b32 s6, s6, 7
  v_mfma_f32_16x16x32_bf16 v[20:23], a[132:135], v[196:199], v[20:23]
  s_add_u32 m0, s9, 16384
  s_add_u32 s6, s6, s11
  v_mfma_f32_16x16x32_bf16 v[24:27], a[136:139], v[196:199], v[24:27]
  buffer_load_dwordx4 v248, s[60:63], s6 offen offset:0 lds
  buffer_load_dwordx4 v249, s[60:63], s6 offen offset:1024 lds
  v_mfma_f32_16x16x32_bf16 v[28:31], a[140:143], v[196:199], v[28:31]
  ds_read_b128 v[196:199], v242 offset:40960
  s_add_u32 m0, s9, 18432
  v_mfma_f32_16x16x32_bf16 v[32:35], a[128:131], v[200:203], v[32:35]
  s_nop 0
  buffer_load_dwordx4 v248, s[44:47], s6 offen offset:0 lds
  v_mfma_f32_16x16x32_bf16 v[36:39], a[132:135], v[200:203], v[36:39]
  buffer_load_dwordx4 v249, s[44:47], s6 offen offset:1024 lds
  s_waitcnt vmcnt(16)
  ds_read_b128 a[160:163], v250 offset:8192
  v_mfma_f32_16x16x32_bf16 v[40:43], a[136:139], v[200:203], v[40:43]
  ds_read_b128 a[164:167], v250 offset:10240
  ds_read_b128 a[168:171], v250 offset:12288
  v_mfma_f32_16x16x32_bf16 v[44:47], a[140:143], v[200:203], v[44:47]
  ds_read_b128 v[200:203], v240 offset:45056
  ds_read_b128 a[172:175], v250 offset:14336
  s_waitcnt lgkmcnt(11)
  v_mfma_f32_16x16x32_bf16 v[48:51], a[128:131], v[204:207], v[48:51]
  ds_read_b128 a[176:179], v251 offset:8192
  ds_read_b128 a[180:183], v251 offset:10240
  v_mfma_f32_16x16x32_bf16 v[52:55], a[132:135], v[204:207], v[52:55]
  ds_read_b128 a[184:187], v251 offset:12288
  ds_read_b128 a[188:191], v251 offset:14336
  v_mfma_f32_16x16x32_bf16 v[56:59], a[136:139], v[204:207], v[56:59]
  v_mfma_f32_16x16x32_bf16 v[60:63], a[140:143], v[204:207], v[60:63]
  ds_read_b128 v[204:207], v242 offset:45056
  s_waitcnt lgkmcnt(15)
  v_mfma_f32_16x16x32_bf16 v[0:3], a[144:147], v[208:211], v[0:3]
  s_waitcnt lgkmcnt(1)
  s_add_u32 s15, s14, 7
  s_and_b32 s15, s15, 7
  v_mfma_f32_16x16x32_bf16 v[4:7], a[148:151], v[208:211], v[4:7]
  s_lshl_b32 s15, s15, 7
  s_add_u32 s15, s15, s100
  v_mfma_f32_16x16x32_bf16 v[8:11], a[152:155], v[208:211], v[8:11]
  s_add_u32 m0, s101, 8192
  s_nop 0
  v_mfma_f32_16x16x32_bf16 v[12:15], a[156:159], v[208:211], v[12:15]
  ds_read_b128 v[208:211], v241 offset:40960
  buffer_load_dwordx4 v248, s[52:55], s15 offen offset:0 lds
  v_mfma_f32_16x16x32_bf16 v[16:19], a[144:147], v[212:215], v[16:19]
  buffer_load_dwordx4 v249, s[52:55], s15 offen offset:1024 lds
  s_add_u32 m0, s101, 10240
  v_mfma_f32_16x16x32_bf16 v[20:23], a[148:151], v[212:215], v[20:23]
  s_add_u32 s15, s15, 16384
  buffer_load_dwordx4 v248, s[52:55], s15 offen offset:0 lds
  v_mfma_f32_16x16x32_bf16 v[24:27], a[152:155], v[212:215], v[24:27]
  buffer_load_dwordx4 v249, s[52:55], s15 offen offset:1024 lds
  s_add_u32 m0, s101, 12288
  v_mfma_f32_16x16x32_bf16 v[28:31], a[156:159], v[212:215], v[28:31]
  ds_read_b128 v[212:215], v243 offset:40960
  s_add_u32 s15, s15, 16384
  v_mfma_f32_16x16x32_bf16 v[32:35], a[144:147], v[216:219], v[32:35]
  buffer_load_dwordx4 v248, s[52:55], s15 offen offset:0 lds
  buffer_load_dwordx4 v249, s[52:55], s15 offen offset:1024 lds
  v_mfma_f32_16x16x32_bf16 v[36:39], a[148:151], v[216:219], v[36:39]
  s_add_u32 m0, s101, 14336
  s_add_u32 s15, s15, 16384
  v_mfma_f32_16x16x32_bf16 v[40:43], a[152:155], v[216:219], v[40:43]
  buffer_load_dwordx4 v248, s[52:55], s15 offen offset:0 lds
  buffer_load_dwordx4 v249, s[52:55], s15 offen offset:1024 lds
  v_mfma_f32_16x16x32_bf16 v[44:47], a[156:159], v[216:219], v[44:47]
  ds_read_b128 v[216:219], v241 offset:45056
  v_mfma_f32_16x16x32_bf16 v[48:51], a[144:147], v[220:223], v[48:51]
  v_mfma_f32_16x16x32_bf16 v[52:55], a[148:151], v[220:223], v[52:55]
  v_mfma_f32_16x16x32_bf16 v[56:59], a[152:155], v[220:223], v[56:59]
  v_mfma_f32_16x16x32_bf16 v[60:63], a[156:159], v[220:223], v[60:63]
  ds_read_b128 v[220:223], v243 offset:45056
  v_mfma_f32_16x16x32_bf16 v[0:3], a[160:163], v[192:195], v[0:3]
  v_mfma_f32_16x16x32_bf16 v[4:7], a[164:167], v[192:195], v[4:7]
  v_mfma_f32_16x16x32_bf16 v[8:11], a[168:171], v[192:195], v[8:11]
  v_mfma_f32_16x16x32_bf16 v[12:15], a[172:175], v[192:195], v[12:15]
  ds_read_b128 v[192:195], v240 offset:49152
  v_mfma_f32_16x16x32_bf16 v[16:19], a[160:163], v[196:199], v[16:19]
  s_waitcnt vmcnt(12)
  ds_read_b128 a[192:195], v250 offset:0
  ds_read_b128 a[196:199], v250 offset:2048
  v_mfma_f32_16x16x32_bf16 v[20:23], a[164:167], v[196:199], v[20:23]
  ds_read_b128 a[200:203], v250 offset:4096
  ds_read_b128 a[204:207], v250 offset:6144
  v_mfma_f32_16x16x32_bf16 v[24:27], a[168:171], v[196:199], v[24:27]
  ds_read_b128 a[208:211], v251 offset:0
  ds_read_b128 a[212:215], v251 offset:2048
  v_mfma_f32_16x16x32_bf16 v[28:31], a[172:175], v[196:199], v[28:31]
  ds_read_b128 v[196:199], v242 offset:49152
  ds_read_b128 a[216:219], v251 offset:4096
  v_mfma_f32_16x16x32_bf16 v[32:35], a[160:163], v[200:203], v[32:35]
  ds_read_b128 a[220:223], v251 offset:6144
  v_mfma_f32_16x16x32_bf16 v[36:39], a[164:167], v[200:203], v[36:39]
  v_mfma_f32_16x16x32_bf16 v[40:43], a[168:171], v[200:203], v[40:43]
  v_mfma_f32_16x16x32_bf16 v[44:47], a[172:175], v[200:203], v[44:47]
  ds_read_b128 v[200:203], v240 offset:53248
  s_waitcnt lgkmcnt(15)
  v_mfma_f32_16x16x32_bf16 v[48:51], a[160:163], v[204:207], v[48:51]
  v_mfma_f32_16x16x32_bf16 v[52:55], a[164:167], v[204:207], v[52:55]
  v_mfma_f32_16x16x32_bf16 v[56:59], a[168:171], v[204:207], v[56:59]
  v_mfma_f32_16x16x32_bf16 v[60:63], a[172:175], v[204:207], v[60:63]
  ds_read_b128 v[204:207], v242 offset:53248
  s_waitcnt lgkmcnt(15)
  v_mfma_f32_16x16x32_bf16 v[0:3], a[176:179], v[208:211], v[0:3]
  v_mfma_f32_16x16x32_bf16 v[4:7], a[180:183], v[208:211], v[4:7]
  v_mfma_f32_16x16x32_bf16 v[8:11], a[184:187], v[208:211], v[8:11]
  v_mfma_f32_16x16x32_bf16 v[12:15], a[188:191], v[208:211], v[12:15]
  ds_read_b128 v[208:211], v241 offset:49152
  s_waitcnt lgkmcnt(15)
  v_mfma_f32_16x16x32_bf16 v[16:19], a[176:179], v[212:215], v[16:19]
  v_mfma_f32_16x16x32_bf16 v[20:23], a[180:183], v[212:215], v[20:23]
  v_mfma_f32_16x16x32_bf16 v[24:27], a[184:187], v[212:215], v[24:27]
  v_mfma_f32_16x16x32_bf16 v[28:31], a[188:191], v[212:215], v[28:31]
  ds_read_b128 v[212:215], v243 offset:49152
  s_waitcnt lgkmcnt(15)
  v_mfma_f32_16x16x32_bf16 v[32:35], a[176:179], v[216:219], v[32:35]
  v_mfma_f32_16x16x32_bf16 v[36:39], a[180:183], v[216:219], v[36:39]
  v_mfma_f32_16x16x32_bf16 v[40:43], a[184:187], v[216:219], v[40:43]
  v_mfma_f32_16x16x32_bf16 v[44:47], a[188:191], v[216:219], v[44:47]
  ds_read_b128 v[216:219], v241 offset:53248
  s_waitcnt lgkmcnt(15)
  v_mfma_f32_16x16x32_bf16 v[48:51], a[176:179], v[220:223], v[48:51]
  v_mfma_f32_16x16x32_bf16 v[52:55], a[180:183], v[220:223], v[52:55]
  v_mfma_f32_16x16x32_bf16 v[56:59], a[184:187], v[220:223], v[56:59]
  v_mfma_f32_16x16x32_bf16 v[60:63], a[188:191], v[220:223], v[60:63]
  ds_read_b128 v[220:223], v243 offset:53248
  s_barrier
  s_waitcnt lgkmcnt(15)
  s_waitcnt lgkmcnt(6)
  v_mfma_f32_16x16x32_bf16 v[0:3], a[192:195], v[192:195], v[0:3]
  v_mfma_f32_16x16x32_bf16 v[4:7], a[196:199], v[192:195], v[4:7]
  v_mfma_f32_16x16x32_bf16 v[8:11], a[200:203], v[192:195], v[8:11]
  s_lshr_b32 s6, s3, 1
  s_add_u32 s6, s6, s14
  v_mfma_f32_16x16x32_bf16 v[12:15], a[204:207], v[192:195], v[12:15]
  ds_read_b128 v[192:195], v240 offset:57344
  s_add_u32 s6, s6, 6
  v_mfma_f32_16x16x32_bf16 v[16:19], a[192:195], v[196:199], v[16:19]
  s_and_b32 s6, s6, 7
  s_lshl_b32 s6, s6, 7
  v_mfma_f32_16x16x32_bf16 v[20:23], a[196:199], v[196:199], v[20:23]
  s_add_u32 m0, s9, 32768
  s_add_u32 s6, s6, s11
  v_mfma_f32_16x16x32_bf16 v[24:27], a[200:203], v[196:199], v[24:27]
  buffer_load_dwordx4 v248, s[60:63], s6 offen offset:0 lds
  buffer_load_dwordx4 v249, s[60:63], s6 offen offset:1024 lds
  v_mfma_f32_16x16x32_bf16 v[28:31], a[204:207], v[196:199], v[28:31]
  ds_read_b128 v[196:199], v242 offset:57344
  s_add_u32 m0, s9, 34816
  s_waitcnt lgkmcnt(7)
  v_mfma_f32_16x16x32_bf16 v[32:35], a[192:195], v[200:203], v[32:35]
  s_nop 0
  buffer_load_dwordx4 v248, s[44:47], s6 offen offset:0 lds
  v_mfma_f32_16x16x32_bf16 v[36:39], a[196:199], v[200:203], v[36:39]
  buffer_load_dwordx4 v249, s[44:47], s6 offen offset:1024 lds
  s_waitcnt vmcnt(4)
  ds_read_b128 a[224:227], v250 offset:8192
  v_mfma_f32_16x16x32_bf16 v[40:43], a[200:203], v[200:203], v[40:43]
  ds_read_b128 a[228:231], v250 offset:10240
  ds_read_b128 a[232:235], v250 offset:12288
  v_mfma_f32_16x16x32_bf16 v[44:47], a[204:207], v[200:203], v[44:47]
  ds_read_b128 v[200:203], v240 offset:61440
  ds_read_b128 a[236:239], v250 offset:14336
  s_waitcnt lgkmcnt(11)
  v_mfma_f32_16x16x32_bf16 v[48:51], a[192:195], v[204:207], v[48:51]
  ds_read_b128 a[240:243], v251 offset:8192
  ds_read_b128 a[244:247], v251 offset:10240
  v_mfma_f32_16x16x32_bf16 v[52:55], a[196:199], v[204:207], v[52:55]
  ds_read_b128 a[248:251], v251 offset:12288
  ds_read_b128 a[252:255], v251 offset:14336
  v_mfma_f32_16x16x32_bf16 v[56:59], a[200:203], v[204:207], v[56:59]
  v_mfma_f32_16x16x32_bf16 v[60:63], a[204:207], v[204:207], v[60:63]
  ds_read_b128 v[204:207], v242 offset:61440
  s_waitcnt lgkmcnt(15)
  v_mfma_f32_16x16x32_bf16 v[0:3], a[208:211], v[208:211], v[0:3]
  v_mfma_f32_16x16x32_bf16 v[4:7], a[212:215], v[208:211], v[4:7]
  v_mfma_f32_16x16x32_bf16 v[8:11], a[216:219], v[208:211], v[8:11]
  v_mfma_f32_16x16x32_bf16 v[12:15], a[220:223], v[208:211], v[12:15]
  ds_read_b128 v[208:211], v241 offset:57344
  s_waitcnt lgkmcnt(15)
  v_mfma_f32_16x16x32_bf16 v[16:19], a[208:211], v[212:215], v[16:19]
  v_mfma_f32_16x16x32_bf16 v[20:23], a[212:215], v[212:215], v[20:23]
  v_mfma_f32_16x16x32_bf16 v[24:27], a[216:219], v[212:215], v[24:27]
  v_mfma_f32_16x16x32_bf16 v[28:31], a[220:223], v[212:215], v[28:31]
  ds_read_b128 v[212:215], v243 offset:57344
  s_waitcnt lgkmcnt(15)
  v_mfma_f32_16x16x32_bf16 v[32:35], a[208:211], v[216:219], v[32:35]
  v_mfma_f32_16x16x32_bf16 v[36:39], a[212:215], v[216:219], v[36:39]
  v_mfma_f32_16x16x32_bf16 v[40:43], a[216:219], v[216:219], v[40:43]
  v_mfma_f32_16x16x32_bf16 v[44:47], a[220:223], v[216:219], v[44:47]
  ds_read_b128 v[216:219], v241 offset:61440
  s_waitcnt lgkmcnt(15)
  v_mfma_f32_16x16x32_bf16 v[48:51], a[208:211], v[220:223], v[48:51]
  v_mfma_f32_16x16x32_bf16 v[52:55], a[212:215], v[220:223], v[52:55]
  v_mfma_f32_16x16x32_bf16 v[56:59], a[216:219], v[220:223], v[56:59]
  v_mfma_f32_16x16x32_bf16 v[60:63], a[220:223], v[220:223], v[60:63]
  ds_read_b128 v[220:223], v243 offset:61440
  s_waitcnt lgkmcnt(15)
  s_waitcnt lgkmcnt(5)
  v_mfma_f32_16x16x32_bf16 v[0:3], a[224:227], v[192:195], v[0:3]
  v_mfma_f32_16x16x32_bf16 v[4:7], a[228:231], v[192:195], v[4:7]
  v_mfma_f32_16x16x32_bf16 v[8:11], a[232:235], v[192:195], v[8:11]
  v_mfma_f32_16x16x32_bf16 v[12:15], a[236:239], v[192:195], v[12:15]
  ds_read_b128 v[192:195], v244 offset:0
  v_mfma_f32_16x16x32_bf16 v[16:19], a[224:227], v[196:199], v[16:19]
  v_mfma_f32_16x16x32_bf16 v[20:23], a[228:231], v[196:199], v[20:23]
  v_mfma_f32_16x16x32_bf16 v[24:27], a[232:235], v[196:199], v[24:27]
  v_mfma_f32_16x16x32_bf16 v[28:31], a[236:239], v[196:199], v[28:31]
  ds_read_b128 v[196:199], v246 offset:0
  v_mfma_f32_16x16x32_bf16 v[32:35], a[224:227], v[200:203], v[32:35]
  v_mfma_f32_16x16x32_bf16 v[36:39], a[228:231], v[200:203], v[36:39]
  v_mfma_f32_16x16x32_bf16 v[40:43], a[232:235], v[200:203], v[40:43]
  v_mfma_f32_16x16x32_bf16 v[44:47], a[236:239], v[200:203], v[44:47]
  ds_read_b128 v[200:203], v244 offset:4096
  s_waitcnt lgkmcnt(7)
  v_mfma_f32_16x16x32_bf16 v[48:51], a[224:227], v[204:207], v[48:51]
  v_mfma_f32_16x16x32_bf16 v[52:55], a[228:231], v[204:207], v[52:55]
  v_mfma_f32_16x16x32_bf16 v[56:59], a[232:235], v[204:207], v[56:59]
  v_mfma_f32_16x16x32_bf16 v[60:63], a[236:239], v[204:207], v[60:63]
  ds_read_b128 v[204:207], v246 offset:4096
  s_waitcnt lgkmcnt(7)
  v_mfma_f32_16x16x32_bf16 v[0:3], a[240:243], v[208:211], v[0:3]
  v_mfma_f32_16x16x32_bf16 v[4:7], a[244:247], v[208:211], v[4:7]
  v_mfma_f32_16x16x32_bf16 v[8:11], a[248:251], v[208:211], v[8:11]
  v_mfma_f32_16x16x32_bf16 v[12:15], a[252:255], v[208:211], v[12:15]
  ds_read_b128 v[208:211], v245 offset:0
  s_waitcnt lgkmcnt(7)
  v_mfma_f32_16x16x32_bf16 v[16:19], a[240:243], v[212:215], v[16:19]
  v_mfma_f32_16x16x32_bf16 v[20:23], a[244:247], v[212:215], v[20:23]
  v_mfma_f32_16x16x32_bf16 v[24:27], a[248:251], v[212:215], v[24:27]
  v_mfma_f32_16x16x32_bf16 v[28:31], a[252:255], v[212:215], v[28:31]
  ds_read_b128 v[212:215], v247 offset:0
  s_waitcnt lgkmcnt(7)
  v_mfma_f32_16x16x32_bf16 v[32:35], a[240:243], v[216:219], v[32:35]
  v_mfma_f32_16x16x32_bf16 v[36:39], a[244:247], v[216:219], v[36:39]
  v_mfma_f32_16x16x32_bf16 v[40:43], a[248:251], v[216:219], v[40:43]
  v_mfma_f32_16x16x32_bf16 v[44:47], a[252:255], v[216:219], v[44:47]
  ds_read_b128 v[216:219], v245 offset:4096
  s_waitcnt lgkmcnt(7)
  v_mfma_f32_16x16x32_bf16 v[48:51], a[240:243], v[220:223], v[48:51]
  v_mfma_f32_16x16x32_bf16 v[52:55], a[244:247], v[220:223], v[52:55]
  v_mfma_f32_16x16x32_bf16 v[56:59], a[248:251], v[220:223], v[56:59]
  v_mfma_f32_16x16x32_bf16 v[60:63], a[252:255], v[220:223], v[60:63]
  ds_read_b128 v[220:223], v247 offset:4096
  s_barrier
  s_waitcnt lgkmcnt(7)
  v_mfma_f32_16x16x32_bf16 v[64:67], a[0:3], v[192:195], 0
  v_mfma_f32_16x16x32_bf16 v[68:71], a[4:7], v[192:195], 0
  v_mfma_f32_16x16x32_bf16 v[72:75], a[8:11], v[192:195], 0
  s_lshr_b32 s6, s3, 1
  s_add_u32 s6, s6, s14
  v_mfma_f32_16x16x32_bf16 v[76:79], a[12:15], v[192:195], 0
  ds_read_b128 v[192:195], v244 offset:8192
  s_add_u32 s6, s6, 0
  s_waitcnt lgkmcnt(7)
  v_mfma_f32_16x16x32_bf16 v[80:83], a[0:3], v[196:199], 0
  s_and_b32 s6, s6, 7
  s_lshl_b32 s6, s6, 7
  v_mfma_f32_16x16x32_bf16 v[84:87], a[4:7], v[196:199], 0
  s_add_u32 m0, s9, 49152
  s_add_u32 s6, s6, s12
  v_mfma_f32_16x16x32_bf16 v[88:91], a[8:11], v[196:199], 0
  buffer_load_dwordx4 v248, s[60:63], s6 offen offset:0 lds
  buffer_load_dwordx4 v249, s[60:63], s6 offen offset:1024 lds
  v_mfma_f32_16x16x32_bf16 v[92:95], a[12:15], v[196:199], 0
  ds_read_b128 v[196:199], v246 offset:8192
  s_add_u32 m0, s9, 51200
  s_waitcnt lgkmcnt(7)
  v_mfma_f32_16x16x32_bf16 v[96:99], a[0:3], v[200:203], 0
  s_nop 0
  buffer_load_dwordx4 v248, s[44:47], s6 offen offset:0 lds
  v_mfma_f32_16x16x32_bf16 v[100:103], a[4:7], v[200:203], 0
  buffer_load_dwordx4 v249, s[44:47], s6 offen offset:1024 lds
  ds_read_b64 v[224:225], v238 offset:0
  v_mfma_f32_16x16x32_bf16 v[104:107], a[8:11], v[200:203], 0
  ds_read_b64 v[228:229], v238 offset:1024
  ds_read_b64 v[226:227], v239 offset:2048
  v_mfma_f32_16x16x32_bf16 v[108:111], a[12:15], v[200:203], 0
  ds_read_b128 v[200:203], v244 offset:12288
  s_add_u32 s8, s95, 0
  s_waitcnt lgkmcnt(10)
  v_mfma_f32_16x16x32_bf16 v[112:115], a[0:3], v[204:207], 0
  s_lshr_b32 s8, s8, 1
  s_lshl_b32 s8, s8, 13
  v_mfma_f32_16x16x32_bf16 v[116:119], a[4:7], v[204:207], 0
  s_add_u32 s7, s8, 50331648
  buffer_store_dwordx4 v[0:3], v236, s[64:67], s7 offen offset:0 sc1
  v_mfma_f32_16x16x32_bf16 v[120:123], a[8:11], v[204:207], 0
  buffer_store_dwordx4 v[4:7], v236, s[64:67], s7 offen offset:2048 sc1
  s_add_u32 s7, s8, 50462720
  v_mfma_f32_16x16x32_bf16 v[124:127], a[12:15], v[204:207], 0
  ds_read_b128 v[204:207], v246 offset:12288
  buffer_store_dwordx4 v[8:11], v236, s[64:67], s7 offen offset:0 sc1
  s_waitcnt lgkmcnt(10)
  v_mfma_f32_16x16x32_bf16 v[64:67], a[16:19], v[208:211], v[64:67]
  buffer_store_dwordx4 v[12:15], v236, s[64:67], s7 offen offset:2048 sc1
  s_add_u32 s8, s95, 0
  v_mfma_f32_16x16x32_bf16 v[68:71], a[20:23], v[208:211], v[68:71]
  s_lshr_b32 s8, s8, 1
  s_lshl_b32 s8, s8, 13
  v_mfma_f32_16x16x32_bf16 v[72:75], a[24:27], v[208:211], v[72:75]
  s_add_u32 s7, s8, 50335744
  buffer_store_dwordx4 v[16:19], v236, s[64:67], s7 offen offset:0 sc1
  v_mfma_f32_16x16x32_bf16 v[76:79], a[28:31], v[208:211], v[76:79]
  ds_read_b128 v[208:211], v245 offset:8192
  buffer_store_dwordx4 v[20:23], v236, s[64:67], s7 offen offset:2048 sc1
  s_waitcnt lgkmcnt(10)
  v_mfma_f32_16x16x32_bf16 v[80:83], a[16:19], v[212:215], v[80:83]
  s_add_u32 s7, s8, 50466816
  buffer_store_dwordx4 v[24:27], v236, s[64:67], s7 offen offset:0 sc1
  v_mfma_f32_16x16x32_bf16 v[84:87], a[20:23], v[212:215], v[84:87]
  buffer_store_dwordx4 v[28:31], v236, s[64:67], s7 offen offset:2048 sc1
  s_waitcnt lgkmcnt(3)
  v_fma_f32 v234, v0, v224, v1
  v_mfma_f32_16x16x32_bf16 v[88:91], a[24:27], v[212:215], v[88:91]
  v_fma_f32 v235, v0, v225, v17
  v_fma_f32 v232, -v16, v225, v234
  v_mfma_f32_16x16x32_bf16 v[92:95], a[28:31], v[212:215], v[92:95]
  ds_read_b128 v[212:215], v247 offset:8192
  v_fma_f32 v233, v16, v224, v235
  v_mfma_f32_16x16x32_bf16 v[96:99], a[16:19], v[216:219], v[96:99]
  v_fma_f32 v234, v232, v224, v2
  v_fma_f32 v235, v232, v225, v18
  v_mfma_f32_16x16x32_bf16 v[100:103], a[20:23], v[216:219], v[100:103]
  v_fma_f32 v232, -v233, v225, v234
  v_fma_f32 v233, v233, v224, v235
  v_mfma_f32_16x16x32_bf16 v[104:107], a[24:27], v[216:219], v[104:107]
  v_fma_f32 v234, v232, v224, v3
  v_fma_f32 v235, v232, v225, v19
  v_mfma_f32_16x16x32_bf16 v[108:111], a[28:31], v[216:219], v[108:111]
  ds_read_b128 v[216:219], v245 offset:12288
  v_fma_f32 v232, -v233, v225, v234
  v_mfma_f32_16x16x32_bf16 v[112:115], a[16:19], v[220:223], v[112:115]
  v_fma_f32 v233, v233, v224, v235
  v_fma_f32 v234, v4, v224, v5
  v_mfma_f32_16x16x32_bf16 v[116:119], a[20:23], v[220:223], v[116:119]
  v_fma_f32 v235, v4, v225, v21
  v_fma_f32 v230, -v20, v225, v234
  v_mfma_f32_16x16x32_bf16 v[120:123], a[24:27], v[220:223], v[120:123]
  v_fma_f32 v231, v20, v224, v235
  v_fma_f32 v234, v230, v224, v6
  v_mfma_f32_16x16x32_bf16 v[124:127], a[28:31], v[220:223], v[124:127]
  ds_read_b128 v[220:223], v247 offset:12288
  v_fma_f32 v235, v230, v225, v22
  v_mfma_f32_16x16x32_bf16 v[64:67], a[32:35], v[192:195], v[64:67]
  v_fma_f32 v230, -v231, v225, v234
  v_fma_f32 v231, v231, v224, v235
  v_mfma_f32_16x16x32_bf16 v[68:71], a[36:39], v[192:195], v[68:71]
  v_fma_f32 v234, v230, v224, v7
  v_fma_f32 v235, v230, v225, v23
  v_mfma_f32_16x16x32_bf16 v[72:75], a[40:43], v[192:195], v[72:75]
  v_fma_f32 v230, -v231, v225, v234
  v_fma_f32 v231, v231, v224, v235
  v_mfma_f32_16x16x32_bf16 v[76:79], a[44:47], v[192:195], v[76:79]
  ds_read_b128 v[192:195], v240 offset:0
  v_fma_f32 v234, v232, v228, v230
  v_mfma_f32_16x16x32_bf16 v[80:83], a[32:35], v[196:199], v[80:83]
  v_fma_f32 v235, v232, v229, v231
  v_fma_f32 v232, -v233, v229, v234
  v_mfma_f32_16x16x32_bf16 v[84:87], a[36:39], v[196:199], v[84:87]
  v_fma_f32 v233, v233, v228, v235
  v_mul_f32 v234, v232, v226
  v_mfma_f32_16x16x32_bf16 v[88:91], a[40:43], v[196:199], v[88:91]
  v_mul_f32 v235, v232, v227
  v_fma_f32 v230, -v233, v227, v234
  v_mfma_f32_16x16x32_bf16 v[92:95], a[44:47], v[196:199], v[92:95]
  ds_read_b128 v[196:199], v242 offset:0
  v_fma_f32 v231, v233, v226, v235
  s_waitcnt lgkmcnt(7)
  v_mfma_f32_16x16x32_bf16 v[96:99], a[32:35], v[200:203], v[96:99]
  v_mov_b32 v234, v230
  v_mov_b32 v235, v231
  v_mfma_f32_16x16x32_bf16 v[100:103], a[36:39], v[200:203], v[100:103]
  s_nop 1
  v_permlane32_swap_b32 v230, v234
  v_mfma_f32_16x16x32_bf16 v[104:107], a[40:43], v[200:203], v[104:107]
  v_permlane32_swap_b32 v231, v235
  v_add_f32 v230, v230, v234
  v_mfma_f32_16x16x32_bf16 v[108:111], a[44:47], v[200:203], v[108:111]
  ds_read_b128 v[200:203], v240 offset:4096
  v_add_f32 v231, v231, v235
  s_waitcnt lgkmcnt(7)
  v_mfma_f32_16x16x32_bf16 v[112:115], a[32:35], v[204:207], v[112:115]
  v_mov_b32 v234, v230
  v_mov_b32 v235, v231
  v_mfma_f32_16x16x32_bf16 v[116:119], a[36:39], v[204:207], v[116:119]
  s_nop 1
  v_permlane16_swap_b32 v230, v234
  v_mfma_f32_16x16x32_bf16 v[120:123], a[40:43], v[204:207], v[120:123]
  v_permlane16_swap_b32 v231, v235
  v_add_f32 v230, v230, v234
  v_mfma_f32_16x16x32_bf16 v[124:127], a[44:47], v[204:207], v[124:127]
  ds_read_b128 v[204:207], v242 offset:4096
  v_add_f32 v231, v231, v235
  s_waitcnt lgkmcnt(7)
  v_mfma_f32_16x16x32_bf16 v[64:67], a[48:51], v[208:211], v[64:67]
  s_add_u32 s8, s95, 0
  s_lshl_b32 s8, s8, 7
  v_mfma_f32_16x16x32_bf16 v[68:71], a[52:55], v[208:211], v[68:71]
  s_add_u32 s8, s8, 58720256
  buffer_store_dwordx2 v[230:231], v237, s[64:67], s8 offen
  v_mfma_f32_16x16x32_bf16 v[72:75], a[56:59], v[208:211], v[72:75]
  v_fma_f32 v234, v8, v224, v9
  v_fma_f32 v235, v8, v225, v25
  v_mfma_f32_16x16x32_bf16 v[76:79], a[60:63], v[208:211], v[76:79]
  ds_read_b128 v[208:211], v241 offset:0
  v_fma_f32 v232, -v24, v225, v234
  s_waitcnt lgkmcnt(7)
  v_mfma_f32_16x16x32_bf16 v[80:83], a[48:51], v[212:215], v[80:83]
  v_fma_f32 v233, v24, v224, v235
  v_fma_f32 v234, v232, v224, v10
  v_mfma_f32_16x16x32_bf16 v[84:87], a[52:55], v[212:215], v[84:87]
  v_fma_f32 v235, v232, v225, v26
  v_fma_f32 v232, -v233, v225, v234
  v_mfma_f32_16x16x32_bf16 v[88:91], a[56:59], v[212:215], v[88:91]
  v_fma_f32 v233, v233, v224, v235
  v_fma_f32 v234, v232, v224, v11
  v_mfma_f32_16x16x32_bf16 v[92:95], a[60:63], v[212:215], v[92:95]
  ds_read_b128 v[212:215], v243 offset:0
  v_fma_f32 v235, v232, v225, v27
  s_waitcnt lgkmcnt(7)
  v_mfma_f32_16x16x32_bf16 v[96:99], a[48:51], v[216:219], v[96:99]
  v_fma_f32 v232, -v233, v225, v234
  v_fma_f32 v233, v233, v224, v235
  v_mfma_f32_16x16x32_bf16 v[100:103], a[52:55], v[216:219], v[100:103]
  v_fma_f32 v234, v12, v224, v13
  v_fma_f32 v235, v12, v225, v29
  v_mfma_f32_16x16x32_bf16 v[104:107], a[56:59], v[216:219], v[104:107]
  v_fma_f32 v230, -v28, v225, v234
  v_fma_f32 v231, v28, v224, v235
  v_mfma_f32_16x16x32_bf16 v[108:111], a[60:63], v[216:219], v[108:111]
  ds_read_b128 v[216:219], v241 offset:4096
  v_fma_f32 v234, v230, v224, v14
  s_waitcnt lgkmcnt(7)
  v_mfma_f32_16x16x32_bf16 v[112:115], a[48:51], v[220:223], v[112:115]
  v_fma_f32 v235, v230, v225, v30
  v_fma_f32 v230, -v231, v225, v234
  v_mfma_f32_16x16x32_bf16 v[116:119], a[52:55], v[220:223], v[116:119]
  v_fma_f32 v231, v231, v224, v235
  v_fma_f32 v234, v230, v224, v15
  v_mfma_f32_16x16x32_bf16 v[120:123], a[56:59], v[220:223], v[120:123]
  v_fma_f32 v235, v230, v225, v31
  v_fma_f32 v230, -v231, v225, v234
  v_mfma_f32_16x16x32_bf16 v[124:127], a[60:63], v[220:223], v[124:127]
  ds_read_b128 v[220:223], v243 offset:4096
  v_fma_f32 v231, v231, v224, v235
  s_barrier
  s_waitcnt lgkmcnt(7)
  v_mfma_f32_16x16x32_bf16 v[64:67], a[64:67], v[192:195], v[64:67]
  v_fma_f32 v234, v232, v228, v230
  v_fma_f32 v235, v232, v229, v231
  v_mfma_f32_16x16x32_bf16 v[68:71], a[68:71], v[192:195], v[68:71]
  v_fma_f32 v232, -v233, v229, v234
  v_fma_f32 v233, v233, v228, v235
  v_mfma_f32_16x16x32_bf16 v[72:75], a[72:75], v[192:195], v[72:75]
  s_lshr_b32 s6, s3, 1
  s_add_u32 s6, s6, s14
  v_mfma_f32_16x16x32_bf16 v[76:79], a[76:79], v[192:195], v[76:79]
  ds_read_b128 v[192:195], v240 offset:8192
  s_add_u32 s6, s6, 2
  s_waitcnt lgkmcnt(7)
  v_mfma_f32_16x16x32_bf16 v[80:83], a[64:67], v[196:199], v[80:83]
  s_and_b32 s6, s6, 7
  s_lshl_b32 s6, s6, 7
  v_mfma_f32_16x16x32_bf16 v[84:87], a[68:71], v[196:199], v[84:87]
  s_add_u32 m0, s9, 65536
  s_add_u32 s6, s6, s12
  v_mfma_f32_16x16x32_bf16 v[88:91], a[72:75], v[196:199], v[88:91]
  buffer_load_dwordx4 v248, s[60:63], s6 offen offset:0 lds
  buffer_load_dwordx4 v249, s[60:63], s6 offen offset:1024 lds
  v_mfma_f32_16x16x32_bf16 v[92:95], a[76:79], v[196:199], v[92:95]
  ds_read_b128 v[196:199], v242 offset:8192
  s_add_u32 m0, s9, 67584
  s_waitcnt lgkmcnt(7)
  v_mfma_f32_16x16x32_bf16 v[96:99], a[64:67], v[200:203], v[96:99]
  s_nop 0
  buffer_load_dwordx4 v248, s[44:47], s6 offen offset:0 lds
  v_mfma_f32_16x16x32_bf16 v[100:103], a[68:71], v[200:203], v[100:103]
  buffer_load_dwordx4 v249, s[44:47], s6 offen offset:1024 lds
  v_mul_f32 v234, v232, v226
  v_mfma_f32_16x16x32_bf16 v[104:107], a[72:75], v[200:203], v[104:107]
  v_mul_f32 v235, v232, v227
  v_fma_f32 v230, -v233, v227, v234
  v_mfma_f32_16x16x32_bf16 v[108:111], a[76:79], v[200:203], v[108:111]
  ds_read_b128 v[200:203], v240 offset:12288
  v_fma_f32 v231, v233, v226, v235
  s_waitcnt lgkmcnt(7)
  v_mfma_f32_16x16x32_bf16 v[112:115], a[64:67], v[204:207], v[112:115]
  v_mov_b32 v234, v230
  v_mov_b32 v235, v231
  v_mfma_f32_16x16x32_bf16 v[116:119], a[68:71], v[204:207], v[116:119]
  s_nop 1
  v_permlane32_swap_b32 v230, v234
  v_mfma_f32_16x16x32_bf16 v[120:123], a[72:75], v[204:207], v[120:123]
  v_permlane32_swap_b32 v231, v235
  v_add_f32 v230, v230, v234
  v_mfma_f32_16x16x32_bf16 v[124:127], a[76:79], v[204:207], v[124:127]
  ds_read_b128 v[204:207], v242 offset:12288
  v_add_f32 v231, v231, v235
  s_waitcnt lgkmcnt(7)
  v_mfma_f32_16x16x32_bf16 v[64:67], a[80:83], v[208:211], v[64:67]
  v_mov_b32 v234, v230
  v_mov_b32 v235, v231
  v_mfma_f32_16x16x32_bf16 v[68:71], a[84:87], v[208:211], v[68:71]
  s_nop 1
  v_permlane16_swap_b32 v230, v234
  v_mfma_f32_16x16x32_bf16 v[72:75], a[88:91], v[208:211], v[72:75]
  v_permlane16_swap_b32 v231, v235
  v_add_f32 v230, v230, v234
  v_mfma_f32_16x16x32_bf16 v[76:79], a[92:95], v[208:211], v[76:79]
  ds_read_b128 v[208:211], v241 offset:8192
  v_add_f32 v231, v231, v235
  s_waitcnt lgkmcnt(7)
  v_mfma_f32_16x16x32_bf16 v[80:83], a[80:83], v[212:215], v[80:83]
  s_add_u32 s8, s95, 0
  s_lshl_b32 s8, s8, 7
  v_mfma_f32_16x16x32_bf16 v[84:87], a[84:87], v[212:215], v[84:87]
  s_add_u32 s8, s8, 58724352
  buffer_store_dwordx2 v[230:231], v237, s[64:67], s8 offen
  v_mfma_f32_16x16x32_bf16 v[88:91], a[88:91], v[212:215], v[88:91]
  ds_read_b64 v[224:225], v238 offset:128
  v_mfma_f32_16x16x32_bf16 v[92:95], a[92:95], v[212:215], v[92:95]
  ds_read_b128 v[212:215], v243 offset:8192
  ds_read_b64 v[228:229], v238 offset:1152
  s_waitcnt lgkmcnt(9)
  v_mfma_f32_16x16x32_bf16 v[96:99], a[80:83], v[216:219], v[96:99]
  ds_read_b64 v[226:227], v239 offset:2176
  s_add_u32 s8, s95, 1
  v_mfma_f32_16x16x32_bf16 v[100:103], a[84:87], v[216:219], v[100:103]
  s_lshr_b32 s8, s8, 1
  s_lshl_b32 s8, s8, 13
  v_mfma_f32_16x16x32_bf16 v[104:107], a[88:91], v[216:219], v[104:107]
  s_add_u32 s7, s8, 50331904
  v_mfma_f32_16x16x32_bf16 v[108:111], a[92:95], v[216:219], v[108:111]
  ds_read_b128 v[216:219], v241 offset:12288
  buffer_store_dwordx4 v[32:35], v236, s[64:67], s7 offen offset:0 sc1
  s_waitcnt lgkmcnt(10)
  v_mfma_f32_16x16x32_bf16 v[112:115], a[80:83], v[220:223], v[112:115]
  buffer_store_dwordx4 v[36:39], v236, s[64:67], s7 offen offset:2048 sc1
  s_add_u32 s7, s8, 50462976
  v_mfma_f32_16x16x32_bf16 v[116:119], a[84:87], v[220:223], v[116:119]
  buffer_store_dwordx4 v[40:43], v236, s[64:67], s7 offen offset:0 sc1
  buffer_store_dwordx4 v[44:47], v236, s[64:67], s7 offen offset:2048 sc1
  v_mfma_f32_16x16x32_bf16 v[120:123], a[88:91], v[220:223], v[120:123]
  s_add_u32 s8, s95, 1
  v_mfma_f32_16x16x32_bf16 v[124:127], a[92:95], v[220:223], v[124:127]
  ds_read_b128 v[220:223], v243 offset:12288
  s_lshr_b32 s8, s8, 1
  s_waitcnt lgkmcnt(10)
  v_mfma_f32_16x16x32_bf16 v[64:67], a[96:99], v[192:195], v[64:67]
  s_lshl_b32 s8, s8, 13
  s_add_u32 s7, s8, 50336000
  v_mfma_f32_16x16x32_bf16 v[68:71], a[100:103], v[192:195], v[68:71]
  buffer_store_dwordx4 v[48:51], v236, s[64:67], s7 offen offset:0 sc1
  buffer_store_dwordx4 v[52:55], v236, s[64:67], s7 offen offset:2048 sc1
  v_mfma_f32_16x16x32_bf16 v[72:75], a[104:107], v[192:195], v[72:75]
  s_add_u32 s7, s8, 50467072
  v_mfma_f32_16x16x32_bf16 v[76:79], a[108:111], v[192:195], v[76:79]
  ds_read_b128 v[192:195], v240 offset:16384
  buffer_store_dwordx4 v[56:59], v236, s[64:67], s7 offen offset:0 sc1
  s_waitcnt lgkmcnt(10)
  v_mfma_f32_16x16x32_bf16 v[80:83], a[96:99], v[196:199], v[80:83]
  buffer_store_dwordx4 v[60:63], v236, s[64:67], s7 offen offset:2048 sc1
  s_waitcnt lgkmcnt(3)
  v_fma_f32 v234, v32, v224, v33
  v_mfma_f32_16x16x32_bf16 v[84:87], a[100:103], v[196:199], v[84:87]
  v_fma_f32 v235, v32, v225, v49
  v_mfma_f32_16x16x32_bf16 v[88:91], a[104:107], v[196:199], v[88:91]
  v_fma_f32 v232, -v48, v225, v234
  v_fma_f32 v233, v48, v224, v235
  v_mfma_f32_16x16x32_bf16 v[92:95], a[108:111], v[196:199], v[92:95]
  ds_read_b128 v[196:199], v242 offset:16384
  v_fma_f32 v234, v232, v224, v34
  v_mfma_f32_16x16x32_bf16 v[96:99], a[96:99], v[200:203], v[96:99]
  v_fma_f32 v235, v232, v225, v50
  v_fma_f32 v232, -v233, v225, v234
  v_mfma_f32_16x16x32_bf16 v[100:103], a[100:103], v[200:203], v[100:103]
  v_fma_f32 v233, v233, v224, v235
  v_mfma_f32_16x16x32_bf16 v[104:107], a[104:107], v[200:203], v[104:107]
  v_fma_f32 v234, v232, v224, v35
  v_mfma_f32_16x16x32_bf16 v[108:111], a[108:111], v[200:203], v[108:111]
  ds_read_b128 v[200:203], v240 offset:20480
  v_fma_f32 v235, v232, v225, v51
  v_mfma_f32_16x16x32_bf16 v[112:115], a[96:99], v[204:207], v[112:115]
  v_fma_f32 v232, -v233, v225, v234
  v_fma_f32 v233, v233, v224, v235
  v_mfma_f32_16x16x32_bf16 v[116:119], a[100:103], v[204:207], v[116:119]
  v_fma_f32 v234, v36, v224, v37
  v_mfma_f32_16x16x32_bf16 v[120:123], a[104:107], v[204:207], v[120:123]
  v_fma_f32 v235, v36, v225, v53
  v_fma_f32 v230, -v52, v225, v234
  v_mfma_f32_16x16x32_bf16 v[124:127], a[108:111], v[204:207], v[124:127]
  ds_read_b128 v[204:207], v242 offset:20480
  v_fma_f32 v231, v52, v224, v235
  v_mfma_f32_16x16x32_bf16 v[64:67], a[112:115], v[208:211], v[64:67]
  v_fma_f32 v234, v230, v224, v38
  v_mfma_f32_16x16x32_bf16 v[68:71], a[116:119], v[208:211], v[68:71]
  v_fma_f32 v235, v230, v225, v54
  v_mfma_f32_16x16x32_bf16 v[72:75], a[120:123], v[208:211], v[72:75]
  v_fma_f32 v230, -v231, v225, v234
  v_fma_f32 v231, v231, v224, v235
  v_mfma_f32_16x16x32_bf16 v[76:79], a[124:127], v[208:211], v[76:79]
  ds_read_b128 v[208:211], v241 offset:16384
  v_fma_f32 v234, v230, v224, v39
  v_mfma_f32_16x16x32_bf16 v[80:83], a[112:115], v[212:215], v[80:83]
  v_fma_f32 v235, v230, v225, v55
  v_mfma_f32_16x16x32_bf16 v[84:87], a[116:119], v[212:215], v[84:87]
  v_fma_f32 v230, -v231, v225, v234
  v_mfma_f32_16x16x32_bf16 v[88:91], a[120:123], v[212:215], v[88:91]
  v_fma_f32 v231, v231, v224, v235
  v_fma_f32 v234, v232, v228, v230
  v_mfma_f32_16x16x32_bf16 v[92:95], a[124:127], v[212:215], v[92:95]
  ds_read_b128 v[212:215], v243 offset:16384
  v_fma_f32 v235, v232, v229, v231
  s_waitcnt lgkmcnt(7)
  v_mfma_f32_16x16x32_bf16 v[96:99], a[112:115], v[216:219], v[96:99]
  v_fma_f32 v232, -v233, v229, v234
  v_mfma_f32_16x16x32_bf16 v[100:103], a[116:119], v[216:219], v[100:103]
  v_fma_f32 v233, v233, v228, v235
  v_mfma_f32_16x16x32_bf16 v[104:107], a[120:123], v[216:219], v[104:107]
  v_mul_f32 v234, v232, v226
  v_mfma_f32_16x16x32_bf16 v[108:111], a[124:127], v[216:219], v[108:111]
  ds_read_b128 v[216:219], v241 offset:20480
  v_mul_f32 v235, v232, v227
  s_waitcnt lgkmcnt(7)
  v_mfma_f32_16x16x32_bf16 v[112:115], a[112:115], v[220:223], v[112:115]
  v_fma_f32 v230, -v233, v227, v234
  v_fma_f32 v231, v233, v226, v235
  v_mfma_f32_16x16x32_bf16 v[116:119], a[116:119], v[220:223], v[116:119]
  v_mov_b32 v234, v230
  v_mfma_f32_16x16x32_bf16 v[120:123], a[120:123], v[220:223], v[120:123]
  v_mov_b32 v235, v231
  v_mfma_f32_16x16x32_bf16 v[124:127], a[124:127], v[220:223], v[124:127]
  ds_read_b128 v[220:223], v243 offset:20480
  s_nop 1
  s_waitcnt vmcnt(26)
  s_barrier
  s_waitcnt lgkmcnt(7)
  v_mfma_f32_16x16x32_bf16 v[64:67], a[128:131], v[192:195], v[64:67]
  v_permlane32_swap_b32 v230, v234
  v_mfma_f32_16x16x32_bf16 v[68:71], a[132:135], v[192:195], v[68:71]
  v_permlane32_swap_b32 v231, v235
  v_mfma_f32_16x16x32_bf16 v[72:75], a[136:139], v[192:195], v[72:75]
  s_lshr_b32 s6, s3, 1
  s_add_u32 s6, s6, s14
  v_mfma_f32_16x16x32_bf16 v[76:79], a[140:143], v[192:195], v[76:79]
  ds_read_b128 v[192:195], v240 offset:24576
  s_add_u32 s6, s6, 4
  s_waitcnt lgkmcnt(7)
  v_mfma_f32_16x16x32_bf16 v[80:83], a[128:131], v[196:199], v[80:83]
  s_and_b32 s6, s6, 7
  s_lshl_b32 s6, s6, 7
  v_mfma_f32_16x16x32_bf16 v[84:87], a[132:135], v[196:199], v[84:87]
  s_add_u32 m0, s9, 0
  s_add_u32 s6, s6, s12
  v_mfma_f32_16x16x32_bf16 v[88:91], a[136:139], v[196:199], v[88:91]
  buffer_load_dwordx4 v248, s[60:63], s6 offen offset:0 lds
  buffer_load_dwordx4 v249, s[60:63], s6 offen offset:1024 lds
  v_mfma_f32_16x16x32_bf16 v[92:95], a[140:143], v[196:199], v[92:95]
  ds_read_b128 v[196:199], v242 offset:24576
  s_add_u32 m0, s9, 2048
  s_waitcnt lgkmcnt(7)
  v_mfma_f32_16x16x32_bf16 v[96:99], a[128:131], v[200:203], v[96:99]
  s_nop 0
  buffer_load_dwordx4 v248, s[44:47], s6 offen offset:0 lds
  v_mfma_f32_16x16x32_bf16 v[100:103], a[132:135], v[200:203], v[100:103]
  buffer_load_dwordx4 v249, s[44:47], s6 offen offset:1024 lds
  v_add_f32 v230, v230, v234
  v_mfma_f32_16x16x32_bf16 v[104:107], a[136:139], v[200:203], v[104:107]
  v_add_f32 v231, v231, v235
  v_mov_b32 v234, v230
  v_mfma_f32_16x16x32_bf16 v[108:111], a[140:143], v[200:203], v[108:111]
  ds_read_b128 v[200:203], v240 offset:28672
  v_mov_b32 v235, v231
  s_waitcnt lgkmcnt(7)
  v_mfma_f32_16x16x32_bf16 v[112:115], a[128:131], v[204:207], v[112:115]
  s_nop 1
  v_permlane16_swap_b32 v230, v234
  v_mfma_f32_16x16x32_bf16 v[116:119], a[132:135], v[204:207], v[116:119]
  v_permlane16_swap_b32 v231, v235
  v_mfma_f32_16x16x32_bf16 v[120:123], a[136:139], v[204:207], v[120:123]
  v_add_f32 v230, v230, v234
  v_mfma_f32_16x16x32_bf16 v[124:127], a[140:143], v[204:207], v[124:127]
  ds_read_b128 v[204:207], v242 offset:28672
  v_add_f32 v231, v231, v235
  s_waitcnt lgkmcnt(7)
  v_mfma_f32_16x16x32_bf16 v[64:67], a[144:147], v[208:211], v[64:67]
  s_add_u32 s8, s95, 1
  v_mfma_f32_16x16x32_bf16 v[68:71], a[148:151], v[208:211], v[68:71]
  s_lshl_b32 s8, s8, 7
  v_mfma_f32_16x16x32_bf16 v[72:75], a[152:155], v[208:211], v[72:75]
  s_add_u32 s8, s8, 58720256
  buffer_store_dwordx2 v[230:231], v237, s[64:67], s8 offen
  v_mfma_f32_16x16x32_bf16 v[76:79], a[156:159], v[208:211], v[76:79]
  ds_read_b128 v[208:211], v241 offset:24576
  v_fma_f32 v234, v40, v224, v41
  s_waitcnt lgkmcnt(7)
  v_mfma_f32_16x16x32_bf16 v[80:83], a[144:147], v[212:215], v[80:83]
  v_fma_f32 v235, v40, v225, v57
  v_mfma_f32_16x16x32_bf16 v[84:87], a[148:151], v[212:215], v[84:87]
  v_fma_f32 v232, -v56, v225, v234
  v_mfma_f32_16x16x32_bf16 v[88:91], a[152:155], v[212:215], v[88:91]
  v_fma_f32 v233, v56, v224, v235
  v_mfma_f32_16x16x32_bf16 v[92:95], a[156:159], v[212:215], v[92:95]
  ds_read_b128 v[212:215], v243 offset:24576
  v_fma_f32 v234, v232, v224, v42
  s_waitcnt lgkmcnt(7)
  v_mfma_f32_16x16x32_bf16 v[96:99], a[144:147], v[216:219], v[96:99]
  v_mfma_f32_16x16x32_bf16 v[100:103], a[148:151], v[216:219], v[100:103]
  v_fma_f32 v235, v232, v225, v58
  v_mfma_f32_16x16x32_bf16 v[104:107], a[152:155], v[216:219], v[104:107]
  v_fma_f32 v232, -v233, v225, v234
  v_mfma_f32_16x16x32_bf16 v[108:111], a[156:159], v[216:219], v[108:111]
  ds_read_b128 v[216:219], v241 offset:28672
  v_fma_f32 v233, v233, v224, v235
  s_waitcnt lgkmcnt(7)
  v_mfma_f32_16x16x32_bf16 v[112:115], a[144:147], v[220:223], v[112:115]
  v_fma_f32 v234, v232, v224, v43
  v_mfma_f32_16x16x32_bf16 v[116:119], a[148:151], v[220:223], v[116:119]
  v_fma_f32 v235, v232, v225, v59
  v_mfma_f32_16x16x32_bf16 v[120:123], a[152:155], v[220:223], v[120:123]
  v_fma_f32 v232, -v233, v225, v234
  v_mfma_f32_16x16x32_bf16 v[124:127], a[156:159], v[220:223], v[124:127]
  ds_read_b128 v[220:223], v243 offset:28672
  v_fma_f32 v233, v233, v224, v235
  s_waitcnt lgkmcnt(7)
  v_mfma_f32_16x16x32_bf16 v[64:67], a[160:163], v[192:195], v[64:67]
  v_fma_f32 v234, v44, v224, v45
  v_mfma_f32_16x16x32_bf16 v[68:71], a[164:167], v[192:195], v[68:71]
  v_fma_f32 v235, v44, v225, v61
  v_mfma_f32_16x16x32_bf16 v[72:75], a[168:171], v[192:195], v[72:75]
  v_fma_f32 v230, -v60, v225, v234
  v_mfma_f32_16x16x32_bf16 v[76:79], a[172:175], v[192:195], v[76:79]
  ds_read_b128 v[192:195], v240 offset:32768
  v_fma_f32 v231, v60, v224, v235
  s_waitcnt lgkmcnt(7)
  v_mfma_f32_16x16x32_bf16 v[80:83], a[160:163], v[196:199], v[80:83]
  v_mfma_f32_16x16x32_bf16 v[84:87], a[164:167], v[196:199], v[84:87]
  v_fma_f32 v234, v230, v224, v46
  v_mfma_f32_16x16x32_bf16 v[88:91], a[168:171], v[196:199], v[88:91]
  v_fma_f32 v235, v230, v225, v62
  v_mfma_f32_16x16x32_bf16 v[92:95], a[172:175], v[196:199], v[92:95]
  ds_read_b128 v[196:199], v242 offset:32768
  v_fma_f32 v230, -v231, v225, v234
  s_waitcnt lgkmcnt(7)
  v_mfma_f32_16x16x32_bf16 v[96:99], a[160:163], v[200:203], v[96:99]
  v_fma_f32 v231, v231, v224, v235
  v_mfma_f32_16x16x32_bf16 v[100:103], a[164:167], v[200:203], v[100:103]
  v_mfma_f32_16x16x32_bf16 v[104:107], a[168:171], v[200:203], v[104:107]
  v_fma_f32 v234, v230, v224, v47
  v_mfma_f32_16x16x32_bf16 v[108:111], a[172:175], v[200:203], v[108:111]
  ds_read_b128 v[200:203], v240 offset:36864
  v_fma_f32 v235, v230, v225, v63
  s_waitcnt lgkmcnt(7)
  v_mfma_f32_16x16x32_bf16 v[112:115], a[160:163], v[204:207], v[112:115]
  v_fma_f32 v230, -v231, v225, v234
  v_mfma_f32_16x16x32_bf16 v[116:119], a[164:167], v[204:207], v[116:119]
  v_mfma_f32_16x16x32_bf16 v[120:123], a[168:171], v[204:207], v[120:123]
  v_fma_f32 v231, v231, v224, v235
  v_mfma_f32_16x16x32_bf16 v[124:127], a[172:175], v[204:207], v[124:127]
  ds_read_b128 v[204:207], v242 offset:36864
  v_fma_f32 v234, v232, v228, v230
  s_waitcnt lgkmcnt(7)
  v_mfma_f32_16x16x32_bf16 v[64:67], a[176:179], v[208:211], v[64:67]
  v_fma_f32 v235, v232, v229, v231
  v_mfma_f32_16x16x32_bf16 v[68:71], a[180:183], v[208:211], v[68:71]
  v_mfma_f32_16x16x32_bf16 v[72:75], a[184:187], v[208:211], v[72:75]
  v_fma_f32 v232, -v233, v229, v234
  v_mfma_f32_16x16x32_bf16 v[76:79], a[188:191], v[208:211], v[76:79]
  ds_read_b128 v[208:211], v241 offset:32768
  v_fma_f32 v233, v233, v228, v235
  s_waitcnt lgkmcnt(7)
  v_mfma_f32_16x16x32_bf16 v[80:83], a[176:179], v[212:215], v[80:83]
  v_mfma_f32_16x16x32_bf16 v[84:87], a[180:183], v[212:215], v[84:87]
  v_mul_f32 v234, v232, v226
  v_mfma_f32_16x16x32_bf16 v[88:91], a[184:187], v[212:215], v[88:91]
  v_mul_f32 v235, v232, v227
  v_mfma_f32_16x16x32_bf16 v[92:95], a[188:191], v[212:215], v[92:95]
  ds_read_b128 v[212:215], v243 offset:32768
  s_waitcnt lgkmcnt(7)
  v_mfma_f32_16x16x32_bf16 v[96:99], a[176:179], v[216:219], v[96:99]
  v_fma_f32 v230, -v233, v227, v234
  v_mfma_f32_16x16x32_bf16 v[100:103], a[180:183], v[216:219], v[100:103]
  v_mfma_f32_16x16x32_bf16 v[104:107], a[184:187], v[216:219], v[104:107]
  v_fma_f32 v231, v233, v226, v235
  v_mfma_f32_16x16x32_bf16 v[108:111], a[188:191], v[216:219], v[108:111]
  ds_read_b128 v[216:219], v241 offset:36864
  v_mov_b32 v234, v230
  s_waitcnt lgkmcnt(7)
  v_mfma_f32_16x16x32_bf16 v[112:115], a[176:179], v[220:223], v[112:115]
  v_mfma_f32_16x16x32_bf16 v[116:119], a[180:183], v[220:223], v[116:119]
  v_mov_b32 v235, v231
  v_mfma_f32_16x16x32_bf16 v[120:123], a[184:187], v[220:223], v[120:123]
  v_mfma_f32_16x16x32_bf16 v[124:127], a[188:191], v[220:223], v[124:127]
  ds_read_b128 v[220:223], v243 offset:36864
  s_nop 1
  s_waitcnt vmcnt(27)
  s_barrier
  s_waitcnt lgkmcnt(7)
  v_mfma_f32_16x16x32_bf16 v[64:67], a[192:195], v[192:195], v[64:67]
  v_permlane32_swap_b32 v230, v234
  v_mfma_f32_16x16x32_bf16 v[68:71], a[196:199], v[192:195], v[68:71]
  v_mfma_f32_16x16x32_bf16 v[72:75], a[200:203], v[192:195], v[72:75]
  s_lshr_b32 s6, s3, 1
  s_add_u32 s6, s6, s14
  v_mfma_f32_16x16x32_bf16 v[76:79], a[204:207], v[192:195], v[76:79]
  ds_read_b128 v[192:195], v240 offset:40960
  s_add_u32 s6, s6, 6
  s_waitcnt lgkmcnt(7)
  v_mfma_f32_16x16x32_bf16 v[80:83], a[192:195], v[196:199], v[80:83]
  s_and_b32 s6, s6, 7
  s_lshl_b32 s6, s6, 7
  v_mfma_f32_16x16x32_bf16 v[84:87], a[196:199], v[196:199], v[84:87]
  s_add_u32 m0, s9, 16384
  s_add_u32 s6, s6, s12
  v_mfma_f32_16x16x32_bf16 v[88:91], a[200:203], v[196:199], v[88:91]
  buffer_load_dwordx4 v248, s[60:63], s6 offen offset:0 lds
  buffer_load_dwordx4 v249, s[60:63], s6 offen offset:1024 lds
  v_mfma_f32_16x16x32_bf16 v[92:95], a[204:207], v[196:199], v[92:95]
  ds_read_b128 v[196:199], v242 offset:40960
  s_add_u32 m0, s9, 18432
  s_waitcnt lgkmcnt(7)
  v_mfma_f32_16x16x32_bf16 v[96:99], a[192:195], v[200:203], v[96:99]
  s_nop 0
  buffer_load_dwordx4 v248, s[44:47], s6 offen offset:0 lds
  v_mfma_f32_16x16x32_bf16 v[100:103], a[196:199], v[200:203], v[100:103]
  buffer_load_dwordx4 v249, s[44:47], s6 offen offset:1024 lds
  v_permlane32_swap_b32 v231, v235
  v_mfma_f32_16x16x32_bf16 v[104:107], a[200:203], v[200:203], v[104:107]
  v_add_f32 v230, v230, v234
  v_add_f32 v231, v231, v235
  v_mfma_f32_16x16x32_bf16 v[108:111], a[204:207], v[200:203], v[108:111]
  ds_read_b128 v[200:203], v240 offset:45056
  s_waitcnt lgkmcnt(7)
  v_mfma_f32_16x16x32_bf16 v[112:115], a[192:195], v[204:207], v[112:115]
  v_mov_b32 v234, v230
  v_mfma_f32_16x16x32_bf16 v[116:119], a[196:199], v[204:207], v[116:119]
  v_mfma_f32_16x16x32_bf16 v[120:123], a[200:203], v[204:207], v[120:123]
  v_mov_b32 v235, v231
  v_mfma_f32_16x16x32_bf16 v[124:127], a[204:207], v[204:207], v[124:127]
  ds_read_b128 v[204:207], v242 offset:45056
  s_waitcnt lgkmcnt(7)
  v_mfma_f32_16x16x32_bf16 v[64:67], a[208:211], v[208:211], v[64:67]
  s_nop 1
  v_mfma_f32_16x16x32_bf16 v[68:71], a[212:215], v[208:211], v[68:71]
  v_mfma_f32_16x16x32_bf16 v[72:75], a[216:219], v[208:211], v[72:75]
  v_mfma_f32_16x16x32_bf16 v[76:79], a[220:223], v[208:211], v[76:79]
  ds_read_b128 v[208:211], v241 offset:40960
  v_permlane16_swap_b32 v230, v234
  s_waitcnt lgkmcnt(7)
  v_mfma_f32_16x16x32_bf16 v[80:83], a[208:211], v[212:215], v[80:83]
  v_mfma_f32_16x16x32_bf16 v[84:87], a[212:215], v[212:215], v[84:87]
  v_permlane16_swap_b32 v231, v235
  v_mfma_f32_16x16x32_bf16 v[88:91], a[216:219], v[212:215], v[88:91]
  v_mfma_f32_16x16x32_bf16 v[92:95], a[220:223], v[212:215], v[92:95]
  ds_read_b128 v[212:215], v243 offset:40960
  s_waitcnt lgkmcnt(7)
  v_mfma_f32_16x16x32_bf16 v[96:99], a[208:211], v[216:219], v[96:99]
  v_add_f32 v230, v230, v234
  v_mfma_f32_16x16x32_bf16 v[100:103], a[212:215], v[216:219], v[100:103]
  v_mfma_f32_16x16x32_bf16 v[104:107], a[216:219], v[216:219], v[104:107]
  v_mfma_f32_16x16x32_bf16 v[108:111], a[220:223], v[216:219], v[108:111]
  ds_read_b128 v[216:219], v241 offset:45056
  v_add_f32 v231, v231, v235
  s_waitcnt lgkmcnt(7)
  v_mfma_f32_16x16x32_bf16 v[112:115], a[208:211], v[220:223], v[112:115]
  v_mfma_f32_16x16x32_bf16 v[116:119], a[212:215], v[220:223], v[116:119]
  v_mfma_f32_16x16x32_bf16 v[120:123], a[216:219], v[220:223], v[120:123]
  s_add_u32 s8, s95, 1
  v_mfma_f32_16x16x32_bf16 v[124:127], a[220:223], v[220:223], v[124:127]
  ds_read_b128 v[220:223], v243 offset:45056
  s_waitcnt lgkmcnt(7)
  v_mfma_f32_16x16x32_bf16 v[64:67], a[224:227], v[192:195], v[64:67]
  v_mfma_f32_16x16x32_bf16 v[68:71], a[228:231], v[192:195], v[68:71]
  s_lshl_b32 s8, s8, 7
  v_mfma_f32_16x16x32_bf16 v[72:75], a[232:235], v[192:195], v[72:75]
  v_mfma_f32_16x16x32_bf16 v[76:79], a[236:239], v[192:195], v[76:79]
  ds_read_b128 v[192:195], v240 offset:49152
  s_waitcnt lgkmcnt(7)
  v_mfma_f32_16x16x32_bf16 v[80:83], a[224:227], v[196:199], v[80:83]
  v_mfma_f32_16x16x32_bf16 v[84:87], a[228:231], v[196:199], v[84:87]
  v_mfma_f32_16x16x32_bf16 v[88:91], a[232:235], v[196:199], v[88:91]
  s_add_u32 s8, s8, 58724352
  v_mfma_f32_16x16x32_bf16 v[92:95], a[236:239], v[196:199], v[92:95]
  ds_read_b128 v[196:199], v242 offset:49152
  s_waitcnt lgkmcnt(7)
  v_mfma_f32_16x16x32_bf16 v[96:99], a[224:227], v[200:203], v[96:99]
  v_mfma_f32_16x16x32_bf16 v[100:103], a[228:231], v[200:203], v[100:103]
  v_mfma_f32_16x16x32_bf16 v[104:107], a[232:235], v[200:203], v[104:107]
  v_mfma_f32_16x16x32_bf16 v[108:111], a[236:239], v[200:203], v[108:111]
  ds_read_b128 v[200:203], v240 offset:53248
  s_waitcnt lgkmcnt(7)
  v_mfma_f32_16x16x32_bf16 v[112:115], a[224:227], v[204:207], v[112:115]
  buffer_store_dwordx2 v[230:231], v237, s[64:67], s8 offen
  v_mfma_f32_16x16x32_bf16 v[116:119], a[228:231], v[204:207], v[116:119]
  v_mfma_f32_16x16x32_bf16 v[120:123], a[232:235], v[204:207], v[120:123]
  v_mfma_f32_16x16x32_bf16 v[124:127], a[236:239], v[204:207], v[124:127]
  ds_read_b128 v[204:207], v242 offset:53248
  s_waitcnt lgkmcnt(7)
  v_mfma_f32_16x16x32_bf16 v[64:67], a[240:243], v[208:211], v[64:67]
  v_mfma_f32_16x16x32_bf16 v[68:71], a[244:247], v[208:211], v[68:71]
  v_mfma_f32_16x16x32_bf16 v[72:75], a[248:251], v[208:211], v[72:75]
  v_mfma_f32_16x16x32_bf16 v[76:79], a[252:255], v[208:211], v[76:79]
  ds_read_b128 v[208:211], v241 offset:49152
  s_waitcnt lgkmcnt(7)
  v_mfma_f32_16x16x32_bf16 v[80:83], a[240:243], v[212:215], v[80:83]
  v_mfma_f32_16x16x32_bf16 v[84:87], a[244:247], v[212:215], v[84:87]
  v_mfma_f32_16x16x32_bf16 v[88:91], a[248:251], v[212:215], v[88:91]
  v_mfma_f32_16x16x32_bf16 v[92:95], a[252:255], v[212:215], v[92:95]
  ds_read_b128 v[212:215], v243 offset:49152
  s_waitcnt lgkmcnt(7)
  v_mfma_f32_16x16x32_bf16 v[96:99], a[240:243], v[216:219], v[96:99]
  v_mfma_f32_16x16x32_bf16 v[100:103], a[244:247], v[216:219], v[100:103]
  v_mfma_f32_16x16x32_bf16 v[104:107], a[248:251], v[216:219], v[104:107]
  v_mfma_f32_16x16x32_bf16 v[108:111], a[252:255], v[216:219], v[108:111]
  ds_read_b128 v[216:219], v241 offset:53248
  s_waitcnt lgkmcnt(7)
  v_mfma_f32_16x16x32_bf16 v[112:115], a[240:243], v[220:223], v[112:115]
  v_mfma_f32_16x16x32_bf16 v[116:119], a[244:247], v[220:223], v[116:119]
  v_mfma_f32_16x16x32_bf16 v[120:123], a[248:251], v[220:223], v[120:123]
  v_mfma_f32_16x16x32_bf16 v[124:127], a[252:255], v[220:223], v[124:127]
  ds_read_b128 v[220:223], v243 offset:53248
  s_waitcnt vmcnt(19)
  s_barrier
  s_waitcnt lgkmcnt(7)
  v_mfma_f32_16x16x32_bf16 v[0:3], a[0:3], v[192:195], 0
  v_mfma_f32_16x16x32_bf16 v[4:7], a[4:7], v[192:195], 0
  v_mfma_f32_16x16x32_bf16 v[8:11], a[8:11], v[192:195], 0
  v_mfma_f32_16x16x32_bf16 v[12:15], a[12:15], v[192:195], 0
  ds_read_b128 v[192:195], v240 offset:57344
  s_waitcnt lgkmcnt(7)
  v_mfma_f32_16x16x32_bf16 v[16:19], a[0:3], v[196:199], 0
  v_mfma_f32_16x16x32_bf16 v[20:23], a[4:7], v[196:199], 0
  v_mfma_f32_16x16x32_bf16 v[24:27], a[8:11], v[196:199], 0
  s_mov_b32 s72, s16
  s_and_b32 s73, s17, 0xffff
  v_mfma_f32_16x16x32_bf16 v[28:31], a[12:15], v[196:199], 0
  ds_read_b128 v[196:199], v242 offset:57344
  s_mov_b32 s74, 2097152
  s_waitcnt lgkmcnt(7)
  v_mfma_f32_16x16x32_bf16 v[32:35], a[0:3], v[200:203], 0
  s_mov_b32 s75, 0x00020000
  s_lshl_b32 s8, s2, 2
  v_mfma_f32_16x16x32_bf16 v[36:39], a[4:7], v[200:203], 0
  s_add_u32 s8, s8, s3
  s_mul_i32 s8, s8, 2048
  v_mfma_f32_16x16x32_bf16 v[40:43], a[8:11], v[200:203], 0
  buffer_load_dwordx4 v[144:147], v140, s[72:75], s8 offen offset:0
  buffer_load_dwordx4 v[144:147], v140, s[72:75], s8 offen offset:1024
  v_mfma_f32_16x16x32_bf16 v[44:47], a[12:15], v[200:203], 0
  ds_read_b128 v[200:203], v240 offset:61440
  s_mov_b32 s72, s20
  s_waitcnt lgkmcnt(7)
  v_mfma_f32_16x16x32_bf16 v[48:51], a[0:3], v[204:207], 0
  s_and_b32 s73, s21, 0xffff
  s_mov_b32 s74, 4194304
  v_mfma_f32_16x16x32_bf16 v[52:55], a[4:7], v[204:207], 0
  s_mov_b32 s75, 0x00020000
  s_lshl_b32 s8, s2, 2
  v_mfma_f32_16x16x32_bf16 v[56:59], a[8:11], v[204:207], 0
  s_add_u32 s8, s8, s3
  s_mul_i32 s8, s8, 4096
  v_mfma_f32_16x16x32_bf16 v[60:63], a[12:15], v[204:207], 0
  ds_read_b128 v[204:207], v242 offset:61440
  buffer_load_dwordx4 v[144:147], v140, s[72:75], s8 offen offset:0
  s_waitcnt lgkmcnt(7)
  v_mfma_f32_16x16x32_bf16 v[0:3], a[16:19], v[208:211], v[0:3]
  buffer_load_dwordx4 v[144:147], v140, s[72:75], s8 offen offset:1024
  buffer_load_dwordx4 v[144:147], v140, s[72:75], s8 offen offset:2048
  v_mfma_f32_16x16x32_bf16 v[4:7], a[20:23], v[208:211], v[4:7]
  buffer_load_dwordx4 v[144:147], v140, s[72:75], s8 offen offset:3072
  s_getpc_b64 s[76:77]
  K1n_S6: s_add_u32 s76, s76, k2_kernel-K1n_S6
  s_addc_u32 s77, s77, 0
  v_mfma_f32_16x16x32_bf16 v[8:11], a[24:27], v[208:211], v[8:11]
  s_lshl_b32 s8, s2, 2
  s_add_u32 s8, s8, s3
  v_mfma_f32_16x16x32_bf16 v[12:15], a[28:31], v[208:211], v[12:15]
  ds_read_b128 v[208:211], v241 offset:57344
  s_lshl_b32 s8, s8, 10
  s_waitcnt lgkmcnt(7)
  v_mfma_f32_16x16x32_bf16 v[16:19], a[16:19], v[212:215], v[16:19]
  v_add_u32 v142, s8, v140
  v_min_u32 v142, K3e-k2_kernel-16, v142
  v_mfma_f32_16x16x32_bf16 v[20:23], a[20:23], v[212:215], v[20:23]
  global_load_dwordx4 v[144:147], v142, s[76:77]
  ds_read_b64 v[224:225], v238 offset:256
  v_mfma_f32_16x16x32_bf16 v[24:27], a[24:27], v[212:215], v[24:27]
  ds_read_b64 v[228:229], v238 offset:1280
  ds_read_b64 v[226:227], v239 offset:2304
  v_mfma_f32_16x16x32_bf16 v[28:31], a[28:31], v[212:215], v[28:31]
  ds_read_b128 v[212:215], v243 offset:57344
  s_add_u32 s8, s95, 2
  s_waitcnt lgkmcnt(10)
  v_mfma_f32_16x16x32_bf16 v[32:35], a[16:19], v[216:219], v[32:35]
  s_lshr_b32 s8, s8, 1
  s_lshl_b32 s8, s8, 13
  v_mfma_f32_16x16x32_bf16 v[36:39], a[20:23], v[216:219], v[36:39]
  s_add_u32 s7, s8, 50331648
  buffer_store_dwordx4 v[64:67], v236, s[64:67], s7 offen offset:0 sc1
  v_mfma_f32_16x16x32_bf16 v[40:43], a[24:27], v[216:219], v[40:43]
  buffer_store_dwordx4 v[68:71], v236, s[64:67], s7 offen offset:2048 sc1
  s_add_u32 s7, s8, 50462720
  v_mfma_f32_16x16x32_bf16 v[44:47], a[28:31], v[216:219], v[44:47]
  ds_read_b128 v[216:219], v241 offset:61440
  buffer_store_dwordx4 v[72:75], v236, s[64:67], s7 offen offset:0 sc1
  s_waitcnt lgkmcnt(10)
  v_mfma_f32_16x16x32_bf16 v[48:51], a[16:19], v[220:223], v[48:51]
  buffer_store_dwordx4 v[76:79], v236, s[64:67], s7 offen offset:2048 sc1
  s_add_u32 s8, s95, 2
  v_mfma_f32_16x16x32_bf16 v[52:55], a[20:23], v[220:223], v[52:55]
  s_lshr_b32 s8, s8, 1
  s_lshl_b32 s8, s8, 13
  v_mfma_f32_16x16x32_bf16 v[56:59], a[24:27], v[220:223], v[56:59]
  s_add_u32 s7, s8, 50335744
  buffer_store_dwordx4 v[80:83], v236, s[64:67], s7 offen offset:0 sc1
  v_mfma_f32_16x16x32_bf16 v[60:63], a[28:31], v[220:223], v[60:63]
  ds_read_b128 v[220:223], v243 offset:61440
  buffer_store_dwordx4 v[84:87], v236, s[64:67], s7 offen offset:2048 sc1
  s_waitcnt lgkmcnt(10)
  v_mfma_f32_16x16x32_bf16 v[0:3], a[32:35], v[192:195], v[0:3]
  s_add_u32 s7, s8, 50466816
  buffer_store_dwordx4 v[88:91], v236, s[64:67], s7 offen offset:0 sc1
  v_mfma_f32_16x16x32_bf16 v[4:7], a[36:39], v[192:195], v[4:7]
  buffer_store_dwordx4 v[92:95], v236, s[64:67], s7 offen offset:2048 sc1
  s_waitcnt lgkmcnt(3)
  v_fma_f32 v234, v64, v224, v65
  v_mfma_f32_16x16x32_bf16 v[8:11], a[40:43], v[192:195], v[8:11]
  v_fma_f32 v235, v64, v225, v81
  v_fma_f32 v232, -v80, v225, v234
  v_mfma_f32_16x16x32_bf16 v[12:15], a[44:47], v[192:195], v[12:15]
  ds_read_b128 v[192:195], v244 offset:0
  v_fma_f32 v233, v80, v224, v235
  v_mfma_f32_16x16x32_bf16 v[16:19], a[32:35], v[196:199], v[16:19]
  v_fma_f32 v234, v232, v224, v66
  v_fma_f32 v235, v232, v225, v82
  v_mfma_f32_16x16x32_bf16 v[20:23], a[36:39], v[196:199], v[20:23]
  v_fma_f32 v232, -v233, v225, v234
  v_fma_f32 v233, v233, v224, v235
  v_mfma_f32_16x16x32_bf16 v[24:27], a[40:43], v[196:199], v[24:27]
  v_fma_f32 v234, v232, v224, v67
  v_fma_f32 v235, v232, v225, v83
  v_mfma_f32_16x16x32_bf16 v[28:31], a[44:47], v[196:199], v[28:31]
  ds_read_b128 v[196:199], v246 offset:0
  v_fma_f32 v232, -v233, v225, v234
  v_mfma_f32_16x16x32_bf16 v[32:35], a[32:35], v[200:203], v[32:35]
  v_fma_f32 v233, v233, v224, v235
  v_fma_f32 v234, v68, v224, v69
  v_mfma_f32_16x16x32_bf16 v[36:39], a[36:39], v[200:203], v[36:39]
  v_fma_f32 v235, v68, v225, v85
  v_fma_f32 v230, -v84, v225, v234
  v_mfma_f32_16x16x32_bf16 v[40:43], a[40:43], v[200:203], v[40:43]
  v_fma_f32 v231, v84, v224, v235
  v_fma_f32 v234, v230, v224, v70
  v_mfma_f32_16x16x32_bf16 v[44:47], a[44:47], v[200:203], v[44:47]
  ds_read_b128 v[200:203], v244 offset:4096
  v_fma_f32 v235, v230, v225, v86
  v_mfma_f32_16x16x32_bf16 v[48:51], a[32:35], v[204:207], v[48:51]
  v_fma_f32 v230, -v231, v225, v234
  v_fma_f32 v231, v231, v224, v235
  v_mfma_f32_16x16x32_bf16 v[52:55], a[36:39], v[204:207], v[52:55]
  v_fma_f32 v234, v230, v224, v71
  v_fma_f32 v235, v230, v225, v87
  v_mfma_f32_16x16x32_bf16 v[56:59], a[40:43], v[204:207], v[56:59]
  v_fma_f32 v230, -v231, v225, v234
  v_fma_f32 v231, v231, v224, v235
  v_mfma_f32_16x16x32_bf16 v[60:63], a[44:47], v[204:207], v[60:63]
  ds_read_b128 v[204:207], v246 offset:4096
  v_fma_f32 v234, v232, v228, v230
  v_mfma_f32_16x16x32_bf16 v[0:3], a[48:51], v[208:211], v[0:3]
  v_fma_f32 v235, v232, v229, v231
  v_fma_f32 v232, -v233, v229, v234
  v_mfma_f32_16x16x32_bf16 v[4:7], a[52:55], v[208:211], v[4:7]
  v_fma_f32 v233, v233, v228, v235
  v_mul_f32 v234, v232, v226
  v_mfma_f32_16x16x32_bf16 v[8:11], a[56:59], v[208:211], v[8:11]
  v_mul_f32 v235, v232, v227
  v_fma_f32 v230, -v233, v227, v234
  v_mfma_f32_16x16x32_bf16 v[12:15], a[60:63], v[208:211], v[12:15]
  ds_read_b128 v[208:211], v245 offset:0
  v_fma_f32 v231, v233, v226, v235
  s_waitcnt lgkmcnt(7)
  v_mfma_f32_16x16x32_bf16 v[16:19], a[48:51], v[212:215], v[16:19]
  v_mov_b32 v234, v230
  v_mov_b32 v235, v231
  v_mfma_f32_16x16x32_bf16 v[20:23], a[52:55], v[212:215], v[20:23]
  s_nop 1
  v_permlane32_swap_b32 v230, v234
  v_mfma_f32_16x16x32_bf16 v[24:27], a[56:59], v[212:215], v[24:27]
  v_permlane32_swap_b32 v231, v235
  v_add_f32 v230, v230, v234
  v_mfma_f32_16x16x32_bf16 v[28:31], a[60:63], v[212:215], v[28:31]
  ds_read_b128 v[212:215], v247 offset:0
  v_add_f32 v231, v231, v235
  s_waitcnt lgkmcnt(7)
  v_mfma_f32_16x16x32_bf16 v[32:35], a[48:51], v[216:219], v[32:35]
  v_mov_b32 v234, v230
  v_mov_b32 v235, v231
  v_mfma_f32_16x16x32_bf16 v[36:39], a[52:55], v[216:219], v[36:39]
  s_nop 1
  v_permlane16_swap_b32 v230, v234
  v_mfma_f32_16x16x32_bf16 v[40:43], a[56:59], v[216:219], v[40:43]
  v_permlane16_swap_b32 v231, v235
  v_add_f32 v230, v230, v234
  v_mfma_f32_16x16x32_bf16 v[44:47], a[60:63], v[216:219], v[44:47]
  ds_read_b128 v[216:219], v245 offset:4096
  v_add_f32 v231, v231, v235
  s_waitcnt lgkmcnt(7)
  v_mfma_f32_16x16x32_bf16 v[48:51], a[48:51], v[220:223], v[48:51]
  s_add_u32 s8, s95, 2
  s_lshl_b32 s8, s8, 7
  v_mfma_f32_16x16x32_bf16 v[52:55], a[52:55], v[220:223], v[52:55]
  s_add_u32 s8, s8, 58720256
  buffer_store_dwordx2 v[230:231], v237, s[64:67], s8 offen
  v_mfma_f32_16x16x32_bf16 v[56:59], a[56:59], v[220:223], v[56:59]
  v_fma_f32 v234, v72, v224, v73
  v_fma_f32 v235, v72, v225, v89
  v_mfma_f32_16x16x32_bf16 v[60:63], a[60:63], v[220:223], v[60:63]
  ds_read_b128 v[220:223], v247 offset:4096
  v_fma_f32 v232, -v88, v225, v234
  s_waitcnt vmcnt(22)
  s_barrier
  s_waitcnt lgkmcnt(7)
  v_mfma_f32_16x16x32_bf16 v[0:3], a[64:67], v[192:195], v[0:3]
  v_fma_f32 v233, v88, v224, v235
  v_fma_f32 v234, v232, v224, v74
  v_mfma_f32_16x16x32_bf16 v[4:7], a[68:71], v[192:195], v[4:7]
  v_fma_f32 v235, v232, v225, v90
  v_fma_f32 v232, -v233, v225, v234
  v_mfma_f32_16x16x32_bf16 v[8:11], a[72:75], v[192:195], v[8:11]
  v_fma_f32 v233, v233, v224, v235
  v_fma_f32 v234, v232, v224, v75
  v_mfma_f32_16x16x32_bf16 v[12:15], a[76:79], v[192:195], v[12:15]
  ds_read_b128 v[192:195], v244 offset:8192
  v_fma_f32 v235, v232, v225, v91
  s_waitcnt lgkmcnt(7)
  v_mfma_f32_16x16x32_bf16 v[16:19], a[64:67], v[196:199], v[16:19]
  v_fma_f32 v232, -v233, v225, v234
  v_fma_f32 v233, v233, v224, v235
  v_mfma_f32_16x16x32_bf16 v[20:23], a[68:71], v[196:199], v[20:23]
  v_fma_f32 v234, v76, v224, v77
  v_fma_f32 v235, v76, v225, v93
  v_mfma_f32_16x16x32_bf16 v[24:27], a[72:75], v[196:199], v[24:27]
  v_fma_f32 v230, -v92, v225, v234
  v_fma_f32 v231, v92, v224, v235
  v_mfma_f32_16x16x32_bf16 v[28:31], a[76:79], v[196:199], v[28:31]
  ds_read_b128 v[196:199], v246 offset:8192
  v_fma_f32 v234, v230, v224, v78
  s_waitcnt lgkmcnt(7)
  v_mfma_f32_16x16x32_bf16 v[32:35], a[64:67], v[200:203], v[32:35]
  v_fma_f32 v235, v230, v225, v94
  v_fma_f32 v230, -v231, v225, v234
  v_mfma_f32_16x16x32_bf16 v[36:39], a[68:71], v[200:203], v[36:39]
  v_fma_f32 v231, v231, v224, v235
  v_fma_f32 v234, v230, v224, v79
  v_mfma_f32_16x16x32_bf16 v[40:43], a[72:75], v[200:203], v[40:43]
  v_fma_f32 v235, v230, v225, v95
  v_fma_f32 v230, -v231, v225, v234
  v_mfma_f32_16x16x32_bf16 v[44:47], a[76:79], v[200:203], v[44:47]
  ds_read_b128 v[200:203], v244 offset:12288
  v_fma_f32 v231, v231, v224, v235
  s_waitcnt lgkmcnt(7)
  v_mfma_f32_16x16x32_bf16 v[48:51], a[64:67], v[204:207], v[48:51]
  v_fma_f32 v234, v232, v228, v230
  v_fma_f32 v235, v232, v229, v231
  v_mfma_f32_16x16x32_bf16 v[52:55], a[68:71], v[204:207], v[52:55]
  v_fma_f32 v232, -v233, v229, v234
  v_fma_f32 v233, v233, v228, v235
  v_mfma_f32_16x16x32_bf16 v[56:59], a[72:75], v[204:207], v[56:59]
  v_mul_f32 v234, v232, v226
  v_mul_f32 v235, v232, v227
  v_mfma_f32_16x16x32_bf16 v[60:63], a[76:79], v[204:207], v[60:63]
  ds_read_b128 v[204:207], v246 offset:12288
  v_fma_f32 v230, -v233, v227, v234
  s_waitcnt lgkmcnt(7)
  v_mfma_f32_16x16x32_bf16 v[0:3], a[80:83], v[208:211], v[0:3]
  v_fma_f32 v231, v233, v226, v235
  v_mov_b32 v234, v230
  v_mfma_f32_16x16x32_bf16 v[4:7], a[84:87], v[208:211], v[4:7]
  v_mov_b32 v235, v231
  s_nop 1
  v_mfma_f32_16x16x32_bf16 v[8:11], a[88:91], v[208:211], v[8:11]
  v_permlane32_swap_b32 v230, v234
  v_permlane32_swap_b32 v231, v235
  v_mfma_f32_16x16x32_bf16 v[12:15], a[92:95], v[208:211], v[12:15]
  ds_read_b128 v[208:211], v245 offset:8192
  v_add_f32 v230, v230, v234
  s_waitcnt lgkmcnt(7)
  v_mfma_f32_16x16x32_bf16 v[16:19], a[80:83], v[212:215], v[16:19]
  v_add_f32 v231, v231, v235
  v_mov_b32 v234, v230
  v_mfma_f32_16x16x32_bf16 v[20:23], a[84:87], v[212:215], v[20:23]
  v_mov_b32 v235, v231
  s_nop 1
  v_mfma_f32_16x16x32_bf16 v[24:27], a[88:91], v[212:215], v[24:27]
  v_permlane16_swap_b32 v230, v234
  v_permlane16_swap_b32 v231, v235
  v_mfma_f32_16x16x32_bf16 v[28:31], a[92:95], v[212:215], v[28:31]
  ds_read_b128 v[212:215], v247 offset:8192
  v_add_f32 v230, v230, v234
  s_waitcnt lgkmcnt(7)
  v_mfma_f32_16x16x32_bf16 v[32:35], a[80:83], v[216:219], v[32:35]
  v_add_f32 v231, v231, v235
  s_add_u32 s8, s95, 2
  v_mfma_f32_16x16x32_bf16 v[36:39], a[84:87], v[216:219], v[36:39]
  s_lshl_b32 s8, s8, 7
  s_add_u32 s8, s8, 58724352
  v_mfma_f32_16x16x32_bf16 v[40:43], a[88:91], v[216:219], v[40:43]
  buffer_store_dwordx2 v[230:231], v237, s[64:67], s8 offen
  ds_read_b64 v[224:225], v238 offset:384
  v_mfma_f32_16x16x32_bf16 v[44:47], a[92:95], v[216:219], v[44:47]
  ds_read_b128 v[216:219], v245 offset:12288
  ds_read_b64 v[228:229], v238 offset:1408
  s_waitcnt lgkmcnt(9)
  v_mfma_f32_16x16x32_bf16 v[48:51], a[80:83], v[220:223], v[48:51]
  ds_read_b64 v[226:227], v239 offset:2432
  s_add_u32 s8, s95, 3
  v_mfma_f32_16x16x32_bf16 v[52:55], a[84:87], v[220:223], v[52:55]
  s_lshr_b32 s8, s8, 1
  s_lshl_b32 s8, s8, 13
  v_mfma_f32_16x16x32_bf16 v[56:59], a[88:91], v[220:223], v[56:59]
  s_add_u32 s7, s8, 50331904
  v_mfma_f32_16x16x32_bf16 v[60:63], a[92:95], v[220:223], v[60:63]
  ds_read_b128 v[220:223], v247 offset:12288
  buffer_store_dwordx4 v[96:99], v236, s[64:67], s7 offen offset:0 sc1
  s_waitcnt lgkmcnt(10)
  v_mfma_f32_16x16x32_bf16 v[0:3], a[96:99], v[192:195], v[0:3]
  buffer_store_dwordx4 v[100:103], v236, s[64:67], s7 offen offset:2048 sc1
  s_add_u32 s7, s8, 50462976
  v_mfma_f32_16x16x32_bf16 v[4:7], a[100:103], v[192:195], v[4:7]
  buffer_store_dwordx4 v[104:107], v236, s[64:67], s7 offen offset:0 sc1
  buffer_store_dwordx4 v[108:111], v236, s[64:67], s7 offen offset:2048 sc1
  v_mfma_f32_16x16x32_bf16 v[8:11], a[104:107], v[192:195], v[8:11]
  s_add_u32 s8, s95, 3
  v_mfma_f32_16x16x32_bf16 v[12:15], a[108:111], v[192:195], v[12:15]
  ds_read_b128 v[192:195], v240 offset:0
  s_lshr_b32 s8, s8, 1
  s_waitcnt lgkmcnt(10)
  v_mfma_f32_16x16x32_bf16 v[16:19], a[96:99], v[196:199], v[16:19]
  s_lshl_b32 s8, s8, 13
  s_add_u32 s7, s8, 50336000
  v_mfma_f32_16x16x32_bf16 v[20:23], a[100:103], v[196:199], v[20:23]
  buffer_store_dwordx4 v[112:115], v236, s[64:67], s7 offen offset:0 sc1
  buffer_store_dwordx4 v[116:119], v236, s[64:67], s7 offen offset:2048 sc1
  v_mfma_f32_16x16x32_bf16 v[24:27], a[104:107], v[196:199], v[24:27]
  s_add_u32 s7, s8, 50467072
  v_mfma_f32_16x16x32_bf16 v[28:31], a[108:111], v[196:199], v[28:31]
  ds_read_b128 v[196:199], v242 offset:0
  buffer_store_dwordx4 v[120:123], v236, s[64:67], s7 offen offset:0 sc1
  s_waitcnt lgkmcnt(10)
  v_mfma_f32_16x16x32_bf16 v[32:35], a[96:99], v[200:203], v[32:35]
  buffer_store_dwordx4 v[124:127], v236, s[64:67], s7 offen offset:2048 sc1
  s_waitcnt lgkmcnt(3)
  v_fma_f32 v234, v96, v224, v97
  v_mfma_f32_16x16x32_bf16 v[36:39], a[100:103], v[200:203], v[36:39]
  v_fma_f32 v235, v96, v225, v113
  v_fma_f32 v232, -v112, v225, v234
  v_mfma_f32_16x16x32_bf16 v[40:43], a[104:107], v[200:203], v[40:43]
  v_fma_f32 v233, v112, v224, v235
  v_mfma_f32_16x16x32_bf16 v[44:47], a[108:111], v[200:203], v[44:47]
  ds_read_b128 v[200:203], v240 offset:4096
  v_fma_f32 v234, v232, v224, v98
  v_mfma_f32_16x16x32_bf16 v[48:51], a[96:99], v[204:207], v[48:51]
  v_fma_f32 v235, v232, v225, v114
  v_fma_f32 v232, -v233, v225, v234
  v_mfma_f32_16x16x32_bf16 v[52:55], a[100:103], v[204:207], v[52:55]
  v_fma_f32 v233, v233, v224, v235
  v_mfma_f32_16x16x32_bf16 v[56:59], a[104:107], v[204:207], v[56:59]
  v_fma_f32 v234, v232, v224, v99
  v_fma_f32 v235, v232, v225, v115
  v_mfma_f32_16x16x32_bf16 v[60:63], a[108:111], v[204:207], v[60:63]
  ds_read_b128 v[204:207], v242 offset:4096
  v_fma_f32 v232, -v233, v225, v234
  v_mfma_f32_16x16x32_bf16 v[0:3], a[112:115], v[208:211], v[0:3]
  v_fma_f32 v233, v233, v224, v235
  v_mfma_f32_16x16x32_bf16 v[4:7], a[116:119], v[208:211], v[4:7]
  v_fma_f32 v234, v100, v224, v101
  v_fma_f32 v235, v100, v225, v117
  v_mfma_f32_16x16x32_bf16 v[8:11], a[120:123], v[208:211], v[8:11]
  v_fma_f32 v230, -v116, v225, v234
  v_mfma_f32_16x16x32_bf16 v[12:15], a[124:127], v[208:211], v[12:15]
  ds_read_b128 v[208:211], v241 offset:0
  v_fma_f32 v231, v116, v224, v235
  v_mfma_f32_16x16x32_bf16 v[16:19], a[112:115], v[212:215], v[16:19]
  v_fma_f32 v234, v230, v224, v102
  v_fma_f32 v235, v230, v225, v118
  v_mfma_f32_16x16x32_bf16 v[20:23], a[116:119], v[212:215], v[20:23]
  v_fma_f32 v230, -v231, v225, v234
  v_mfma_f32_16x16x32_bf16 v[24:27], a[120:123], v[212:215], v[24:27]
  v_fma_f32 v231, v231, v224, v235
  v_mfma_f32_16x16x32_bf16 v[28:31], a[124:127], v[212:215], v[28:31]
  ds_read_b128 v[212:215], v243 offset:0
  v_fma_f32 v234, v230, v224, v103
  v_mfma_f32_16x16x32_bf16 v[32:35], a[112:115], v[216:219], v[32:35]
  v_fma_f32 v235, v230, v225, v119
  v_fma_f32 v230, -v231, v225, v234
  v_mfma_f32_16x16x32_bf16 v[36:39], a[116:119], v[216:219], v[36:39]
  v_fma_f32 v231, v231, v224, v235
  v_mfma_f32_16x16x32_bf16 v[40:43], a[120:123], v[216:219], v[40:43]
  v_fma_f32 v234, v232, v228, v230
  v_mfma_f32_16x16x32_bf16 v[44:47], a[124:127], v[216:219], v[44:47]
  ds_read_b128 v[216:219], v241 offset:4096
  v_fma_f32 v235, v232, v229, v231
  s_waitcnt lgkmcnt(7)
  v_mfma_f32_16x16x32_bf16 v[48:51], a[112:115], v[220:223], v[48:51]
  v_fma_f32 v232, -v233, v229, v234
  v_fma_f32 v233, v233, v228, v235
  v_mfma_f32_16x16x32_bf16 v[52:55], a[116:119], v[220:223], v[52:55]
  v_mul_f32 v234, v232, v226
  v_mfma_f32_16x16x32_bf16 v[56:59], a[120:123], v[220:223], v[56:59]
  v_mul_f32 v235, v232, v227
  v_mfma_f32_16x16x32_bf16 v[60:63], a[124:127], v[220:223], v[60:63]
  ds_read_b128 v[220:223], v243 offset:4096
  v_fma_f32 v230, -v233, v227, v234
  s_waitcnt vmcnt(26)
  s_barrier
  s_waitcnt lgkmcnt(7)
  v_mfma_f32_16x16x32_bf16 v[0:3], a[128:131], v[192:195], v[0:3]
  v_fma_f32 v231, v233, v226, v235
  v_mov_b32 v234, v230
  v_mfma_f32_16x16x32_bf16 v[4:7], a[132:135], v[192:195], v[4:7]
  v_mov_b32 v235, v231
  v_mfma_f32_16x16x32_bf16 v[8:11], a[136:139], v[192:195], v[8:11]
  s_nop 1
  v_mfma_f32_16x16x32_bf16 v[12:15], a[140:143], v[192:195], v[12:15]
  ds_read_b128 v[192:195], v240 offset:8192
  v_permlane32_swap_b32 v230, v234
  s_waitcnt lgkmcnt(7)
  v_mfma_f32_16x16x32_bf16 v[16:19], a[128:131], v[196:199], v[16:19]
  v_permlane32_swap_b32 v231, v235
  v_mfma_f32_16x16x32_bf16 v[20:23], a[132:135], v[196:199], v[20:23]
  v_add_f32 v230, v230, v234
  v_mfma_f32_16x16x32_bf16 v[24:27], a[136:139], v[196:199], v[24:27]
  v_add_f32 v231, v231, v235
  v_mov_b32 v234, v230
  v_mfma_f32_16x16x32_bf16 v[28:31], a[140:143], v[196:199], v[28:31]
  ds_read_b128 v[196:199], v242 offset:8192
  v_mov_b32 v235, v231
  s_waitcnt lgkmcnt(7)
  v_mfma_f32_16x16x32_bf16 v[32:35], a[128:131], v[200:203], v[32:35]
  s_nop 1
  v_mfma_f32_16x16x32_bf16 v[36:39], a[132:135], v[200:203], v[36:39]
  v_permlane16_swap_b32 v230, v234
  v_mfma_f32_16x16x32_bf16 v[40:43], a[136:139], v[200:203], v[40:43]
  v_permlane16_swap_b32 v231, v235
  v_mfma_f32_16x16x32_bf16 v[44:47], a[140:143], v[200:203], v[44:47]
  ds_read_b128 v[200:203], v240 offset:12288
  v_add_f32 v230, v230, v234
  s_waitcnt lgkmcnt(7)
  v_mfma_f32_16x16x32_bf16 v[48:51], a[128:131], v[204:207], v[48:51]
  v_add_f32 v231, v231, v235
  v_mfma_f32_16x16x32_bf16 v[52:55], a[132:135], v[204:207], v[52:55]
  s_add_u32 s8, s95, 3
  v_mfma_f32_16x16x32_bf16 v[56:59], a[136:139], v[204:207], v[56:59]
  s_lshl_b32 s8, s8, 7
  v_mfma_f32_16x16x32_bf16 v[60:63], a[140:143], v[204:207], v[60:63]
  ds_read_b128 v[204:207], v242 offset:12288
  s_add_u32 s8, s8, 58720256
  s_waitcnt lgkmcnt(7)
  v_mfma_f32_16x16x32_bf16 v[0:3], a[144:147], v[208:211], v[0:3]
  buffer_store_dwordx2 v[230:231], v237, s[64:67], s8 offen
  v_mfma_f32_16x16x32_bf16 v[4:7], a[148:151], v[208:211], v[4:7]
  v_fma_f32 v234, v104, v224, v105
  v_mfma_f32_16x16x32_bf16 v[8:11], a[152:155], v[208:211], v[8:11]
  v_fma_f32 v235, v104, v225, v121
  v_mfma_f32_16x16x32_bf16 v[12:15], a[156:159], v[208:211], v[12:15]
  ds_read_b128 v[208:211], v241 offset:8192
  v_fma_f32 v232, -v120, v225, v234
  s_waitcnt lgkmcnt(7)
  v_mfma_f32_16x16x32_bf16 v[16:19], a[144:147], v[212:215], v[16:19]
  v_fma_f32 v233, v120, v224, v235
  v_mfma_f32_16x16x32_bf16 v[20:23], a[148:151], v[212:215], v[20:23]
  v_fma_f32 v234, v232, v224, v106
  v_mfma_f32_16x16x32_bf16 v[24:27], a[152:155], v[212:215], v[24:27]
  v_fma_f32 v235, v232, v225, v122
  v_mfma_f32_16x16x32_bf16 v[28:31], a[156:159], v[212:215], v[28:31]
  ds_read_b128 v[212:215], v243 offset:8192
  v_fma_f32 v232, -v233, v225, v234
  s_waitcnt lgkmcnt(7)
  v_mfma_f32_16x16x32_bf16 v[32:35], a[144:147], v[216:219], v[32:35]
  v_fma_f32 v233, v233, v224, v235
  v_mfma_f32_16x16x32_bf16 v[36:39], a[148:151], v[216:219], v[36:39]
  v_fma_f32 v234, v232, v224, v107
  v_mfma_f32_16x16x32_bf16 v[40:43], a[152:155], v[216:219], v[40:43]
  v_fma_f32 v235, v232, v225, v123
  v_mfma_f32_16x16x32_bf16 v[44:47], a[156:159], v[216:219], v[44:47]
  ds_read_b128 v[216:219], v241 offset:12288
  v_fma_f32 v232, -v233, v225, v234
  s_waitcnt lgkmcnt(7)
  v_mfma_f32_16x16x32_bf16 v[48:51], a[144:147], v[220:223], v[48:51]
  v_fma_f32 v233, v233, v224, v235
  v_mfma_f32_16x16x32_bf16 v[52:55], a[148:151], v[220:223], v[52:55]
  v_mfma_f32_16x16x32_bf16 v[56:59], a[152:155], v[220:223], v[56:59]
  v_fma_f32 v234, v108, v224, v109
  v_mfma_f32_16x16x32_bf16 v[60:63], a[156:159], v[220:223], v[60:63]
  ds_read_b128 v[220:223], v243 offset:12288
  v_fma_f32 v235, v108, v225, v125
  s_waitcnt lgkmcnt(7)
  v_mfma_f32_16x16x32_bf16 v[0:3], a[160:163], v[192:195], v[0:3]
  v_fma_f32 v230, -v124, v225, v234
  v_mfma_f32_16x16x32_bf16 v[4:7], a[164:167], v[192:195], v[4:7]
  v_fma_f32 v231, v124, v224, v235
  v_mfma_f32_16x16x32_bf16 v[8:11], a[168:171], v[192:195], v[8:11]
  v_fma_f32 v234, v230, v224, v110
  v_mfma_f32_16x16x32_bf16 v[12:15], a[172:175], v[192:195], v[12:15]
  ds_read_b128 v[192:195], v240 offset:16384
  s_waitcnt lgkmcnt(7)
  v_mfma_f32_16x16x32_bf16 v[16:19], a[160:163], v[196:199], v[16:19]
  v_fma_f32 v235, v230, v225, v126
  v_mfma_f32_16x16x32_bf16 v[20:23], a[164:167], v[196:199], v[20:23]
  v_fma_f32 v230, -v231, v225, v234
  v_mfma_f32_16x16x32_bf16 v[24:27], a[168:171], v[196:199], v[24:27]
  v_fma_f32 v231, v231, v224, v235
  v_mfma_f32_16x16x32_bf16 v[28:31], a[172:175], v[196:199], v[28:31]
  ds_read_b128 v[196:199], v242 offset:16384
  s_waitcnt lgkmcnt(7)
  v_mfma_f32_16x16x32_bf16 v[32:35], a[160:163], v[200:203], v[32:35]
  v_fma_f32 v234, v230, v224, v111
  v_mfma_f32_16x16x32_bf16 v[36:39], a[164:167], v[200:203], v[36:39]
  v_fma_f32 v235, v230, v225, v127
  v_mfma_f32_16x16x32_bf16 v[40:43], a[168:171], v[200:203], v[40:43]
  v_fma_f32 v230, -v231, v225, v234
  v_mfma_f32_16x16x32_bf16 v[44:47], a[172:175], v[200:203], v[44:47]
  ds_read_b128 v[200:203], v240 offset:20480
  s_waitcnt lgkmcnt(7)
  v_mfma_f32_16x16x32_bf16 v[48:51], a[160:163], v[204:207], v[48:51]
  v_fma_f32 v231, v231, v224, v235
  v_mfma_f32_16x16x32_bf16 v[52:55], a[164:167], v[204:207], v[52:55]
  v_fma_f32 v234, v232, v228, v230
  v_mfma_f32_16x16x32_bf16 v[56:59], a[168:171], v[204:207], v[56:59]
  v_mfma_f32_16x16x32_bf16 v[60:63], a[172:175], v[204:207], v[60:63]
  ds_read_b128 v[204:207], v242 offset:20480
  v_fma_f32 v235, v232, v229, v231
  s_waitcnt lgkmcnt(7)
  v_mfma_f32_16x16x32_bf16 v[0:3], a[176:179], v[208:211], v[0:3]
  v_fma_f32 v232, -v233, v229, v234
  v_mfma_f32_16x16x32_bf16 v[4:7], a[180:183], v[208:211], v[4:7]
  v_fma_f32 v233, v233, v228, v235
  v_mfma_f32_16x16x32_bf16 v[8:11], a[184:187], v[208:211], v[8:11]
  v_mfma_f32_16x16x32_bf16 v[12:15], a[188:191], v[208:211], v[12:15]
  ds_read_b128 v[208:211], v241 offset:16384
  v_mul_f32 v234, v232, v226
  s_waitcnt lgkmcnt(7)
  v_mfma_f32_16x16x32_bf16 v[16:19], a[176:179], v[212:215], v[16:19]
  v_mfma_f32_16x16x32_bf16 v[20:23], a[180:183], v[212:215], v[20:23]
  v_mul_f32 v235, v232, v227
  v_mfma_f32_16x16x32_bf16 v[24:27], a[184:187], v[212:215], v[24:27]
  v_fma_f32 v230, -v233, v227, v234
  v_mfma_f32_16x16x32_bf16 v[28:31], a[188:191], v[212:215], v[28:31]
  ds_read_b128 v[212:215], v243 offset:16384
  s_waitcnt lgkmcnt(7)
  v_mfma_f32_16x16x32_bf16 v[32:35], a[176:179], v[216:219], v[32:35]
  v_fma_f32 v231, v233, v226, v235
  v_mfma_f32_16x16x32_bf16 v[36:39], a[180:183], v[216:219], v[36:39]
  v_mfma_f32_16x16x32_bf16 v[40:43], a[184:187], v[216:219], v[40:43]
  v_mov_b32 v234, v230
  v_mfma_f32_16x16x32_bf16 v[44:47], a[188:191], v[216:219], v[44:47]
  ds_read_b128 v[216:219], v241 offset:20480
  v_mov_b32 v235, v231
  s_waitcnt lgkmcnt(7)
  v_mfma_f32_16x16x32_bf16 v[48:51], a[176:179], v[220:223], v[48:51]
  v_mfma_f32_16x16x32_bf16 v[52:55], a[180:183], v[220:223], v[52:55]
  s_nop 1
  v_mfma_f32_16x16x32_bf16 v[56:59], a[184:187], v[220:223], v[56:59]
  v_mfma_f32_16x16x32_bf16 v[60:63], a[188:191], v[220:223], v[60:63]
  ds_read_b128 v[220:223], v243 offset:20480
  v_permlane32_swap_b32 v230, v234
  s_barrier
  s_waitcnt lgkmcnt(7)
  v_mfma_f32_16x16x32_bf16 v[0:3], a[192:195], v[192:195], v[0:3]
  v_mfma_f32_16x16x32_bf16 v[4:7], a[196:199], v[192:195], v[4:7]
  v_permlane32_swap_b32 v231, v235
  v_mfma_f32_16x16x32_bf16 v[8:11], a[200:203], v[192:195], v[8:11]
  v_mfma_f32_16x16x32_bf16 v[12:15], a[204:207], v[192:195], v[12:15]
  ds_read_b128 v[192:195], v240 offset:24576
  v_add_f32 v230, v230, v234
  s_waitcnt lgkmcnt(7)
  v_mfma_f32_16x16x32_bf16 v[16:19], a[192:195], v[196:199], v[16:19]
  v_mfma_f32_16x16x32_bf16 v[20:23], a[196:199], v[196:199], v[20:23]
  v_add_f32 v231, v231, v235
  v_mfma_f32_16x16x32_bf16 v[24:27], a[200:203], v[196:199], v[24:27]
  v_mfma_f32_16x16x32_bf16 v[28:31], a[204:207], v[196:199], v[28:31]
  ds_read_b128 v[196:199], v242 offset:24576
  v_mov_b32 v234, v230
  s_waitcnt lgkmcnt(7)
  v_mfma_f32_16x16x32_bf16 v[32:35], a[192:195], v[200:203], v[32:35]
  v_mfma_f32_16x16x32_bf16 v[36:39], a[196:199], v[200:203], v[36:39]
  v_mov_b32 v235, v231
  v_mfma_f32_16x16x32_bf16 v[40:43], a[200:203], v[200:203], v[40:43]
  v_mfma_f32_16x16x32_bf16 v[44:47], a[204:207], v[200:203], v[44:47]
  ds_read_b128 v[200:203], v240 offset:28672
  s_waitcnt lgkmcnt(7)
  v_mfma_f32_16x16x32_bf16 v[48:51], a[192:195], v[204:207], v[48:51]
  s_nop 1
  v_mfma_f32_16x16x32_bf16 v[52:55], a[196:199], v[204:207], v[52:55]
  v_mfma_f32_16x16x32_bf16 v[56:59], a[200:203], v[204:207], v[56:59]
  v_permlane16_swap_b32 v230, v234
  v_mfma_f32_16x16x32_bf16 v[60:63], a[204:207], v[204:207], v[60:63]
  ds_read_b128 v[204:207], v242 offset:28672
  s_waitcnt lgkmcnt(7)
  v_mfma_f32_16x16x32_bf16 v[0:3], a[208:211], v[208:211], v[0:3]
  v_mfma_f32_16x16x32_bf16 v[4:7], a[212:215], v[208:211], v[4:7]
  v_permlane16_swap_b32 v231, v235
  v_mfma_f32_16x16x32_bf16 v[8:11], a[216:219], v[208:211], v[8:11]
  v_mfma_f32_16x16x32_bf16 v[12:15], a[220:223], v[208:211], v[12:15]
  ds_read_b128 v[208:211], v241 offset:24576
  s_waitcnt lgkmcnt(7)
  v_mfma_f32_16x16x32_bf16 v[16:19], a[208:211], v[212:215], v[16:19]
  v_add_f32 v230, v230, v234
  v_mfma_f32_16x16x32_bf16 v[20:23], a[212:215], v[212:215], v[20:23]
  v_mfma_f32_16x16x32_bf16 v[24:27], a[216:219], v[212:215], v[24:27]
  v_mfma_f32_16x16x32_bf16 v[28:31], a[220:223], v[212:215], v[28:31]
  ds_read_b128 v[212:215], v243 offset:24576
  s_waitcnt lgkmcnt(7)
  v_mfma_f32_16x16x32_bf16 v[32:35], a[208:211], v[216:219], v[32:35]
  v_add_f32 v231, v231, v235
  v_mfma_f32_16x16x32_bf16 v[36:39], a[212:215], v[216:219], v[36:39]
  v_mfma_f32_16x16x32_bf16 v[40:43], a[216:219], v[216:219], v[40:43]
  v_mfma_f32_16x16x32_bf16 v[44:47], a[220:223], v[216:219], v[44:47]
  ds_read_b128 v[216:219], v241 offset:28672
  s_add_u32 s8, s95, 3
  s_waitcnt lgkmcnt(7)
  v_mfma_f32_16x16x32_bf16 v[48:51], a[208:211], v[220:223], v[48:51]
  v_mfma_f32_16x16x32_bf16 v[52:55], a[212:215], v[220:223], v[52:55]
  v_mfma_f32_16x16x32_bf16 v[56:59], a[216:219], v[220:223], v[56:59]
  v_mfma_f32_16x16x32_bf16 v[60:63], a[220:223], v[220:223], v[60:63]
  ds_read_b128 v[220:223], v243 offset:28672
  s_lshl_b32 s8, s8, 7
  s_waitcnt lgkmcnt(7)
  v_mfma_f32_16x16x32_bf16 v[0:3], a[224:227], v[192:195], v[0:3]
  v_mfma_f32_16x16x32_bf16 v[4:7], a[228:231], v[192:195], v[4:7]
  v_mfma_f32_16x16x32_bf16 v[8:11], a[232:235], v[192:195], v[8:11]
  v_mfma_f32_16x16x32_bf16 v[12:15], a[236:239], v[192:195], v[12:15]
  s_waitcnt lgkmcnt(6)
  v_mfma_f32_16x16x32_bf16 v[16:19], a[224:227], v[196:199], v[16:19]
  s_add_u32 s8, s8, 58724352
  v_mfma_f32_16x16x32_bf16 v[20:23], a[228:231], v[196:199], v[20:23]
  v_mfma_f32_16x16x32_bf16 v[24:27], a[232:235], v[196:199], v[24:27]
  v_mfma_f32_16x16x32_bf16 v[28:31], a[236:239], v[196:199], v[28:31]
  s_waitcnt lgkmcnt(5)
  v_mfma_f32_16x16x32_bf16 v[32:35], a[224:227], v[200:203], v[32:35]
  v_mfma_f32_16x16x32_bf16 v[36:39], a[228:231], v[200:203], v[36:39]
  v_mfma_f32_16x16x32_bf16 v[40:43], a[232:235], v[200:203], v[40:43]
  v_mfma_f32_16x16x32_bf16 v[44:47], a[236:239], v[200:203], v[44:47]
  s_waitcnt lgkmcnt(4)
  v_mfma_f32_16x16x32_bf16 v[48:51], a[224:227], v[204:207], v[48:51]
  buffer_store_dwordx2 v[230:231], v237, s[64:67], s8 offen
  v_mfma_f32_16x16x32_bf16 v[52:55], a[228:231], v[204:207], v[52:55]
  v_mfma_f32_16x16x32_bf16 v[56:59], a[232:235], v[204:207], v[56:59]
  v_mfma_f32_16x16x32_bf16 v[60:63], a[236:239], v[204:207], v[60:63]
  s_waitcnt lgkmcnt(3)
  v_mfma_f32_16x16x32_bf16 v[0:3], a[240:243], v[208:211], v[0:3]
  v_mfma_f32_16x16x32_bf16 v[4:7], a[244:247], v[208:211], v[4:7]
  v_mfma_f32_16x16x32_bf16 v[8:11], a[248:251], v[208:211], v[8:11]
  v_mfma_f32_16x16x32_bf16 v[12:15], a[252:255], v[208:211], v[12:15]
  s_waitcnt lgkmcnt(2)
  v_mfma_f32_16x16x32_bf16 v[16:19], a[240:243], v[212:215], v[16:19]
  v_mfma_f32_16x16x32_bf16 v[20:23], a[244:247], v[212:215], v[20:23]
  v_mfma_f32_16x16x32_bf16 v[24:27], a[248:251], v[212:215], v[24:27]
  v_mfma_f32_16x16x32_bf16 v[28:31], a[252:255], v[212:215], v[28:31]
  s_waitcnt lgkmcnt(1)
  v_mfma_f32_16x16x32_bf16 v[32:35], a[240:243], v[216:219], v[32:35]
  v_mfma_f32_16x16x32_bf16 v[36:39], a[244:247], v[216:219], v[36:39]
  v_mfma_f32_16x16x32_bf16 v[40:43], a[248:251], v[216:219], v[40:43]
  v_mfma_f32_16x16x32_bf16 v[44:47], a[252:255], v[216:219], v[44:47]
  s_waitcnt lgkmcnt(0)
  v_mfma_f32_16x16x32_bf16 v[48:51], a[240:243], v[220:223], v[48:51]
  v_mfma_f32_16x16x32_bf16 v[52:55], a[244:247], v[220:223], v[52:55]
  v_mfma_f32_16x16x32_bf16 v[56:59], a[248:251], v[220:223], v[56:59]
  v_mfma_f32_16x16x32_bf16 v[60:63], a[252:255], v[220:223], v[60:63]
  s_nop 15
  ds_read_b64 v[224:225], v238 offset:512
  ds_read_b64 v[228:229], v238 offset:1536
  ds_read_b64 v[226:227], v239 offset:2560
  s_add_u32 s8, s95, 4
  s_lshr_b32 s8, s8, 1
  s_lshl_b32 s8, s8, 13
  s_add_u32 s7, s8, 50331648
  buffer_store_dwordx4 v[0:3], v236, s[64:67], s7 offen offset:0 sc1
  buffer_store_dwordx4 v[4:7], v236, s[64:67], s7 offen offset:2048 sc1
  s_add_u32 s7, s8, 50462720
  buffer_store_dwordx4 v[8:11], v236, s[64:67], s7 offen offset:0 sc1
  buffer_store_dwordx4 v[12:15], v236, s[64:67], s7 offen offset:2048 sc1
  s_add_u32 s8, s95, 4
  s_lshr_b32 s8, s8, 1
  s_lshl_b32 s8, s8, 13
  s_add_u32 s7, s8, 50335744
  buffer_store_dwordx4 v[16:19], v236, s[64:67], s7 offen offset:0 sc1
  buffer_store_dwordx4 v[20:23], v236, s[64:67], s7 offen offset:2048 sc1
  s_add_u32 s7, s8, 50466816
  buffer_store_dwordx4 v[24:27], v236, s[64:67], s7 offen offset:0 sc1
  buffer_store_dwordx4 v[28:31], v236, s[64:67], s7 offen offset:2048 sc1
  s_waitcnt lgkmcnt(0)
  v_fma_f32 v234, v0, v224, v1
  v_fma_f32 v235, v0, v225, v17
  v_fma_f32 v232, -v16, v225, v234
  v_fma_f32 v233, v16, v224, v235
  v_fma_f32 v234, v232, v224, v2
  v_fma_f32 v235, v232, v225, v18
  v_fma_f32 v232, -v233, v225, v234
  v_fma_f32 v233, v233, v224, v235
  v_fma_f32 v234, v232, v224, v3
  v_fma_f32 v235, v232, v225, v19
  v_fma_f32 v232, -v233, v225, v234
  v_fma_f32 v233, v233, v224, v235
  v_fma_f32 v234, v4, v224, v5
  v_fma_f32 v235, v4, v225, v21
  v_fma_f32 v230, -v20, v225, v234
  v_fma_f32 v231, v20, v224, v235
  v_fma_f32 v234, v230, v224, v6
  v_fma_f32 v235, v230, v225, v22
  v_fma_f32 v230, -v231, v225, v234
  v_fma_f32 v231, v231, v224, v235
  v_fma_f32 v234, v230, v224, v7
  v_fma_f32 v235, v230, v225, v23
  v_fma_f32 v230, -v231, v225, v234
  v_fma_f32 v231, v231, v224, v235
  v_fma_f32 v234, v232, v228, v230
  v_fma_f32 v235, v232, v229, v231
  v_fma_f32 v232, -v233, v229, v234
  v_fma_f32 v233, v233, v228, v235
  v_mul_f32 v234, v232, v226
  v_mul_f32 v235, v232, v227
  v_fma_f32 v230, -v233, v227, v234
  v_fma_f32 v231, v233, v226, v235
  v_mov_b32 v234, v230
  v_mov_b32 v235, v231
  s_nop 1
  v_permlane32_swap_b32 v230, v234
  v_permlane32_swap_b32 v231, v235
  v_add_f32 v230, v230, v234
  v_add_f32 v231, v231, v235
  v_mov_b32 v234, v230
  v_mov_b32 v235, v231
  s_nop 1
  v_permlane16_swap_b32 v230, v234
  v_permlane16_swap_b32 v231, v235
  v_add_f32 v230, v230, v234
  v_add_f32 v231, v231, v235
  s_add_u32 s8, s95, 4
  s_lshl_b32 s8, s8, 7
  s_add_u32 s8, s8, 58720256
  buffer_store_dwordx2 v[230:231], v237, s[64:67], s8 offen
  v_fma_f32 v234, v8, v224, v9
  v_fma_f32 v235, v8, v225, v25
  v_fma_f32 v232, -v24, v225, v234
  v_fma_f32 v233, v24, v224, v235
  v_fma_f32 v234, v232, v224, v10
  v_fma_f32 v235, v232, v225, v26
  v_fma_f32 v232, -v233, v225, v234
  v_fma_f32 v233, v233, v224, v235
  v_fma_f32 v234, v232, v224, v11
  v_fma_f32 v235, v232, v225, v27
  v_fma_f32 v232, -v233, v225, v234
  v_fma_f32 v233, v233, v224, v235
  v_fma_f32 v234, v12, v224, v13
  v_fma_f32 v235, v12, v225, v29
  v_fma_f32 v230, -v28, v225, v234
  v_fma_f32 v231, v28, v224, v235
  v_fma_f32 v234, v230, v224, v14
  v_fma_f32 v235, v230, v225, v30
  v_fma_f32 v230, -v231, v225, v234
  v_fma_f32 v231, v231, v224, v235
  v_fma_f32 v234, v230, v224, v15
  v_fma_f32 v235, v230, v225, v31
  v_fma_f32 v230, -v231, v225, v234
  v_fma_f32 v231, v231, v224, v235
  v_fma_f32 v234, v232, v228, v230
  v_fma_f32 v235, v232, v229, v231
  v_fma_f32 v232, -v233, v229, v234
  v_fma_f32 v233, v233, v228, v235
  v_mul_f32 v234, v232, v226
  v_mul_f32 v235, v232, v227
  v_fma_f32 v230, -v233, v227, v234
  v_fma_f32 v231, v233, v226, v235
  v_mov_b32 v234, v230
  v_mov_b32 v235, v231
  s_nop 1
  v_permlane32_swap_b32 v230, v234
  v_permlane32_swap_b32 v231, v235
  v_add_f32 v230, v230, v234
  v_add_f32 v231, v231, v235
  v_mov_b32 v234, v230
  v_mov_b32 v235, v231
  s_nop 1
  v_permlane16_swap_b32 v230, v234
  v_permlane16_swap_b32 v231, v235
  v_add_f32 v230, v230, v234
  v_add_f32 v231, v231, v235
  s_add_u32 s8, s95, 4
  s_lshl_b32 s8, s8, 7
  s_add_u32 s8, s8, 58724352
  buffer_store_dwordx2 v[230:231], v237, s[64:67], s8 offen
  ds_read_b64 v[224:225], v238 offset:640
  ds_read_b64 v[228:229], v238 offset:1664
  ds_read_b64 v[226:227], v239 offset:2688
  s_add_u32 s8, s95, 5
  s_lshr_b32 s8, s8, 1
  s_lshl_b32 s8, s8, 13
  s_add_u32 s7, s8, 50331904
  buffer_store_dwordx4 v[32:35], v236, s[64:67], s7 offen offset:0 sc1
  buffer_store_dwordx4 v[36:39], v236, s[64:67], s7 offen offset:2048 sc1
  s_add_u32 s7, s8, 50462976
  buffer_store_dwordx4 v[40:43], v236, s[64:67], s7 offen offset:0 sc1
  buffer_store_dwordx4 v[44:47], v236, s[64:67], s7 offen offset:2048 sc1
  s_add_u32 s8, s95, 5
  s_lshr_b32 s8, s8, 1
  s_lshl_b32 s8, s8, 13
  s_add_u32 s7, s8, 50336000
  buffer_store_dwordx4 v[48:51], v236, s[64:67], s7 offen offset:0 sc1
  buffer_store_dwordx4 v[52:55], v236, s[64:67], s7 offen offset:2048 sc1
  s_add_u32 s7, s8, 50467072
  buffer_store_dwordx4 v[56:59], v236, s[64:67], s7 offen offset:0 sc1
  buffer_store_dwordx4 v[60:63], v236, s[64:67], s7 offen offset:2048 sc1
  s_waitcnt lgkmcnt(0)
  v_fma_f32 v234, v32, v224, v33
  v_fma_f32 v235, v32, v225, v49
  v_fma_f32 v232, -v48, v225, v234
  v_fma_f32 v233, v48, v224, v235
  v_fma_f32 v234, v232, v224, v34
  v_fma_f32 v235, v232, v225, v50
  v_fma_f32 v232, -v233, v225, v234
  v_fma_f32 v233, v233, v224, v235
  v_fma_f32 v234, v232, v224, v35
  v_fma_f32 v235, v232, v225, v51
  v_fma_f32 v232, -v233, v225, v234
  v_fma_f32 v233, v233, v224, v235
  v_fma_f32 v234, v36, v224, v37
  v_fma_f32 v235, v36, v225, v53
  v_fma_f32 v230, -v52, v225, v234
  v_fma_f32 v231, v52, v224, v235
  v_fma_f32 v234, v230, v224, v38
  v_fma_f32 v235, v230, v225, v54
  v_fma_f32 v230, -v231, v225, v234
  v_fma_f32 v231, v231, v224, v235
  v_fma_f32 v234, v230, v224, v39
  v_fma_f32 v235, v230, v225, v55
  v_fma_f32 v230, -v231, v225, v234
  v_fma_f32 v231, v231, v224, v235
  v_fma_f32 v234, v232, v228, v230
  v_fma_f32 v235, v232, v229, v231
  v_fma_f32 v232, -v233, v229, v234
  v_fma_f32 v233, v233, v228, v235
  v_mul_f32 v234, v232, v226
  v_mul_f32 v235, v232, v227
  v_fma_f32 v230, -v233, v227, v234
  v_fma_f32 v231, v233, v226, v235
  v_mov_b32 v234, v230
  v_mov_b32 v235, v231
  s_nop 1
  v_permlane32_swap_b32 v230, v234
  v_permlane32_swap_b32 v231, v235
  v_add_f32 v230, v230, v234
  v_add_f32 v231, v231, v235
  v_mov_b32 v234, v230
  v_mov_b32 v235, v231
  s_nop 1
  v_permlane16_swap_b32 v230, v234
  v_permlane16_swap_b32 v231, v235
  v_add_f32 v230, v230, v234
  v_add_f32 v231, v231, v235
  s_add_u32 s8, s95, 5
  s_lshl_b32 s8, s8, 7
  s_add_u32 s8, s8, 58720256
  buffer_store_dwordx2 v[230:231], v237, s[64:67], s8 offen
  v_fma_f32 v234, v40, v224, v41
  v_fma_f32 v235, v40, v225, v57
  v_fma_f32 v232, -v56, v225, v234
  v_fma_f32 v233, v56, v224, v235
  v_fma_f32 v234, v232, v224, v42
  v_fma_f32 v235, v232, v225, v58
  v_fma_f32 v232, -v233, v225, v234
  v_fma_f32 v233, v233, v224, v235
  v_fma_f32 v234, v232, v224, v43
  v_fma_f32 v235, v232, v225, v59
  v_fma_f32 v232, -v233, v225, v234
  v_fma_f32 v233, v233, v224, v235
  v_fma_f32 v234, v44, v224, v45
  v_fma_f32 v235, v44, v225, v61
  v_fma_f32 v230, -v60, v225, v234
  v_fma_f32 v231, v60, v224, v235
  v_fma_f32 v234, v230, v224, v46
  v_fma_f32 v235, v230, v225, v62
  v_fma_f32 v230, -v231, v225, v234
  v_fma_f32 v231, v231, v224, v235
  v_fma_f32 v234, v230, v224, v47
  v_fma_f32 v235, v230, v225, v63
  v_fma_f32 v230, -v231, v225, v234
  v_fma_f32 v231, v231, v224, v235
  v_fma_f32 v234, v232, v228, v230
  v_fma_f32 v235, v232, v229, v231
  v_fma_f32 v232, -v233, v229, v234
  v_fma_f32 v233, v233, v228, v235
  v_mul_f32 v234, v232, v226
  v_mul_f32 v235, v232, v227
  v_fma_f32 v230, -v233, v227, v234
  v_fma_f32 v231, v233, v226, v235
  v_mov_b32 v234, v230
  v_mov_b32 v235, v231
  s_nop 1
  v_permlane32_swap_b32 v230, v234
  v_permlane32_swap_b32 v231, v235
  v_add_f32 v230, v230, v234
  v_add_f32 v231, v231, v235
  v_mov_b32 v234, v230
  v_mov_b32 v235, v231
  s_nop 1
  v_permlane16_swap_b32 v230, v234
  v_permlane16_swap_b32 v231, v235
  v_add_f32 v230, v230, v234
  v_add_f32 v231, v231, v235
  s_add_u32 s8, s95, 5
  s_lshl_b32 s8, s8, 7
  s_add_u32 s8, s8, 58724352
  buffer_store_dwordx2 v[230:231], v237, s[64:67], s8 offen
  s_endpgm
K1e_S6:

.section .rodata,"a"
.p2align 6
.amdhsa_kernel k1_kernel
  .amdhsa_next_free_vgpr 512
  .amdhsa_next_free_sgpr 102
  .amdhsa_accum_offset 256
  .amdhsa_group_segment_fixed_size 0
  .amdhsa_kernarg_size 144
  .amdhsa_user_sgpr_count 2
  .amdhsa_user_sgpr_kernarg_segment_ptr 1
  .amdhsa_system_sgpr_workgroup_id_x 1
.end_amdhsa_kernel

.text
.globl k2_kernel
.p2align 8
.type k2_kernel,@function
k2_kernel:
  s_cmp_ge_u32 s2, 256
  s_cbranch_scc1 K2_exit
  s_load_dwordx16 s[16:31], s[0:1], 0
  s_load_dwordx16 s[32:47], s[0:1], 64
  s_load_dwordx4 s[48:51], s[0:1], 128
  v_lshrrev_b32 v1, 6, v0
  v_and_b32 v233, 63, v0
  v_readfirstlane_b32 s3, v1
  s_and_b32 s4, s2, 31
  s_lshr_b32 s5, s2, 5
  s_lshr_b32 s10, s3, 2
  s_and_b32 s11, s3, 3
  v_lshlrev_b32 v231, 4, v233
  s_waitcnt lgkmcnt(0)
  s_mov_b32 s64, s50
  s_and_b32 s65, s51, 0xffff
  s_mov_b32 s66, 67108864
  s_mov_b32 s67, 0x00020000
  s_add_u32 s68, s50, 58720256
  s_addc_u32 s69, s51, 0
  s_and_b32 s69, s69, 0xffff
  s_mov_b32 s70, 262144
  s_mov_b32 s71, 0x00020000
  s_mov_b32 s52, s16
  s_and_b32 s53, s17, 0xffff
  s_mov_b32 s54, 2097152
  s_mov_b32 s55, 0x00020000
  s_mov_b32 s56, s20
  s_and_b32 s57, s21, 0xffff
  s_mov_b32 s58, 4194304
  s_mov_b32 s59, 0x00020000
  s_mov_b32 s60, s50
  s_and_b32 s61, s51, 0xffff
  s_mov_b32 s62, 33554432
  s_mov_b32 s63, 0x00020000
  s_sub_u32 s6, 15, s5
  s_lshl_b32 s6, s6, 7
  s_lshl_b32 s7, s11, 5
  s_add_u32 s91, s6, s7
  s_lshl_b32 s6, s5, 7
  s_add_u32 s93, s6, s7
  s_lshl_b32 s6, s5, 1
  s_add_u32 s7, s6, 1
  s_cmp_eq_u32 s10, 0
  s_cselect_b32 s14, s91, s93
  s_cselect_b32 s13, 99, s7
  s_sub_u32 s79, 15, s6
  s_lshl_b32 s88, s3, 13
  s_cmp_lt_u32 s3, 6
  s_mov_b32 s7, 32768
  s_cselect_b32 s6, 16384, s7
  s_add_u32 s88, s88, s6
  s_lshl_b32 s89, s14, 10
  v_lshrrev_b32 v234, 3, v233
  v_and_b32 v235, 7, v233
  v_add_u32 v236, 0, v234
  v_bfe_u32 v237, v236, 1, 3
  v_xor_b32 v237, v237, v235
  v_lshlrev_b32 v237, 4, v237
  v_lshl_add_u32 v237, v236, 10, v237
  v_subrev_u32 v247, 0, v237
  v_add_u32 v236, 8, v234
  v_bfe_u32 v237, v236, 1, 3
  v_xor_b32 v237, v237, v235
  v_lshlrev_b32 v237, 4, v237
  v_lshl_add_u32 v237, v236, 10, v237
  v_subrev_u32 v248, 1024, v237
  v_and_b32 v234, 15, v233
  v_lshlrev_b32 v235, 7, v234
  v_add_u32 v235, s88, v235
  v_bfe_u32 v236, v233, 1, 3
  v_lshrrev_b32 v237, 4, v233
  v_xor_b32 v236, v236, v237
  v_lshl_add_u32 v249, v236, 4, v235
  v_xor_b32 v250, 64, v249
  v_lshlrev_b32 v237, 2, v237
  v_sub_u32 v232, v234, v237
  v_lshlrev_b32 v225, 4, v234
  v_bfe_u32 v235, v233, 4, 1
  v_lshl_add_u32 v225, v235, 9, v225
  v_lshrrev_b32 v235, 5, v233
  v_lshl_add_u32 v225, v235, 10, v225
  v_lshlrev_b32 v235, 1, v235
  v_and_b32 v234, 3, v233
  v_xor_b32 v235, v234, v235
  v_lshlrev_b32 v253, 4, v235
  v_lshrrev_b32 v234, 2, v233
  v_lshl_add_u32 v253, v234, 13, v253
  v_add_u32 v254, 130048, v253
  s_lshl_b32 s90, s4, 8
  s_lshr_b32 s6, s3, 1
  s_lshl_b32 s6, s6, 6
  s_add_u32 s90, s90, s6
  s_and_b32 s6, s3, 1
  s_lshl_b32 s6, s6, 18
  s_add_u32 s90, s90, s6
  v_lshrrev_b32 v234, 4, v233
  v_lshlrev_b32 v251, 9, v234
  v_bfe_u32 v235, v233, 2, 2
  v_lshl_add_u32 v251, v235, 6, v251
  v_and_b32 v235, 3, v233
  v_lshl_add_u32 v251, v235, 3, v251
  v_and_b32 v234, 1, v234
  v_lshl_add_u32 v251, v234, 5, v251
  v_add_u32 v251, 98304, v251
  v_xor_b32 v252, 32, v251
  s_lshl_b32 s6, s10, 16
  s_lshl_b32 s7, s11, 12
  s_add_u32 s76, s6, s7
  s_lshl_b32 s77, s4, 19
  s_add_u32 s77, s77, s7
  v_add_u32 v224, s6, v231
  s_mov_b32 s94, 0x5d800000
  s_mov_b32 s95, 0xf149f2ca
  s_lshl_b32 s6, s3, 11
  s_add_u32 m0, s6, 98304
  s_add_u32 s6, s90, 0
  buffer_load_dwordx4 v253, s[56:59], s6 offen offset:0 lds
  buffer_load_dwordx4 v254, s[56:59], s6 offen offset:1024 lds
  s_add_u32 m0, s88, 0
  s_add_u32 s6, s89, 0
  buffer_load_dwordx4 v247, s[52:55], s6 offen lds
  buffer_load_dwordx4 v248, s[52:55], s6 offen offset:1024 lds
  s_add_u32 m0, s88, 2048
  s_add_u32 s6, s89, 16384
  buffer_load_dwordx4 v247, s[52:55], s6 offen lds
  buffer_load_dwordx4 v248, s[52:55], s6 offen offset:1024 lds
  s_barrier
  s_add_u32 m0, s88, 4096
  s_add_u32 s6, s89, 128
  buffer_load_dwordx4 v247, s[52:55], s6 offen lds
  buffer_load_dwordx4 v248, s[52:55], s6 offen offset:1024 lds
  s_add_u32 m0, s88, 6144
  s_add_u32 s6, s89, 16512
  buffer_load_dwordx4 v247, s[52:55], s6 offen lds
  buffer_load_dwordx4 v248, s[52:55], s6 offen offset:1024 lds
  s_lshl_b32 s6, s3, 11
  s_add_u32 m0, s6, 114688
  s_add_u32 s6, s90, 524288
  buffer_load_dwordx4 v253, s[56:59], s6 offen offset:0 lds
  buffer_load_dwordx4 v254, s[56:59], s6 offen offset:1024 lds
  s_lshl_b32 s6, s3, 11
  s_add_u32 m0, s6, 131072
  s_add_u32 s6, s90, 1048576
  buffer_load_dwordx4 v253, s[56:59], s6 offen offset:0 lds
  buffer_load_dwordx4 v254, s[56:59], s6 offen offset:1024 lds
  s_mov_b32 s73, 0
  s_waitcnt vmcnt(8)
  ds_read_b128 v[64:67], v249 offset:0
  ds_read_b128 v[68:71], v249 offset:2048
  ds_read_b128 v[72:75], v250 offset:0
  ds_read_b128 v[76:79], v250 offset:2048
  s_waitcnt lgkmcnt(0)
  s_add_u32 m0, s88, 0
  s_add_u32 s6, s89, 256
  buffer_load_dwordx4 v247, s[52:55], s6 offen lds
  buffer_load_dwordx4 v248, s[52:55], s6 offen offset:1024 lds
  s_add_u32 m0, s88, 2048
  s_add_u32 s6, s89, 16640
  buffer_load_dwordx4 v247, s[52:55], s6 offen lds
  buffer_load_dwordx4 v248, s[52:55], s6 offen offset:1024 lds
  s_waitcnt vmcnt(8)
  ds_read_b128 v[80:83], v249 offset:4096
  ds_read_b128 v[84:87], v249 offset:6144
  ds_read_b128 v[88:91], v250 offset:4096
  ds_read_b128 v[92:95], v250 offset:6144
  s_waitcnt lgkmcnt(0)
  s_add_u32 m0, s88, 4096
  s_add_u32 s6, s89, 384
  buffer_load_dwordx4 v247, s[52:55], s6 offen lds
  buffer_load_dwordx4 v248, s[52:55], s6 offen offset:1024 lds
  s_add_u32 m0, s88, 6144
  s_add_u32 s6, s89, 16768
  buffer_load_dwordx4 v247, s[52:55], s6 offen lds
  buffer_load_dwordx4 v248, s[52:55], s6 offen offset:1024 lds
  s_barrier
  s_waitcnt vmcnt(10)
  s_barrier
  ds_read_b64_tr_b16 v[192:193], v251 offset:0
  ds_read_b64_tr_b16 v[194:195], v251 offset:256
  ds_read_b64_tr_b16 v[196:197], v252 offset:0
  ds_read_b64_tr_b16 v[198:199], v252 offset:256
  ds_read_b64_tr_b16 v[200:201], v251 offset:4096
  ds_read_b64_tr_b16 v[202:203], v251 offset:4352
  ds_read_b64_tr_b16 v[204:205], v252 offset:4096
  ds_read_b64_tr_b16 v[206:207], v252 offset:4352
  ds_read_b64_tr_b16 v[208:209], v251 offset:8192
  ds_read_b64_tr_b16 v[210:211], v251 offset:8448
  ds_read_b64_tr_b16 v[212:213], v252 offset:8192
  ds_read_b64_tr_b16 v[214:215], v252 offset:8448
  ds_read_b64_tr_b16 v[216:217], v251 offset:12288
  ds_read_b64_tr_b16 v[218:219], v251 offset:12544
  ds_read_b64_tr_b16 v[220:221], v252 offset:12288
  ds_read_b64_tr_b16 v[222:223], v252 offset:12544
  s_waitcnt lgkmcnt(14)
  v_mfma_f32_16x16x32_bf16 v[0:3], v[192:195], v[64:67], 0
  v_mfma_f32_16x16x32_bf16 v[32:35], v[192:195], v[68:71], 0
  ds_read_b64_tr_b16 v[192:193], v251 offset:2048
  ds_read_b64_tr_b16 v[194:195], v251 offset:2304
  s_lshl_b32 s8, s2, 3
  s_add_u32 s8, s8, s3
  s_waitcnt lgkmcnt(14)
  v_mfma_f32_16x16x32_bf16 v[4:7], v[196:199], v[64:67], 0
  v_mfma_f32_16x16x32_bf16 v[36:39], v[196:199], v[68:71], 0
  ds_read_b64_tr_b16 v[196:197], v252 offset:2048
  ds_read_b64_tr_b16 v[198:199], v252 offset:2304
  s_lshr_b32 s96, s8, 5
  s_and_b32 s97, s8, 31
  s_waitcnt lgkmcnt(14)
  v_mfma_f32_16x16x32_bf16 v[8:11], v[200:203], v[64:67], 0
  v_mfma_f32_16x16x32_bf16 v[40:43], v[200:203], v[68:71], 0
  ds_read_b64_tr_b16 v[200:201], v251 offset:6144
  ds_read_b64_tr_b16 v[202:203], v251 offset:6400
  v_and_b32 v189, 15, v233
  v_lshrrev_b32 v188, 4, v233
  s_waitcnt lgkmcnt(14)
  v_mfma_f32_16x16x32_bf16 v[12:15], v[204:207], v[64:67], 0
  v_mfma_f32_16x16x32_bf16 v[44:47], v[204:207], v[68:71], 0
  ds_read_b64_tr_b16 v[204:205], v252 offset:6144
  ds_read_b64_tr_b16 v[206:207], v252 offset:6400
  s_lshl_b32 s8, s97, 7
  v_lshlrev_b32 v186, 3, v189
  s_waitcnt lgkmcnt(14)
  v_mfma_f32_16x16x32_bf16 v[16:19], v[208:211], v[64:67], 0
  v_mfma_f32_16x16x32_bf16 v[48:51], v[208:211], v[68:71], 0
  ds_read_b64_tr_b16 v[208:209], v251 offset:10240
  ds_read_b64_tr_b16 v[210:211], v251 offset:10496
  v_add_u32 v186, s8, v186
  s_mov_b32 s9, 59768832
  s_waitcnt lgkmcnt(14)
  v_mfma_f32_16x16x32_bf16 v[20:23], v[212:215], v[64:67], 0
  v_mfma_f32_16x16x32_bf16 v[52:55], v[212:215], v[68:71], 0
  ds_read_b64_tr_b16 v[212:213], v252 offset:10240
  ds_read_b64_tr_b16 v[214:215], v252 offset:10496
  s_waitcnt vmcnt(4)
  ds_read_b128 v[96:99], v249 offset:0
  ds_read_b128 v[100:103], v249 offset:2048
  ds_read_b128 v[104:107], v250 offset:0
  ds_read_b128 v[108:111], v250 offset:2048
  s_add_u32 s8, s9, 8192
  buffer_load_dwordx2 v[180:181], v186, s[64:67], s8 offen
  s_waitcnt lgkmcnt(15)
  v_mfma_f32_16x16x32_bf16 v[24:27], v[216:219], v[64:67], 0
  v_mfma_f32_16x16x32_bf16 v[56:59], v[216:219], v[68:71], 0
  ds_read_b64_tr_b16 v[216:217], v251 offset:14336
  ds_read_b64_tr_b16 v[218:219], v251 offset:14592
  v_lshlrev_b32 v187, 16, v188
  v_sub_u32 v187, v186, v187
  s_waitcnt lgkmcnt(15)
  v_mfma_f32_16x16x32_bf16 v[28:31], v[220:223], v[64:67], 0
  v_mfma_f32_16x16x32_bf16 v[60:63], v[220:223], v[68:71], 0
  ds_read_b64_tr_b16 v[220:221], v252 offset:14336
  ds_read_b64_tr_b16 v[222:223], v252 offset:14592
  s_lshl_b32 s8, s96, 12
  s_sub_u32 s8, s8, 65536
  s_waitcnt lgkmcnt(15)
  v_mfma_f32_16x16x32_bf16 v[0:3], v[192:195], v[72:75], v[0:3]
  v_mfma_f32_16x16x32_bf16 v[32:35], v[192:195], v[76:79], v[32:35]
  ds_read_b64_tr_b16 v[192:193], v251 offset:16384
  ds_read_b64_tr_b16 v[194:195], v251 offset:16640
  v_add_u32 v187, s8, v187
  buffer_load_dwordx2 v[128:129], v187, s[68:71], 0 offen
  s_waitcnt lgkmcnt(15)
  v_mfma_f32_16x16x32_bf16 v[4:7], v[196:199], v[72:75], v[4:7]
  v_mfma_f32_16x16x32_bf16 v[36:39], v[196:199], v[76:79], v[36:39]
  ds_read_b64_tr_b16 v[196:197], v252 offset:16384
  ds_read_b64_tr_b16 v[198:199], v252 offset:16640
  v_add_u32 v187, 0x1000, v187
  buffer_load_dwordx2 v[130:131], v187, s[68:71], 0 offen
  s_waitcnt lgkmcnt(15)
  v_mfma_f32_16x16x32_bf16 v[8:11], v[200:203], v[72:75], v[8:11]
  v_mfma_f32_16x16x32_bf16 v[40:43], v[200:203], v[76:79], v[40:43]
  ds_read_b64_tr_b16 v[200:201], v251 offset:20480
  ds_read_b64_tr_b16 v[202:203], v251 offset:20736
  s_waitcnt lgkmcnt(10)
  s_add_u32 m0, s88, 0
  s_add_u32 s6, s89, 512
  buffer_load_dwordx4 v247, s[52:55], s6 offen lds
  buffer_load_dwordx4 v248, s[52:55], s6 offen offset:1024 lds
  s_add_u32 m0, s88, 2048
  s_add_u32 s6, s89, 16896
  buffer_load_dwordx4 v247, s[52:55], s6 offen lds
  buffer_load_dwordx4 v248, s[52:55], s6 offen offset:1024 lds
  v_add_u32 v187, 0x1000, v187
  buffer_load_dwordx2 v[132:133], v187, s[68:71], 0 offen
  v_mfma_f32_16x16x32_bf16 v[12:15], v[204:207], v[72:75], v[12:15]
  v_mfma_f32_16x16x32_bf16 v[44:47], v[204:207], v[76:79], v[44:47]
  ds_read_b64_tr_b16 v[204:205], v252 offset:20480
  ds_read_b64_tr_b16 v[206:207], v252 offset:20736
  v_add_u32 v187, 0x1000, v187
  buffer_load_dwordx2 v[134:135], v187, s[68:71], 0 offen
  v_mfma_f32_16x16x32_bf16 v[16:19], v[208:211], v[72:75], v[16:19]
  v_mfma_f32_16x16x32_bf16 v[48:51], v[208:211], v[76:79], v[48:51]
  ds_read_b64_tr_b16 v[208:209], v251 offset:24576
  ds_read_b64_tr_b16 v[210:211], v251 offset:24832
  v_add_u32 v187, 0x1000, v187
  buffer_load_dwordx2 v[136:137], v187, s[68:71], 0 offen
  v_mfma_f32_16x16x32_bf16 v[20:23], v[212:215], v[72:75], v[20:23]
  v_mfma_f32_16x16x32_bf16 v[52:55], v[212:215], v[76:79], v[52:55]
  ds_read_b64_tr_b16 v[212:213], v252 offset:24576
  ds_read_b64_tr_b16 v[214:215], v252 offset:24832
  v_add_u32 v187, 0x1000, v187
  buffer_load_dwordx2 v[138:139], v187, s[68:71], 0 offen
  s_waitcnt lgkmcnt(14)
  v_mfma_f32_16x16x32_bf16 v[24:27], v[216:219], v[72:75], v[24:27]
  v_mfma_f32_16x16x32_bf16 v[56:59], v[216:219], v[76:79], v[56:59]
  ds_read_b64_tr_b16 v[216:217], v251 offset:28672
  ds_read_b64_tr_b16 v[218:219], v251 offset:28928
  v_add_u32 v187, 0x1000, v187
  buffer_load_dwordx2 v[140:141], v187, s[68:71], 0 offen
  s_waitcnt lgkmcnt(14)
  v_mfma_f32_16x16x32_bf16 v[28:31], v[220:223], v[72:75], v[28:31]
  v_mfma_f32_16x16x32_bf16 v[60:63], v[220:223], v[76:79], v[60:63]
  ds_read_b64_tr_b16 v[220:221], v252 offset:28672
  ds_read_b64_tr_b16 v[222:223], v252 offset:28928
  v_add_u32 v187, 0x1000, v187
  buffer_load_dwordx2 v[142:143], v187, s[68:71], 0 offen
  s_barrier
  s_lshl_b32 s6, s3, 11
  s_add_u32 m0, s6, 98304
  s_add_u32 s6, s90, 1572864
  buffer_load_dwordx4 v253, s[56:59], s6 offen offset:0 lds
  buffer_load_dwordx4 v254, s[56:59], s6 offen offset:1024 lds
  s_waitcnt lgkmcnt(14)
  v_mfma_f32_16x16x32_bf16 v[0:3], v[192:195], v[80:83], v[0:3]
  v_mfma_f32_16x16x32_bf16 v[32:35], v[192:195], v[84:87], v[32:35]
  ds_read_b64_tr_b16 v[192:193], v251 offset:18432
  ds_read_b64_tr_b16 v[194:195], v251 offset:18688
  v_add_u32 v187, 0x1000, v187
  buffer_load_dwordx2 v[144:145], v187, s[68:71], 0 offen
  s_waitcnt lgkmcnt(14)
  v_mfma_f32_16x16x32_bf16 v[4:7], v[196:199], v[80:83], v[4:7]
  v_mfma_f32_16x16x32_bf16 v[36:39], v[196:199], v[84:87], v[36:39]
  ds_read_b64_tr_b16 v[196:197], v252 offset:18432
  ds_read_b64_tr_b16 v[198:199], v252 offset:18688
  v_add_u32 v187, 0x1000, v187
  buffer_load_dwordx2 v[146:147], v187, s[68:71], 0 offen
  s_waitcnt lgkmcnt(14)
  v_mfma_f32_16x16x32_bf16 v[8:11], v[200:203], v[80:83], v[8:11]
  v_mfma_f32_16x16x32_bf16 v[40:43], v[200:203], v[84:87], v[40:43]
  ds_read_b64_tr_b16 v[200:201], v251 offset:22528
  ds_read_b64_tr_b16 v[202:203], v251 offset:22784
  v_add_u32 v187, 0x1000, v187
  buffer_load_dwordx2 v[148:149], v187, s[68:71], 0 offen
  s_waitcnt lgkmcnt(14)
  v_mfma_f32_16x16x32_bf16 v[12:15], v[204:207], v[80:83], v[12:15]
  v_mfma_f32_16x16x32_bf16 v[44:47], v[204:207], v[84:87], v[44:47]
  ds_read_b64_tr_b16 v[204:205], v252 offset:22528
  ds_read_b64_tr_b16 v[206:207], v252 offset:22784
  v_add_u32 v187, 0x1000, v187
  buffer_load_dwordx2 v[150:151], v187, s[68:71], 0 offen
  s_waitcnt lgkmcnt(14)
  v_mfma_f32_16x16x32_bf16 v[16:19], v[208:211], v[80:83], v[16:19]
  v_mfma_f32_16x16x32_bf16 v[48:51], v[208:211], v[84:87], v[48:51]
  ds_read_b64_tr_b16 v[208:209], v251 offset:26624
  ds_read_b64_tr_b16 v[210:211], v251 offset:26880
  v_add_u32 v187, 0x1000, v187
  buffer_load_dwordx2 v[152:153], v187, s[68:71], 0 offen
  s_waitcnt lgkmcnt(14)
  v_mfma_f32_16x16x32_bf16 v[20:23], v[212:215], v[80:83], v[20:23]
  v_mfma_f32_16x16x32_bf16 v[52:55], v[212:215], v[84:87], v[52:55]
  ds_read_b64_tr_b16 v[212:213], v252 offset:26624
  ds_read_b64_tr_b16 v[214:215], v252 offset:26880
  s_waitcnt vmcnt(20)
  ds_read_b128 v[112:115], v249 offset:4096
  ds_read_b128 v[116:119], v249 offset:6144
  ds_read_b128 v[120:123], v250 offset:4096
  ds_read_b128 v[124:127], v250 offset:6144
  v_add_u32 v187, 0x1000, v187
  buffer_load_dwordx2 v[154:155], v187, s[68:71], 0 offen
  s_waitcnt lgkmcnt(15)
  v_mfma_f32_16x16x32_bf16 v[24:27], v[216:219], v[80:83], v[24:27]
  v_mfma_f32_16x16x32_bf16 v[56:59], v[216:219], v[84:87], v[56:59]
  ds_read_b64_tr_b16 v[216:217], v251 offset:30720
  ds_read_b64_tr_b16 v[218:219], v251 offset:30976
  v_add_u32 v187, 0x1000, v187
  buffer_load_dwordx2 v[156:157], v187, s[68:71], 0 offen
  s_waitcnt lgkmcnt(15)
  v_mfma_f32_16x16x32_bf16 v[28:31], v[220:223], v[80:83], v[28:31]
  v_mfma_f32_16x16x32_bf16 v[60:63], v[220:223], v[84:87], v[60:63]
  ds_read_b64_tr_b16 v[220:221], v252 offset:30720
  ds_read_b64_tr_b16 v[222:223], v252 offset:30976
  v_add_u32 v187, 0x1000, v187
  buffer_load_dwordx2 v[158:159], v187, s[68:71], 0 offen
  s_waitcnt lgkmcnt(15)
  v_mfma_f32_16x16x32_bf16 v[0:3], v[192:195], v[88:91], v[0:3]
  v_mfma_f32_16x16x32_bf16 v[32:35], v[192:195], v[92:95], v[32:35]
  ds_read_b64_tr_b16 v[192:193], v251 offset:32768
  ds_read_b64_tr_b16 v[194:195], v251 offset:33024
  buffer_load_dwordx2 v[176:177], v186, s[64:67], s9 offen
  s_add_u32 s8, s9, 4096
  s_waitcnt lgkmcnt(15)
  v_mfma_f32_16x16x32_bf16 v[4:7], v[196:199], v[88:91], v[4:7]
  v_mfma_f32_16x16x32_bf16 v[36:39], v[196:199], v[92:95], v[36:39]
  ds_read_b64_tr_b16 v[196:197], v252 offset:32768
  ds_read_b64_tr_b16 v[198:199], v252 offset:33024
  buffer_load_dwordx2 v[178:179], v186, s[64:67], s8 offen
  s_add_u32 s8, s9, 24576
  s_waitcnt lgkmcnt(15)
  v_mfma_f32_16x16x32_bf16 v[8:11], v[200:203], v[88:91], v[8:11]
  v_mfma_f32_16x16x32_bf16 v[40:43], v[200:203], v[92:95], v[40:43]
  ds_read_b64_tr_b16 v[200:201], v251 offset:36864
  ds_read_b64_tr_b16 v[202:203], v251 offset:37120
  s_waitcnt lgkmcnt(10)
  s_add_u32 m0, s88, 4096
  s_add_u32 s6, s89, 640
  buffer_load_dwordx4 v247, s[52:55], s6 offen lds
  buffer_load_dwordx4 v248, s[52:55], s6 offen offset:1024 lds
  s_add_u32 m0, s88, 6144
  s_add_u32 s6, s89, 17024
  buffer_load_dwordx4 v247, s[52:55], s6 offen lds
  buffer_load_dwordx4 v248, s[52:55], s6 offen offset:1024 lds
  buffer_load_dwordx2 v[184:185], v186, s[64:67], s8 offen
  v_lshl_add_u32 v187, v188, 12, v186
  v_mfma_f32_16x16x32_bf16 v[12:15], v[204:207], v[88:91], v[12:15]
  v_mfma_f32_16x16x32_bf16 v[44:47], v[204:207], v[92:95], v[44:47]
  ds_read_b64_tr_b16 v[204:205], v252 offset:36864
  ds_read_b64_tr_b16 v[206:207], v252 offset:37120
  s_add_u32 s8, s9, 8192
  buffer_load_dwordx2 v[182:183], v187, s[64:67], s8 offen
  v_mfma_f32_16x16x32_bf16 v[16:19], v[208:211], v[88:91], v[16:19]
  v_mfma_f32_16x16x32_bf16 v[48:51], v[208:211], v[92:95], v[48:51]
  ds_read_b64_tr_b16 v[208:209], v251 offset:40960
  ds_read_b64_tr_b16 v[210:211], v251 offset:41216
  s_lshl_b32 s8, s96, 17
  s_lshr_b32 s9, s97, 1
  v_mfma_f32_16x16x32_bf16 v[20:23], v[212:215], v[88:91], v[20:23]
  v_mfma_f32_16x16x32_bf16 v[52:55], v[212:215], v[92:95], v[52:55]
  ds_read_b64_tr_b16 v[212:213], v252 offset:40960
  ds_read_b64_tr_b16 v[214:215], v252 offset:41216
  s_lshl_b32 s9, s9, 13
  s_add_u32 s8, s8, s9
  s_waitcnt lgkmcnt(14)
  v_mfma_f32_16x16x32_bf16 v[24:27], v[216:219], v[88:91], v[24:27]
  v_mfma_f32_16x16x32_bf16 v[56:59], v[216:219], v[92:95], v[56:59]
  ds_read_b64_tr_b16 v[216:217], v251 offset:45056
  ds_read_b64_tr_b16 v[218:219], v251 offset:45312
  s_and_b32 s9, s97, 1
  s_lshl_b32 s9, s9, 8
  s_waitcnt lgkmcnt(14)
  v_mfma_f32_16x16x32_bf16 v[28:31], v[220:223], v[88:91], v[28:31]
  v_mfma_f32_16x16x32_bf16 v[60:63], v[220:223], v[92:95], v[60:63]
  ds_read_b64_tr_b16 v[220:221], v252 offset:45056
  ds_read_b64_tr_b16 v[222:223], v252 offset:45312
  s_add_u32 s8, s8, s9
  s_add_u32 s8, s8, 50331648
  s_waitcnt vmcnt(16)
  s_barrier
  s_lshl_b32 s6, s3, 11
  s_add_u32 m0, s6, 114688
  s_add_u32 s6, s90, 2097152
  buffer_load_dwordx4 v253, s[56:59], s6 offen offset:0 lds
  buffer_load_dwordx4 v254, s[56:59], s6 offen offset:1024 lds
  s_waitcnt lgkmcnt(14)
  v_mfma_f32_16x16x32_bf16 v[0:3], v[192:195], v[96:99], v[0:3]
  v_mfma_f32_16x16x32_bf16 v[32:35], v[192:195], v[100:103], v[32:35]
  ds_read_b64_tr_b16 v[192:193], v251 offset:34816
  ds_read_b64_tr_b16 v[194:195], v251 offset:35072
  s_add_u32 s9, s8, 4096
  v_lshlrev_b32 v187, 4, v189
  s_waitcnt lgkmcnt(14)
  v_mfma_f32_16x16x32_bf16 v[4:7], v[196:199], v[96:99], v[4:7]
  v_mfma_f32_16x16x32_bf16 v[36:39], v[196:199], v[100:103], v[36:39]
  ds_read_b64_tr_b16 v[196:197], v252 offset:34816
  ds_read_b64_tr_b16 v[198:199], v252 offset:35072
  v_lshl_add_u32 v187, v188, 10, v187
  buffer_load_dwordx4 v[160:163], v187, s[64:67], s8 offen offset:0
  s_waitcnt lgkmcnt(14)
  v_mfma_f32_16x16x32_bf16 v[8:11], v[200:203], v[96:99], v[8:11]
  v_mfma_f32_16x16x32_bf16 v[40:43], v[200:203], v[100:103], v[40:43]
  ds_read_b64_tr_b16 v[200:201], v251 offset:38912
  ds_read_b64_tr_b16 v[202:203], v251 offset:39168
  buffer_load_dwordx4 v[164:167], v187, s[64:67], s8 offen offset:512
  buffer_load_dwordx4 v[168:171], v187, s[64:67], s9 offen offset:0
  s_waitcnt lgkmcnt(14)
  v_mfma_f32_16x16x32_bf16 v[12:15], v[204:207], v[96:99], v[12:15]
  v_mfma_f32_16x16x32_bf16 v[44:47], v[204:207], v[100:103], v[44:47]
  ds_read_b64_tr_b16 v[204:205], v252 offset:38912
  ds_read_b64_tr_b16 v[206:207], v252 offset:39168
  buffer_load_dwordx4 v[172:175], v187, s[64:67], s9 offen offset:512
  s_lshl_b32 s98, s96, 6
  s_waitcnt lgkmcnt(14)
  v_mfma_f32_16x16x32_bf16 v[16:19], v[208:211], v[96:99], v[16:19]
  v_mfma_f32_16x16x32_bf16 v[48:51], v[208:211], v[100:103], v[48:51]
  ds_read_b64_tr_b16 v[208:209], v251 offset:43008
  ds_read_b64_tr_b16 v[210:211], v251 offset:43264
  s_lshl_b32 s8, s97, 1
  s_add_u32 s98, s98, s8
  s_waitcnt lgkmcnt(14)
  v_mfma_f32_16x16x32_bf16 v[20:23], v[212:215], v[96:99], v[20:23]
  v_mfma_f32_16x16x32_bf16 v[52:55], v[212:215], v[100:103], v[52:55]
  ds_read_b64_tr_b16 v[212:213], v252 offset:43008
  ds_read_b64_tr_b16 v[214:215], v252 offset:43264
  ds_read_b128 v[64:67], v249 offset:0
  ds_read_b128 v[68:71], v249 offset:2048
  ds_read_b128 v[72:75], v250 offset:0
  ds_read_b128 v[76:79], v250 offset:2048
  s_lshl_b32 s98, s98, 10
  s_add_u32 s98, s98, 60817408
  s_waitcnt lgkmcnt(15)
  v_mfma_f32_16x16x32_bf16 v[24:27], v[216:219], v[96:99], v[24:27]
  v_mfma_f32_16x16x32_bf16 v[56:59], v[216:219], v[100:103], v[56:59]
  ds_read_b64_tr_b16 v[216:217], v251 offset:47104
  ds_read_b64_tr_b16 v[218:219], v251 offset:47360
  s_waitcnt lgkmcnt(15)
  v_mfma_f32_16x16x32_bf16 v[28:31], v[220:223], v[96:99], v[28:31]
  v_mfma_f32_16x16x32_bf16 v[60:63], v[220:223], v[100:103], v[60:63]
  ds_read_b64_tr_b16 v[220:221], v252 offset:47104
  ds_read_b64_tr_b16 v[222:223], v252 offset:47360
  s_waitcnt lgkmcnt(15)
  v_mfma_f32_16x16x32_bf16 v[0:3], v[192:195], v[104:107], v[0:3]
  v_mfma_f32_16x16x32_bf16 v[32:35], v[192:195], v[108:111], v[32:35]
  ds_read_b64_tr_b16 v[192:193], v251 offset:0
  ds_read_b64_tr_b16 v[194:195], v251 offset:256
  s_waitcnt lgkmcnt(15)
  v_mfma_f32_16x16x32_bf16 v[4:7], v[196:199], v[104:107], v[4:7]
  v_mfma_f32_16x16x32_bf16 v[36:39], v[196:199], v[108:111], v[36:39]
  ds_read_b64_tr_b16 v[196:197], v252 offset:0
  ds_read_b64_tr_b16 v[198:199], v252 offset:256
  s_waitcnt lgkmcnt(15)
  v_mfma_f32_16x16x32_bf16 v[8:11], v[200:203], v[104:107], v[8:11]
  v_mfma_f32_16x16x32_bf16 v[40:43], v[200:203], v[108:111], v[40:43]
  ds_read_b64_tr_b16 v[200:201], v251 offset:4096
  ds_read_b64_tr_b16 v[202:203], v251 offset:4352
  s_waitcnt lgkmcnt(10)
  s_add_u32 m0, s88, 0
  s_add_u32 s6, s89, 768
  buffer_load_dwordx4 v247, s[52:55], s6 offen lds
  buffer_load_dwordx4 v248, s[52:55], s6 offen offset:1024 lds
  s_add_u32 m0, s88, 2048
  s_add_u32 s6, s89, 17152
  buffer_load_dwordx4 v247, s[52:55], s6 offen lds
  buffer_load_dwordx4 v248, s[52:55], s6 offen offset:1024 lds
  v_mfma_f32_16x16x32_bf16 v[12:15], v[204:207], v[104:107], v[12:15]
  v_mfma_f32_16x16x32_bf16 v[44:47], v[204:207], v[108:111], v[44:47]
  ds_read_b64_tr_b16 v[204:205], v252 offset:4096
  ds_read_b64_tr_b16 v[206:207], v252 offset:4352
  v_mfma_f32_16x16x32_bf16 v[16:19], v[208:211], v[104:107], v[16:19]
  v_mfma_f32_16x16x32_bf16 v[48:51], v[208:211], v[108:111], v[48:51]
  ds_read_b64_tr_b16 v[208:209], v251 offset:8192
  ds_read_b64_tr_b16 v[210:211], v251 offset:8448
  v_mfma_f32_16x16x32_bf16 v[20:23], v[212:215], v[104:107], v[20:23]
  v_mfma_f32_16x16x32_bf16 v[52:55], v[212:215], v[108:111], v[52:55]
  ds_read_b64_tr_b16 v[212:213], v252 offset:8192
  ds_read_b64_tr_b16 v[214:215], v252 offset:8448
  s_waitcnt lgkmcnt(14)
  v_mfma_f32_16x16x32_bf16 v[24:27], v[216:219], v[104:107], v[24:27]
  v_mfma_f32_16x16x32_bf16 v[56:59], v[216:219], v[108:111], v[56:59]
  ds_read_b64_tr_b16 v[216:217], v251 offset:12288
  ds_read_b64_tr_b16 v[218:219], v251 offset:12544
  s_waitcnt lgkmcnt(14)
  v_mfma_f32_16x16x32_bf16 v[28:31], v[220:223], v[104:107], v[28:31]
  v_mfma_f32_16x16x32_bf16 v[60:63], v[220:223], v[108:111], v[60:63]
  ds_read_b64_tr_b16 v[220:221], v252 offset:12288
  ds_read_b64_tr_b16 v[222:223], v252 offset:12544
  s_waitcnt vmcnt(8)
  s_barrier
  s_lshl_b32 s6, s3, 11
  s_add_u32 m0, s6, 131072
  s_add_u32 s6, s90, 2621440
  buffer_load_dwordx4 v253, s[56:59], s6 offen offset:0 lds
  buffer_load_dwordx4 v254, s[56:59], s6 offen offset:1024 lds
  s_waitcnt lgkmcnt(14)
  v_mfma_f32_16x16x32_bf16 v[0:3], v[192:195], v[112:115], v[0:3]
  v_mfma_f32_16x16x32_bf16 v[32:35], v[192:195], v[116:119], v[32:35]
  ds_read_b64_tr_b16 v[192:193], v251 offset:2048
  ds_read_b64_tr_b16 v[194:195], v251 offset:2304
  s_waitcnt lgkmcnt(14)
  v_mfma_f32_16x16x32_bf16 v[4:7], v[196:199], v[112:115], v[4:7]
  v_mfma_f32_16x16x32_bf16 v[36:39], v[196:199], v[116:119], v[36:39]
  ds_read_b64_tr_b16 v[196:197], v252 offset:2048
  ds_read_b64_tr_b16 v[198:199], v252 offset:2304
  s_waitcnt lgkmcnt(14)
  v_mfma_f32_16x16x32_bf16 v[8:11], v[200:203], v[112:115], v[8:11]
  v_mfma_f32_16x16x32_bf16 v[40:43], v[200:203], v[116:119], v[40:43]
  ds_read_b64_tr_b16 v[200:201], v251 offset:6144
  ds_read_b64_tr_b16 v[202:203], v251 offset:6400
  s_waitcnt lgkmcnt(14)
  v_mfma_f32_16x16x32_bf16 v[12:15], v[204:207], v[112:115], v[12:15]
  v_mfma_f32_16x16x32_bf16 v[44:47], v[204:207], v[116:119], v[44:47]
  ds_read_b64_tr_b16 v[204:205], v252 offset:6144
  ds_read_b64_tr_b16 v[206:207], v252 offset:6400
  s_waitcnt lgkmcnt(14)
  v_mfma_f32_16x16x32_bf16 v[16:19], v[208:211], v[112:115], v[16:19]
  v_mfma_f32_16x16x32_bf16 v[48:51], v[208:211], v[116:119], v[48:51]
  ds_read_b64_tr_b16 v[208:209], v251 offset:10240
  ds_read_b64_tr_b16 v[210:211], v251 offset:10496
  s_mov_b32 m0, s76
  s_lshl_b32 s6, s73, 14
  s_add_u32 s6, s6, s77
  buffer_load_dwordx4 v231, s[60:63], s6 offen offset:0 lds
  buffer_load_dwordx4 v231, s[60:63], s6 offen offset:1024 lds
  buffer_load_dwordx4 v231, s[60:63], s6 offen offset:2048 lds
  buffer_load_dwordx4 v231, s[60:63], s6 offen offset:3072 lds
  s_waitcnt lgkmcnt(14)
  v_mfma_f32_16x16x32_bf16 v[20:23], v[212:215], v[112:115], v[20:23]
  v_mfma_f32_16x16x32_bf16 v[52:55], v[212:215], v[116:119], v[52:55]
  ds_read_b64_tr_b16 v[212:213], v252 offset:10240
  ds_read_b64_tr_b16 v[214:215], v252 offset:10496
  ds_read_b128 v[80:83], v249 offset:4096
  ds_read_b128 v[84:87], v249 offset:6144
  ds_read_b128 v[88:91], v250 offset:4096
  ds_read_b128 v[92:95], v250 offset:6144
  s_waitcnt lgkmcnt(15)
  v_mfma_f32_16x16x32_bf16 v[24:27], v[216:219], v[112:115], v[24:27]
  v_mfma_f32_16x16x32_bf16 v[56:59], v[216:219], v[116:119], v[56:59]
  ds_read_b64_tr_b16 v[216:217], v251 offset:14336
  ds_read_b64_tr_b16 v[218:219], v251 offset:14592
  s_waitcnt lgkmcnt(15)
  v_mfma_f32_16x16x32_bf16 v[28:31], v[220:223], v[112:115], v[28:31]
  v_mfma_f32_16x16x32_bf16 v[60:63], v[220:223], v[116:119], v[60:63]
  ds_read_b64_tr_b16 v[220:221], v252 offset:14336
  ds_read_b64_tr_b16 v[222:223], v252 offset:14592
  s_waitcnt lgkmcnt(15)
  v_mfma_f32_16x16x32_bf16 v[0:3], v[192:195], v[120:123], v[0:3]
  v_mfma_f32_16x16x32_bf16 v[32:35], v[192:195], v[124:127], v[32:35]
  ds_read_b64_tr_b16 v[192:193], v251 offset:16384
  ds_read_b64_tr_b16 v[194:195], v251 offset:16640
  v_cmp_lt_u32 s[80:81], 0, v188
  v_cmp_lt_u32 s[82:83], 1, v188
  v_cmp_lt_u32 s[84:85], 2, v188
  s_waitcnt vmcnt(10)
  v_fma_f32 v238, v128, v180, v130
  v_fma_f32 v239, v128, v181, v131
  s_waitcnt lgkmcnt(15)
  v_mfma_f32_16x16x32_bf16 v[4:7], v[196:199], v[120:123], v[4:7]
  v_mfma_f32_16x16x32_bf16 v[36:39], v[196:199], v[124:127], v[36:39]
  ds_read_b64_tr_b16 v[196:197], v252 offset:16384
  ds_read_b64_tr_b16 v[198:199], v252 offset:16640
  v_fma_f32 v190, -v129, v181, v238
  v_fma_f32 v191, v129, v180, v239
  v_fma_f32 v238, v190, v180, v132
  v_fma_f32 v239, v190, v181, v133
  v_fma_f32 v190, -v191, v181, v238
  s_waitcnt lgkmcnt(15)
  v_mfma_f32_16x16x32_bf16 v[8:11], v[200:203], v[120:123], v[8:11]
  v_mfma_f32_16x16x32_bf16 v[40:43], v[200:203], v[124:127], v[40:43]
  ds_read_b64_tr_b16 v[200:201], v251 offset:20480
  ds_read_b64_tr_b16 v[202:203], v251 offset:20736
  s_waitcnt lgkmcnt(10)
  s_add_u32 m0, s88, 4096
  s_add_u32 s6, s89, 896
  buffer_load_dwordx4 v247, s[52:55], s6 offen lds
  buffer_load_dwordx4 v248, s[52:55], s6 offen offset:1024 lds
  s_add_u32 m0, s88, 6144
  s_add_u32 s6, s89, 17280
  buffer_load_dwordx4 v247, s[52:55], s6 offen lds
  buffer_load_dwordx4 v248, s[52:55], s6 offen offset:1024 lds
  v_fma_f32 v191, v191, v180, v239
  v_fma_f32 v238, v190, v180, v134
  v_fma_f32 v239, v190, v181, v135
  v_fma_f32 v190, -v191, v181, v238
  v_fma_f32 v191, v191, v180, v239
  v_mfma_f32_16x16x32_bf16 v[12:15], v[204:207], v[120:123], v[12:15]
  v_mfma_f32_16x16x32_bf16 v[44:47], v[204:207], v[124:127], v[44:47]
  ds_read_b64_tr_b16 v[204:205], v252 offset:20480
  ds_read_b64_tr_b16 v[206:207], v252 offset:20736
  v_fma_f32 v238, v190, v180, v136
  v_fma_f32 v239, v190, v181, v137
  v_fma_f32 v190, -v191, v181, v238
  v_fma_f32 v191, v191, v180, v239
  v_fma_f32 v238, v190, v180, v138
  v_mfma_f32_16x16x32_bf16 v[16:19], v[208:211], v[120:123], v[16:19]
  v_mfma_f32_16x16x32_bf16 v[48:51], v[208:211], v[124:127], v[48:51]
  ds_read_b64_tr_b16 v[208:209], v251 offset:24576
  ds_read_b64_tr_b16 v[210:211], v251 offset:24832
  v_fma_f32 v239, v190, v181, v139
  v_fma_f32 v190, -v191, v181, v238
  v_fma_f32 v191, v191, v180, v239
  v_fma_f32 v238, v190, v180, v140
  v_fma_f32 v239, v190, v181, v141
  v_mfma_f32_16x16x32_bf16 v[20:23], v[212:215], v[120:123], v[20:23]
  v_mfma_f32_16x16x32_bf16 v[52:55], v[212:215], v[124:127], v[52:55]
  ds_read_b64_tr_b16 v[212:213], v252 offset:24576
  ds_read_b64_tr_b16 v[214:215], v252 offset:24832
  v_fma_f32 v190, -v191, v181, v238
  v_fma_f32 v191, v191, v180, v239
  v_fma_f32 v238, v190, v180, v142
  v_fma_f32 v239, v190, v181, v143
  v_fma_f32 v190, -v191, v181, v238
  s_waitcnt lgkmcnt(14)
  v_mfma_f32_16x16x32_bf16 v[24:27], v[216:219], v[120:123], v[24:27]
  v_mfma_f32_16x16x32_bf16 v[56:59], v[216:219], v[124:127], v[56:59]
  ds_read_b64_tr_b16 v[216:217], v251 offset:28672
  ds_read_b64_tr_b16 v[218:219], v251 offset:28928
  v_fma_f32 v191, v191, v180, v239
  v_fma_f32 v238, v190, v180, v144
  v_fma_f32 v239, v190, v181, v145
  v_fma_f32 v190, -v191, v181, v238
  v_fma_f32 v191, v191, v180, v239
  s_waitcnt lgkmcnt(14)
  v_mfma_f32_16x16x32_bf16 v[28:31], v[220:223], v[120:123], v[28:31]
  v_mfma_f32_16x16x32_bf16 v[60:63], v[220:223], v[124:127], v[60:63]
  ds_read_b64_tr_b16 v[220:221], v252 offset:28672
  ds_read_b64_tr_b16 v[222:223], v252 offset:28928
  v_fma_f32 v238, v190, v180, v146
  v_fma_f32 v239, v190, v181, v147
  v_fma_f32 v190, -v191, v181, v238
  v_fma_f32 v191, v191, v180, v239
  v_fma_f32 v238, v190, v180, v148
  s_waitcnt vmcnt(8)
  s_barrier
  s_lshl_b32 s6, s3, 11
  s_add_u32 m0, s6, 98304
  s_add_u32 s6, s90, 3145728
  buffer_load_dwordx4 v253, s[56:59], s6 offen offset:0 lds
  buffer_load_dwordx4 v254, s[56:59], s6 offen offset:1024 lds
  s_waitcnt lgkmcnt(14)
  v_mfma_f32_16x16x32_bf16 v[0:3], v[192:195], v[64:67], v[0:3]
  v_mfma_f32_16x16x32_bf16 v[32:35], v[192:195], v[68:71], v[32:35]
  ds_read_b64_tr_b16 v[192:193], v251 offset:18432
  ds_read_b64_tr_b16 v[194:195], v251 offset:18688
  v_fma_f32 v239, v190, v181, v149
  v_fma_f32 v190, -v191, v181, v238
  v_fma_f32 v191, v191, v180, v239
  v_fma_f32 v238, v190, v180, v150
  v_fma_f32 v239, v190, v181, v151
  s_waitcnt lgkmcnt(14)
  v_mfma_f32_16x16x32_bf16 v[4:7], v[196:199], v[64:67], v[4:7]
  v_mfma_f32_16x16x32_bf16 v[36:39], v[196:199], v[68:71], v[36:39]
  ds_read_b64_tr_b16 v[196:197], v252 offset:18432
  ds_read_b64_tr_b16 v[198:199], v252 offset:18688
  v_fma_f32 v190, -v191, v181, v238
  v_fma_f32 v191, v191, v180, v239
  v_fma_f32 v238, v190, v180, v152
  v_fma_f32 v239, v190, v181, v153
  v_fma_f32 v190, -v191, v181, v238
  s_waitcnt lgkmcnt(14)
  v_mfma_f32_16x16x32_bf16 v[8:11], v[200:203], v[64:67], v[8:11]
  v_mfma_f32_16x16x32_bf16 v[40:43], v[200:203], v[68:71], v[40:43]
  ds_read_b64_tr_b16 v[200:201], v251 offset:22528
  ds_read_b64_tr_b16 v[202:203], v251 offset:22784
  v_fma_f32 v191, v191, v180, v239
  v_fma_f32 v238, v190, v180, v154
  v_fma_f32 v239, v190, v181, v155
  v_fma_f32 v190, -v191, v181, v238
  v_fma_f32 v191, v191, v180, v239
  s_waitcnt lgkmcnt(14)
  v_mfma_f32_16x16x32_bf16 v[12:15], v[204:207], v[64:67], v[12:15]
  v_mfma_f32_16x16x32_bf16 v[44:47], v[204:207], v[68:71], v[44:47]
  ds_read_b64_tr_b16 v[204:205], v252 offset:22528
  ds_read_b64_tr_b16 v[206:207], v252 offset:22784
  v_fma_f32 v238, v190, v180, v156
  v_fma_f32 v239, v190, v181, v157
  v_fma_f32 v190, -v191, v181, v238
  v_fma_f32 v191, v191, v180, v239
  v_fma_f32 v238, v190, v180, v158
  s_waitcnt lgkmcnt(14)
  v_mfma_f32_16x16x32_bf16 v[16:19], v[208:211], v[64:67], v[16:19]
  v_mfma_f32_16x16x32_bf16 v[48:51], v[208:211], v[68:71], v[48:51]
  ds_read_b64_tr_b16 v[208:209], v251 offset:26624
  ds_read_b64_tr_b16 v[210:211], v251 offset:26880
  v_fma_f32 v239, v190, v181, v159
  v_fma_f32 v190, -v191, v181, v238
  v_fma_f32 v191, v191, v180, v239
  v_cndmask_b32 v182, 1.0, v182, s[80:81]
  v_cndmask_b32 v183, 0, v183, s[80:81]
  s_waitcnt lgkmcnt(14)
  v_mfma_f32_16x16x32_bf16 v[20:23], v[212:215], v[64:67], v[20:23]
  v_mfma_f32_16x16x32_bf16 v[52:55], v[212:215], v[68:71], v[52:55]
  ds_read_b64_tr_b16 v[212:213], v252 offset:26624
  ds_read_b64_tr_b16 v[214:215], v252 offset:26880
  ds_read_b128 v[96:99], v249 offset:0
  ds_read_b128 v[100:103], v249 offset:2048
  ds_read_b128 v[104:107], v250 offset:0
  ds_read_b128 v[108:111], v250 offset:2048
  v_mul_f32 v238, v190, v182
  v_mul_f32 v239, v190, v183
  v_fma_f32 v190, -v191, v183, v238
  v_fma_f32 v191, v191, v182, v239
  v_mov_b32 v238, v190
  s_waitcnt lgkmcnt(15)
  v_mfma_f32_16x16x32_bf16 v[24:27], v[216:219], v[64:67], v[24:27]
  v_mfma_f32_16x16x32_bf16 v[56:59], v[216:219], v[68:71], v[56:59]
  ds_read_b64_tr_b16 v[216:217], v251 offset:30720
  ds_read_b64_tr_b16 v[218:219], v251 offset:30976
  v_mov_b32 v239, v191
  s_nop 1
  v_permlane32_swap_b32 v190, v238
  v_permlane32_swap_b32 v191, v239
  v_add_f32 v190, v190, v238
  s_waitcnt lgkmcnt(15)
  v_mfma_f32_16x16x32_bf16 v[28:31], v[220:223], v[64:67], v[28:31]
  v_mfma_f32_16x16x32_bf16 v[60:63], v[220:223], v[68:71], v[60:63]
  ds_read_b64_tr_b16 v[220:221], v252 offset:30720
  ds_read_b64_tr_b16 v[222:223], v252 offset:30976
  v_add_f32 v191, v191, v239
  v_mov_b32 v238, v190
  v_mov_b32 v239, v191
  s_nop 1
  v_permlane16_swap_b32 v190, v238
  s_waitcnt lgkmcnt(15)
  v_mfma_f32_16x16x32_bf16 v[0:3], v[192:195], v[72:75], v[0:3]
  v_mfma_f32_16x16x32_bf16 v[32:35], v[192:195], v[76:79], v[32:35]
  ds_read_b64_tr_b16 v[192:193], v251 offset:32768
  ds_read_b64_tr_b16 v[194:195], v251 offset:33024
  v_permlane16_swap_b32 v191, v239
  v_add_f32 v190, v190, v238
  v_add_f32 v191, v191, v239
  v_fma_f32 v238, v160, v176, v161
  v_fma_f32 v239, v160, v177, v169
  s_waitcnt lgkmcnt(15)
  v_mfma_f32_16x16x32_bf16 v[4:7], v[196:199], v[72:75], v[4:7]
  v_mfma_f32_16x16x32_bf16 v[36:39], v[196:199], v[76:79], v[36:39]
  ds_read_b64_tr_b16 v[196:197], v252 offset:32768
  ds_read_b64_tr_b16 v[198:199], v252 offset:33024
  v_fma_f32 v128, -v168, v177, v238
  v_fma_f32 v129, v168, v176, v239
  v_fma_f32 v238, v128, v176, v162
  v_fma_f32 v239, v128, v177, v170
  v_fma_f32 v128, -v129, v177, v238
  s_waitcnt lgkmcnt(15)
  v_mfma_f32_16x16x32_bf16 v[8:11], v[200:203], v[72:75], v[8:11]
  v_mfma_f32_16x16x32_bf16 v[40:43], v[200:203], v[76:79], v[40:43]
  ds_read_b64_tr_b16 v[200:201], v251 offset:36864
  ds_read_b64_tr_b16 v[202:203], v251 offset:37120
  v_fma_f32 v129, v129, v176, v239
  v_fma_f32 v238, v128, v176, v163
  v_fma_f32 v239, v128, v177, v171
  v_fma_f32 v128, -v129, v177, v238
  v_fma_f32 v129, v129, v176, v239
  s_waitcnt lgkmcnt(15)
  v_mfma_f32_16x16x32_bf16 v[12:15], v[204:207], v[72:75], v[12:15]
  v_mfma_f32_16x16x32_bf16 v[44:47], v[204:207], v[76:79], v[44:47]
  ds_read_b64_tr_b16 v[204:205], v252 offset:36864
  ds_read_b64_tr_b16 v[206:207], v252 offset:37120
  v_fma_f32 v238, v128, v176, v164
  v_fma_f32 v239, v128, v177, v172
  v_fma_f32 v128, -v129, v177, v238
  v_fma_f32 v129, v129, v176, v239
  v_fma_f32 v238, v128, v176, v165
  s_waitcnt lgkmcnt(15)
  v_mfma_f32_16x16x32_bf16 v[16:19], v[208:211], v[72:75], v[16:19]
  v_mfma_f32_16x16x32_bf16 v[48:51], v[208:211], v[76:79], v[48:51]
  ds_read_b64_tr_b16 v[208:209], v251 offset:40960
  ds_read_b64_tr_b16 v[210:211], v251 offset:41216
  v_fma_f32 v239, v128, v177, v173
  v_fma_f32 v128, -v129, v177, v238
  v_fma_f32 v129, v129, v176, v239
  v_fma_f32 v238, v128, v176, v166
  v_fma_f32 v239, v128, v177, v174
  s_waitcnt lgkmcnt(15)
  v_mfma_f32_16x16x32_bf16 v[20:23], v[212:215], v[72:75], v[20:23]
  v_mfma_f32_16x16x32_bf16 v[52:55], v[212:215], v[76:79], v[52:55]
  ds_read_b64_tr_b16 v[212:213], v252 offset:40960
  ds_read_b64_tr_b16 v[214:215], v252 offset:41216
  v_fma_f32 v128, -v129, v177, v238
  v_fma_f32 v129, v129, v176, v239
  v_fma_f32 v238, v128, v176, v167
  v_fma_f32 v239, v128, v177, v175
  v_fma_f32 v128, -v129, v177, v238
  s_waitcnt lgkmcnt(14)
  v_mfma_f32_16x16x32_bf16 v[24:27], v[216:219], v[72:75], v[24:27]
  v_mfma_f32_16x16x32_bf16 v[56:59], v[216:219], v[76:79], v[56:59]
  ds_read_b64_tr_b16 v[216:217], v251 offset:45056
  ds_read_b64_tr_b16 v[218:219], v251 offset:45312
  v_fma_f32 v129, v129, v176, v239
  v_lshlrev_b32 v186, 2, v189
  ds_bpermute_b32 v130, v186, v128
  ds_bpermute_b32 v131, v186, v129
  v_add_u32 v186, 64, v186
  s_waitcnt lgkmcnt(15)
  v_mfma_f32_16x16x32_bf16 v[28:31], v[220:223], v[72:75], v[28:31]
  v_mfma_f32_16x16x32_bf16 v[60:63], v[220:223], v[76:79], v[60:63]
  ds_read_b64_tr_b16 v[220:221], v252 offset:45056
  ds_read_b64_tr_b16 v[222:223], v252 offset:45312
  ds_bpermute_b32 v132, v186, v128
  ds_bpermute_b32 v133, v186, v129
  v_add_u32 v186, 64, v186
  ds_bpermute_b32 v134, v186, v128
  ds_bpermute_b32 v135, v186, v129
  s_waitcnt vmcnt(0)
  s_barrier
  s_lshl_b32 s6, s3, 11
  s_add_u32 m0, s6, 114688
  s_add_u32 s6, s90, 3670016
  buffer_load_dwordx4 v253, s[56:59], s6 offen offset:0 lds
  buffer_load_dwordx4 v254, s[56:59], s6 offen offset:1024 lds
  s_waitcnt lgkmcnt(15)
  v_mfma_f32_16x16x32_bf16 v[0:3], v[192:195], v[80:83], v[0:3]
  v_mfma_f32_16x16x32_bf16 v[32:35], v[192:195], v[84:87], v[32:35]
  ds_read_b64_tr_b16 v[192:193], v251 offset:34816
  ds_read_b64_tr_b16 v[194:195], v251 offset:35072
  v_bfe_u32 v187, v189, 2, 1
  v_lshlrev_b32 v187, 10, v187
  v_bfe_u32 v240, v189, 3, 1
  v_lshl_add_u32 v187, v240, 9, v187
  v_and_b32 v240, 3, v189
  s_waitcnt lgkmcnt(15)
  v_mfma_f32_16x16x32_bf16 v[4:7], v[196:199], v[80:83], v[4:7]
  v_mfma_f32_16x16x32_bf16 v[36:39], v[196:199], v[84:87], v[36:39]
  ds_read_b64_tr_b16 v[196:197], v252 offset:34816
  ds_read_b64_tr_b16 v[198:199], v252 offset:35072
  v_lshl_add_u32 v187, v240, 2, v187
  v_lshl_add_u32 v187, v188, 7, v187
  s_waitcnt lgkmcnt(4)
  v_fma_f32 v238, v190, v178, v130
  v_fma_f32 v239, v190, v179, v131
  v_fma_f32 v240, -v191, v179, v238
  v_mfma_f32_16x16x32_bf16 v[8:11], v[200:203], v[80:83], v[8:11]
  v_mfma_f32_16x16x32_bf16 v[40:43], v[200:203], v[84:87], v[40:43]
  ds_read_b64_tr_b16 v[200:201], v251 offset:38912
  ds_read_b64_tr_b16 v[202:203], v251 offset:39168
  v_fma_f32 v241, v191, v178, v239
  v_cndmask_b32 v190, v190, v240, s[80:81]
  v_cndmask_b32 v191, v191, v241, s[80:81]
  v_fma_f32 v238, v190, v178, v132
  v_fma_f32 v239, v190, v179, v133
  v_mfma_f32_16x16x32_bf16 v[12:15], v[204:207], v[80:83], v[12:15]
  v_mfma_f32_16x16x32_bf16 v[44:47], v[204:207], v[84:87], v[44:47]
  ds_read_b64_tr_b16 v[204:205], v252 offset:38912
  ds_read_b64_tr_b16 v[206:207], v252 offset:39168
  v_fma_f32 v240, -v191, v179, v238
  v_fma_f32 v241, v191, v178, v239
  v_cndmask_b32 v190, v190, v240, s[82:83]
  v_cndmask_b32 v191, v191, v241, s[82:83]
  v_fma_f32 v238, v190, v178, v134
  v_mfma_f32_16x16x32_bf16 v[16:19], v[208:211], v[80:83], v[16:19]
  v_mfma_f32_16x16x32_bf16 v[48:51], v[208:211], v[84:87], v[48:51]
  ds_read_b64_tr_b16 v[208:209], v251 offset:43008
  ds_read_b64_tr_b16 v[210:211], v251 offset:43264
  v_fma_f32 v239, v190, v179, v135
  v_fma_f32 v240, -v191, v179, v238
  v_fma_f32 v241, v191, v178, v239
  v_cndmask_b32 v190, v190, v240, s[84:85]
  v_cndmask_b32 v191, v191, v241, s[84:85]
  v_mfma_f32_16x16x32_bf16 v[20:23], v[212:215], v[80:83], v[20:23]
  v_mfma_f32_16x16x32_bf16 v[52:55], v[212:215], v[84:87], v[52:55]
  ds_read_b64_tr_b16 v[212:213], v252 offset:43008
  ds_read_b64_tr_b16 v[214:215], v252 offset:43264
  ds_read_b128 v[112:115], v249 offset:4096
  ds_read_b128 v[116:119], v249 offset:6144
  ds_read_b128 v[120:123], v250 offset:4096
  ds_read_b128 v[124:127], v250 offset:6144
  v_fma_f32 v238, v190, v176, v160
  v_fma_f32 v239, v190, v177, v168
  v_fma_f32 v190, -v191, v177, v238
  v_fma_f32 v191, v191, v176, v239
  v_mul_f32 v238, v190, v184
  v_mfma_f32_16x16x32_bf16 v[24:27], v[216:219], v[80:83], v[24:27]
  v_mfma_f32_16x16x32_bf16 v[56:59], v[216:219], v[84:87], v[56:59]
  ds_read_b64_tr_b16 v[216:217], v251 offset:47104
  ds_read_b64_tr_b16 v[218:219], v251 offset:47360
  v_mul_f32 v239, v190, v185
  v_fma_f32 v136, -v191, v185, v238
  v_fma_f32 v137, v191, v184, v239
  v_cvt_pk_bf16_f32 v144, v136, -v137
  buffer_store_dword v144, v187, s[64:67], s98 offen offset:0
  v_mfma_f32_16x16x32_bf16 v[28:31], v[220:223], v[80:83], v[28:31]
  v_mfma_f32_16x16x32_bf16 v[60:63], v[220:223], v[84:87], v[60:63]
  ds_read_b64_tr_b16 v[220:221], v252 offset:47104
  ds_read_b64_tr_b16 v[222:223], v252 offset:47360
  v_fma_f32 v238, v190, v176, v161
  v_fma_f32 v239, v190, v177, v169
  v_fma_f32 v190, -v191, v177, v238
  v_fma_f32 v191, v191, v176, v239
  v_mul_f32 v238, v190, v184
  s_waitcnt lgkmcnt(15)
  v_mfma_f32_16x16x32_bf16 v[0:3], v[192:195], v[88:91], v[0:3]
  v_mfma_f32_16x16x32_bf16 v[32:35], v[192:195], v[92:95], v[32:35]
  ds_read_b64_tr_b16 v[192:193], v251 offset:0
  ds_read_b64_tr_b16 v[194:195], v251 offset:256
  v_mul_f32 v239, v190, v185
  v_fma_f32 v138, -v191, v185, v238
  v_fma_f32 v139, v191, v184, v239
  v_cvt_pk_bf16_f32 v145, v138, -v139
  buffer_store_dword v145, v187, s[64:67], s98 offen offset:16
  s_waitcnt lgkmcnt(15)
  v_mfma_f32_16x16x32_bf16 v[4:7], v[196:199], v[88:91], v[4:7]
  v_mfma_f32_16x16x32_bf16 v[36:39], v[196:199], v[92:95], v[36:39]
  ds_read_b64_tr_b16 v[196:197], v252 offset:0
  ds_read_b64_tr_b16 v[198:199], v252 offset:256
  v_fma_f32 v238, v190, v176, v162
  v_fma_f32 v239, v190, v177, v170
  v_fma_f32 v190, -v191, v177, v238
  v_fma_f32 v191, v191, v176, v239
  v_mul_f32 v238, v190, v184
  s_waitcnt lgkmcnt(15)
  v_mfma_f32_16x16x32_bf16 v[8:11], v[200:203], v[88:91], v[8:11]
  v_mfma_f32_16x16x32_bf16 v[40:43], v[200:203], v[92:95], v[40:43]
  ds_read_b64_tr_b16 v[200:201], v251 offset:4096
  ds_read_b64_tr_b16 v[202:203], v251 offset:4352
  v_mul_f32 v239, v190, v185
  v_fma_f32 v140, -v191, v185, v238
  v_fma_f32 v141, v191, v184, v239
  v_cvt_pk_bf16_f32 v146, v140, -v141
  buffer_store_dword v146, v187, s[64:67], s98 offen offset:32
  s_waitcnt lgkmcnt(15)
  v_mfma_f32_16x16x32_bf16 v[12:15], v[204:207], v[88:91], v[12:15]
  v_mfma_f32_16x16x32_bf16 v[44:47], v[204:207], v[92:95], v[44:47]
  ds_read_b64_tr_b16 v[204:205], v252 offset:4096
  ds_read_b64_tr_b16 v[206:207], v252 offset:4352
  v_fma_f32 v238, v190, v176, v163
  v_fma_f32 v239, v190, v177, v171
  v_fma_f32 v190, -v191, v177, v238
  v_fma_f32 v191, v191, v176, v239
  v_mul_f32 v238, v190, v184
  s_waitcnt lgkmcnt(15)
  v_mfma_f32_16x16x32_bf16 v[16:19], v[208:211], v[88:91], v[16:19]
  v_mfma_f32_16x16x32_bf16 v[48:51], v[208:211], v[92:95], v[48:51]
  ds_read_b64_tr_b16 v[208:209], v251 offset:8192
  ds_read_b64_tr_b16 v[210:211], v251 offset:8448
  v_mul_f32 v239, v190, v185
  v_fma_f32 v142, -v191, v185, v238
  v_fma_f32 v143, v191, v184, v239
  v_cvt_pk_bf16_f32 v147, v142, -v143
  buffer_store_dword v147, v187, s[64:67], s98 offen offset:48
  s_waitcnt lgkmcnt(15)
  v_mfma_f32_16x16x32_bf16 v[20:23], v[212:215], v[88:91], v[20:23]
  v_mfma_f32_16x16x32_bf16 v[52:55], v[212:215], v[92:95], v[52:55]
  ds_read_b64_tr_b16 v[212:213], v252 offset:8192
  ds_read_b64_tr_b16 v[214:215], v252 offset:8448
  v_fma_f32 v238, v190, v176, v164
  v_fma_f32 v239, v190, v177, v172
  v_fma_f32 v190, -v191, v177, v238
  v_fma_f32 v191, v191, v176, v239
  v_mul_f32 v238, v190, v184
  s_waitcnt lgkmcnt(14)
  v_mfma_f32_16x16x32_bf16 v[24:27], v[216:219], v[88:91], v[24:27]
  v_mfma_f32_16x16x32_bf16 v[56:59], v[216:219], v[92:95], v[56:59]
  ds_read_b64_tr_b16 v[216:217], v251 offset:12288
  ds_read_b64_tr_b16 v[218:219], v251 offset:12544
  v_mul_f32 v239, v190, v185
  v_fma_f32 v136, -v191, v185, v238
  v_fma_f32 v137, v191, v184, v239
  v_cvt_pk_bf16_f32 v148, v136, -v137
  buffer_store_dword v148, v187, s[64:67], s98 offen offset:64
  s_waitcnt lgkmcnt(14)
  v_mfma_f32_16x16x32_bf16 v[28:31], v[220:223], v[88:91], v[28:31]
  v_mfma_f32_16x16x32_bf16 v[60:63], v[220:223], v[92:95], v[60:63]
  ds_read_b64_tr_b16 v[220:221], v252 offset:12288
  ds_read_b64_tr_b16 v[222:223], v252 offset:12544
  v_fma_f32 v238, v190, v176, v165
  v_fma_f32 v239, v190, v177, v173
  v_fma_f32 v190, -v191, v177, v238
  v_fma_f32 v191, v191, v176, v239
  v_mul_f32 v238, v190, v184
  s_waitcnt vmcnt(5)
  s_barrier
  s_waitcnt lgkmcnt(14)
  v_mfma_f32_16x16x32_bf16 v[0:3], v[192:195], v[96:99], v[0:3]
  v_mfma_f32_16x16x32_bf16 v[32:35], v[192:195], v[100:103], v[32:35]
  ds_read_b64_tr_b16 v[192:193], v251 offset:2048
  ds_read_b64_tr_b16 v[194:195], v251 offset:2304
  v_mul_f32 v239, v190, v185
  v_fma_f32 v138, -v191, v185, v238
  v_fma_f32 v139, v191, v184, v239
  v_cvt_pk_bf16_f32 v149, v138, -v139
  buffer_store_dword v149, v187, s[64:67], s98 offen offset:80
  s_waitcnt lgkmcnt(14)
  v_mfma_f32_16x16x32_bf16 v[4:7], v[196:199], v[96:99], v[4:7]
  v_mfma_f32_16x16x32_bf16 v[36:39], v[196:199], v[100:103], v[36:39]
  ds_read_b64_tr_b16 v[196:197], v252 offset:2048
  ds_read_b64_tr_b16 v[198:199], v252 offset:2304
  v_fma_f32 v238, v190, v176, v166
  v_fma_f32 v239, v190, v177, v174
  v_fma_f32 v190, -v191, v177, v238
  v_fma_f32 v191, v191, v176, v239
  v_mul_f32 v238, v190, v184
  s_waitcnt lgkmcnt(14)
  v_mfma_f32_16x16x32_bf16 v[8:11], v[200:203], v[96:99], v[8:11]
  v_mfma_f32_16x16x32_bf16 v[40:43], v[200:203], v[100:103], v[40:43]
  ds_read_b64_tr_b16 v[200:201], v251 offset:6144
  ds_read_b64_tr_b16 v[202:203], v251 offset:6400
  v_mul_f32 v239, v190, v185
  v_fma_f32 v140, -v191, v185, v238
  v_fma_f32 v141, v191, v184, v239
  v_cvt_pk_bf16_f32 v150, v140, -v141
  buffer_store_dword v150, v187, s[64:67], s98 offen offset:96
  s_waitcnt lgkmcnt(14)
  v_mfma_f32_16x16x32_bf16 v[12:15], v[204:207], v[96:99], v[12:15]
  v_mfma_f32_16x16x32_bf16 v[44:47], v[204:207], v[100:103], v[44:47]
  ds_read_b64_tr_b16 v[204:205], v252 offset:6144
  ds_read_b64_tr_b16 v[206:207], v252 offset:6400
  v_fma_f32 v238, v190, v176, v167
  v_fma_f32 v239, v190, v177, v175
  v_fma_f32 v190, -v191, v177, v238
  v_fma_f32 v191, v191, v176, v239
  v_mul_f32 v238, v190, v184
  s_waitcnt lgkmcnt(14)
  v_mfma_f32_16x16x32_bf16 v[16:19], v[208:211], v[96:99], v[16:19]
  v_mfma_f32_16x16x32_bf16 v[48:51], v[208:211], v[100:103], v[48:51]
  ds_read_b64_tr_b16 v[208:209], v251 offset:10240
  ds_read_b64_tr_b16 v[210:211], v251 offset:10496
  v_mul_f32 v239, v190, v185
  v_fma_f32 v142, -v191, v185, v238
  v_fma_f32 v143, v191, v184, v239
  v_cvt_pk_bf16_f32 v151, v142, -v143
  buffer_store_dword v151, v187, s[64:67], s98 offen offset:112
  s_waitcnt lgkmcnt(14)
  v_mfma_f32_16x16x32_bf16 v[20:23], v[212:215], v[96:99], v[20:23]
  v_mfma_f32_16x16x32_bf16 v[52:55], v[212:215], v[100:103], v[52:55]
  ds_read_b64_tr_b16 v[212:213], v252 offset:10240
  ds_read_b64_tr_b16 v[214:215], v252 offset:10496
  s_waitcnt lgkmcnt(14)
  v_mfma_f32_16x16x32_bf16 v[24:27], v[216:219], v[96:99], v[24:27]
  v_mfma_f32_16x16x32_bf16 v[56:59], v[216:219], v[100:103], v[56:59]
  ds_read_b64_tr_b16 v[216:217], v251 offset:14336
  ds_read_b64_tr_b16 v[218:219], v251 offset:14592
  s_waitcnt lgkmcnt(14)
  v_mfma_f32_16x16x32_bf16 v[28:31], v[220:223], v[96:99], v[28:31]
  v_mfma_f32_16x16x32_bf16 v[60:63], v[220:223], v[100:103], v[60:63]
  ds_read_b64_tr_b16 v[220:221], v252 offset:14336
  ds_read_b64_tr_b16 v[222:223], v252 offset:14592
  s_waitcnt lgkmcnt(14)
  v_mfma_f32_16x16x32_bf16 v[0:3], v[192:195], v[104:107], v[0:3]
  v_mfma_f32_16x16x32_bf16 v[32:35], v[192:195], v[108:111], v[32:35]
  ds_read_b64_tr_b16 v[192:193], v251 offset:16384
  ds_read_b64_tr_b16 v[194:195], v251 offset:16640
  s_waitcnt lgkmcnt(14)
  v_mfma_f32_16x16x32_bf16 v[4:7], v[196:199], v[104:107], v[4:7]
  v_mfma_f32_16x16x32_bf16 v[36:39], v[196:199], v[108:111], v[36:39]
  ds_read_b64_tr_b16 v[196:197], v252 offset:16384
  ds_read_b64_tr_b16 v[198:199], v252 offset:16640
  s_waitcnt lgkmcnt(14)
  v_mfma_f32_16x16x32_bf16 v[8:11], v[200:203], v[104:107], v[8:11]
  v_mfma_f32_16x16x32_bf16 v[40:43], v[200:203], v[108:111], v[40:43]
  ds_read_b64_tr_b16 v[200:201], v251 offset:20480
  ds_read_b64_tr_b16 v[202:203], v251 offset:20736
  s_waitcnt lgkmcnt(14)
  v_mfma_f32_16x16x32_bf16 v[12:15], v[204:207], v[104:107], v[12:15]
  v_mfma_f32_16x16x32_bf16 v[44:47], v[204:207], v[108:111], v[44:47]
  ds_read_b64_tr_b16 v[204:205], v252 offset:20480
  ds_read_b64_tr_b16 v[206:207], v252 offset:20736
  s_waitcnt lgkmcnt(14)
  v_mfma_f32_16x16x32_bf16 v[16:19], v[208:211], v[104:107], v[16:19]
  v_mfma_f32_16x16x32_bf16 v[48:51], v[208:211], v[108:111], v[48:51]
  ds_read_b64_tr_b16 v[208:209], v251 offset:24576
  ds_read_b64_tr_b16 v[210:211], v251 offset:24832
  s_waitcnt lgkmcnt(14)
  v_mfma_f32_16x16x32_bf16 v[20:23], v[212:215], v[104:107], v[20:23]
  v_mfma_f32_16x16x32_bf16 v[52:55], v[212:215], v[108:111], v[52:55]
  ds_read_b64_tr_b16 v[212:213], v252 offset:24576
  ds_read_b64_tr_b16 v[214:215], v252 offset:24832
  s_waitcnt lgkmcnt(14)
  v_mfma_f32_16x16x32_bf16 v[24:27], v[216:219], v[104:107], v[24:27]
  v_mfma_f32_16x16x32_bf16 v[56:59], v[216:219], v[108:111], v[56:59]
  ds_read_b64_tr_b16 v[216:217], v251 offset:28672
  ds_read_b64_tr_b16 v[218:219], v251 offset:28928
  s_waitcnt lgkmcnt(14)
  v_mfma_f32_16x16x32_bf16 v[28:31], v[220:223], v[104:107], v[28:31]
  v_mfma_f32_16x16x32_bf16 v[60:63], v[220:223], v[108:111], v[60:63]
  ds_read_b64_tr_b16 v[220:221], v252 offset:28672
  ds_read_b64_tr_b16 v[222:223], v252 offset:28928
  s_barrier
  s_waitcnt lgkmcnt(14)
  v_mfma_f32_16x16x32_bf16 v[0:3], v[192:195], v[112:115], v[0:3]
  v_mfma_f32_16x16x32_bf16 v[32:35], v[192:195], v[116:119], v[32:35]
  ds_read_b64_tr_b16 v[192:193], v251 offset:18432
  ds_read_b64_tr_b16 v[194:195], v251 offset:18688
  s_waitcnt lgkmcnt(14)
  v_mfma_f32_16x16x32_bf16 v[4:7], v[196:199], v[112:115], v[4:7]
  v_mfma_f32_16x16x32_bf16 v[36:39], v[196:199], v[116:119], v[36:39]
  ds_read_b64_tr_b16 v[196:197], v252 offset:18432
  ds_read_b64_tr_b16 v[198:199], v252 offset:18688
  s_waitcnt lgkmcnt(14)
  v_mfma_f32_16x16x32_bf16 v[8:11], v[200:203], v[112:115], v[8:11]
  v_mfma_f32_16x16x32_bf16 v[40:43], v[200:203], v[116:119], v[40:43]
  ds_read_b64_tr_b16 v[200:201], v251 offset:22528
  ds_read_b64_tr_b16 v[202:203], v251 offset:22784
  s_waitcnt lgkmcnt(14)
  v_mfma_f32_16x16x32_bf16 v[12:15], v[204:207], v[112:115], v[12:15]
  v_mfma_f32_16x16x32_bf16 v[44:47], v[204:207], v[116:119], v[44:47]
  ds_read_b64_tr_b16 v[204:205], v252 offset:22528
  ds_read_b64_tr_b16 v[206:207], v252 offset:22784
  s_waitcnt lgkmcnt(14)
  v_mfma_f32_16x16x32_bf16 v[16:19], v[208:211], v[112:115], v[16:19]
  v_mfma_f32_16x16x32_bf16 v[48:51], v[208:211], v[116:119], v[48:51]
  ds_read_b64_tr_b16 v[208:209], v251 offset:26624
  ds_read_b64_tr_b16 v[210:211], v251 offset:26880
  s_waitcnt lgkmcnt(14)
  v_mfma_f32_16x16x32_bf16 v[20:23], v[212:215], v[112:115], v[20:23]
  v_mfma_f32_16x16x32_bf16 v[52:55], v[212:215], v[116:119], v[52:55]
  ds_read_b64_tr_b16 v[212:213], v252 offset:26624
  ds_read_b64_tr_b16 v[214:215], v252 offset:26880
  s_waitcnt lgkmcnt(14)
  v_mfma_f32_16x16x32_bf16 v[24:27], v[216:219], v[112:115], v[24:27]
  v_mfma_f32_16x16x32_bf16 v[56:59], v[216:219], v[116:119], v[56:59]
  ds_read_b64_tr_b16 v[216:217], v251 offset:30720
  ds_read_b64_tr_b16 v[218:219], v251 offset:30976
  s_waitcnt lgkmcnt(14)
  v_mfma_f32_16x16x32_bf16 v[28:31], v[220:223], v[112:115], v[28:31]
  v_mfma_f32_16x16x32_bf16 v[60:63], v[220:223], v[116:119], v[60:63]
  ds_read_b64_tr_b16 v[220:221], v252 offset:30720
  ds_read_b64_tr_b16 v[222:223], v252 offset:30976
  s_waitcnt lgkmcnt(14)
  v_mfma_f32_16x16x32_bf16 v[0:3], v[192:195], v[120:123], v[0:3]
  v_mfma_f32_16x16x32_bf16 v[32:35], v[192:195], v[124:127], v[32:35]
  s_waitcnt lgkmcnt(12)
  v_mfma_f32_16x16x32_bf16 v[4:7], v[196:199], v[120:123], v[4:7]
  v_mfma_f32_16x16x32_bf16 v[36:39], v[196:199], v[124:127], v[36:39]
  s_waitcnt lgkmcnt(10)
  v_mfma_f32_16x16x32_bf16 v[8:11], v[200:203], v[120:123], v[8:11]
  v_mfma_f32_16x16x32_bf16 v[40:43], v[200:203], v[124:127], v[40:43]
  s_waitcnt lgkmcnt(8)
  v_mfma_f32_16x16x32_bf16 v[12:15], v[204:207], v[120:123], v[12:15]
  v_mfma_f32_16x16x32_bf16 v[44:47], v[204:207], v[124:127], v[44:47]
  s_waitcnt lgkmcnt(6)
  v_mfma_f32_16x16x32_bf16 v[16:19], v[208:211], v[120:123], v[16:19]
  v_mfma_f32_16x16x32_bf16 v[48:51], v[208:211], v[124:127], v[48:51]
  s_waitcnt lgkmcnt(4)
  v_mfma_f32_16x16x32_bf16 v[20:23], v[212:215], v[120:123], v[20:23]
  v_mfma_f32_16x16x32_bf16 v[52:55], v[212:215], v[124:127], v[52:55]
  s_waitcnt lgkmcnt(2)
  v_mfma_f32_16x16x32_bf16 v[24:27], v[216:219], v[120:123], v[24:27]
  v_mfma_f32_16x16x32_bf16 v[56:59], v[216:219], v[124:127], v[56:59]
  s_waitcnt lgkmcnt(0)
  v_mfma_f32_16x16x32_bf16 v[28:31], v[220:223], v[120:123], v[28:31]
  v_mfma_f32_16x16x32_bf16 v[60:63], v[220:223], v[124:127], v[60:63]
  s_barrier
  s_mov_b32 s74, 1
  s_add_u32 m0, s76, 32768
  s_lshl_b32 s6, s74, 14
  s_add_u32 s6, s6, s77
  buffer_load_dwordx4 v231, s[60:63], s6 offen offset:0 lds
  buffer_load_dwordx4 v231, s[60:63], s6 offen offset:1024 lds
  buffer_load_dwordx4 v231, s[60:63], s6 offen offset:2048 lds
  buffer_load_dwordx4 v231, s[60:63], s6 offen offset:3072 lds
  s_add_u32 m0, s76, 49152
  s_lshl_b32 s6, s73, 14
  s_add_u32 s6, s6, s77
  s_add_u32 s6, s6, 16777216
  buffer_load_dwordx4 v231, s[60:63], s6 offen offset:0 lds
  buffer_load_dwordx4 v231, s[60:63], s6 offen offset:1024 lds
  buffer_load_dwordx4 v231, s[60:63], s6 offen offset:2048 lds
  buffer_load_dwordx4 v231, s[60:63], s6 offen offset:3072 lds
  s_mov_b32 s7, 0x3e0293ee
  v_mul_f32 v0, s7, v0
  v_mul_f32 v1, s7, v1
  v_mul_f32 v2, s7, v2
  v_mul_f32 v3, s7, v3
  v_mul_f32 v4, s7, v4
  v_mul_f32 v5, s7, v5
  v_mul_f32 v6, s7, v6
  v_mul_f32 v7, s7, v7
  v_mul_f32 v8, s7, v8
  v_mul_f32 v9, s7, v9
  v_mul_f32 v10, s7, v10
  v_mul_f32 v11, s7, v11
  v_mul_f32 v12, s7, v12
  v_mul_f32 v13, s7, v13
  v_mul_f32 v14, s7, v14
  v_mul_f32 v15, s7, v15
  v_mul_f32 v16, s7, v16
  v_mul_f32 v17, s7, v17
  v_mul_f32 v18, s7, v18
  v_mul_f32 v19, s7, v19
  v_mul_f32 v20, s7, v20
  v_mul_f32 v21, s7, v21
  v_mul_f32 v22, s7, v22
  v_mul_f32 v23, s7, v23
  v_mul_f32 v24, s7, v24
  v_mul_f32 v25, s7, v25
  v_mul_f32 v26, s7, v26
  v_mul_f32 v27, s7, v27
  v_mul_f32 v28, s7, v28
  v_mul_f32 v29, s7, v29
  v_mul_f32 v30, s7, v30
  v_mul_f32 v31, s7, v31
  v_mul_f32 v32, s7, v32
  v_mul_f32 v33, s7, v33
  v_mul_f32 v34, s7, v34
  v_mul_f32 v35, s7, v35
  v_mul_f32 v36, s7, v36
  v_mul_f32 v37, s7, v37
  v_mul_f32 v38, s7, v38
  v_mul_f32 v39, s7, v39
  v_mul_f32 v40, s7, v40
  v_mul_f32 v41, s7, v41
  v_mul_f32 v42, s7, v42
  v_mul_f32 v43, s7, v43
  v_mul_f32 v44, s7, v44
  v_mul_f32 v45, s7, v45
  v_mul_f32 v46, s7, v46
  v_mul_f32 v47, s7, v47
  v_mul_f32 v48, s7, v48
  v_mul_f32 v49, s7, v49
  v_mul_f32 v50, s7, v50
  v_mul_f32 v51, s7, v51
  v_mul_f32 v52, s7, v52
  v_mul_f32 v53, s7, v53
  v_mul_f32 v54, s7, v54
  v_mul_f32 v55, s7, v55
  v_mul_f32 v56, s7, v56
  v_mul_f32 v57, s7, v57
  v_mul_f32 v58, s7, v58
  v_mul_f32 v59, s7, v59
  v_mul_f32 v60, s7, v60
  v_mul_f32 v61, s7, v61
  v_mul_f32 v62, s7, v62
  v_mul_f32 v63, s7, v63
  v_cvt_pk_bf16_f32 v112, v0, v1
  v_cvt_pk_bf16_f32 v113, v2, v3
  v_cvt_pk_bf16_f32 v114, v4, v5
  v_cvt_pk_bf16_f32 v115, v6, v7
  v_cvt_pk_bf16_f32 v116, v8, v9
  v_cvt_pk_bf16_f32 v117, v10, v11
  v_cvt_pk_bf16_f32 v118, v12, v13
  v_cvt_pk_bf16_f32 v119, v14, v15
  v_cvt_pk_bf16_f32 v120, v16, v17
  v_cvt_pk_bf16_f32 v121, v18, v19
  v_cvt_pk_bf16_f32 v122, v20, v21
  v_cvt_pk_bf16_f32 v123, v22, v23
  v_cvt_pk_bf16_f32 v124, v24, v25
  v_cvt_pk_bf16_f32 v125, v26, v27
  v_cvt_pk_bf16_f32 v126, v28, v29
  v_cvt_pk_bf16_f32 v127, v30, v31
  v_cvt_pk_bf16_f32 v128, v32, v33
  v_cvt_pk_bf16_f32 v129, v34, v35
  v_cvt_pk_bf16_f32 v130, v36, v37
  v_cvt_pk_bf16_f32 v131, v38, v39
  v_cvt_pk_bf16_f32 v132, v40, v41
  v_cvt_pk_bf16_f32 v133, v42, v43
  v_cvt_pk_bf16_f32 v134, v44, v45
  v_cvt_pk_bf16_f32 v135, v46, v47
  v_cvt_pk_bf16_f32 v136, v48, v49
  v_cvt_pk_bf16_f32 v137, v50, v51
  v_cvt_pk_bf16_f32 v138, v52, v53
  v_cvt_pk_bf16_f32 v139, v54, v55
  v_cvt_pk_bf16_f32 v140, v56, v57
  v_cvt_pk_bf16_f32 v141, v58, v59
  v_cvt_pk_bf16_f32 v142, v60, v61
  v_cvt_pk_bf16_f32 v143, v62, v63
  v_mov_b32 v0, 0
  v_mov_b32 v1, 0
  v_mov_b32 v2, 0
  v_mov_b32 v3, 0
  v_mov_b32 v4, 0
  v_mov_b32 v5, 0
  v_mov_b32 v6, 0
  v_mov_b32 v7, 0
  v_mov_b32 v8, 0
  v_mov_b32 v9, 0
  v_mov_b32 v10, 0
  v_mov_b32 v11, 0
  v_mov_b32 v12, 0
  v_mov_b32 v13, 0
  v_mov_b32 v14, 0
  v_mov_b32 v15, 0
  v_mov_b32 v16, 0
  v_mov_b32 v17, 0
  v_mov_b32 v18, 0
  v_mov_b32 v19, 0
  v_mov_b32 v20, 0
  v_mov_b32 v21, 0
  v_mov_b32 v22, 0
  v_mov_b32 v23, 0
  v_mov_b32 v24, 0
  v_mov_b32 v25, 0
  v_mov_b32 v26, 0
  v_mov_b32 v27, 0
  v_mov_b32 v28, 0
  v_mov_b32 v29, 0
  v_mov_b32 v30, 0
  v_mov_b32 v31, 0
  v_mov_b32 v32, 0
  v_mov_b32 v33, 0
  v_mov_b32 v34, 0
  v_mov_b32 v35, 0
  v_mov_b32 v36, 0
  v_mov_b32 v37, 0
  v_mov_b32 v38, 0
  v_mov_b32 v39, 0
  v_mov_b32 v40, 0
  v_mov_b32 v41, 0
  v_mov_b32 v42, 0
  v_mov_b32 v43, 0
  v_mov_b32 v44, 0
  v_mov_b32 v45, 0
  v_mov_b32 v46, 0
  v_mov_b32 v47, 0
  v_mov_b32 v48, 0
  v_mov_b32 v49, 0
  v_mov_b32 v50, 0
  v_mov_b32 v51, 0
  v_mov_b32 v52, 0
  v_mov_b32 v53, 0
  v_mov_b32 v54, 0
  v_mov_b32 v55, 0
  v_mov_b32 v56, 0
  v_mov_b32 v57, 0
  v_mov_b32 v58, 0
  v_mov_b32 v59, 0
  v_mov_b32 v60, 0
  v_mov_b32 v61, 0
  v_mov_b32 v62, 0
  v_mov_b32 v63, 0
  v_mov_b32 v144, 0
  v_mov_b32 v145, 0
  v_mov_b32 v146, 0
  v_mov_b32 v147, 0
  v_mov_b32 v148, 0
  v_mov_b32 v149, 0
  v_mov_b32 v150, 0
  v_mov_b32 v151, 0
  v_mov_b32 v152, 0
  v_mov_b32 v153, 0
  v_mov_b32 v154, 0
  v_mov_b32 v155, 0
  v_mov_b32 v156, 0
  v_mov_b32 v157, 0
  v_mov_b32 v158, 0
  v_mov_b32 v159, 0
  v_mov_b32 v226, 0
  v_mov_b32 v227, 0
  v_mov_b32 v208, 0x3f803f80
  v_mov_b32 v209, 0x3f803f80
  v_mov_b32 v210, 0x3f803f80
  v_mov_b32 v211, 0x3f803f80
  s_mov_b32 s12, 0
  s_mov_b32 s15, 1
  s_mov_b32 s72, 0
  s_mov_b32 s92, 0
  s_mov_b32 s78, 0
  s_add_u32 s6, s79, 2
  s_cmp_lt_u32 s13, 2
  s_cselect_b32 s75, s6, 2
  s_lshl_b32 s6, s11, 13
  s_add_u32 s6, s6, 131072
  v_add_u32 v249, s6, v231
  s_cmp_eq_u32 s10, 0
  s_cbranch_scc0 K2_qk0
  ds_write_b128 v249, v[112:115] offset:0
  ds_write_b128 v249, v[116:119] offset:1024
  ds_write_b128 v249, v[120:123] offset:2048
  ds_write_b128 v249, v[124:127] offset:3072
  ds_write_b128 v249, v[128:131] offset:4096
  ds_write_b128 v249, v[132:135] offset:5120
  ds_write_b128 v249, v[136:139] offset:6144
  ds_write_b128 v249, v[140:143] offset:7168
  s_waitcnt lgkmcnt(0)
  s_barrier
K2_qk0:
  ds_read_b128 v[160:163], v224 offset:0
  ds_read_b128 v[164:167], v224 offset:1024
  ds_read_b128 v[168:171], v224 offset:2048
  ds_read_b128 v[172:175], v224 offset:3072
  ds_read_b128 v[176:179], v224 offset:4096
  ds_read_b128 v[180:183], v224 offset:5120
  ds_read_b128 v[184:187], v224 offset:6144
  ds_read_b128 v[188:191], v224 offset:7168
  s_waitcnt lgkmcnt(7)
  v_mfma_f32_16x16x32_bf16 v[64:67], v[160:163], v[112:115], v[144:147]
  v_mfma_f32_16x16x32_bf16 v[80:83], v[160:163], v[128:131], v[148:151]
  ds_read_b128 v[160:163], v224 offset:8192
  s_waitcnt lgkmcnt(7)
  v_mfma_f32_16x16x32_bf16 v[64:67], v[164:167], v[116:119], v[64:67]
  v_mfma_f32_16x16x32_bf16 v[80:83], v[164:167], v[132:135], v[80:83]
  ds_read_b128 v[164:167], v224 offset:9216
  s_waitcnt lgkmcnt(7)
  v_mfma_f32_16x16x32_bf16 v[64:67], v[168:171], v[120:123], v[64:67]
  v_mfma_f32_16x16x32_bf16 v[80:83], v[168:171], v[136:139], v[80:83]
  ds_read_b128 v[168:171], v224 offset:10240
  s_waitcnt lgkmcnt(7)
  v_mfma_f32_16x16x32_bf16 v[64:67], v[172:175], v[124:127], v[64:67]
  v_mfma_f32_16x16x32_bf16 v[80:83], v[172:175], v[140:143], v[80:83]
  ds_read_b128 v[172:175], v224 offset:11264
  s_waitcnt lgkmcnt(7)
  v_mfma_f32_16x16x32_bf16 v[68:71], v[176:179], v[112:115], v[144:147]
  v_mfma_f32_16x16x32_bf16 v[84:87], v[176:179], v[128:131], v[148:151]
  ds_read_b128 v[176:179], v224 offset:12288
  s_waitcnt lgkmcnt(7)
  v_mfma_f32_16x16x32_bf16 v[68:71], v[180:183], v[116:119], v[68:71]
  v_mfma_f32_16x16x32_bf16 v[84:87], v[180:183], v[132:135], v[84:87]
  ds_read_b128 v[180:183], v224 offset:13312
  s_waitcnt lgkmcnt(7)
  v_mfma_f32_16x16x32_bf16 v[68:71], v[184:187], v[120:123], v[68:71]
  v_mfma_f32_16x16x32_bf16 v[84:87], v[184:187], v[136:139], v[84:87]
  ds_read_b128 v[184:187], v224 offset:14336
  s_waitcnt lgkmcnt(7)
  v_mfma_f32_16x16x32_bf16 v[68:71], v[188:191], v[124:127], v[68:71]
  v_mfma_f32_16x16x32_bf16 v[84:87], v[188:191], v[140:143], v[84:87]
  ds_read_b128 v[188:191], v224 offset:15360
  s_waitcnt lgkmcnt(7)
  v_mfma_f32_16x16x32_bf16 v[72:75], v[160:163], v[112:115], v[144:147]
  v_mfma_f32_16x16x32_bf16 v[88:91], v[160:163], v[128:131], v[148:151]
  s_waitcnt lgkmcnt(6)
  v_mfma_f32_16x16x32_bf16 v[72:75], v[164:167], v[116:119], v[72:75]
  v_mfma_f32_16x16x32_bf16 v[88:91], v[164:167], v[132:135], v[88:91]
  s_waitcnt lgkmcnt(5)
  v_mfma_f32_16x16x32_bf16 v[72:75], v[168:171], v[120:123], v[72:75]
  v_mfma_f32_16x16x32_bf16 v[88:91], v[168:171], v[136:139], v[88:91]
  s_waitcnt lgkmcnt(4)
  v_mfma_f32_16x16x32_bf16 v[72:75], v[172:175], v[124:127], v[72:75]
  v_mfma_f32_16x16x32_bf16 v[88:91], v[172:175], v[140:143], v[88:91]
  s_waitcnt lgkmcnt(3)
  v_mfma_f32_16x16x32_bf16 v[76:79], v[176:179], v[112:115], v[144:147]
  v_mfma_f32_16x16x32_bf16 v[92:95], v[176:179], v[128:131], v[148:151]
  s_waitcnt lgkmcnt(2)
  v_mfma_f32_16x16x32_bf16 v[76:79], v[180:183], v[116:119], v[76:79]
  v_mfma_f32_16x16x32_bf16 v[92:95], v[180:183], v[132:135], v[92:95]
  s_waitcnt lgkmcnt(1)
  v_mfma_f32_16x16x32_bf16 v[76:79], v[184:187], v[120:123], v[76:79]
  v_mfma_f32_16x16x32_bf16 v[92:95], v[184:187], v[136:139], v[92:95]
  s_waitcnt lgkmcnt(0)
  v_mfma_f32_16x16x32_bf16 v[76:79], v[188:191], v[124:127], v[76:79]
  v_mfma_f32_16x16x32_bf16 v[92:95], v[188:191], v[140:143], v[92:95]
  v_xor_b32 v224, 0x8000, v224
  s_lshl_b32 s8, s75, 14
  s_add_u32 s8, s8, s77
  s_lshl_b32 s9, s74, 14
  s_add_u32 s9, s9, s77
  s_add_u32 s9, s9, 16777216
  s_add_u32 s89, s76, s92
  s_lshl_b32 s88, s73, 6
  s_add_u32 s90, s88, 63
  s_cmp_gt_u32 s90, s14
  s_cselect_b32 s90, 1, s15
  s_cmp_eq_u32 s12, s13
  s_cselect_b32 s99, 1, 0
  s_cmp_eq_u32 s12, 15
  s_cselect_b32 s99, 1, s99
K2_loop:
  s_waitcnt vmcnt(0)
  s_barrier
  ds_read_b128 v[160:163], v224 offset:0
  ds_read_b128 v[164:167], v224 offset:1024
  ds_read_b128 v[168:171], v224 offset:2048
  ds_read_b128 v[172:175], v224 offset:3072
  ds_read_b128 v[176:179], v224 offset:4096
  ds_read_b128 v[180:183], v224 offset:5120
  ds_read_b128 v[184:187], v224 offset:6144
  ds_read_b128 v[188:191], v224 offset:7168
  s_cmp_lg_u32 s90, 0
  s_cbranch_scc1 K2_specA
K2_expA:
  s_add_u32 m0, s89, 0
  v_exp_f32 v234, v64
  buffer_load_dwordx4 v231, s[60:63], s8 offen offset:0 lds
  v_exp_f32 v235, v65
  v_exp_f32 v236, v66
  v_exp_f32 v237, v67
  v_exp_f32 v238, v68
  buffer_load_dwordx4 v231, s[60:63], s8 offen offset:1024 lds
  v_exp_f32 v239, v69
  v_cvt_pk_bf16_f32 v96, v234, v235
  v_exp_f32 v240, v70
  v_exp_f32 v241, v71
  v_cvt_pk_bf16_f32 v97, v236, v237
  v_exp_f32 v234, v72
  buffer_load_dwordx4 v231, s[60:63], s8 offen offset:2048 lds
  v_exp_f32 v235, v73
  v_cvt_pk_bf16_f32 v98, v238, v239
  v_or3_b32 v228, v96, v97, v98
  v_exp_f32 v236, v74
  v_exp_f32 v237, v75
  v_cvt_pk_bf16_f32 v99, v240, v241
  v_exp_f32 v238, v76
  buffer_load_dwordx4 v231, s[60:63], s8 offen offset:3072 lds
  v_exp_f32 v239, v77
  v_cvt_pk_bf16_f32 v100, v234, v235
  v_or3_b32 v228, v228, v99, v100
  v_exp_f32 v240, v78
  v_exp_f32 v241, v79
  v_cvt_pk_bf16_f32 v101, v236, v237
  s_add_u32 m0, s89, 16384
  v_exp_f32 v234, v80
  buffer_load_dwordx4 v231, s[60:63], s9 offen offset:0 lds
  v_exp_f32 v235, v81
  v_cvt_pk_bf16_f32 v102, v238, v239
  v_or3_b32 v228, v228, v101, v102
  v_exp_f32 v236, v82
  v_exp_f32 v237, v83
  v_cvt_pk_bf16_f32 v103, v240, v241
  v_exp_f32 v238, v84
  buffer_load_dwordx4 v231, s[60:63], s9 offen offset:1024 lds
  v_exp_f32 v239, v85
  v_cvt_pk_bf16_f32 v104, v234, v235
  v_or3_b32 v228, v228, v103, v104
  v_exp_f32 v240, v86
  v_exp_f32 v241, v87
  v_cvt_pk_bf16_f32 v105, v236, v237
  v_exp_f32 v234, v88
  buffer_load_dwordx4 v231, s[60:63], s9 offen offset:2048 lds
  v_exp_f32 v235, v89
  v_cvt_pk_bf16_f32 v106, v238, v239
  v_or3_b32 v228, v228, v105, v106
  v_exp_f32 v236, v90
  v_exp_f32 v237, v91
  v_cvt_pk_bf16_f32 v107, v240, v241
  v_exp_f32 v238, v92
  buffer_load_dwordx4 v231, s[60:63], s9 offen offset:3072 lds
  v_exp_f32 v239, v93
  v_cvt_pk_bf16_f32 v108, v234, v235
  v_or3_b32 v228, v228, v107, v108
  v_exp_f32 v240, v94
  v_exp_f32 v241, v95
  v_cvt_pk_bf16_f32 v109, v236, v237
  v_cvt_pk_bf16_f32 v110, v238, v239
  v_or3_b32 v228, v228, v109, v110
  v_cvt_pk_bf16_f32 v111, v240, v241
  v_or_b32 v228, v228, v111
  v_and_b32 v228, 0x40004000, v228
  v_cmp_ne_u32 vcc, 0, v228
  s_cbranch_vccnz K2_chkA
K2_okA:
  s_cmp_lg_u32 s99, 0
  s_cbranch_scc1 K2_postA
K2_postretA:
  s_barrier
  s_waitcnt lgkmcnt(7)
  v_mfma_f32_16x16x32_bf16 v[64:67], v[160:163], v[112:115], v[144:147]
  v_mfma_f32_16x16x32_bf16 v[192:195], v[160:163], v[128:131], v[148:151]
  ds_read_b128 v[160:163], v224 offset:8192
  s_waitcnt lgkmcnt(7)
  v_mfma_f32_16x16x32_bf16 v[64:67], v[164:167], v[116:119], v[64:67]
  v_mfma_f32_16x16x32_bf16 v[192:195], v[164:167], v[132:135], v[192:195]
  ds_read_b128 v[164:167], v224 offset:9216
  s_waitcnt lgkmcnt(7)
  v_mfma_f32_16x16x32_bf16 v[64:67], v[168:171], v[120:123], v[64:67]
  v_mfma_f32_16x16x32_bf16 v[192:195], v[168:171], v[136:139], v[192:195]
  ds_read_b128 v[168:171], v224 offset:10240
  s_waitcnt lgkmcnt(7)
  v_mfma_f32_16x16x32_bf16 v[64:67], v[172:175], v[124:127], v[64:67]
  v_mfma_f32_16x16x32_bf16 v[192:195], v[172:175], v[140:143], v[192:195]
  ds_read_b128 v[172:175], v224 offset:11264
  s_waitcnt lgkmcnt(7)
  v_mfma_f32_16x16x32_bf16 v[68:71], v[176:179], v[112:115], v[144:147]
  v_mfma_f32_16x16x32_bf16 v[196:199], v[176:179], v[128:131], v[148:151]
  ds_read_b128 v[176:179], v224 offset:12288
  s_waitcnt lgkmcnt(7)
  v_mfma_f32_16x16x32_bf16 v[68:71], v[180:183], v[116:119], v[68:71]
  v_mfma_f32_16x16x32_bf16 v[196:199], v[180:183], v[132:135], v[196:199]
  ds_read_b128 v[180:183], v224 offset:13312
  s_waitcnt lgkmcnt(7)
  v_mfma_f32_16x16x32_bf16 v[68:71], v[184:187], v[120:123], v[68:71]
  v_mfma_f32_16x16x32_bf16 v[196:199], v[184:187], v[136:139], v[196:199]
  ds_read_b128 v[184:187], v224 offset:14336
  s_waitcnt lgkmcnt(7)
  v_mfma_f32_16x16x32_bf16 v[68:71], v[188:191], v[124:127], v[68:71]
  v_mfma_f32_16x16x32_bf16 v[196:199], v[188:191], v[140:143], v[196:199]
  ds_read_b128 v[188:191], v224 offset:15360
  s_waitcnt lgkmcnt(7)
  v_mfma_f32_16x16x32_bf16 v[72:75], v[160:163], v[112:115], v[144:147]
  v_mfma_f32_16x16x32_bf16 v[200:203], v[160:163], v[128:131], v[148:151]
  ds_read_b128 v[160:163], v224 offset:16384
  s_waitcnt lgkmcnt(7)
  v_mfma_f32_16x16x32_bf16 v[72:75], v[164:167], v[116:119], v[72:75]
  v_mfma_f32_16x16x32_bf16 v[200:203], v[164:167], v[132:135], v[200:203]
  ds_read_b128 v[164:167], v224 offset:17408
  s_waitcnt lgkmcnt(7)
  v_mfma_f32_16x16x32_bf16 v[72:75], v[168:171], v[120:123], v[72:75]
  v_mfma_f32_16x16x32_bf16 v[200:203], v[168:171], v[136:139], v[200:203]
  ds_read_b128 v[168:171], v224 offset:18432
  s_waitcnt lgkmcnt(7)
  v_mfma_f32_16x16x32_bf16 v[72:75], v[172:175], v[124:127], v[72:75]
  v_mfma_f32_16x16x32_bf16 v[200:203], v[172:175], v[140:143], v[200:203]
  ds_read_b128 v[172:175], v224 offset:19456
  s_waitcnt lgkmcnt(7)
  v_mfma_f32_16x16x32_bf16 v[76:79], v[176:179], v[112:115], v[144:147]
  v_mfma_f32_16x16x32_bf16 v[204:207], v[176:179], v[128:131], v[148:151]
  ds_read_b128 v[176:179], v224 offset:20480
  s_waitcnt lgkmcnt(7)
  v_mfma_f32_16x16x32_bf16 v[76:79], v[180:183], v[116:119], v[76:79]
  v_mfma_f32_16x16x32_bf16 v[204:207], v[180:183], v[132:135], v[204:207]
  ds_read_b128 v[180:183], v224 offset:21504
  s_waitcnt lgkmcnt(7)
  v_mfma_f32_16x16x32_bf16 v[76:79], v[184:187], v[120:123], v[76:79]
  v_mfma_f32_16x16x32_bf16 v[204:207], v[184:187], v[136:139], v[204:207]
  ds_read_b128 v[184:187], v224 offset:22528
  s_waitcnt lgkmcnt(7)
  v_mfma_f32_16x16x32_bf16 v[76:79], v[188:191], v[124:127], v[76:79]
  v_mfma_f32_16x16x32_bf16 v[204:207], v[188:191], v[140:143], v[204:207]
  ds_read_b128 v[188:191], v224 offset:23552
  s_mov_b32 s73, s74
  s_mov_b32 s74, s75
  s_add_u32 s6, s12, 3
  s_add_u32 s7, s6, s79
  s_cmp_gt_u32 s6, s13
  s_cselect_b32 s75, s7, s6
  s_min_u32 s75, s75, 31
  s_xor_b32 s92, s92, 0x8000
  s_add_u32 s12, s12, 1
  s_lshl_b32 s8, s75, 14
  s_add_u32 s8, s8, s77
  s_lshl_b32 s9, s74, 14
  s_add_u32 s9, s9, s77
  s_add_u32 s9, s9, 16777216
  s_add_u32 s89, s76, s92
  s_lshl_b32 s88, s73, 6
  s_add_u32 s90, s88, 63
  s_cmp_gt_u32 s90, s14
  s_cselect_b32 s90, 1, s15
  s_cmp_eq_u32 s12, s13
  s_cselect_b32 s99, 1, 0
  s_cmp_eq_u32 s12, 15
  s_cselect_b32 s99, 1, s99
  s_waitcnt lgkmcnt(7)
  v_mfma_f32_16x16x32_bf16 v[0:3], v[160:163], v[96:99], v[0:3]
  v_mfma_f32_16x16x32_bf16 v[32:35], v[160:163], v[104:107], v[32:35]
  ds_read_b128 v[160:163], v224 offset:24576
  s_waitcnt lgkmcnt(7)
  v_mfma_f32_16x16x32_bf16 v[4:7], v[164:167], v[96:99], v[4:7]
  v_mfma_f32_16x16x32_bf16 v[36:39], v[164:167], v[104:107], v[36:39]
  ds_read_b128 v[164:167], v224 offset:25600
  s_waitcnt lgkmcnt(7)
  v_mfma_f32_16x16x32_bf16 v[8:11], v[168:171], v[96:99], v[8:11]
  v_mfma_f32_16x16x32_bf16 v[40:43], v[168:171], v[104:107], v[40:43]
  ds_read_b128 v[168:171], v224 offset:26624
  s_waitcnt lgkmcnt(7)
  v_mfma_f32_16x16x32_bf16 v[12:15], v[172:175], v[96:99], v[12:15]
  v_mfma_f32_16x16x32_bf16 v[44:47], v[172:175], v[104:107], v[44:47]
  ds_read_b128 v[172:175], v224 offset:27648
  v_mfma_f32_16x16x32_bf16 v[152:155], v[208:211], v[96:99], v[152:155]
  v_mfma_f32_16x16x32_bf16 v[156:159], v[208:211], v[104:107], v[156:159]
  s_waitcnt lgkmcnt(7)
  v_mfma_f32_16x16x32_bf16 v[16:19], v[176:179], v[96:99], v[16:19]
  v_mfma_f32_16x16x32_bf16 v[48:51], v[176:179], v[104:107], v[48:51]
  ds_read_b128 v[176:179], v224 offset:28672
  s_waitcnt lgkmcnt(7)
  v_mfma_f32_16x16x32_bf16 v[20:23], v[180:183], v[96:99], v[20:23]
  v_mfma_f32_16x16x32_bf16 v[52:55], v[180:183], v[104:107], v[52:55]
  ds_read_b128 v[180:183], v224 offset:29696
  s_waitcnt lgkmcnt(7)
  v_mfma_f32_16x16x32_bf16 v[24:27], v[184:187], v[96:99], v[24:27]
  v_mfma_f32_16x16x32_bf16 v[56:59], v[184:187], v[104:107], v[56:59]
  ds_read_b128 v[184:187], v224 offset:30720
  s_waitcnt lgkmcnt(7)
  v_mfma_f32_16x16x32_bf16 v[28:31], v[188:191], v[96:99], v[28:31]
  v_mfma_f32_16x16x32_bf16 v[60:63], v[188:191], v[104:107], v[60:63]
  ds_read_b128 v[188:191], v224 offset:31744
  s_waitcnt lgkmcnt(7)
  v_mfma_f32_16x16x32_bf16 v[0:3], v[160:163], v[100:103], v[0:3]
  v_mfma_f32_16x16x32_bf16 v[32:35], v[160:163], v[108:111], v[32:35]
  s_waitcnt lgkmcnt(6)
  v_mfma_f32_16x16x32_bf16 v[4:7], v[164:167], v[100:103], v[4:7]
  v_mfma_f32_16x16x32_bf16 v[36:39], v[164:167], v[108:111], v[36:39]
  s_waitcnt lgkmcnt(5)
  v_mfma_f32_16x16x32_bf16 v[8:11], v[168:171], v[100:103], v[8:11]
  v_mfma_f32_16x16x32_bf16 v[40:43], v[168:171], v[108:111], v[40:43]
  s_waitcnt lgkmcnt(4)
  v_mfma_f32_16x16x32_bf16 v[12:15], v[172:175], v[100:103], v[12:15]
  v_mfma_f32_16x16x32_bf16 v[44:47], v[172:175], v[108:111], v[44:47]
  v_mfma_f32_16x16x32_bf16 v[152:155], v[208:211], v[100:103], v[152:155]
  v_mfma_f32_16x16x32_bf16 v[156:159], v[208:211], v[108:111], v[156:159]
  s_waitcnt lgkmcnt(3)
  v_mfma_f32_16x16x32_bf16 v[16:19], v[176:179], v[100:103], v[16:19]
  v_mfma_f32_16x16x32_bf16 v[48:51], v[176:179], v[108:111], v[48:51]
  s_waitcnt lgkmcnt(2)
  v_mfma_f32_16x16x32_bf16 v[20:23], v[180:183], v[100:103], v[20:23]
  v_mfma_f32_16x16x32_bf16 v[52:55], v[180:183], v[108:111], v[52:55]
  s_waitcnt lgkmcnt(1)
  v_mfma_f32_16x16x32_bf16 v[24:27], v[184:187], v[100:103], v[24:27]
  v_mfma_f32_16x16x32_bf16 v[56:59], v[184:187], v[108:111], v[56:59]
  s_waitcnt lgkmcnt(0)
  v_mfma_f32_16x16x32_bf16 v[28:31], v[188:191], v[100:103], v[28:31]
  v_mfma_f32_16x16x32_bf16 v[60:63], v[188:191], v[108:111], v[60:63]
  v_xor_b32 v224, 0x8000, v224
  s_waitcnt vmcnt(0)
  s_barrier
  ds_read_b128 v[160:163], v224 offset:0
  ds_read_b128 v[164:167], v224 offset:1024
  ds_read_b128 v[168:171], v224 offset:2048
  ds_read_b128 v[172:175], v224 offset:3072
  ds_read_b128 v[176:179], v224 offset:4096
  ds_read_b128 v[180:183], v224 offset:5120
  ds_read_b128 v[184:187], v224 offset:6144
  ds_read_b128 v[188:191], v224 offset:7168
  s_cmp_lg_u32 s90, 0
  s_cbranch_scc1 K2_specB
K2_expB:
  s_add_u32 m0, s89, 0
  v_exp_f32 v234, v64
  buffer_load_dwordx4 v231, s[60:63], s8 offen offset:0 lds
  v_exp_f32 v235, v65
  v_exp_f32 v236, v66
  v_exp_f32 v237, v67
  v_exp_f32 v238, v68
  buffer_load_dwordx4 v231, s[60:63], s8 offen offset:1024 lds
  v_exp_f32 v239, v69
  v_cvt_pk_bf16_f32 v96, v234, v235
  v_exp_f32 v240, v70
  v_exp_f32 v241, v71
  v_cvt_pk_bf16_f32 v97, v236, v237
  v_exp_f32 v234, v72
  buffer_load_dwordx4 v231, s[60:63], s8 offen offset:2048 lds
  v_exp_f32 v235, v73
  v_cvt_pk_bf16_f32 v98, v238, v239
  v_or3_b32 v228, v96, v97, v98
  v_exp_f32 v236, v74
  v_exp_f32 v237, v75
  v_cvt_pk_bf16_f32 v99, v240, v241
  v_exp_f32 v238, v76
  buffer_load_dwordx4 v231, s[60:63], s8 offen offset:3072 lds
  v_exp_f32 v239, v77
  v_cvt_pk_bf16_f32 v100, v234, v235
  v_or3_b32 v228, v228, v99, v100
  v_exp_f32 v240, v78
  v_exp_f32 v241, v79
  v_cvt_pk_bf16_f32 v101, v236, v237
  s_add_u32 m0, s89, 16384
  v_exp_f32 v234, v192
  buffer_load_dwordx4 v231, s[60:63], s9 offen offset:0 lds
  v_exp_f32 v235, v193
  v_cvt_pk_bf16_f32 v102, v238, v239
  v_or3_b32 v228, v228, v101, v102
  v_exp_f32 v236, v194
  v_exp_f32 v237, v195
  v_cvt_pk_bf16_f32 v103, v240, v241
  v_exp_f32 v238, v196
  buffer_load_dwordx4 v231, s[60:63], s9 offen offset:1024 lds
  v_exp_f32 v239, v197
  v_cvt_pk_bf16_f32 v104, v234, v235
  v_or3_b32 v228, v228, v103, v104
  v_exp_f32 v240, v198
  v_exp_f32 v241, v199
  v_cvt_pk_bf16_f32 v105, v236, v237
  v_exp_f32 v234, v200
  buffer_load_dwordx4 v231, s[60:63], s9 offen offset:2048 lds
  v_exp_f32 v235, v201
  v_cvt_pk_bf16_f32 v106, v238, v239
  v_or3_b32 v228, v228, v105, v106
  v_exp_f32 v236, v202
  v_exp_f32 v237, v203
  v_cvt_pk_bf16_f32 v107, v240, v241
  v_exp_f32 v238, v204
  buffer_load_dwordx4 v231, s[60:63], s9 offen offset:3072 lds
  v_exp_f32 v239, v205
  v_cvt_pk_bf16_f32 v108, v234, v235
  v_or3_b32 v228, v228, v107, v108
  v_exp_f32 v240, v206
  v_exp_f32 v241, v207
  v_cvt_pk_bf16_f32 v109, v236, v237
  v_cvt_pk_bf16_f32 v110, v238, v239
  v_or3_b32 v228, v228, v109, v110
  v_cvt_pk_bf16_f32 v111, v240, v241
  v_or_b32 v228, v228, v111
  v_and_b32 v228, 0x40004000, v228
  v_cmp_ne_u32 vcc, 0, v228
  s_cbranch_vccnz K2_chkB
K2_okB:
  s_cmp_lg_u32 s99, 0
  s_cbranch_scc1 K2_postB
K2_postretB:
  s_barrier
  s_waitcnt lgkmcnt(7)
  v_mfma_f32_16x16x32_bf16 v[64:67], v[160:163], v[112:115], v[144:147]
  v_mfma_f32_16x16x32_bf16 v[80:83], v[160:163], v[128:131], v[148:151]
  ds_read_b128 v[160:163], v224 offset:8192
  s_waitcnt lgkmcnt(7)
  v_mfma_f32_16x16x32_bf16 v[64:67], v[164:167], v[116:119], v[64:67]
  v_mfma_f32_16x16x32_bf16 v[80:83], v[164:167], v[132:135], v[80:83]
  ds_read_b128 v[164:167], v224 offset:9216
  s_waitcnt lgkmcnt(7)
  v_mfma_f32_16x16x32_bf16 v[64:67], v[168:171], v[120:123], v[64:67]
  v_mfma_f32_16x16x32_bf16 v[80:83], v[168:171], v[136:139], v[80:83]
  ds_read_b128 v[168:171], v224 offset:10240
  s_waitcnt lgkmcnt(7)
  v_mfma_f32_16x16x32_bf16 v[64:67], v[172:175], v[124:127], v[64:67]
  v_mfma_f32_16x16x32_bf16 v[80:83], v[172:175], v[140:143], v[80:83]
  ds_read_b128 v[172:175], v224 offset:11264
  s_waitcnt lgkmcnt(7)
  v_mfma_f32_16x16x32_bf16 v[68:71], v[176:179], v[112:115], v[144:147]
  v_mfma_f32_16x16x32_bf16 v[84:87], v[176:179], v[128:131], v[148:151]
  ds_read_b128 v[176:179], v224 offset:12288
  s_waitcnt lgkmcnt(7)
  v_mfma_f32_16x16x32_bf16 v[68:71], v[180:183], v[116:119], v[68:71]
  v_mfma_f32_16x16x32_bf16 v[84:87], v[180:183], v[132:135], v[84:87]
  ds_read_b128 v[180:183], v224 offset:13312
  s_waitcnt lgkmcnt(7)
  v_mfma_f32_16x16x32_bf16 v[68:71], v[184:187], v[120:123], v[68:71]
  v_mfma_f32_16x16x32_bf16 v[84:87], v[184:187], v[136:139], v[84:87]
  ds_read_b128 v[184:187], v224 offset:14336
  s_waitcnt lgkmcnt(7)
  v_mfma_f32_16x16x32_bf16 v[68:71], v[188:191], v[124:127], v[68:71]
  v_mfma_f32_16x16x32_bf16 v[84:87], v[188:191], v[140:143], v[84:87]
  ds_read_b128 v[188:191], v224 offset:15360
  s_waitcnt lgkmcnt(7)
  v_mfma_f32_16x16x32_bf16 v[72:75], v[160:163], v[112:115], v[144:147]
  v_mfma_f32_16x16x32_bf16 v[88:91], v[160:163], v[128:131], v[148:151]
  ds_read_b128 v[160:163], v224 offset:16384
  s_waitcnt lgkmcnt(7)
  v_mfma_f32_16x16x32_bf16 v[72:75], v[164:167], v[116:119], v[72:75]
  v_mfma_f32_16x16x32_bf16 v[88:91], v[164:167], v[132:135], v[88:91]
  ds_read_b128 v[164:167], v224 offset:17408
  s_waitcnt lgkmcnt(7)
  v_mfma_f32_16x16x32_bf16 v[72:75], v[168:171], v[120:123], v[72:75]
  v_mfma_f32_16x16x32_bf16 v[88:91], v[168:171], v[136:139], v[88:91]
  ds_read_b128 v[168:171], v224 offset:18432
  s_waitcnt lgkmcnt(7)
  v_mfma_f32_16x16x32_bf16 v[72:75], v[172:175], v[124:127], v[72:75]
  v_mfma_f32_16x16x32_bf16 v[88:91], v[172:175], v[140:143], v[88:91]
  ds_read_b128 v[172:175], v224 offset:19456
  s_waitcnt lgkmcnt(7)
  v_mfma_f32_16x16x32_bf16 v[76:79], v[176:179], v[112:115], v[144:147]
  v_mfma_f32_16x16x32_bf16 v[92:95], v[176:179], v[128:131], v[148:151]
  ds_read_b128 v[176:179], v224 offset:20480
  s_waitcnt lgkmcnt(7)
  v_mfma_f32_16x16x32_bf16 v[76:79], v[180:183], v[116:119], v[76:79]
  v_mfma_f32_16x16x32_bf16 v[92:95], v[180:183], v[132:135], v[92:95]
  ds_read_b128 v[180:183], v224 offset:21504
  s_waitcnt lgkmcnt(7)
  v_mfma_f32_16x16x32_bf16 v[76:79], v[184:187], v[120:123], v[76:79]
  v_mfma_f32_16x16x32_bf16 v[92:95], v[184:187], v[136:139], v[92:95]
  ds_read_b128 v[184:187], v224 offset:22528
  s_waitcnt lgkmcnt(7)
  v_mfma_f32_16x16x32_bf16 v[76:79], v[188:191], v[124:127], v[76:79]
  v_mfma_f32_16x16x32_bf16 v[92:95], v[188:191], v[140:143], v[92:95]
  ds_read_b128 v[188:191], v224 offset:23552
  s_mov_b32 s73, s74
  s_mov_b32 s74, s75
  s_add_u32 s6, s12, 3
  s_add_u32 s7, s6, s79
  s_cmp_gt_u32 s6, s13
  s_cselect_b32 s75, s7, s6
  s_min_u32 s75, s75, 31
  s_xor_b32 s92, s92, 0x8000
  s_add_u32 s12, s12, 1
  s_lshl_b32 s8, s75, 14
  s_add_u32 s8, s8, s77
  s_lshl_b32 s9, s74, 14
  s_add_u32 s9, s9, s77
  s_add_u32 s9, s9, 16777216
  s_add_u32 s89, s76, s92
  s_lshl_b32 s88, s73, 6
  s_add_u32 s90, s88, 63
  s_cmp_gt_u32 s90, s14
  s_cselect_b32 s90, 1, s15
  s_cmp_eq_u32 s12, s13
  s_cselect_b32 s99, 1, 0
  s_cmp_eq_u32 s12, 15
  s_cselect_b32 s99, 1, s99
  s_waitcnt lgkmcnt(7)
  v_mfma_f32_16x16x32_bf16 v[0:3], v[160:163], v[96:99], v[0:3]
  v_mfma_f32_16x16x32_bf16 v[32:35], v[160:163], v[104:107], v[32:35]
  ds_read_b128 v[160:163], v224 offset:24576
  s_waitcnt lgkmcnt(7)
  v_mfma_f32_16x16x32_bf16 v[4:7], v[164:167], v[96:99], v[4:7]
  v_mfma_f32_16x16x32_bf16 v[36:39], v[164:167], v[104:107], v[36:39]
  ds_read_b128 v[164:167], v224 offset:25600
  s_waitcnt lgkmcnt(7)
  v_mfma_f32_16x16x32_bf16 v[8:11], v[168:171], v[96:99], v[8:11]
  v_mfma_f32_16x16x32_bf16 v[40:43], v[168:171], v[104:107], v[40:43]
  ds_read_b128 v[168:171], v224 offset:26624
  s_waitcnt lgkmcnt(7)
  v_mfma_f32_16x16x32_bf16 v[12:15], v[172:175], v[96:99], v[12:15]
  v_mfma_f32_16x16x32_bf16 v[44:47], v[172:175], v[104:107], v[44:47]
  ds_read_b128 v[172:175], v224 offset:27648
  v_mfma_f32_16x16x32_bf16 v[152:155], v[208:211], v[96:99], v[152:155]
  v_mfma_f32_16x16x32_bf16 v[156:159], v[208:211], v[104:107], v[156:159]
  s_waitcnt lgkmcnt(7)
  v_mfma_f32_16x16x32_bf16 v[16:19], v[176:179], v[96:99], v[16:19]
  v_mfma_f32_16x16x32_bf16 v[48:51], v[176:179], v[104:107], v[48:51]
  ds_read_b128 v[176:179], v224 offset:28672
  s_waitcnt lgkmcnt(7)
  v_mfma_f32_16x16x32_bf16 v[20:23], v[180:183], v[96:99], v[20:23]
  v_mfma_f32_16x16x32_bf16 v[52:55], v[180:183], v[104:107], v[52:55]
  ds_read_b128 v[180:183], v224 offset:29696
  s_waitcnt lgkmcnt(7)
  v_mfma_f32_16x16x32_bf16 v[24:27], v[184:187], v[96:99], v[24:27]
  v_mfma_f32_16x16x32_bf16 v[56:59], v[184:187], v[104:107], v[56:59]
  ds_read_b128 v[184:187], v224 offset:30720
  s_waitcnt lgkmcnt(7)
  v_mfma_f32_16x16x32_bf16 v[28:31], v[188:191], v[96:99], v[28:31]
  v_mfma_f32_16x16x32_bf16 v[60:63], v[188:191], v[104:107], v[60:63]
  ds_read_b128 v[188:191], v224 offset:31744
  s_waitcnt lgkmcnt(7)
  v_mfma_f32_16x16x32_bf16 v[0:3], v[160:163], v[100:103], v[0:3]
  v_mfma_f32_16x16x32_bf16 v[32:35], v[160:163], v[108:111], v[32:35]
  s_waitcnt lgkmcnt(6)
  v_mfma_f32_16x16x32_bf16 v[4:7], v[164:167], v[100:103], v[4:7]
  v_mfma_f32_16x16x32_bf16 v[36:39], v[164:167], v[108:111], v[36:39]
  s_waitcnt lgkmcnt(5)
  v_mfma_f32_16x16x32_bf16 v[8:11], v[168:171], v[100:103], v[8:11]
  v_mfma_f32_16x16x32_bf16 v[40:43], v[168:171], v[108:111], v[40:43]
  s_waitcnt lgkmcnt(4)
  v_mfma_f32_16x16x32_bf16 v[12:15], v[172:175], v[100:103], v[12:15]
  v_mfma_f32_16x16x32_bf16 v[44:47], v[172:175], v[108:111], v[44:47]
  v_mfma_f32_16x16x32_bf16 v[152:155], v[208:211], v[100:103], v[152:155]
  v_mfma_f32_16x16x32_bf16 v[156:159], v[208:211], v[108:111], v[156:159]
  s_waitcnt lgkmcnt(3)
  v_mfma_f32_16x16x32_bf16 v[16:19], v[176:179], v[100:103], v[16:19]
  v_mfma_f32_16x16x32_bf16 v[48:51], v[176:179], v[108:111], v[48:51]
  s_waitcnt lgkmcnt(2)
  v_mfma_f32_16x16x32_bf16 v[20:23], v[180:183], v[100:103], v[20:23]
  v_mfma_f32_16x16x32_bf16 v[52:55], v[180:183], v[108:111], v[52:55]
  s_waitcnt lgkmcnt(1)
  v_mfma_f32_16x16x32_bf16 v[24:27], v[184:187], v[100:103], v[24:27]
  v_mfma_f32_16x16x32_bf16 v[56:59], v[184:187], v[108:111], v[56:59]
  s_waitcnt lgkmcnt(0)
  v_mfma_f32_16x16x32_bf16 v[28:31], v[188:191], v[100:103], v[28:31]
  v_mfma_f32_16x16x32_bf16 v[60:63], v[188:191], v[108:111], v[60:63]
  v_xor_b32 v224, 0x8000, v224
  s_cmp_lt_u32 s12, 16
  s_cbranch_scc1 K2_loop
  s_waitcnt vmcnt(3)
  s_barrier
  ds_read_b128 v[160:163], v224 offset:16384
  ds_read_b128 v[164:167], v224 offset:17408
  ds_read_b128 v[168:171], v224 offset:18432
  ds_read_b128 v[172:175], v224 offset:19456
  ds_read_b128 v[176:179], v224 offset:20480
  ds_read_b128 v[180:183], v224 offset:21504
  ds_read_b128 v[184:187], v224 offset:22528
  ds_read_b128 v[188:191], v224 offset:23552
  s_cmp_lg_u32 s90, 0
  s_cbranch_scc1 K2_specZ
K2_expZ:
  v_exp_f32 v234, v64
  v_exp_f32 v235, v65
  v_exp_f32 v236, v66
  v_exp_f32 v237, v67
  v_exp_f32 v238, v68
  v_exp_f32 v239, v69
  v_cvt_pk_bf16_f32 v96, v234, v235
  v_exp_f32 v240, v70
  v_exp_f32 v241, v71
  v_cvt_pk_bf16_f32 v97, v236, v237
  v_exp_f32 v234, v72
  v_exp_f32 v235, v73
  v_cvt_pk_bf16_f32 v98, v238, v239
  v_or3_b32 v228, v96, v97, v98
  v_exp_f32 v236, v74
  v_exp_f32 v237, v75
  v_cvt_pk_bf16_f32 v99, v240, v241
  v_exp_f32 v238, v76
  v_exp_f32 v239, v77
  v_cvt_pk_bf16_f32 v100, v234, v235
  v_or3_b32 v228, v228, v99, v100
  v_exp_f32 v240, v78
  v_exp_f32 v241, v79
  v_cvt_pk_bf16_f32 v101, v236, v237
  v_exp_f32 v234, v80
  v_exp_f32 v235, v81
  v_cvt_pk_bf16_f32 v102, v238, v239
  v_or3_b32 v228, v228, v101, v102
  v_exp_f32 v236, v82
  v_exp_f32 v237, v83
  v_cvt_pk_bf16_f32 v103, v240, v241
  v_exp_f32 v238, v84
  v_exp_f32 v239, v85
  v_cvt_pk_bf16_f32 v104, v234, v235
  v_or3_b32 v228, v228, v103, v104
  v_exp_f32 v240, v86
  v_exp_f32 v241, v87
  v_cvt_pk_bf16_f32 v105, v236, v237
  v_exp_f32 v234, v88
  v_exp_f32 v235, v89
  v_cvt_pk_bf16_f32 v106, v238, v239
  v_or3_b32 v228, v228, v105, v106
  v_exp_f32 v236, v90
  v_exp_f32 v237, v91
  v_cvt_pk_bf16_f32 v107, v240, v241
  v_exp_f32 v238, v92
  v_exp_f32 v239, v93
  v_cvt_pk_bf16_f32 v108, v234, v235
  v_or3_b32 v228, v228, v107, v108
  v_exp_f32 v240, v94
  v_exp_f32 v241, v95
  v_cvt_pk_bf16_f32 v109, v236, v237
  v_cvt_pk_bf16_f32 v110, v238, v239
  v_or3_b32 v228, v228, v109, v110
  v_cvt_pk_bf16_f32 v111, v240, v241
  v_or_b32 v228, v228, v111
  v_and_b32 v228, 0x40004000, v228
  v_cmp_ne_u32 vcc, 0, v228
  s_cbranch_vccnz K2_chkZ
K2_okZ:
  s_barrier
  s_waitcnt lgkmcnt(7)
  v_mfma_f32_16x16x32_bf16 v[0:3], v[160:163], v[96:99], v[0:3]
  v_mfma_f32_16x16x32_bf16 v[32:35], v[160:163], v[104:107], v[32:35]
  ds_read_b128 v[160:163], v224 offset:24576
  s_waitcnt lgkmcnt(7)
  v_mfma_f32_16x16x32_bf16 v[4:7], v[164:167], v[96:99], v[4:7]
  v_mfma_f32_16x16x32_bf16 v[36:39], v[164:167], v[104:107], v[36:39]
  ds_read_b128 v[164:167], v224 offset:25600
  s_waitcnt lgkmcnt(7)
  v_mfma_f32_16x16x32_bf16 v[8:11], v[168:171], v[96:99], v[8:11]
  v_mfma_f32_16x16x32_bf16 v[40:43], v[168:171], v[104:107], v[40:43]
  ds_read_b128 v[168:171], v224 offset:26624
  s_waitcnt lgkmcnt(7)
  v_mfma_f32_16x16x32_bf16 v[12:15], v[172:175], v[96:99], v[12:15]
  v_mfma_f32_16x16x32_bf16 v[44:47], v[172:175], v[104:107], v[44:47]
  ds_read_b128 v[172:175], v224 offset:27648
  v_mfma_f32_16x16x32_bf16 v[152:155], v[208:211], v[96:99], v[152:155]
  v_mfma_f32_16x16x32_bf16 v[156:159], v[208:211], v[104:107], v[156:159]
  s_waitcnt lgkmcnt(7)
  v_mfma_f32_16x16x32_bf16 v[16:19], v[176:179], v[96:99], v[16:19]
  v_mfma_f32_16x16x32_bf16 v[48:51], v[176:179], v[104:107], v[48:51]
  ds_read_b128 v[176:179], v224 offset:28672
  s_waitcnt lgkmcnt(7)
  v_mfma_f32_16x16x32_bf16 v[20:23], v[180:183], v[96:99], v[20:23]
  v_mfma_f32_16x16x32_bf16 v[52:55], v[180:183], v[104:107], v[52:55]
  ds_read_b128 v[180:183], v224 offset:29696
  s_waitcnt lgkmcnt(7)
  v_mfma_f32_16x16x32_bf16 v[24:27], v[184:187], v[96:99], v[24:27]
  v_mfma_f32_16x16x32_bf16 v[56:59], v[184:187], v[104:107], v[56:59]
  ds_read_b128 v[184:187], v224 offset:30720
  s_waitcnt lgkmcnt(7)
  v_mfma_f32_16x16x32_bf16 v[28:31], v[188:191], v[96:99], v[28:31]
  v_mfma_f32_16x16x32_bf16 v[60:63], v[188:191], v[104:107], v[60:63]
  ds_read_b128 v[188:191], v224 offset:31744
  s_waitcnt lgkmcnt(7)
  v_mfma_f32_16x16x32_bf16 v[0:3], v[160:163], v[100:103], v[0:3]
  v_mfma_f32_16x16x32_bf16 v[32:35], v[160:163], v[108:111], v[32:35]
  s_waitcnt lgkmcnt(6)
  v_mfma_f32_16x16x32_bf16 v[4:7], v[164:167], v[100:103], v[4:7]
  v_mfma_f32_16x16x32_bf16 v[36:39], v[164:167], v[108:111], v[36:39]
  s_waitcnt lgkmcnt(5)
  v_mfma_f32_16x16x32_bf16 v[8:11], v[168:171], v[100:103], v[8:11]
  v_mfma_f32_16x16x32_bf16 v[40:43], v[168:171], v[108:111], v[40:43]
  s_waitcnt lgkmcnt(4)
  v_mfma_f32_16x16x32_bf16 v[12:15], v[172:175], v[100:103], v[12:15]
  v_mfma_f32_16x16x32_bf16 v[44:47], v[172:175], v[108:111], v[44:47]
  v_mfma_f32_16x16x32_bf16 v[152:155], v[208:211], v[100:103], v[152:155]
  v_mfma_f32_16x16x32_bf16 v[156:159], v[208:211], v[108:111], v[156:159]
  s_waitcnt lgkmcnt(3)
  v_mfma_f32_16x16x32_bf16 v[16:19], v[176:179], v[100:103], v[16:19]
  v_mfma_f32_16x16x32_bf16 v[48:51], v[176:179], v[108:111], v[48:51]
  s_waitcnt lgkmcnt(2)
  v_mfma_f32_16x16x32_bf16 v[20:23], v[180:183], v[100:103], v[20:23]
  v_mfma_f32_16x16x32_bf16 v[52:55], v[180:183], v[108:111], v[52:55]
  s_waitcnt lgkmcnt(1)
  v_mfma_f32_16x16x32_bf16 v[24:27], v[184:187], v[100:103], v[24:27]
  v_mfma_f32_16x16x32_bf16 v[56:59], v[184:187], v[108:111], v[56:59]
  s_waitcnt lgkmcnt(0)
  v_mfma_f32_16x16x32_bf16 v[28:31], v[188:191], v[100:103], v[28:31]
  v_mfma_f32_16x16x32_bf16 v[60:63], v[188:191], v[108:111], v[60:63]
  s_lshl_b32 s6, s11, 14
  s_add_u32 s6, s6, 65536
  v_add_u32 v236, s6, v231
  s_lshl_b32 s6, s11, 10
  s_add_u32 s6, s6, 131072
  v_add_u32 v237, s6, v231
  s_barrier
  s_cmp_eq_u32 s10, 0
  s_cbranch_scc1 K2_merge
  v_mov_b32 v208, v226
  v_mov_b32 v209, v227
  v_mov_b32 v210, v152
  v_mov_b32 v211, v156
  ds_write_b128 v237, v[208:211]
  ds_write_b128 v236, v[0:3] offset:0
  ds_write_b128 v236, v[4:7] offset:1024
  ds_write_b128 v236, v[8:11] offset:2048
  ds_write_b128 v236, v[12:15] offset:3072
  ds_write_b128 v236, v[16:19] offset:4096
  ds_write_b128 v236, v[20:23] offset:5120
  ds_write_b128 v236, v[24:27] offset:6144
  ds_write_b128 v236, v[28:31] offset:7168
  ds_write_b128 v236, v[32:35] offset:8192
  ds_write_b128 v236, v[36:39] offset:9216
  ds_write_b128 v236, v[40:43] offset:10240
  ds_write_b128 v236, v[44:47] offset:11264
  ds_write_b128 v236, v[48:51] offset:12288
  ds_write_b128 v236, v[52:55] offset:13312
  ds_write_b128 v236, v[56:59] offset:14336
  ds_write_b128 v236, v[60:63] offset:15360
  s_waitcnt vmcnt(0) lgkmcnt(0)
  s_barrier
  s_endpgm
K2_merge:
  ds_read_b128 v[208:211], v237
  ds_read_b128 v[64:67], v236 offset:0
  ds_read_b128 v[68:71], v236 offset:1024
  ds_read_b128 v[72:75], v236 offset:2048
  ds_read_b128 v[76:79], v236 offset:3072
  ds_read_b128 v[80:83], v236 offset:4096
  ds_read_b128 v[84:87], v236 offset:5120
  ds_read_b128 v[88:91], v236 offset:6144
  ds_read_b128 v[92:95], v236 offset:7168
  ds_read_b128 v[96:99], v236 offset:8192
  ds_read_b128 v[100:103], v236 offset:9216
  ds_read_b128 v[104:107], v236 offset:10240
  ds_read_b128 v[108:111], v236 offset:11264
  ds_read_b128 v[112:115], v236 offset:12288
  ds_read_b128 v[116:119], v236 offset:13312
  ds_read_b128 v[120:123], v236 offset:14336
  ds_read_b128 v[124:127], v236 offset:15360
  s_waitcnt lgkmcnt(15)
  v_max_f32 v234, v226, v208
  v_sub_f32 v238, v226, v234
  v_sub_f32 v240, v208, v234
  v_max_f32 v234, v227, v209
  v_sub_f32 v239, v227, v234
  v_sub_f32 v241, v209, v234
  v_exp_f32 v238, v238
  v_exp_f32 v239, v239
  v_exp_f32 v240, v240
  v_exp_f32 v241, v241
  s_nop 0
  v_mul_f32 v242, v238, v152
  v_fmac_f32 v242, v240, v210
  v_mul_f32 v243, v239, v156
  v_fmac_f32 v243, v241, v211
  v_rcp_f32 v242, v242
  v_rcp_f32 v243, v243
  s_nop 0
  v_mul_f32 v238, v238, v242
  v_mul_f32 v240, v240, v242
  v_mul_f32 v239, v239, v243
  v_mul_f32 v241, v241, v243
  v_mul_f32 v0, v0, v238
  v_mul_f32 v1, v1, v238
  v_mul_f32 v2, v2, v238
  v_mul_f32 v3, v3, v238
  v_mul_f32 v4, v4, v238
  v_mul_f32 v5, v5, v238
  v_mul_f32 v6, v6, v238
  v_mul_f32 v7, v7, v238
  v_mul_f32 v8, v8, v238
  v_mul_f32 v9, v9, v238
  v_mul_f32 v10, v10, v238
  v_mul_f32 v11, v11, v238
  v_mul_f32 v12, v12, v238
  v_mul_f32 v13, v13, v238
  v_mul_f32 v14, v14, v238
  v_mul_f32 v15, v15, v238
  v_mul_f32 v16, v16, v238
  v_mul_f32 v17, v17, v238
  v_mul_f32 v18, v18, v238
  v_mul_f32 v19, v19, v238
  v_mul_f32 v20, v20, v238
  v_mul_f32 v21, v21, v238
  v_mul_f32 v22, v22, v238
  v_mul_f32 v23, v23, v238
  v_mul_f32 v24, v24, v238
  v_mul_f32 v25, v25, v238
  v_mul_f32 v26, v26, v238
  v_mul_f32 v27, v27, v238
  v_mul_f32 v28, v28, v238
  v_mul_f32 v29, v29, v238
  v_mul_f32 v30, v30, v238
  v_mul_f32 v31, v31, v238
  v_mul_f32 v32, v32, v239
  v_mul_f32 v33, v33, v239
  v_mul_f32 v34, v34, v239
  v_mul_f32 v35, v35, v239
  v_mul_f32 v36, v36, v239
  v_mul_f32 v37, v37, v239
  v_mul_f32 v38, v38, v239
  v_mul_f32 v39, v39, v239
  v_mul_f32 v40, v40, v239
  v_mul_f32 v41, v41, v239
  v_mul_f32 v42, v42, v239
  v_mul_f32 v43, v43, v239
  v_mul_f32 v44, v44, v239
  v_mul_f32 v45, v45, v239
  v_mul_f32 v46, v46, v239
  v_mul_f32 v47, v47, v239
  v_mul_f32 v48, v48, v239
  v_mul_f32 v49, v49, v239
  v_mul_f32 v50, v50, v239
  v_mul_f32 v51, v51, v239
  v_mul_f32 v52, v52, v239
  v_mul_f32 v53, v53, v239
  v_mul_f32 v54, v54, v239
  v_mul_f32 v55, v55, v239
  v_mul_f32 v56, v56, v239
  v_mul_f32 v57, v57, v239
  v_mul_f32 v58, v58, v239
  v_mul_f32 v59, v59, v239
  v_mul_f32 v60, v60, v239
  v_mul_f32 v61, v61, v239
  v_mul_f32 v62, v62, v239
  v_mul_f32 v63, v63, v239
  s_waitcnt lgkmcnt(0)
  v_fmac_f32 v0, v64, v240
  v_fmac_f32 v1, v65, v240
  v_fmac_f32 v2, v66, v240
  v_fmac_f32 v3, v67, v240
  v_fmac_f32 v4, v68, v240
  v_fmac_f32 v5, v69, v240
  v_fmac_f32 v6, v70, v240
  v_fmac_f32 v7, v71, v240
  v_fmac_f32 v8, v72, v240
  v_fmac_f32 v9, v73, v240
  v_fmac_f32 v10, v74, v240
  v_fmac_f32 v11, v75, v240
  v_fmac_f32 v12, v76, v240
  v_fmac_f32 v13, v77, v240
  v_fmac_f32 v14, v78, v240
  v_fmac_f32 v15, v79, v240
  v_fmac_f32 v16, v80, v240
  v_fmac_f32 v17, v81, v240
  v_fmac_f32 v18, v82, v240
  v_fmac_f32 v19, v83, v240
  v_fmac_f32 v20, v84, v240
  v_fmac_f32 v21, v85, v240
  v_fmac_f32 v22, v86, v240
  v_fmac_f32 v23, v87, v240
  v_fmac_f32 v24, v88, v240
  v_fmac_f32 v25, v89, v240
  v_fmac_f32 v26, v90, v240
  v_fmac_f32 v27, v91, v240
  v_fmac_f32 v28, v92, v240
  v_fmac_f32 v29, v93, v240
  v_fmac_f32 v30, v94, v240
  v_fmac_f32 v31, v95, v240
  v_fmac_f32 v32, v96, v241
  v_fmac_f32 v33, v97, v241
  v_fmac_f32 v34, v98, v241
  v_fmac_f32 v35, v99, v241
  v_fmac_f32 v36, v100, v241
  v_fmac_f32 v37, v101, v241
  v_fmac_f32 v38, v102, v241
  v_fmac_f32 v39, v103, v241
  v_fmac_f32 v40, v104, v241
  v_fmac_f32 v41, v105, v241
  v_fmac_f32 v42, v106, v241
  v_fmac_f32 v43, v107, v241
  v_fmac_f32 v44, v108, v241
  v_fmac_f32 v45, v109, v241
  v_fmac_f32 v46, v110, v241
  v_fmac_f32 v47, v111, v241
  v_fmac_f32 v48, v112, v241
  v_fmac_f32 v49, v113, v241
  v_fmac_f32 v50, v114, v241
  v_fmac_f32 v51, v115, v241
  v_fmac_f32 v52, v116, v241
  v_fmac_f32 v53, v117, v241
  v_fmac_f32 v54, v118, v241
  v_fmac_f32 v55, v119, v241
  v_fmac_f32 v56, v120, v241
  v_fmac_f32 v57, v121, v241
  v_fmac_f32 v58, v122, v241
  v_fmac_f32 v59, v123, v241
  v_fmac_f32 v60, v124, v241
  v_fmac_f32 v61, v125, v241
  v_fmac_f32 v62, v126, v241
  v_fmac_f32 v63, v127, v241
  s_lshl_b32 s6, s91, 13
  s_lshl_b32 s7, s4, 13
  s_add_u32 s6, s6, s7
  s_add_u32 s6, s6, 33554432
  s_add_u32 s7, s6, 4096
  v_cvt_pk_bf16_f32 v96, v0, v1
  v_cvt_pk_bf16_f32 v97, v2, v3
  v_cvt_pk_bf16_f32 v98, v4, v5
  v_cvt_pk_bf16_f32 v99, v6, v7
  buffer_store_dwordx4 v[96:99], v225, s[64:67], s6 offen offset:0 sc1
  v_cvt_pk_bf16_f32 v100, v8, v9
  v_cvt_pk_bf16_f32 v101, v10, v11
  v_cvt_pk_bf16_f32 v102, v12, v13
  v_cvt_pk_bf16_f32 v103, v14, v15
  buffer_store_dwordx4 v[100:103], v225, s[64:67], s6 offen offset:2048 sc1
  v_cvt_pk_bf16_f32 v104, v16, v17
  v_cvt_pk_bf16_f32 v105, v18, v19
  v_cvt_pk_bf16_f32 v106, v20, v21
  v_cvt_pk_bf16_f32 v107, v22, v23
  buffer_store_dwordx4 v[104:107], v225, s[64:67], s7 offen offset:0 sc1
  v_cvt_pk_bf16_f32 v108, v24, v25
  v_cvt_pk_bf16_f32 v109, v26, v27
  v_cvt_pk_bf16_f32 v110, v28, v29
  v_cvt_pk_bf16_f32 v111, v30, v31
  buffer_store_dwordx4 v[108:111], v225, s[64:67], s7 offen offset:2048 sc1
  v_cvt_pk_bf16_f32 v96, v32, v33
  v_cvt_pk_bf16_f32 v97, v34, v35
  v_cvt_pk_bf16_f32 v98, v36, v37
  v_cvt_pk_bf16_f32 v99, v38, v39
  buffer_store_dwordx4 v[96:99], v225, s[64:67], s6 offen offset:256 sc1
  v_cvt_pk_bf16_f32 v100, v40, v41
  v_cvt_pk_bf16_f32 v101, v42, v43
  v_cvt_pk_bf16_f32 v102, v44, v45
  v_cvt_pk_bf16_f32 v103, v46, v47
  buffer_store_dwordx4 v[100:103], v225, s[64:67], s6 offen offset:2304 sc1
  v_cvt_pk_bf16_f32 v104, v48, v49
  v_cvt_pk_bf16_f32 v105, v50, v51
  v_cvt_pk_bf16_f32 v106, v52, v53
  v_cvt_pk_bf16_f32 v107, v54, v55
  buffer_store_dwordx4 v[104:107], v225, s[64:67], s7 offen offset:256 sc1
  v_cvt_pk_bf16_f32 v108, v56, v57
  v_cvt_pk_bf16_f32 v109, v58, v59
  v_cvt_pk_bf16_f32 v110, v60, v61
  v_cvt_pk_bf16_f32 v111, v62, v63
  buffer_store_dwordx4 v[108:111], v225, s[64:67], s7 offen offset:2304 sc1
K2_exit:
  s_endpgm
K2_specA:
  s_cmp_eq_u32 s72, 0
  s_cbranch_scc1 K2_nofinA
  s_nop 3
  v_rcp_f32 v234, v152
  v_rcp_f32 v235, v156
  v_mov_b32 v152, 0
  v_mov_b32 v153, 0
  v_mov_b32 v154, 0
  v_mov_b32 v155, 0
  v_mov_b32 v156, 0
  v_mov_b32 v157, 0
  v_mov_b32 v158, 0
  v_mov_b32 v159, 0
  s_mov_b32 s72, 0
  v_mul_f32 v0, v0, v234
  v_mul_f32 v1, v1, v234
  v_mul_f32 v2, v2, v234
  v_mul_f32 v3, v3, v234
  v_mul_f32 v4, v4, v234
  v_mul_f32 v5, v5, v234
  v_mul_f32 v6, v6, v234
  v_mul_f32 v7, v7, v234
  v_mul_f32 v8, v8, v234
  v_mul_f32 v9, v9, v234
  v_mul_f32 v10, v10, v234
  v_mul_f32 v11, v11, v234
  v_mul_f32 v12, v12, v234
  v_mul_f32 v13, v13, v234
  v_mul_f32 v14, v14, v234
  v_mul_f32 v15, v15, v234
  v_mul_f32 v16, v16, v234
  v_mul_f32 v17, v17, v234
  v_mul_f32 v18, v18, v234
  v_mul_f32 v19, v19, v234
  v_mul_f32 v20, v20, v234
  v_mul_f32 v21, v21, v234
  v_mul_f32 v22, v22, v234
  v_mul_f32 v23, v23, v234
  v_mul_f32 v24, v24, v234
  v_mul_f32 v25, v25, v234
  v_mul_f32 v26, v26, v234
  v_mul_f32 v27, v27, v234
  v_mul_f32 v28, v28, v234
  v_mul_f32 v29, v29, v234
  v_mul_f32 v30, v30, v234
  v_mul_f32 v31, v31, v234
  v_mul_f32 v32, v32, v235
  v_mul_f32 v33, v33, v235
  v_mul_f32 v34, v34, v235
  v_mul_f32 v35, v35, v235
  v_mul_f32 v36, v36, v235
  v_mul_f32 v37, v37, v235
  v_mul_f32 v38, v38, v235
  v_mul_f32 v39, v39, v235
  v_mul_f32 v40, v40, v235
  v_mul_f32 v41, v41, v235
  v_mul_f32 v42, v42, v235
  v_mul_f32 v43, v43, v235
  v_mul_f32 v44, v44, v235
  v_mul_f32 v45, v45, v235
  v_mul_f32 v46, v46, v235
  v_mul_f32 v47, v47, v235
  v_mul_f32 v48, v48, v235
  v_mul_f32 v49, v49, v235
  v_mul_f32 v50, v50, v235
  v_mul_f32 v51, v51, v235
  v_mul_f32 v52, v52, v235
  v_mul_f32 v53, v53, v235
  v_mul_f32 v54, v54, v235
  v_mul_f32 v55, v55, v235
  v_mul_f32 v56, v56, v235
  v_mul_f32 v57, v57, v235
  v_mul_f32 v58, v58, v235
  v_mul_f32 v59, v59, v235
  v_mul_f32 v60, v60, v235
  v_mul_f32 v61, v61, v235
  v_mul_f32 v62, v62, v235
  v_mul_f32 v63, v63, v235
  s_lshl_b32 s6, s93, 13
  s_lshl_b32 s7, s4, 13
  s_add_u32 s6, s6, s7
  s_add_u32 s6, s6, 33554432
  s_add_u32 s7, s6, 4096
  v_cvt_pk_bf16_f32 v96, v0, v1
  v_cvt_pk_bf16_f32 v97, v2, v3
  v_cvt_pk_bf16_f32 v98, v4, v5
  v_cvt_pk_bf16_f32 v99, v6, v7
  buffer_store_dwordx4 v[96:99], v225, s[64:67], s6 offen offset:0 sc1
  v_cvt_pk_bf16_f32 v100, v8, v9
  v_cvt_pk_bf16_f32 v101, v10, v11
  v_cvt_pk_bf16_f32 v102, v12, v13
  v_cvt_pk_bf16_f32 v103, v14, v15
  buffer_store_dwordx4 v[100:103], v225, s[64:67], s6 offen offset:2048 sc1
  v_cvt_pk_bf16_f32 v104, v16, v17
  v_cvt_pk_bf16_f32 v105, v18, v19
  v_cvt_pk_bf16_f32 v106, v20, v21
  v_cvt_pk_bf16_f32 v107, v22, v23
  buffer_store_dwordx4 v[104:107], v225, s[64:67], s7 offen offset:0 sc1
  v_cvt_pk_bf16_f32 v108, v24, v25
  v_cvt_pk_bf16_f32 v109, v26, v27
  v_cvt_pk_bf16_f32 v110, v28, v29
  v_cvt_pk_bf16_f32 v111, v30, v31
  buffer_store_dwordx4 v[108:111], v225, s[64:67], s7 offen offset:2048 sc1
  v_cvt_pk_bf16_f32 v96, v32, v33
  v_cvt_pk_bf16_f32 v97, v34, v35
  v_cvt_pk_bf16_f32 v98, v36, v37
  v_cvt_pk_bf16_f32 v99, v38, v39
  buffer_store_dwordx4 v[96:99], v225, s[64:67], s6 offen offset:256 sc1
  v_cvt_pk_bf16_f32 v100, v40, v41
  v_cvt_pk_bf16_f32 v101, v42, v43
  v_cvt_pk_bf16_f32 v102, v44, v45
  v_cvt_pk_bf16_f32 v103, v46, v47
  buffer_store_dwordx4 v[100:103], v225, s[64:67], s6 offen offset:2304 sc1
  v_cvt_pk_bf16_f32 v104, v48, v49
  v_cvt_pk_bf16_f32 v105, v50, v51
  v_cvt_pk_bf16_f32 v106, v52, v53
  v_cvt_pk_bf16_f32 v107, v54, v55
  buffer_store_dwordx4 v[104:107], v225, s[64:67], s7 offen offset:256 sc1
  v_cvt_pk_bf16_f32 v108, v56, v57
  v_cvt_pk_bf16_f32 v109, v58, v59
  v_cvt_pk_bf16_f32 v110, v60, v61
  v_cvt_pk_bf16_f32 v111, v62, v63
  buffer_store_dwordx4 v[108:111], v225, s[64:67], s7 offen offset:2304 sc1
  v_mov_b32 v0, 0
  v_mov_b32 v1, 0
  v_mov_b32 v2, 0
  v_mov_b32 v3, 0
  v_mov_b32 v4, 0
  v_mov_b32 v5, 0
  v_mov_b32 v6, 0
  v_mov_b32 v7, 0
  v_mov_b32 v8, 0
  v_mov_b32 v9, 0
  v_mov_b32 v10, 0
  v_mov_b32 v11, 0
  v_mov_b32 v12, 0
  v_mov_b32 v13, 0
  v_mov_b32 v14, 0
  v_mov_b32 v15, 0
  v_mov_b32 v16, 0
  v_mov_b32 v17, 0
  v_mov_b32 v18, 0
  v_mov_b32 v19, 0
  v_mov_b32 v20, 0
  v_mov_b32 v21, 0
  v_mov_b32 v22, 0
  v_mov_b32 v23, 0
  v_mov_b32 v24, 0
  v_mov_b32 v25, 0
  v_mov_b32 v26, 0
  v_mov_b32 v27, 0
  v_mov_b32 v28, 0
  v_mov_b32 v29, 0
  v_mov_b32 v30, 0
  v_mov_b32 v31, 0
  v_mov_b32 v32, 0
  v_mov_b32 v33, 0
  v_mov_b32 v34, 0
  v_mov_b32 v35, 0
  v_mov_b32 v36, 0
  v_mov_b32 v37, 0
  v_mov_b32 v38, 0
  v_mov_b32 v39, 0
  v_mov_b32 v40, 0
  v_mov_b32 v41, 0
  v_mov_b32 v42, 0
  v_mov_b32 v43, 0
  v_mov_b32 v44, 0
  v_mov_b32 v45, 0
  v_mov_b32 v46, 0
  v_mov_b32 v47, 0
  v_mov_b32 v48, 0
  v_mov_b32 v49, 0
  v_mov_b32 v50, 0
  v_mov_b32 v51, 0
  v_mov_b32 v52, 0
  v_mov_b32 v53, 0
  v_mov_b32 v54, 0
  v_mov_b32 v55, 0
  v_mov_b32 v56, 0
  v_mov_b32 v57, 0
  v_mov_b32 v58, 0
  v_mov_b32 v59, 0
  v_mov_b32 v60, 0
  v_mov_b32 v61, 0
  v_mov_b32 v62, 0
  v_mov_b32 v63, 0
K2_nofinA:
  s_add_u32 s7, s88, 63
  s_cmp_gt_u32 s7, s14
  s_cbranch_scc0 K2_nomaskA
  s_sub_u32 s7, s14, s88
  v_add_u32 v230, s7, v232
  v_mov_b32 v245, s95
  v_cmp_le_i32 s[80:81], 0, v230
  v_cmp_le_i32 s[82:83], 1, v230
  v_cmp_le_i32 s[84:85], 2, v230
  v_cmp_le_i32 s[86:87], 3, v230
  v_cndmask_b32 v64, v245, v64, s[80:81]
  v_cndmask_b32 v65, v245, v65, s[82:83]
  v_cndmask_b32 v66, v245, v66, s[84:85]
  v_cndmask_b32 v67, v245, v67, s[86:87]
  v_cmp_le_i32 s[80:81], 16, v230
  v_cmp_le_i32 s[82:83], 17, v230
  v_cmp_le_i32 s[84:85], 18, v230
  v_cmp_le_i32 s[86:87], 19, v230
  v_cndmask_b32 v68, v245, v68, s[80:81]
  v_cndmask_b32 v69, v245, v69, s[82:83]
  v_cndmask_b32 v70, v245, v70, s[84:85]
  v_cndmask_b32 v71, v245, v71, s[86:87]
  v_cmp_le_i32 s[80:81], 32, v230
  v_cmp_le_i32 s[82:83], 33, v230
  v_cmp_le_i32 s[84:85], 34, v230
  v_cmp_le_i32 s[86:87], 35, v230
  v_cndmask_b32 v72, v245, v72, s[80:81]
  v_cndmask_b32 v73, v245, v73, s[82:83]
  v_cndmask_b32 v74, v245, v74, s[84:85]
  v_cndmask_b32 v75, v245, v75, s[86:87]
  v_cmp_le_i32 s[80:81], 48, v230
  v_cmp_le_i32 s[82:83], 49, v230
  v_cmp_le_i32 s[84:85], 50, v230
  v_cmp_le_i32 s[86:87], 51, v230
  v_cndmask_b32 v76, v245, v76, s[80:81]
  v_cndmask_b32 v77, v245, v77, s[82:83]
  v_cndmask_b32 v78, v245, v78, s[84:85]
  v_cndmask_b32 v79, v245, v79, s[86:87]
  v_cmp_le_i32 s[80:81], -16, v230
  v_cmp_le_i32 s[82:83], -15, v230
  v_cmp_le_i32 s[84:85], -14, v230
  v_cmp_le_i32 s[86:87], -13, v230
  v_cndmask_b32 v80, v245, v80, s[80:81]
  v_cndmask_b32 v81, v245, v81, s[82:83]
  v_cndmask_b32 v82, v245, v82, s[84:85]
  v_cndmask_b32 v83, v245, v83, s[86:87]
  v_cmp_le_i32 s[80:81], 0, v230
  v_cmp_le_i32 s[82:83], 1, v230
  v_cmp_le_i32 s[84:85], 2, v230
  v_cmp_le_i32 s[86:87], 3, v230
  v_cndmask_b32 v84, v245, v84, s[80:81]
  v_cndmask_b32 v85, v245, v85, s[82:83]
  v_cndmask_b32 v86, v245, v86, s[84:85]
  v_cndmask_b32 v87, v245, v87, s[86:87]
  v_cmp_le_i32 s[80:81], 16, v230
  v_cmp_le_i32 s[82:83], 17, v230
  v_cmp_le_i32 s[84:85], 18, v230
  v_cmp_le_i32 s[86:87], 19, v230
  v_cndmask_b32 v88, v245, v88, s[80:81]
  v_cndmask_b32 v89, v245, v89, s[82:83]
  v_cndmask_b32 v90, v245, v90, s[84:85]
  v_cndmask_b32 v91, v245, v91, s[86:87]
  v_cmp_le_i32 s[80:81], 32, v230
  v_cmp_le_i32 s[82:83], 33, v230
  v_cmp_le_i32 s[84:85], 34, v230
  v_cmp_le_i32 s[86:87], 35, v230
  v_cndmask_b32 v92, v245, v92, s[80:81]
  v_cndmask_b32 v93, v245, v93, s[82:83]
  v_cndmask_b32 v94, v245, v94, s[84:85]
  v_cndmask_b32 v95, v245, v95, s[86:87]
K2_nomaskA:
  s_cmp_eq_u32 s15, 0
  s_cbranch_scc1 K2_expA
  v_max3_f32 v234, v64, v65, v66
  v_max3_f32 v234, v234, v67, v68
  v_max3_f32 v234, v234, v69, v70
  v_max3_f32 v234, v234, v71, v72
  v_max3_f32 v234, v234, v73, v74
  v_max3_f32 v234, v234, v75, v76
  v_max3_f32 v234, v234, v77, v78
  v_max_f32 v234, v234, v79
  v_max3_f32 v235, v80, v81, v82
  v_max3_f32 v235, v235, v83, v84
  v_max3_f32 v235, v235, v85, v86
  v_max3_f32 v235, v235, v87, v88
  v_max3_f32 v235, v235, v89, v90
  v_max3_f32 v235, v235, v91, v92
  v_max3_f32 v235, v235, v93, v94
  v_max_f32 v235, v235, v95
  v_mov_b32 v236, v234
  v_mov_b32 v237, v235
  s_nop 1
  v_permlane32_swap_b32 v234, v236
  v_permlane32_swap_b32 v235, v237
  s_nop 1
  v_max_f32 v234, v234, v236
  v_max_f32 v235, v235, v237
  v_mov_b32 v236, v234
  v_mov_b32 v237, v235
  s_nop 1
  v_permlane16_swap_b32 v234, v236
  v_permlane16_swap_b32 v235, v237
  s_nop 1
  v_max_f32 v234, v234, v236
  v_max_f32 v235, v235, v237
  v_max_f32 v234, 0xe0ad78ec, v234
  v_mov_b32 v226, v234
  v_add_f32 v234, 0x42800000, v234
  v_sub_f32 v144, 0, v234
  v_mov_b32 v145, v144
  v_mov_b32 v146, v144
  v_mov_b32 v147, v144
  v_sub_f32 v64, v64, v234
  v_sub_f32 v65, v65, v234
  v_sub_f32 v66, v66, v234
  v_sub_f32 v67, v67, v234
  v_sub_f32 v68, v68, v234
  v_sub_f32 v69, v69, v234
  v_sub_f32 v70, v70, v234
  v_sub_f32 v71, v71, v234
  v_sub_f32 v72, v72, v234
  v_sub_f32 v73, v73, v234
  v_sub_f32 v74, v74, v234
  v_sub_f32 v75, v75, v234
  v_sub_f32 v76, v76, v234
  v_sub_f32 v77, v77, v234
  v_sub_f32 v78, v78, v234
  v_sub_f32 v79, v79, v234
  v_max_f32 v235, 0xe0ad78ec, v235
  v_mov_b32 v227, v235
  v_add_f32 v235, 0x42800000, v235
  v_sub_f32 v148, 0, v235
  v_mov_b32 v149, v148
  v_mov_b32 v150, v148
  v_mov_b32 v151, v148
  v_sub_f32 v80, v80, v235
  v_sub_f32 v81, v81, v235
  v_sub_f32 v82, v82, v235
  v_sub_f32 v83, v83, v235
  v_sub_f32 v84, v84, v235
  v_sub_f32 v85, v85, v235
  v_sub_f32 v86, v86, v235
  v_sub_f32 v87, v87, v235
  v_sub_f32 v88, v88, v235
  v_sub_f32 v89, v89, v235
  v_sub_f32 v90, v90, v235
  v_sub_f32 v91, v91, v235
  v_sub_f32 v92, v92, v235
  v_sub_f32 v93, v93, v235
  v_sub_f32 v94, v94, v235
  v_sub_f32 v95, v95, v235
  s_mov_b32 s15, 0
  s_branch K2_expA
K2_chkA:
  v_max3_f32 v234, v64, v65, v66
  v_max3_f32 v234, v234, v67, v68
  v_max3_f32 v234, v234, v69, v70
  v_max3_f32 v234, v234, v71, v72
  v_max3_f32 v234, v234, v73, v74
  v_max3_f32 v234, v234, v75, v76
  v_max3_f32 v234, v234, v77, v78
  v_max_f32 v234, v234, v79
  v_max3_f32 v235, v80, v81, v82
  v_max3_f32 v235, v235, v83, v84
  v_max3_f32 v235, v235, v85, v86
  v_max3_f32 v235, v235, v87, v88
  v_max3_f32 v235, v235, v89, v90
  v_max3_f32 v235, v235, v91, v92
  v_max3_f32 v235, v235, v93, v94
  v_max_f32 v235, v235, v95
  v_mov_b32 v236, v234
  v_mov_b32 v237, v235
  s_nop 1
  v_permlane32_swap_b32 v234, v236
  v_permlane32_swap_b32 v235, v237
  s_nop 1
  v_max_f32 v234, v234, v236
  v_max_f32 v235, v235, v237
  v_mov_b32 v236, v234
  v_mov_b32 v237, v235
  s_nop 1
  v_permlane16_swap_b32 v234, v236
  v_permlane16_swap_b32 v235, v237
  s_nop 1
  v_max_f32 v234, v234, v236
  v_max_f32 v235, v235, v237
  v_add_f32 v234, 0x42800000, v234
  v_max_f32 v234, 0, v234
  v_exp_f32 v236, -v234
  v_add_f32 v226, v226, v234
  v_sub_f32 v144, v144, v234
  v_mov_b32 v145, v144
  v_mov_b32 v146, v144
  v_mov_b32 v147, v144
  v_mul_f32 v152, v152, v236
  v_mul_f32 v153, v153, v236
  v_mul_f32 v154, v154, v236
  v_mul_f32 v155, v155, v236
  v_mul_f32 v0, v0, v236
  v_mul_f32 v1, v1, v236
  v_mul_f32 v2, v2, v236
  v_mul_f32 v3, v3, v236
  v_mul_f32 v4, v4, v236
  v_mul_f32 v5, v5, v236
  v_mul_f32 v6, v6, v236
  v_mul_f32 v7, v7, v236
  v_mul_f32 v8, v8, v236
  v_mul_f32 v9, v9, v236
  v_mul_f32 v10, v10, v236
  v_mul_f32 v11, v11, v236
  v_mul_f32 v12, v12, v236
  v_mul_f32 v13, v13, v236
  v_mul_f32 v14, v14, v236
  v_mul_f32 v15, v15, v236
  v_mul_f32 v16, v16, v236
  v_mul_f32 v17, v17, v236
  v_mul_f32 v18, v18, v236
  v_mul_f32 v19, v19, v236
  v_mul_f32 v20, v20, v236
  v_mul_f32 v21, v21, v236
  v_mul_f32 v22, v22, v236
  v_mul_f32 v23, v23, v236
  v_mul_f32 v24, v24, v236
  v_mul_f32 v25, v25, v236
  v_mul_f32 v26, v26, v236
  v_mul_f32 v27, v27, v236
  v_mul_f32 v28, v28, v236
  v_mul_f32 v29, v29, v236
  v_mul_f32 v30, v30, v236
  v_mul_f32 v31, v31, v236
  v_sub_f32 v64, v64, v234
  v_sub_f32 v65, v65, v234
  v_sub_f32 v66, v66, v234
  v_sub_f32 v67, v67, v234
  v_sub_f32 v68, v68, v234
  v_sub_f32 v69, v69, v234
  v_sub_f32 v70, v70, v234
  v_sub_f32 v71, v71, v234
  v_sub_f32 v72, v72, v234
  v_sub_f32 v73, v73, v234
  v_sub_f32 v74, v74, v234
  v_sub_f32 v75, v75, v234
  v_sub_f32 v76, v76, v234
  v_sub_f32 v77, v77, v234
  v_sub_f32 v78, v78, v234
  v_sub_f32 v79, v79, v234
  v_add_f32 v235, 0x42800000, v235
  v_max_f32 v235, 0, v235
  v_exp_f32 v237, -v235
  v_add_f32 v227, v227, v235
  v_sub_f32 v148, v148, v235
  v_mov_b32 v149, v148
  v_mov_b32 v150, v148
  v_mov_b32 v151, v148
  v_mul_f32 v156, v156, v237
  v_mul_f32 v157, v157, v237
  v_mul_f32 v158, v158, v237
  v_mul_f32 v159, v159, v237
  v_mul_f32 v32, v32, v237
  v_mul_f32 v33, v33, v237
  v_mul_f32 v34, v34, v237
  v_mul_f32 v35, v35, v237
  v_mul_f32 v36, v36, v237
  v_mul_f32 v37, v37, v237
  v_mul_f32 v38, v38, v237
  v_mul_f32 v39, v39, v237
  v_mul_f32 v40, v40, v237
  v_mul_f32 v41, v41, v237
  v_mul_f32 v42, v42, v237
  v_mul_f32 v43, v43, v237
  v_mul_f32 v44, v44, v237
  v_mul_f32 v45, v45, v237
  v_mul_f32 v46, v46, v237
  v_mul_f32 v47, v47, v237
  v_mul_f32 v48, v48, v237
  v_mul_f32 v49, v49, v237
  v_mul_f32 v50, v50, v237
  v_mul_f32 v51, v51, v237
  v_mul_f32 v52, v52, v237
  v_mul_f32 v53, v53, v237
  v_mul_f32 v54, v54, v237
  v_mul_f32 v55, v55, v237
  v_mul_f32 v56, v56, v237
  v_mul_f32 v57, v57, v237
  v_mul_f32 v58, v58, v237
  v_mul_f32 v59, v59, v237
  v_mul_f32 v60, v60, v237
  v_mul_f32 v61, v61, v237
  v_mul_f32 v62, v62, v237
  v_mul_f32 v63, v63, v237
  v_sub_f32 v80, v80, v235
  v_sub_f32 v81, v81, v235
  v_sub_f32 v82, v82, v235
  v_sub_f32 v83, v83, v235
  v_sub_f32 v84, v84, v235
  v_sub_f32 v85, v85, v235
  v_sub_f32 v86, v86, v235
  v_sub_f32 v87, v87, v235
  v_sub_f32 v88, v88, v235
  v_sub_f32 v89, v89, v235
  v_sub_f32 v90, v90, v235
  v_sub_f32 v91, v91, v235
  v_sub_f32 v92, v92, v235
  v_sub_f32 v93, v93, v235
  v_sub_f32 v94, v94, v235
  v_sub_f32 v95, v95, v235
  v_exp_f32 v234, v64
  v_exp_f32 v235, v65
  v_exp_f32 v236, v66
  v_exp_f32 v237, v67
  v_exp_f32 v238, v68
  v_exp_f32 v239, v69
  v_cvt_pk_bf16_f32 v96, v234, v235
  v_exp_f32 v240, v70
  v_exp_f32 v241, v71
  v_cvt_pk_bf16_f32 v97, v236, v237
  v_exp_f32 v234, v72
  v_exp_f32 v235, v73
  v_cvt_pk_bf16_f32 v98, v238, v239
  v_or3_b32 v228, v96, v97, v98
  v_exp_f32 v236, v74
  v_exp_f32 v237, v75
  v_cvt_pk_bf16_f32 v99, v240, v241
  v_exp_f32 v238, v76
  v_exp_f32 v239, v77
  v_cvt_pk_bf16_f32 v100, v234, v235
  v_or3_b32 v228, v228, v99, v100
  v_exp_f32 v240, v78
  v_exp_f32 v241, v79
  v_cvt_pk_bf16_f32 v101, v236, v237
  v_exp_f32 v234, v80
  v_exp_f32 v235, v81
  v_cvt_pk_bf16_f32 v102, v238, v239
  v_or3_b32 v228, v228, v101, v102
  v_exp_f32 v236, v82
  v_exp_f32 v237, v83
  v_cvt_pk_bf16_f32 v103, v240, v241
  v_exp_f32 v238, v84
  v_exp_f32 v239, v85
  v_cvt_pk_bf16_f32 v104, v234, v235
  v_or3_b32 v228, v228, v103, v104
  v_exp_f32 v240, v86
  v_exp_f32 v241, v87
  v_cvt_pk_bf16_f32 v105, v236, v237
  v_exp_f32 v234, v88
  v_exp_f32 v235, v89
  v_cvt_pk_bf16_f32 v106, v238, v239
  v_or3_b32 v228, v228, v105, v106
  v_exp_f32 v236, v90
  v_exp_f32 v237, v91
  v_cvt_pk_bf16_f32 v107, v240, v241
  v_exp_f32 v238, v92
  v_exp_f32 v239, v93
  v_cvt_pk_bf16_f32 v108, v234, v235
  v_or3_b32 v228, v228, v107, v108
  v_exp_f32 v240, v94
  v_exp_f32 v241, v95
  v_cvt_pk_bf16_f32 v109, v236, v237
  v_cvt_pk_bf16_f32 v110, v238, v239
  v_or3_b32 v228, v228, v109, v110
  v_cvt_pk_bf16_f32 v111, v240, v241
  v_or_b32 v228, v228, v111
  s_branch K2_okA
K2_postA:
  s_cmp_eq_u32 s12, s13
  s_cbranch_scc0 K2_noswA
  ds_read_b128 v[112:115], v249 offset:0
  ds_read_b128 v[116:119], v249 offset:1024
  ds_read_b128 v[120:123], v249 offset:2048
  ds_read_b128 v[124:127], v249 offset:3072
  ds_read_b128 v[128:131], v249 offset:4096
  ds_read_b128 v[132:135], v249 offset:5120
  ds_read_b128 v[136:139], v249 offset:6144
  ds_read_b128 v[140:143], v249 offset:7168
  v_mov_b32 v144, 0
  v_mov_b32 v145, 0
  v_mov_b32 v146, 0
  v_mov_b32 v147, 0
  v_mov_b32 v148, 0
  v_mov_b32 v149, 0
  v_mov_b32 v150, 0
  v_mov_b32 v151, 0
  s_mov_b32 s15, 1
  s_mov_b32 s72, 1
  s_mov_b32 s14, s91
  s_waitcnt lgkmcnt(0)
K2_noswA:
  s_branch K2_postretA
K2_specB:
  s_cmp_eq_u32 s72, 0
  s_cbranch_scc1 K2_nofinB
  s_nop 3
  v_rcp_f32 v234, v152
  v_rcp_f32 v235, v156
  v_mov_b32 v152, 0
  v_mov_b32 v153, 0
  v_mov_b32 v154, 0
  v_mov_b32 v155, 0
  v_mov_b32 v156, 0
  v_mov_b32 v157, 0
  v_mov_b32 v158, 0
  v_mov_b32 v159, 0
  s_mov_b32 s72, 0
  v_mul_f32 v0, v0, v234
  v_mul_f32 v1, v1, v234
  v_mul_f32 v2, v2, v234
  v_mul_f32 v3, v3, v234
  v_mul_f32 v4, v4, v234
  v_mul_f32 v5, v5, v234
  v_mul_f32 v6, v6, v234
  v_mul_f32 v7, v7, v234
  v_mul_f32 v8, v8, v234
  v_mul_f32 v9, v9, v234
  v_mul_f32 v10, v10, v234
  v_mul_f32 v11, v11, v234
  v_mul_f32 v12, v12, v234
  v_mul_f32 v13, v13, v234
  v_mul_f32 v14, v14, v234
  v_mul_f32 v15, v15, v234
  v_mul_f32 v16, v16, v234
  v_mul_f32 v17, v17, v234
  v_mul_f32 v18, v18, v234
  v_mul_f32 v19, v19, v234
  v_mul_f32 v20, v20, v234
  v_mul_f32 v21, v21, v234
  v_mul_f32 v22, v22, v234
  v_mul_f32 v23, v23, v234
  v_mul_f32 v24, v24, v234
  v_mul_f32 v25, v25, v234
  v_mul_f32 v26, v26, v234
  v_mul_f32 v27, v27, v234
  v_mul_f32 v28, v28, v234
  v_mul_f32 v29, v29, v234
  v_mul_f32 v30, v30, v234
  v_mul_f32 v31, v31, v234
  v_mul_f32 v32, v32, v235
  v_mul_f32 v33, v33, v235
  v_mul_f32 v34, v34, v235
  v_mul_f32 v35, v35, v235
  v_mul_f32 v36, v36, v235
  v_mul_f32 v37, v37, v235
  v_mul_f32 v38, v38, v235
  v_mul_f32 v39, v39, v235
  v_mul_f32 v40, v40, v235
  v_mul_f32 v41, v41, v235
  v_mul_f32 v42, v42, v235
  v_mul_f32 v43, v43, v235
  v_mul_f32 v44, v44, v235
  v_mul_f32 v45, v45, v235
  v_mul_f32 v46, v46, v235
  v_mul_f32 v47, v47, v235
  v_mul_f32 v48, v48, v235
  v_mul_f32 v49, v49, v235
  v_mul_f32 v50, v50, v235
  v_mul_f32 v51, v51, v235
  v_mul_f32 v52, v52, v235
  v_mul_f32 v53, v53, v235
  v_mul_f32 v54, v54, v235
  v_mul_f32 v55, v55, v235
  v_mul_f32 v56, v56, v235
  v_mul_f32 v57, v57, v235
  v_mul_f32 v58, v58, v235
  v_mul_f32 v59, v59, v235
  v_mul_f32 v60, v60, v235
  v_mul_f32 v61, v61, v235
  v_mul_f32 v62, v62, v235
  v_mul_f32 v63, v63, v235
  s_lshl_b32 s6, s93, 13
  s_lshl_b32 s7, s4, 13
  s_add_u32 s6, s6, s7
  s_add_u32 s6, s6, 33554432
  s_add_u32 s7, s6, 4096
  v_cvt_pk_bf16_f32 v96, v0, v1
  v_cvt_pk_bf16_f32 v97, v2, v3
  v_cvt_pk_bf16_f32 v98, v4, v5
  v_cvt_pk_bf16_f32 v99, v6, v7
  buffer_store_dwordx4 v[96:99], v225, s[64:67], s6 offen offset:0 sc1
  v_cvt_pk_bf16_f32 v100, v8, v9
  v_cvt_pk_bf16_f32 v101, v10, v11
  v_cvt_pk_bf16_f32 v102, v12, v13
  v_cvt_pk_bf16_f32 v103, v14, v15
  buffer_store_dwordx4 v[100:103], v225, s[64:67], s6 offen offset:2048 sc1
  v_cvt_pk_bf16_f32 v104, v16, v17
  v_cvt_pk_bf16_f32 v105, v18, v19
  v_cvt_pk_bf16_f32 v106, v20, v21
  v_cvt_pk_bf16_f32 v107, v22, v23
  buffer_store_dwordx4 v[104:107], v225, s[64:67], s7 offen offset:0 sc1
  v_cvt_pk_bf16_f32 v108, v24, v25
  v_cvt_pk_bf16_f32 v109, v26, v27
  v_cvt_pk_bf16_f32 v110, v28, v29
  v_cvt_pk_bf16_f32 v111, v30, v31
  buffer_store_dwordx4 v[108:111], v225, s[64:67], s7 offen offset:2048 sc1
  v_cvt_pk_bf16_f32 v96, v32, v33
  v_cvt_pk_bf16_f32 v97, v34, v35
  v_cvt_pk_bf16_f32 v98, v36, v37
  v_cvt_pk_bf16_f32 v99, v38, v39
  buffer_store_dwordx4 v[96:99], v225, s[64:67], s6 offen offset:256 sc1
  v_cvt_pk_bf16_f32 v100, v40, v41
  v_cvt_pk_bf16_f32 v101, v42, v43
  v_cvt_pk_bf16_f32 v102, v44, v45
  v_cvt_pk_bf16_f32 v103, v46, v47
  buffer_store_dwordx4 v[100:103], v225, s[64:67], s6 offen offset:2304 sc1
  v_cvt_pk_bf16_f32 v104, v48, v49
  v_cvt_pk_bf16_f32 v105, v50, v51
  v_cvt_pk_bf16_f32 v106, v52, v53
  v_cvt_pk_bf16_f32 v107, v54, v55
  buffer_store_dwordx4 v[104:107], v225, s[64:67], s7 offen offset:256 sc1
  v_cvt_pk_bf16_f32 v108, v56, v57
  v_cvt_pk_bf16_f32 v109, v58, v59
  v_cvt_pk_bf16_f32 v110, v60, v61
  v_cvt_pk_bf16_f32 v111, v62, v63
  buffer_store_dwordx4 v[108:111], v225, s[64:67], s7 offen offset:2304 sc1
  v_mov_b32 v0, 0
  v_mov_b32 v1, 0
  v_mov_b32 v2, 0
  v_mov_b32 v3, 0
  v_mov_b32 v4, 0
  v_mov_b32 v5, 0
  v_mov_b32 v6, 0
  v_mov_b32 v7, 0
  v_mov_b32 v8, 0
  v_mov_b32 v9, 0
  v_mov_b32 v10, 0
  v_mov_b32 v11, 0
  v_mov_b32 v12, 0
  v_mov_b32 v13, 0
  v_mov_b32 v14, 0
  v_mov_b32 v15, 0
  v_mov_b32 v16, 0
  v_mov_b32 v17, 0
  v_mov_b32 v18, 0
  v_mov_b32 v19, 0
  v_mov_b32 v20, 0
  v_mov_b32 v21, 0
  v_mov_b32 v22, 0
  v_mov_b32 v23, 0
  v_mov_b32 v24, 0
  v_mov_b32 v25, 0
  v_mov_b32 v26, 0
  v_mov_b32 v27, 0
  v_mov_b32 v28, 0
  v_mov_b32 v29, 0
  v_mov_b32 v30, 0
  v_mov_b32 v31, 0
  v_mov_b32 v32, 0
  v_mov_b32 v33, 0
  v_mov_b32 v34, 0
  v_mov_b32 v35, 0
  v_mov_b32 v36, 0
  v_mov_b32 v37, 0
  v_mov_b32 v38, 0
  v_mov_b32 v39, 0
  v_mov_b32 v40, 0
  v_mov_b32 v41, 0
  v_mov_b32 v42, 0
  v_mov_b32 v43, 0
  v_mov_b32 v44, 0
  v_mov_b32 v45, 0
  v_mov_b32 v46, 0
  v_mov_b32 v47, 0
  v_mov_b32 v48, 0
  v_mov_b32 v49, 0
  v_mov_b32 v50, 0
  v_mov_b32 v51, 0
  v_mov_b32 v52, 0
  v_mov_b32 v53, 0
  v_mov_b32 v54, 0
  v_mov_b32 v55, 0
  v_mov_b32 v56, 0
  v_mov_b32 v57, 0
  v_mov_b32 v58, 0
  v_mov_b32 v59, 0
  v_mov_b32 v60, 0
  v_mov_b32 v61, 0
  v_mov_b32 v62, 0
  v_mov_b32 v63, 0
K2_nofinB:
  s_add_u32 s7, s88, 63
  s_cmp_gt_u32 s7, s14
  s_cbranch_scc0 K2_nomaskB
  s_sub_u32 s7, s14, s88
  v_add_u32 v230, s7, v232
  v_mov_b32 v245, s95
  v_cmp_le_i32 s[80:81], 0, v230
  v_cmp_le_i32 s[82:83], 1, v230
  v_cmp_le_i32 s[84:85], 2, v230
  v_cmp_le_i32 s[86:87], 3, v230
  v_cndmask_b32 v64, v245, v64, s[80:81]
  v_cndmask_b32 v65, v245, v65, s[82:83]
  v_cndmask_b32 v66, v245, v66, s[84:85]
  v_cndmask_b32 v67, v245, v67, s[86:87]
  v_cmp_le_i32 s[80:81], 16, v230
  v_cmp_le_i32 s[82:83], 17, v230
  v_cmp_le_i32 s[84:85], 18, v230
  v_cmp_le_i32 s[86:87], 19, v230
  v_cndmask_b32 v68, v245, v68, s[80:81]
  v_cndmask_b32 v69, v245, v69, s[82:83]
  v_cndmask_b32 v70, v245, v70, s[84:85]
  v_cndmask_b32 v71, v245, v71, s[86:87]
  v_cmp_le_i32 s[80:81], 32, v230
  v_cmp_le_i32 s[82:83], 33, v230
  v_cmp_le_i32 s[84:85], 34, v230
  v_cmp_le_i32 s[86:87], 35, v230
  v_cndmask_b32 v72, v245, v72, s[80:81]
  v_cndmask_b32 v73, v245, v73, s[82:83]
  v_cndmask_b32 v74, v245, v74, s[84:85]
  v_cndmask_b32 v75, v245, v75, s[86:87]
  v_cmp_le_i32 s[80:81], 48, v230
  v_cmp_le_i32 s[82:83], 49, v230
  v_cmp_le_i32 s[84:85], 50, v230
  v_cmp_le_i32 s[86:87], 51, v230
  v_cndmask_b32 v76, v245, v76, s[80:81]
  v_cndmask_b32 v77, v245, v77, s[82:83]
  v_cndmask_b32 v78, v245, v78, s[84:85]
  v_cndmask_b32 v79, v245, v79, s[86:87]
  v_cmp_le_i32 s[80:81], -16, v230
  v_cmp_le_i32 s[82:83], -15, v230
  v_cmp_le_i32 s[84:85], -14, v230
  v_cmp_le_i32 s[86:87], -13, v230
  v_cndmask_b32 v192, v245, v192, s[80:81]
  v_cndmask_b32 v193, v245, v193, s[82:83]
  v_cndmask_b32 v194, v245, v194, s[84:85]
  v_cndmask_b32 v195, v245, v195, s[86:87]
  v_cmp_le_i32 s[80:81], 0, v230
  v_cmp_le_i32 s[82:83], 1, v230
  v_cmp_le_i32 s[84:85], 2, v230
  v_cmp_le_i32 s[86:87], 3, v230
  v_cndmask_b32 v196, v245, v196, s[80:81]
  v_cndmask_b32 v197, v245, v197, s[82:83]
  v_cndmask_b32 v198, v245, v198, s[84:85]
  v_cndmask_b32 v199, v245, v199, s[86:87]
  v_cmp_le_i32 s[80:81], 16, v230
  v_cmp_le_i32 s[82:83], 17, v230
  v_cmp_le_i32 s[84:85], 18, v230
  v_cmp_le_i32 s[86:87], 19, v230
  v_cndmask_b32 v200, v245, v200, s[80:81]
  v_cndmask_b32 v201, v245, v201, s[82:83]
  v_cndmask_b32 v202, v245, v202, s[84:85]
  v_cndmask_b32 v203, v245, v203, s[86:87]
  v_cmp_le_i32 s[80:81], 32, v230
  v_cmp_le_i32 s[82:83], 33, v230
  v_cmp_le_i32 s[84:85], 34, v230
  v_cmp_le_i32 s[86:87], 35, v230
  v_cndmask_b32 v204, v245, v204, s[80:81]
  v_cndmask_b32 v205, v245, v205, s[82:83]
  v_cndmask_b32 v206, v245, v206, s[84:85]
  v_cndmask_b32 v207, v245, v207, s[86:87]
K2_nomaskB:
  s_cmp_eq_u32 s15, 0
  s_cbranch_scc1 K2_expB
  v_max3_f32 v234, v64, v65, v66
  v_max3_f32 v234, v234, v67, v68
  v_max3_f32 v234, v234, v69, v70
  v_max3_f32 v234, v234, v71, v72
  v_max3_f32 v234, v234, v73, v74
  v_max3_f32 v234, v234, v75, v76
  v_max3_f32 v234, v234, v77, v78
  v_max_f32 v234, v234, v79
  v_max3_f32 v235, v192, v193, v194
  v_max3_f32 v235, v235, v195, v196
  v_max3_f32 v235, v235, v197, v198
  v_max3_f32 v235, v235, v199, v200
  v_max3_f32 v235, v235, v201, v202
  v_max3_f32 v235, v235, v203, v204
  v_max3_f32 v235, v235, v205, v206
  v_max_f32 v235, v235, v207
  v_mov_b32 v236, v234
  v_mov_b32 v237, v235
  s_nop 1
  v_permlane32_swap_b32 v234, v236
  v_permlane32_swap_b32 v235, v237
  s_nop 1
  v_max_f32 v234, v234, v236
  v_max_f32 v235, v235, v237
  v_mov_b32 v236, v234
  v_mov_b32 v237, v235
  s_nop 1
  v_permlane16_swap_b32 v234, v236
  v_permlane16_swap_b32 v235, v237
  s_nop 1
  v_max_f32 v234, v234, v236
  v_max_f32 v235, v235, v237
  v_max_f32 v234, 0xe0ad78ec, v234
  v_mov_b32 v226, v234
  v_add_f32 v234, 0x42800000, v234
  v_sub_f32 v144, 0, v234
  v_mov_b32 v145, v144
  v_mov_b32 v146, v144
  v_mov_b32 v147, v144
  v_sub_f32 v64, v64, v234
  v_sub_f32 v65, v65, v234
  v_sub_f32 v66, v66, v234
  v_sub_f32 v67, v67, v234
  v_sub_f32 v68, v68, v234
  v_sub_f32 v69, v69, v234
  v_sub_f32 v70, v70, v234
  v_sub_f32 v71, v71, v234
  v_sub_f32 v72, v72, v234
  v_sub_f32 v73, v73, v234
  v_sub_f32 v74, v74, v234
  v_sub_f32 v75, v75, v234
  v_sub_f32 v76, v76, v234
  v_sub_f32 v77, v77, v234
  v_sub_f32 v78, v78, v234
  v_sub_f32 v79, v79, v234
  v_max_f32 v235, 0xe0ad78ec, v235
  v_mov_b32 v227, v235
  v_add_f32 v235, 0x42800000, v235
  v_sub_f32 v148, 0, v235
  v_mov_b32 v149, v148
  v_mov_b32 v150, v148
  v_mov_b32 v151, v148
  v_sub_f32 v192, v192, v235
  v_sub_f32 v193, v193, v235
  v_sub_f32 v194, v194, v235
  v_sub_f32 v195, v195, v235
  v_sub_f32 v196, v196, v235
  v_sub_f32 v197, v197, v235
  v_sub_f32 v198, v198, v235
  v_sub_f32 v199, v199, v235
  v_sub_f32 v200, v200, v235
  v_sub_f32 v201, v201, v235
  v_sub_f32 v202, v202, v235
  v_sub_f32 v203, v203, v235
  v_sub_f32 v204, v204, v235
  v_sub_f32 v205, v205, v235
  v_sub_f32 v206, v206, v235
  v_sub_f32 v207, v207, v235
  s_mov_b32 s15, 0
  s_branch K2_expB
K2_chkB:
  v_max3_f32 v234, v64, v65, v66
  v_max3_f32 v234, v234, v67, v68
  v_max3_f32 v234, v234, v69, v70
  v_max3_f32 v234, v234, v71, v72
  v_max3_f32 v234, v234, v73, v74
  v_max3_f32 v234, v234, v75, v76
  v_max3_f32 v234, v234, v77, v78
  v_max_f32 v234, v234, v79
  v_max3_f32 v235, v192, v193, v194
  v_max3_f32 v235, v235, v195, v196
  v_max3_f32 v235, v235, v197, v198
  v_max3_f32 v235, v235, v199, v200
  v_max3_f32 v235, v235, v201, v202
  v_max3_f32 v235, v235, v203, v204
  v_max3_f32 v235, v235, v205, v206
  v_max_f32 v235, v235, v207
  v_mov_b32 v236, v234
  v_mov_b32 v237, v235
  s_nop 1
  v_permlane32_swap_b32 v234, v236
  v_permlane32_swap_b32 v235, v237
  s_nop 1
  v_max_f32 v234, v234, v236
  v_max_f32 v235, v235, v237
  v_mov_b32 v236, v234
  v_mov_b32 v237, v235
  s_nop 1
  v_permlane16_swap_b32 v234, v236
  v_permlane16_swap_b32 v235, v237
  s_nop 1
  v_max_f32 v234, v234, v236
  v_max_f32 v235, v235, v237
  v_add_f32 v234, 0x42800000, v234
  v_max_f32 v234, 0, v234
  v_exp_f32 v236, -v234
  v_add_f32 v226, v226, v234
  v_sub_f32 v144, v144, v234
  v_mov_b32 v145, v144
  v_mov_b32 v146, v144
  v_mov_b32 v147, v144
  v_mul_f32 v152, v152, v236
  v_mul_f32 v153, v153, v236
  v_mul_f32 v154, v154, v236
  v_mul_f32 v155, v155, v236
  v_mul_f32 v0, v0, v236
  v_mul_f32 v1, v1, v236
  v_mul_f32 v2, v2, v236
  v_mul_f32 v3, v3, v236
  v_mul_f32 v4, v4, v236
  v_mul_f32 v5, v5, v236
  v_mul_f32 v6, v6, v236
  v_mul_f32 v7, v7, v236
  v_mul_f32 v8, v8, v236
  v_mul_f32 v9, v9, v236
  v_mul_f32 v10, v10, v236
  v_mul_f32 v11, v11, v236
  v_mul_f32 v12, v12, v236
  v_mul_f32 v13, v13, v236
  v_mul_f32 v14, v14, v236
  v_mul_f32 v15, v15, v236
  v_mul_f32 v16, v16, v236
  v_mul_f32 v17, v17, v236
  v_mul_f32 v18, v18, v236
  v_mul_f32 v19, v19, v236
  v_mul_f32 v20, v20, v236
  v_mul_f32 v21, v21, v236
  v_mul_f32 v22, v22, v236
  v_mul_f32 v23, v23, v236
  v_mul_f32 v24, v24, v236
  v_mul_f32 v25, v25, v236
  v_mul_f32 v26, v26, v236
  v_mul_f32 v27, v27, v236
  v_mul_f32 v28, v28, v236
  v_mul_f32 v29, v29, v236
  v_mul_f32 v30, v30, v236
  v_mul_f32 v31, v31, v236
  v_sub_f32 v64, v64, v234
  v_sub_f32 v65, v65, v234
  v_sub_f32 v66, v66, v234
  v_sub_f32 v67, v67, v234
  v_sub_f32 v68, v68, v234
  v_sub_f32 v69, v69, v234
  v_sub_f32 v70, v70, v234
  v_sub_f32 v71, v71, v234
  v_sub_f32 v72, v72, v234
  v_sub_f32 v73, v73, v234
  v_sub_f32 v74, v74, v234
  v_sub_f32 v75, v75, v234
  v_sub_f32 v76, v76, v234
  v_sub_f32 v77, v77, v234
  v_sub_f32 v78, v78, v234
  v_sub_f32 v79, v79, v234
  v_add_f32 v235, 0x42800000, v235
  v_max_f32 v235, 0, v235
  v_exp_f32 v237, -v235
  v_add_f32 v227, v227, v235
  v_sub_f32 v148, v148, v235
  v_mov_b32 v149, v148
  v_mov_b32 v150, v148
  v_mov_b32 v151, v148
  v_mul_f32 v156, v156, v237
  v_mul_f32 v157, v157, v237
  v_mul_f32 v158, v158, v237
  v_mul_f32 v159, v159, v237
  v_mul_f32 v32, v32, v237
  v_mul_f32 v33, v33, v237
  v_mul_f32 v34, v34, v237
  v_mul_f32 v35, v35, v237
  v_mul_f32 v36, v36, v237
  v_mul_f32 v37, v37, v237
  v_mul_f32 v38, v38, v237
  v_mul_f32 v39, v39, v237
  v_mul_f32 v40, v40, v237
  v_mul_f32 v41, v41, v237
  v_mul_f32 v42, v42, v237
  v_mul_f32 v43, v43, v237
  v_mul_f32 v44, v44, v237
  v_mul_f32 v45, v45, v237
  v_mul_f32 v46, v46, v237
  v_mul_f32 v47, v47, v237
  v_mul_f32 v48, v48, v237
  v_mul_f32 v49, v49, v237
  v_mul_f32 v50, v50, v237
  v_mul_f32 v51, v51, v237
  v_mul_f32 v52, v52, v237
  v_mul_f32 v53, v53, v237
  v_mul_f32 v54, v54, v237
  v_mul_f32 v55, v55, v237
  v_mul_f32 v56, v56, v237
  v_mul_f32 v57, v57, v237
  v_mul_f32 v58, v58, v237
  v_mul_f32 v59, v59, v237
  v_mul_f32 v60, v60, v237
  v_mul_f32 v61, v61, v237
  v_mul_f32 v62, v62, v237
  v_mul_f32 v63, v63, v237
  v_sub_f32 v192, v192, v235
  v_sub_f32 v193, v193, v235
  v_sub_f32 v194, v194, v235
  v_sub_f32 v195, v195, v235
  v_sub_f32 v196, v196, v235
  v_sub_f32 v197, v197, v235
  v_sub_f32 v198, v198, v235
  v_sub_f32 v199, v199, v235
  v_sub_f32 v200, v200, v235
  v_sub_f32 v201, v201, v235
  v_sub_f32 v202, v202, v235
  v_sub_f32 v203, v203, v235
  v_sub_f32 v204, v204, v235
  v_sub_f32 v205, v205, v235
  v_sub_f32 v206, v206, v235
  v_sub_f32 v207, v207, v235
  v_exp_f32 v234, v64
  v_exp_f32 v235, v65
  v_exp_f32 v236, v66
  v_exp_f32 v237, v67
  v_exp_f32 v238, v68
  v_exp_f32 v239, v69
  v_cvt_pk_bf16_f32 v96, v234, v235
  v_exp_f32 v240, v70
  v_exp_f32 v241, v71
  v_cvt_pk_bf16_f32 v97, v236, v237
  v_exp_f32 v234, v72
  v_exp_f32 v235, v73
  v_cvt_pk_bf16_f32 v98, v238, v239
  v_or3_b32 v228, v96, v97, v98
  v_exp_f32 v236, v74
  v_exp_f32 v237, v75
  v_cvt_pk_bf16_f32 v99, v240, v241
  v_exp_f32 v238, v76
  v_exp_f32 v239, v77
  v_cvt_pk_bf16_f32 v100, v234, v235
  v_or3_b32 v228, v228, v99, v100
  v_exp_f32 v240, v78
  v_exp_f32 v241, v79
  v_cvt_pk_bf16_f32 v101, v236, v237
  v_exp_f32 v234, v192
  v_exp_f32 v235, v193
  v_cvt_pk_bf16_f32 v102, v238, v239
  v_or3_b32 v228, v228, v101, v102
  v_exp_f32 v236, v194
  v_exp_f32 v237, v195
  v_cvt_pk_bf16_f32 v103, v240, v241
  v_exp_f32 v238, v196
  v_exp_f32 v239, v197
  v_cvt_pk_bf16_f32 v104, v234, v235
  v_or3_b32 v228, v228, v103, v104
  v_exp_f32 v240, v198
  v_exp_f32 v241, v199
  v_cvt_pk_bf16_f32 v105, v236, v237
  v_exp_f32 v234, v200
  v_exp_f32 v235, v201
  v_cvt_pk_bf16_f32 v106, v238, v239
  v_or3_b32 v228, v228, v105, v106
  v_exp_f32 v236, v202
  v_exp_f32 v237, v203
  v_cvt_pk_bf16_f32 v107, v240, v241
  v_exp_f32 v238, v204
  v_exp_f32 v239, v205
  v_cvt_pk_bf16_f32 v108, v234, v235
  v_or3_b32 v228, v228, v107, v108
  v_exp_f32 v240, v206
  v_exp_f32 v241, v207
  v_cvt_pk_bf16_f32 v109, v236, v237
  v_cvt_pk_bf16_f32 v110, v238, v239
  v_or3_b32 v228, v228, v109, v110
  v_cvt_pk_bf16_f32 v111, v240, v241
  v_or_b32 v228, v228, v111
  s_branch K2_okB
K2_postB:
  s_cmp_eq_u32 s12, s13
  s_cbranch_scc0 K2_noswB
  ds_read_b128 v[112:115], v249 offset:0
  ds_read_b128 v[116:119], v249 offset:1024
  ds_read_b128 v[120:123], v249 offset:2048
  ds_read_b128 v[124:127], v249 offset:3072
  ds_read_b128 v[128:131], v249 offset:4096
  ds_read_b128 v[132:135], v249 offset:5120
  ds_read_b128 v[136:139], v249 offset:6144
  ds_read_b128 v[140:143], v249 offset:7168
  v_mov_b32 v144, 0
  v_mov_b32 v145, 0
  v_mov_b32 v146, 0
  v_mov_b32 v147, 0
  v_mov_b32 v148, 0
  v_mov_b32 v149, 0
  v_mov_b32 v150, 0
  v_mov_b32 v151, 0
  s_mov_b32 s15, 1
  s_mov_b32 s72, 1
  s_mov_b32 s14, s91
  s_waitcnt lgkmcnt(0)
K2_noswB:
  s_cmp_eq_u32 s12, 15
  s_cbranch_scc1 K2_pf
  s_branch K2_postretB
K2_specZ:
  s_cmp_eq_u32 s72, 0
  s_cbranch_scc1 K2_nofinZ
  s_nop 3
  v_rcp_f32 v234, v152
  v_rcp_f32 v235, v156
  v_mov_b32 v152, 0
  v_mov_b32 v153, 0
  v_mov_b32 v154, 0
  v_mov_b32 v155, 0
  v_mov_b32 v156, 0
  v_mov_b32 v157, 0
  v_mov_b32 v158, 0
  v_mov_b32 v159, 0
  s_mov_b32 s72, 0
  v_mul_f32 v0, v0, v234
  v_mul_f32 v1, v1, v234
  v_mul_f32 v2, v2, v234
  v_mul_f32 v3, v3, v234
  v_mul_f32 v4, v4, v234
  v_mul_f32 v5, v5, v234
  v_mul_f32 v6, v6, v234
  v_mul_f32 v7, v7, v234
  v_mul_f32 v8, v8, v234
  v_mul_f32 v9, v9, v234
  v_mul_f32 v10, v10, v234
  v_mul_f32 v11, v11, v234
  v_mul_f32 v12, v12, v234
  v_mul_f32 v13, v13, v234
  v_mul_f32 v14, v14, v234
  v_mul_f32 v15, v15, v234
  v_mul_f32 v16, v16, v234
  v_mul_f32 v17, v17, v234
  v_mul_f32 v18, v18, v234
  v_mul_f32 v19, v19, v234
  v_mul_f32 v20, v20, v234
  v_mul_f32 v21, v21, v234
  v_mul_f32 v22, v22, v234
  v_mul_f32 v23, v23, v234
  v_mul_f32 v24, v24, v234
  v_mul_f32 v25, v25, v234
  v_mul_f32 v26, v26, v234
  v_mul_f32 v27, v27, v234
  v_mul_f32 v28, v28, v234
  v_mul_f32 v29, v29, v234
  v_mul_f32 v30, v30, v234
  v_mul_f32 v31, v31, v234
  v_mul_f32 v32, v32, v235
  v_mul_f32 v33, v33, v235
  v_mul_f32 v34, v34, v235
  v_mul_f32 v35, v35, v235
  v_mul_f32 v36, v36, v235
  v_mul_f32 v37, v37, v235
  v_mul_f32 v38, v38, v235
  v_mul_f32 v39, v39, v235
  v_mul_f32 v40, v40, v235
  v_mul_f32 v41, v41, v235
  v_mul_f32 v42, v42, v235
  v_mul_f32 v43, v43, v235
  v_mul_f32 v44, v44, v235
  v_mul_f32 v45, v45, v235
  v_mul_f32 v46, v46, v235
  v_mul_f32 v47, v47, v235
  v_mul_f32 v48, v48, v235
  v_mul_f32 v49, v49, v235
  v_mul_f32 v50, v50, v235
  v_mul_f32 v51, v51, v235
  v_mul_f32 v52, v52, v235
  v_mul_f32 v53, v53, v235
  v_mul_f32 v54, v54, v235
  v_mul_f32 v55, v55, v235
  v_mul_f32 v56, v56, v235
  v_mul_f32 v57, v57, v235
  v_mul_f32 v58, v58, v235
  v_mul_f32 v59, v59, v235
  v_mul_f32 v60, v60, v235
  v_mul_f32 v61, v61, v235
  v_mul_f32 v62, v62, v235
  v_mul_f32 v63, v63, v235
  s_lshl_b32 s6, s93, 13
  s_lshl_b32 s7, s4, 13
  s_add_u32 s6, s6, s7
  s_add_u32 s6, s6, 33554432
  s_add_u32 s7, s6, 4096
  v_cvt_pk_bf16_f32 v96, v0, v1
  v_cvt_pk_bf16_f32 v97, v2, v3
  v_cvt_pk_bf16_f32 v98, v4, v5
  v_cvt_pk_bf16_f32 v99, v6, v7
  buffer_store_dwordx4 v[96:99], v225, s[64:67], s6 offen offset:0 sc1
  v_cvt_pk_bf16_f32 v100, v8, v9
  v_cvt_pk_bf16_f32 v101, v10, v11
  v_cvt_pk_bf16_f32 v102, v12, v13
  v_cvt_pk_bf16_f32 v103, v14, v15
  buffer_store_dwordx4 v[100:103], v225, s[64:67], s6 offen offset:2048 sc1
  v_cvt_pk_bf16_f32 v104, v16, v17
  v_cvt_pk_bf16_f32 v105, v18, v19
  v_cvt_pk_bf16_f32 v106, v20, v21
  v_cvt_pk_bf16_f32 v107, v22, v23
  buffer_store_dwordx4 v[104:107], v225, s[64:67], s7 offen offset:0 sc1
  v_cvt_pk_bf16_f32 v108, v24, v25
  v_cvt_pk_bf16_f32 v109, v26, v27
  v_cvt_pk_bf16_f32 v110, v28, v29
  v_cvt_pk_bf16_f32 v111, v30, v31
  buffer_store_dwordx4 v[108:111], v225, s[64:67], s7 offen offset:2048 sc1
  v_cvt_pk_bf16_f32 v96, v32, v33
  v_cvt_pk_bf16_f32 v97, v34, v35
  v_cvt_pk_bf16_f32 v98, v36, v37
  v_cvt_pk_bf16_f32 v99, v38, v39
  buffer_store_dwordx4 v[96:99], v225, s[64:67], s6 offen offset:256 sc1
  v_cvt_pk_bf16_f32 v100, v40, v41
  v_cvt_pk_bf16_f32 v101, v42, v43
  v_cvt_pk_bf16_f32 v102, v44, v45
  v_cvt_pk_bf16_f32 v103, v46, v47
  buffer_store_dwordx4 v[100:103], v225, s[64:67], s6 offen offset:2304 sc1
  v_cvt_pk_bf16_f32 v104, v48, v49
  v_cvt_pk_bf16_f32 v105, v50, v51
  v_cvt_pk_bf16_f32 v106, v52, v53
  v_cvt_pk_bf16_f32 v107, v54, v55
  buffer_store_dwordx4 v[104:107], v225, s[64:67], s7 offen offset:256 sc1
  v_cvt_pk_bf16_f32 v108, v56, v57
  v_cvt_pk_bf16_f32 v109, v58, v59
  v_cvt_pk_bf16_f32 v110, v60, v61
  v_cvt_pk_bf16_f32 v111, v62, v63
  buffer_store_dwordx4 v[108:111], v225, s[64:67], s7 offen offset:2304 sc1
  v_mov_b32 v0, 0
  v_mov_b32 v1, 0
  v_mov_b32 v2, 0
  v_mov_b32 v3, 0
  v_mov_b32 v4, 0
  v_mov_b32 v5, 0
  v_mov_b32 v6, 0
  v_mov_b32 v7, 0
  v_mov_b32 v8, 0
  v_mov_b32 v9, 0
  v_mov_b32 v10, 0
  v_mov_b32 v11, 0
  v_mov_b32 v12, 0
  v_mov_b32 v13, 0
  v_mov_b32 v14, 0
  v_mov_b32 v15, 0
  v_mov_b32 v16, 0
  v_mov_b32 v17, 0
  v_mov_b32 v18, 0
  v_mov_b32 v19, 0
  v_mov_b32 v20, 0
  v_mov_b32 v21, 0
  v_mov_b32 v22, 0
  v_mov_b32 v23, 0
  v_mov_b32 v24, 0
  v_mov_b32 v25, 0
  v_mov_b32 v26, 0
  v_mov_b32 v27, 0
  v_mov_b32 v28, 0
  v_mov_b32 v29, 0
  v_mov_b32 v30, 0
  v_mov_b32 v31, 0
  v_mov_b32 v32, 0
  v_mov_b32 v33, 0
  v_mov_b32 v34, 0
  v_mov_b32 v35, 0
  v_mov_b32 v36, 0
  v_mov_b32 v37, 0
  v_mov_b32 v38, 0
  v_mov_b32 v39, 0
  v_mov_b32 v40, 0
  v_mov_b32 v41, 0
  v_mov_b32 v42, 0
  v_mov_b32 v43, 0
  v_mov_b32 v44, 0
  v_mov_b32 v45, 0
  v_mov_b32 v46, 0
  v_mov_b32 v47, 0
  v_mov_b32 v48, 0
  v_mov_b32 v49, 0
  v_mov_b32 v50, 0
  v_mov_b32 v51, 0
  v_mov_b32 v52, 0
  v_mov_b32 v53, 0
  v_mov_b32 v54, 0
  v_mov_b32 v55, 0
  v_mov_b32 v56, 0
  v_mov_b32 v57, 0
  v_mov_b32 v58, 0
  v_mov_b32 v59, 0
  v_mov_b32 v60, 0
  v_mov_b32 v61, 0
  v_mov_b32 v62, 0
  v_mov_b32 v63, 0
K2_nofinZ:
  s_add_u32 s7, s88, 63
  s_cmp_gt_u32 s7, s14
  s_cbranch_scc0 K2_nomaskZ
  s_sub_u32 s7, s14, s88
  v_add_u32 v230, s7, v232
  v_mov_b32 v245, s95
  v_cmp_le_i32 s[80:81], 0, v230
  v_cmp_le_i32 s[82:83], 1, v230
  v_cmp_le_i32 s[84:85], 2, v230
  v_cmp_le_i32 s[86:87], 3, v230
  v_cndmask_b32 v64, v245, v64, s[80:81]
  v_cndmask_b32 v65, v245, v65, s[82:83]
  v_cndmask_b32 v66, v245, v66, s[84:85]
  v_cndmask_b32 v67, v245, v67, s[86:87]
  v_cmp_le_i32 s[80:81], 16, v230
  v_cmp_le_i32 s[82:83], 17, v230
  v_cmp_le_i32 s[84:85], 18, v230
  v_cmp_le_i32 s[86:87], 19, v230
  v_cndmask_b32 v68, v245, v68, s[80:81]
  v_cndmask_b32 v69, v245, v69, s[82:83]
  v_cndmask_b32 v70, v245, v70, s[84:85]
  v_cndmask_b32 v71, v245, v71, s[86:87]
  v_cmp_le_i32 s[80:81], 32, v230
  v_cmp_le_i32 s[82:83], 33, v230
  v_cmp_le_i32 s[84:85], 34, v230
  v_cmp_le_i32 s[86:87], 35, v230
  v_cndmask_b32 v72, v245, v72, s[80:81]
  v_cndmask_b32 v73, v245, v73, s[82:83]
  v_cndmask_b32 v74, v245, v74, s[84:85]
  v_cndmask_b32 v75, v245, v75, s[86:87]
  v_cmp_le_i32 s[80:81], 48, v230
  v_cmp_le_i32 s[82:83], 49, v230
  v_cmp_le_i32 s[84:85], 50, v230
  v_cmp_le_i32 s[86:87], 51, v230
  v_cndmask_b32 v76, v245, v76, s[80:81]
  v_cndmask_b32 v77, v245, v77, s[82:83]
  v_cndmask_b32 v78, v245, v78, s[84:85]
  v_cndmask_b32 v79, v245, v79, s[86:87]
  v_cmp_le_i32 s[80:81], -16, v230
  v_cmp_le_i32 s[82:83], -15, v230
  v_cmp_le_i32 s[84:85], -14, v230
  v_cmp_le_i32 s[86:87], -13, v230
  v_cndmask_b32 v80, v245, v80, s[80:81]
  v_cndmask_b32 v81, v245, v81, s[82:83]
  v_cndmask_b32 v82, v245, v82, s[84:85]
  v_cndmask_b32 v83, v245, v83, s[86:87]
  v_cmp_le_i32 s[80:81], 0, v230
  v_cmp_le_i32 s[82:83], 1, v230
  v_cmp_le_i32 s[84:85], 2, v230
  v_cmp_le_i32 s[86:87], 3, v230
  v_cndmask_b32 v84, v245, v84, s[80:81]
  v_cndmask_b32 v85, v245, v85, s[82:83]
  v_cndmask_b32 v86, v245, v86, s[84:85]
  v_cndmask_b32 v87, v245, v87, s[86:87]
  v_cmp_le_i32 s[80:81], 16, v230
  v_cmp_le_i32 s[82:83], 17, v230
  v_cmp_le_i32 s[84:85], 18, v230
  v_cmp_le_i32 s[86:87], 19, v230
  v_cndmask_b32 v88, v245, v88, s[80:81]
  v_cndmask_b32 v89, v245, v89, s[82:83]
  v_cndmask_b32 v90, v245, v90, s[84:85]
  v_cndmask_b32 v91, v245, v91, s[86:87]
  v_cmp_le_i32 s[80:81], 32, v230
  v_cmp_le_i32 s[82:83], 33, v230
  v_cmp_le_i32 s[84:85], 34, v230
  v_cmp_le_i32 s[86:87], 35, v230
  v_cndmask_b32 v92, v245, v92, s[80:81]
  v_cndmask_b32 v93, v245, v93, s[82:83]
  v_cndmask_b32 v94, v245, v94, s[84:85]
  v_cndmask_b32 v95, v245, v95, s[86:87]
K2_nomaskZ:
  s_cmp_eq_u32 s15, 0
  s_cbranch_scc1 K2_expZ
  v_max3_f32 v234, v64, v65, v66
  v_max3_f32 v234, v234, v67, v68
  v_max3_f32 v234, v234, v69, v70
  v_max3_f32 v234, v234, v71, v72
  v_max3_f32 v234, v234, v73, v74
  v_max3_f32 v234, v234, v75, v76
  v_max3_f32 v234, v234, v77, v78
  v_max_f32 v234, v234, v79
  v_max3_f32 v235, v80, v81, v82
  v_max3_f32 v235, v235, v83, v84
  v_max3_f32 v235, v235, v85, v86
  v_max3_f32 v235, v235, v87, v88
  v_max3_f32 v235, v235, v89, v90
  v_max3_f32 v235, v235, v91, v92
  v_max3_f32 v235, v235, v93, v94
  v_max_f32 v235, v235, v95
  v_mov_b32 v236, v234
  v_mov_b32 v237, v235
  s_nop 1
  v_permlane32_swap_b32 v234, v236
  v_permlane32_swap_b32 v235, v237
  s_nop 1
  v_max_f32 v234, v234, v236
  v_max_f32 v235, v235, v237
  v_mov_b32 v236, v234
  v_mov_b32 v237, v235
  s_nop 1
  v_permlane16_swap_b32 v234, v236
  v_permlane16_swap_b32 v235, v237
  s_nop 1
  v_max_f32 v234, v234, v236
  v_max_f32 v235, v235, v237
  v_max_f32 v234, 0xe0ad78ec, v234
  v_mov_b32 v226, v234
  v_add_f32 v234, 0x42800000, v234
  v_sub_f32 v144, 0, v234
  v_mov_b32 v145, v144
  v_mov_b32 v146, v144
  v_mov_b32 v147, v144
  v_sub_f32 v64, v64, v234
  v_sub_f32 v65, v65, v234
  v_sub_f32 v66, v66, v234
  v_sub_f32 v67, v67, v234
  v_sub_f32 v68, v68, v234
  v_sub_f32 v69, v69, v234
  v_sub_f32 v70, v70, v234
  v_sub_f32 v71, v71, v234
  v_sub_f32 v72, v72, v234
  v_sub_f32 v73, v73, v234
  v_sub_f32 v74, v74, v234
  v_sub_f32 v75, v75, v234
  v_sub_f32 v76, v76, v234
  v_sub_f32 v77, v77, v234
  v_sub_f32 v78, v78, v234
  v_sub_f32 v79, v79, v234
  v_max_f32 v235, 0xe0ad78ec, v235
  v_mov_b32 v227, v235
  v_add_f32 v235, 0x42800000, v235
  v_sub_f32 v148, 0, v235
  v_mov_b32 v149, v148
  v_mov_b32 v150, v148
  v_mov_b32 v151, v148
  v_sub_f32 v80, v80, v235
  v_sub_f32 v81, v81, v235
  v_sub_f32 v82, v82, v235
  v_sub_f32 v83, v83, v235
  v_sub_f32 v84, v84, v235
  v_sub_f32 v85, v85, v235
  v_sub_f32 v86, v86, v235
  v_sub_f32 v87, v87, v235
  v_sub_f32 v88, v88, v235
  v_sub_f32 v89, v89, v235
  v_sub_f32 v90, v90, v235
  v_sub_f32 v91, v91, v235
  v_sub_f32 v92, v92, v235
  v_sub_f32 v93, v93, v235
  v_sub_f32 v94, v94, v235
  v_sub_f32 v95, v95, v235
  s_mov_b32 s15, 0
  s_branch K2_expZ
K2_chkZ:
  v_max3_f32 v234, v64, v65, v66
  v_max3_f32 v234, v234, v67, v68
  v_max3_f32 v234, v234, v69, v70
  v_max3_f32 v234, v234, v71, v72
  v_max3_f32 v234, v234, v73, v74
  v_max3_f32 v234, v234, v75, v76
  v_max3_f32 v234, v234, v77, v78
  v_max_f32 v234, v234, v79
  v_max3_f32 v235, v80, v81, v82
  v_max3_f32 v235, v235, v83, v84
  v_max3_f32 v235, v235, v85, v86
  v_max3_f32 v235, v235, v87, v88
  v_max3_f32 v235, v235, v89, v90
  v_max3_f32 v235, v235, v91, v92
  v_max3_f32 v235, v235, v93, v94
  v_max_f32 v235, v235, v95
  v_mov_b32 v236, v234
  v_mov_b32 v237, v235
  s_nop 1
  v_permlane32_swap_b32 v234, v236
  v_permlane32_swap_b32 v235, v237
  s_nop 1
  v_max_f32 v234, v234, v236
  v_max_f32 v235, v235, v237
  v_mov_b32 v236, v234
  v_mov_b32 v237, v235
  s_nop 1
  v_permlane16_swap_b32 v234, v236
  v_permlane16_swap_b32 v235, v237
  s_nop 1
  v_max_f32 v234, v234, v236
  v_max_f32 v235, v235, v237
  v_add_f32 v234, 0x42800000, v234
  v_max_f32 v234, 0, v234
  v_exp_f32 v236, -v234
  v_add_f32 v226, v226, v234
  v_sub_f32 v144, v144, v234
  v_mov_b32 v145, v144
  v_mov_b32 v146, v144
  v_mov_b32 v147, v144
  v_mul_f32 v152, v152, v236
  v_mul_f32 v153, v153, v236
  v_mul_f32 v154, v154, v236
  v_mul_f32 v155, v155, v236
  v_mul_f32 v0, v0, v236
  v_mul_f32 v1, v1, v236
  v_mul_f32 v2, v2, v236
  v_mul_f32 v3, v3, v236
  v_mul_f32 v4, v4, v236
  v_mul_f32 v5, v5, v236
  v_mul_f32 v6, v6, v236
  v_mul_f32 v7, v7, v236
  v_mul_f32 v8, v8, v236
  v_mul_f32 v9, v9, v236
  v_mul_f32 v10, v10, v236
  v_mul_f32 v11, v11, v236
  v_mul_f32 v12, v12, v236
  v_mul_f32 v13, v13, v236
  v_mul_f32 v14, v14, v236
  v_mul_f32 v15, v15, v236
  v_mul_f32 v16, v16, v236
  v_mul_f32 v17, v17, v236
  v_mul_f32 v18, v18, v236
  v_mul_f32 v19, v19, v236
  v_mul_f32 v20, v20, v236
  v_mul_f32 v21, v21, v236
  v_mul_f32 v22, v22, v236
  v_mul_f32 v23, v23, v236
  v_mul_f32 v24, v24, v236
  v_mul_f32 v25, v25, v236
  v_mul_f32 v26, v26, v236
  v_mul_f32 v27, v27, v236
  v_mul_f32 v28, v28, v236
  v_mul_f32 v29, v29, v236
  v_mul_f32 v30, v30, v236
  v_mul_f32 v31, v31, v236
  v_sub_f32 v64, v64, v234
  v_sub_f32 v65, v65, v234
  v_sub_f32 v66, v66, v234
  v_sub_f32 v67, v67, v234
  v_sub_f32 v68, v68, v234
  v_sub_f32 v69, v69, v234
  v_sub_f32 v70, v70, v234
  v_sub_f32 v71, v71, v234
  v_sub_f32 v72, v72, v234
  v_sub_f32 v73, v73, v234
  v_sub_f32 v74, v74, v234
  v_sub_f32 v75, v75, v234
  v_sub_f32 v76, v76, v234
  v_sub_f32 v77, v77, v234
  v_sub_f32 v78, v78, v234
  v_sub_f32 v79, v79, v234
  v_add_f32 v235, 0x42800000, v235
  v_max_f32 v235, 0, v235
  v_exp_f32 v237, -v235
  v_add_f32 v227, v227, v235
  v_sub_f32 v148, v148, v235
  v_mov_b32 v149, v148
  v_mov_b32 v150, v148
  v_mov_b32 v151, v148
  v_mul_f32 v156, v156, v237
  v_mul_f32 v157, v157, v237
  v_mul_f32 v158, v158, v237
  v_mul_f32 v159, v159, v237
  v_mul_f32 v32, v32, v237
  v_mul_f32 v33, v33, v237
  v_mul_f32 v34, v34, v237
  v_mul_f32 v35, v35, v237
  v_mul_f32 v36, v36, v237
  v_mul_f32 v37, v37, v237
  v_mul_f32 v38, v38, v237
  v_mul_f32 v39, v39, v237
  v_mul_f32 v40, v40, v237
  v_mul_f32 v41, v41, v237
  v_mul_f32 v42, v42, v237
  v_mul_f32 v43, v43, v237
  v_mul_f32 v44, v44, v237
  v_mul_f32 v45, v45, v237
  v_mul_f32 v46, v46, v237
  v_mul_f32 v47, v47, v237
  v_mul_f32 v48, v48, v237
  v_mul_f32 v49, v49, v237
  v_mul_f32 v50, v50, v237
  v_mul_f32 v51, v51, v237
  v_mul_f32 v52, v52, v237
  v_mul_f32 v53, v53, v237
  v_mul_f32 v54, v54, v237
  v_mul_f32 v55, v55, v237
  v_mul_f32 v56, v56, v237
  v_mul_f32 v57, v57, v237
  v_mul_f32 v58, v58, v237
  v_mul_f32 v59, v59, v237
  v_mul_f32 v60, v60, v237
  v_mul_f32 v61, v61, v237
  v_mul_f32 v62, v62, v237
  v_mul_f32 v63, v63, v237
  v_sub_f32 v80, v80, v235
  v_sub_f32 v81, v81, v235
  v_sub_f32 v82, v82, v235
  v_sub_f32 v83, v83, v235
  v_sub_f32 v84, v84, v235
  v_sub_f32 v85, v85, v235
  v_sub_f32 v86, v86, v235
  v_sub_f32 v87, v87, v235
  v_sub_f32 v88, v88, v235
  v_sub_f32 v89, v89, v235
  v_sub_f32 v90, v90, v235
  v_sub_f32 v91, v91, v235
  v_sub_f32 v92, v92, v235
  v_sub_f32 v93, v93, v235
  v_sub_f32 v94, v94, v235
  v_sub_f32 v95, v95, v235
  v_exp_f32 v234, v64
  v_exp_f32 v235, v65
  v_exp_f32 v236, v66
  v_exp_f32 v237, v67
  v_exp_f32 v238, v68
  v_exp_f32 v239, v69
  v_cvt_pk_bf16_f32 v96, v234, v235
  v_exp_f32 v240, v70
  v_exp_f32 v241, v71
  v_cvt_pk_bf16_f32 v97, v236, v237
  v_exp_f32 v234, v72
  v_exp_f32 v235, v73
  v_cvt_pk_bf16_f32 v98, v238, v239
  v_or3_b32 v228, v96, v97, v98
  v_exp_f32 v236, v74
  v_exp_f32 v237, v75
  v_cvt_pk_bf16_f32 v99, v240, v241
  v_exp_f32 v238, v76
  v_exp_f32 v239, v77
  v_cvt_pk_bf16_f32 v100, v234, v235
  v_or3_b32 v228, v228, v99, v100
  v_exp_f32 v240, v78
  v_exp_f32 v241, v79
  v_cvt_pk_bf16_f32 v101, v236, v237
  v_exp_f32 v234, v80
  v_exp_f32 v235, v81
  v_cvt_pk_bf16_f32 v102, v238, v239
  v_or3_b32 v228, v228, v101, v102
  v_exp_f32 v236, v82
  v_exp_f32 v237, v83
  v_cvt_pk_bf16_f32 v103, v240, v241
  v_exp_f32 v238, v84
  v_exp_f32 v239, v85
  v_cvt_pk_bf16_f32 v104, v234, v235
  v_or3_b32 v228, v228, v103, v104
  v_exp_f32 v240, v86
  v_exp_f32 v241, v87
  v_cvt_pk_bf16_f32 v105, v236, v237
  v_exp_f32 v234, v88
  v_exp_f32 v235, v89
  v_cvt_pk_bf16_f32 v106, v238, v239
  v_or3_b32 v228, v228, v105, v106
  v_exp_f32 v236, v90
  v_exp_f32 v237, v91
  v_cvt_pk_bf16_f32 v107, v240, v241
  v_exp_f32 v238, v92
  v_exp_f32 v239, v93
  v_cvt_pk_bf16_f32 v108, v234, v235
  v_or3_b32 v228, v228, v107, v108
  v_exp_f32 v240, v94
  v_exp_f32 v241, v95
  v_cvt_pk_bf16_f32 v109, v236, v237
  v_cvt_pk_bf16_f32 v110, v238, v239
  v_or3_b32 v228, v228, v109, v110
  v_cvt_pk_bf16_f32 v111, v240, v241
  v_or_b32 v228, v228, v111
  s_branch K2_okZ
K2_pf:
  s_lshl_b32 s6, s2, 3
  s_add_u32 s6, s6, s3
  s_lshl_b32 s7, s6, 11
  s_mov_b32 s52, s26
  s_and_b32 s53, s27, 0xffff
  s_mov_b32 s54, 4194304
  s_mov_b32 s55, 0x00020000
  buffer_load_dwordx4 v[216:219], v231, s[52:55], s7 offen
  buffer_load_dwordx4 v[216:219], v231, s[52:55], s7 offen offset:1024
  s_and_b32 s7, s6, 511
  s_lshl_b32 s7, s7, 10
  s_bitcmp1_b32 s6, 9
  s_cselect_b32 s56, s38, s40
  s_cselect_b32 s57, s39, s41
  s_and_b32 s57, s57, 0xffff
  s_mov_b32 s58, 524288
  s_mov_b32 s59, 0x00020000
  buffer_load_dwordx4 v[216:219], v231, s[56:59], s7 offen
  s_branch K2_postretB
K2e:

.section .rodata,"a"
.p2align 6
.amdhsa_kernel k2_kernel
  .amdhsa_next_free_vgpr 256
  .amdhsa_next_free_sgpr 102
  .amdhsa_accum_offset 256
  .amdhsa_group_segment_fixed_size 0
  .amdhsa_kernarg_size 144
  .amdhsa_user_sgpr_count 2
  .amdhsa_user_sgpr_kernarg_segment_ptr 1
  .amdhsa_system_sgpr_workgroup_id_x 1
.end_amdhsa_kernel

.text
.globl k3_kernel
.p2align 8
.type k3_kernel,@function
k3_kernel:
  s_cmp_ge_u32 s2, 256
  s_cbranch_scc1 K3_exit
  s_load_dwordx16 s[16:31], s[0:1], 0
  s_load_dwordx16 s[32:47], s[0:1], 64
  s_load_dwordx4 s[48:51], s[0:1], 128
  v_lshrrev_b32 v1, 6, v0
  s_nop 0
  v_readfirstlane_b32 s3, v1
  v_mbcnt_lo_u32_b32 v255, -1, 0
  v_mbcnt_hi_u32_b32 v255, -1, v255
  s_bfe_u32 s6, s2, 0x20001
  s_lshl_b32 s6, s6, 3
  s_bfe_u32 s7, s2, 0x30003
  s_add_u32 s4, s6, s7
  s_and_b32 s6, s2, 1
  s_lshl_b32 s6, s6, 2
  s_lshr_b32 s7, s2, 6
  s_add_u32 s72, s6, s7
  v_lshlrev_b32 v240, 4, v255
  s_mul_i32 s10, s3, 20480
  v_lshrrev_b32 v250, 2, v255
  v_lshlrev_b32 v241, 10, v250
  v_and_b32 v250, 3, v255
  v_lshrrev_b32 v251, 4, v255
  v_xor_b32 v251, v250, v251
  v_lshl_add_u32 v243, v251, 4, v241
  v_lshl_add_u32 v241, v250, 4, v241
  s_lshl_b32 s15, s72, 16
  s_lshl_b32 s6, s3, 7
  s_add_u32 s15, s15, s6
  s_lshl_b32 s14, s4, 17
  s_lshl_b32 s6, s3, 13
  s_add_u32 s14, s14, s6
  s_add_u32 s14, s14, 60817408
  s_lshl_b32 s11, s4, 19
  s_lshl_b32 s6, s3, 15
  s_add_u32 s11, s11, s6
  s_add_u32 s11, s11, 33554432
  s_lshl_b32 s12, s3, 19
  s_lshl_b32 s6, s72, 7
  s_add_u32 s12, s12, s6
  s_waitcnt lgkmcnt(0)
  s_mov_b32 s64, s50
  s_and_b32 s65, s51, 0xffff
  s_mov_b32 s66, 67108864
  s_mov_b32 s67, 0x00020000
  s_mov_b32 s52, s26
  s_and_b32 s53, s27, 0xffff
  s_mov_b32 s54, 4194304
  s_mov_b32 s55, 0x00020000
  s_mov_b32 s56, s38
  s_and_b32 s57, s39, 0xffff
  s_mov_b32 s58, 524288
  s_mov_b32 s59, 0x00020000
  s_mov_b32 s60, s40
  s_and_b32 s61, s41, 0xffff
  s_mov_b32 s62, 524288
  s_mov_b32 s63, 0x00020000
  s_add_u32 m0, s10, 12288
  s_add_u32 s6, s15, 0
  buffer_load_dwordx4 v243, s[56:59], s6 offen lds
  s_add_u32 m0, s10, 13312
  s_add_u32 s6, s15, 16384
  buffer_load_dwordx4 v243, s[56:59], s6 offen lds
  s_add_u32 m0, s10, 14336
  s_add_u32 s6, s15, 32768
  buffer_load_dwordx4 v243, s[56:59], s6 offen lds
  s_add_u32 m0, s10, 15360
  s_add_u32 s6, s15, 49152
  buffer_load_dwordx4 v243, s[56:59], s6 offen lds
  s_add_u32 m0, s10, 16384
  s_add_u32 s6, s15, 0
  buffer_load_dwordx4 v243, s[60:63], s6 offen lds
  s_add_u32 m0, s10, 17408
  s_add_u32 s6, s15, 16384
  buffer_load_dwordx4 v243, s[60:63], s6 offen lds
  s_add_u32 m0, s10, 18432
  s_add_u32 s6, s15, 32768
  buffer_load_dwordx4 v243, s[60:63], s6 offen lds
  s_add_u32 m0, s10, 19456
  s_add_u32 s6, s15, 49152
  buffer_load_dwordx4 v243, s[60:63], s6 offen lds
  s_add_u32 s6, s14, 0
  s_add_u32 s7, s14, 65536
  buffer_load_dwordx4 v[176:179], v240, s[64:67], s6 offen
  buffer_load_dwordx4 v[180:183], v240, s[64:67], s7 offen
  s_add_u32 s6, s14, 1024
  s_add_u32 s7, s14, 66560
  buffer_load_dwordx4 v[184:187], v240, s[64:67], s6 offen
  buffer_load_dwordx4 v[188:191], v240, s[64:67], s7 offen
  s_add_u32 s6, s14, 2048
  s_add_u32 s7, s14, 67584
  buffer_load_dwordx4 v[192:195], v240, s[64:67], s6 offen
  buffer_load_dwordx4 v[196:199], v240, s[64:67], s7 offen
  s_add_u32 s6, s11, 0
  s_add_u32 s7, s11, 262144
  buffer_load_dwordx4 v[128:131], v240, s[64:67], s6 offen
  buffer_load_dwordx4 v[132:135], v240, s[64:67], s7 offen
  s_add_u32 m0, s10, 0
  s_add_u32 s8, s12, 0
  buffer_load_dwordx4 v241, s[52:55], s8 offen lds
  s_add_u32 m0, s10, 2048
  s_add_u32 s8, s8, 64
  buffer_load_dwordx4 v241, s[52:55], s8 offen lds
  s_add_u32 s6, s11, 1024
  s_add_u32 s7, s11, 263168
  buffer_load_dwordx4 v[136:139], v240, s[64:67], s6 offen
  buffer_load_dwordx4 v[140:143], v240, s[64:67], s7 offen
  s_add_u32 m0, s10, 1024
  s_add_u32 s8, s12, 16384
  buffer_load_dwordx4 v241, s[52:55], s8 offen lds
  s_add_u32 m0, s10, 3072
  s_add_u32 s8, s8, 64
  buffer_load_dwordx4 v241, s[52:55], s8 offen lds
  s_add_u32 s6, s11, 2048
  s_add_u32 s7, s11, 264192
  buffer_load_dwordx4 v[144:147], v240, s[64:67], s6 offen
  buffer_load_dwordx4 v[148:151], v240, s[64:67], s7 offen
  s_add_u32 m0, s10, 4096
  s_add_u32 s8, s12, 32768
  buffer_load_dwordx4 v241, s[52:55], s8 offen lds
  s_add_u32 m0, s10, 6144
  s_add_u32 s8, s8, 64
  buffer_load_dwordx4 v241, s[52:55], s8 offen lds
  s_add_u32 s6, s11, 3072
  s_add_u32 s7, s11, 265216
  buffer_load_dwordx4 v[152:155], v240, s[64:67], s6 offen
  buffer_load_dwordx4 v[156:159], v240, s[64:67], s7 offen
  s_add_u32 m0, s10, 5120
  s_add_u32 s8, s12, 49152
  buffer_load_dwordx4 v241, s[52:55], s8 offen lds
  s_add_u32 m0, s10, 7168
  s_add_u32 s8, s8, 64
  buffer_load_dwordx4 v241, s[52:55], s8 offen lds
  s_add_u32 s6, s11, 4096
  s_add_u32 s7, s11, 266240
  buffer_load_dwordx4 v[160:163], v240, s[64:67], s6 offen
  buffer_load_dwordx4 v[164:167], v240, s[64:67], s7 offen
  s_add_u32 m0, s10, 8192
  s_add_u32 s8, s12, 65536
  buffer_load_dwordx4 v241, s[52:55], s8 offen lds
  s_add_u32 m0, s10, 10240
  s_add_u32 s8, s8, 64
  buffer_load_dwordx4 v241, s[52:55], s8 offen lds
  s_add_u32 s6, s11, 5120
  s_add_u32 s7, s11, 267264
  buffer_load_dwordx4 v[168:171], v240, s[64:67], s6 offen
  buffer_load_dwordx4 v[172:175], v240, s[64:67], s7 offen
  s_add_u32 m0, s10, 9216
  s_add_u32 s8, s12, 81920
  buffer_load_dwordx4 v241, s[52:55], s8 offen lds
  s_add_u32 m0, s10, 11264
  s_add_u32 s8, s8, 64
  buffer_load_dwordx4 v241, s[52:55], s8 offen lds
  s_mov_b32 s68, s46
  s_and_b32 s69, s47, 0xffff
  s_mov_b32 s70, 8388608
  s_mov_b32 s71, 0x00020000
  s_mov_b32 s76, s28
  s_and_b32 s77, s29, 0xffff
  s_mov_b32 s78, 2097152
  s_mov_b32 s79, 0x00020000
  s_mov_b32 s80, s44
  s_and_b32 s81, s45, 0xffff
  s_mov_b32 s82, 1024
  s_mov_b32 s83, 0x00020000
  v_lshrrev_b32 v250, 5, v255
  v_lshlrev_b32 v242, 8, v250
  v_bfe_u32 v250, v255, 2, 2
  v_lshl_add_u32 v242, v250, 6, v242
  v_bfe_u32 v250, v255, 4, 1
  v_lshl_add_u32 v242, v250, 5, v242
  v_and_b32 v250, 3, v255
  v_lshl_add_u32 v242, v250, 3, v242
  v_add_u32 v242, s10, v242
  v_and_b32 v250, 31, v255
  v_lshlrev_b32 v251, 6, v250
  s_add_u32 s6, s10, 12288
  v_add_u32 v251, s6, v251
  v_bfe_u32 v252, v255, 2, 2
  v_lshrrev_b32 v253, 5, v255
  v_xor_b32 v252, v252, v253
  v_lshl_add_u32 v244, v252, 4, v251
  s_mov_b32 s9, 0x05040100
  s_mov_b32 s13, 0x07060302
  s_lshl_b32 s6, s72, 6
  s_bfe_u32 s7, s3, 0x10001
  s_lshl_b32 s7, s7, 5
  s_add_u32 s6, s6, s7
  s_lshl_b32 s7, s4, 6
  s_lshr_b32 s8, s3, 2
  s_lshl_b32 s8, s8, 5
  s_add_u32 s7, s7, s8
  s_and_b32 s8, s3, 1
  s_lshl_b32 s8, s8, 4
  s_add_u32 s7, s7, s8
  v_add_u32 v250, s6, v250
  v_lshlrev_b32 v245, 2, v250
  v_lshl_add_u32 v245, v253, 14, v245
  s_lshl_b32 s73, s7, 12
  v_and_b32 v250, 31, v255
  s_lshl_b32 s6, s72, 6
  s_lshr_b32 s7, s3, 2
  s_lshl_b32 s7, s7, 5
  s_add_u32 s6, s6, s7
  v_add_u32 v250, s6, v250
  v_lshlrev_b32 v247, 1, v250
  v_lshl_add_u32 v246, v253, 12, v247
  v_lshlrev_b32 v252, 2, v250
  v_lshl_add_u32 v252, v253, 14, v252
  s_lshl_b32 s7, s4, 6
  s_and_b32 s8, s3, 3
  s_lshl_b32 s8, s8, 3
  s_add_u32 s7, s7, s8
  s_lshl_b32 s84, s7, 12
  s_lshl_b32 s74, s7, 10
  s_add_u32 s6, s10, 12288
  v_add_u32 v253, s6, v240
  s_lshl_b32 s6, s3, 10
  s_add_u32 s6, s6, 12288
  v_add_u32 v254, s6, v240
  s_lshl_b32 s6, s3, 14
  v_add_u32 v248, s6, v240
  s_lshl_b32 s6, s3, 11
  v_add_u32 v249, s6, v240
  s_waitcnt vmcnt(16)
  ds_read_b64_tr_b16 v[208:209], v242 offset:0
  ds_read_b64_tr_b16 v[210:211], v242 offset:1024
  ds_read_b64_tr_b16 v[212:213], v242 offset:2048
  ds_read_b64_tr_b16 v[214:215], v242 offset:3072
  ds_read_b64_tr_b16 v[216:217], v242 offset:512
  ds_read_b64_tr_b16 v[218:219], v242 offset:1536
  ds_read_b64_tr_b16 v[220:221], v242 offset:2560
  ds_read_b64_tr_b16 v[222:223], v242 offset:3584
  s_waitcnt lgkmcnt(4)
  v_mfma_f32_32x32x16_bf16 v[0:15], v[128:131], v[208:211], 0
  v_mfma_f32_32x32x16_bf16 v[16:31], v[128:131], v[212:215], 0
  v_mfma_f32_32x32x16_bf16 v[32:47], v[132:135], v[208:211], 0
  v_mfma_f32_32x32x16_bf16 v[48:63], v[132:135], v[212:215], 0
  s_waitcnt vmcnt(8)
  ds_read_b64_tr_b16 v[208:209], v242 offset:4096
  ds_read_b64_tr_b16 v[210:211], v242 offset:5120
  ds_read_b64_tr_b16 v[212:213], v242 offset:6144
  ds_read_b64_tr_b16 v[214:215], v242 offset:7168
  s_waitcnt lgkmcnt(4)
  v_mfma_f32_32x32x16_bf16 v[0:15], v[136:139], v[216:219], v[0:15]
  v_mfma_f32_32x32x16_bf16 v[16:31], v[136:139], v[220:223], v[16:31]
  v_mfma_f32_32x32x16_bf16 v[32:47], v[140:143], v[216:219], v[32:47]
  v_mfma_f32_32x32x16_bf16 v[48:63], v[140:143], v[220:223], v[48:63]
  s_add_u32 s6, s11, 6144
  s_add_u32 s7, s11, 268288
  buffer_load_dwordx4 v[128:131], v240, s[64:67], s6 offen
  buffer_load_dwordx4 v[132:135], v240, s[64:67], s7 offen
  s_add_u32 m0, s10, 0
  s_add_u32 s8, s12, 98304
  buffer_load_dwordx4 v241, s[52:55], s8 offen lds
  s_add_u32 m0, s10, 2048
  s_add_u32 s8, s8, 64
  buffer_load_dwordx4 v241, s[52:55], s8 offen lds
  s_add_u32 s6, s11, 7168
  s_add_u32 s7, s11, 269312
  buffer_load_dwordx4 v[136:139], v240, s[64:67], s6 offen
  buffer_load_dwordx4 v[140:143], v240, s[64:67], s7 offen
  s_add_u32 m0, s10, 1024
  s_add_u32 s8, s12, 114688
  buffer_load_dwordx4 v241, s[52:55], s8 offen lds
  s_add_u32 m0, s10, 3072
  s_add_u32 s8, s8, 64
  buffer_load_dwordx4 v241, s[52:55], s8 offen lds
  ds_read_b64_tr_b16 v[216:217], v242 offset:4608
  ds_read_b64_tr_b16 v[218:219], v242 offset:5632
  ds_read_b64_tr_b16 v[220:221], v242 offset:6656
  ds_read_b64_tr_b16 v[222:223], v242 offset:7680
  s_waitcnt lgkmcnt(4)
  v_mfma_f32_32x32x16_bf16 v[0:15], v[144:147], v[208:211], v[0:15]
  v_mfma_f32_32x32x16_bf16 v[16:31], v[144:147], v[212:215], v[16:31]
  v_mfma_f32_32x32x16_bf16 v[32:47], v[148:151], v[208:211], v[32:47]
  v_mfma_f32_32x32x16_bf16 v[48:63], v[148:151], v[212:215], v[48:63]
  s_waitcnt vmcnt(8)
  ds_read_b64_tr_b16 v[208:209], v242 offset:8192
  ds_read_b64_tr_b16 v[210:211], v242 offset:9216
  ds_read_b64_tr_b16 v[212:213], v242 offset:10240
  ds_read_b64_tr_b16 v[214:215], v242 offset:11264
  s_waitcnt lgkmcnt(4)
  v_mfma_f32_32x32x16_bf16 v[0:15], v[152:155], v[216:219], v[0:15]
  v_mfma_f32_32x32x16_bf16 v[16:31], v[152:155], v[220:223], v[16:31]
  v_mfma_f32_32x32x16_bf16 v[32:47], v[156:159], v[216:219], v[32:47]
  v_mfma_f32_32x32x16_bf16 v[48:63], v[156:159], v[220:223], v[48:63]
  s_add_u32 s6, s11, 8192
  s_add_u32 s7, s11, 270336
  buffer_load_dwordx4 v[144:147], v240, s[64:67], s6 offen
  buffer_load_dwordx4 v[148:151], v240, s[64:67], s7 offen
  s_add_u32 m0, s10, 4096
  s_add_u32 s8, s12, 131072
  buffer_load_dwordx4 v241, s[52:55], s8 offen lds
  s_add_u32 m0, s10, 6144
  s_add_u32 s8, s8, 64
  buffer_load_dwordx4 v241, s[52:55], s8 offen lds
  s_add_u32 s6, s11, 9216
  s_add_u32 s7, s11, 271360
  buffer_load_dwordx4 v[152:155], v240, s[64:67], s6 offen
  buffer_load_dwordx4 v[156:159], v240, s[64:67], s7 offen
  s_add_u32 m0, s10, 5120
  s_add_u32 s8, s12, 147456
  buffer_load_dwordx4 v241, s[52:55], s8 offen lds
  s_add_u32 m0, s10, 7168
  s_add_u32 s8, s8, 64
  buffer_load_dwordx4 v241, s[52:55], s8 offen lds
  ds_read_b128 v[224:227], v244 offset:0
  ds_read_b128 v[228:231], v244 offset:4096
  ds_read_b128 v[232:235], v244 offset:2048
  ds_read_b128 v[236:239], v244 offset:6144
  s_waitcnt lgkmcnt(0)
  v_perm_b32 v200, v228, v224, s9
  v_perm_b32 v201, v228, v224, s13
  v_perm_b32 v202, v229, v225, s9
  v_perm_b32 v203, v229, v225, s13
  v_perm_b32 v204, v236, v232, s9
  v_perm_b32 v205, v236, v232, s13
  v_perm_b32 v206, v237, v233, s9
  v_perm_b32 v207, v237, v233, s13
  s_nop 1
  v_mfma_f32_32x32x16_bf16 v[64:79], v[176:179], v[200:203], 0
  v_mfma_f32_32x32x16_bf16 v[80:95], v[176:179], v[204:207], 0
  v_mfma_f32_32x32x16_bf16 v[96:111], v[180:183], v[200:203], 0
  v_mfma_f32_32x32x16_bf16 v[112:127], v[180:183], v[204:207], 0
  s_add_u32 s6, s14, 3072
  s_add_u32 s7, s14, 68608
  buffer_load_dwordx4 v[176:179], v240, s[64:67], s6 offen
  buffer_load_dwordx4 v[180:183], v240, s[64:67], s7 offen
  v_perm_b32 v200, v230, v226, s9
  v_perm_b32 v201, v230, v226, s13
  v_perm_b32 v202, v231, v227, s9
  v_perm_b32 v203, v231, v227, s13
  v_perm_b32 v204, v238, v234, s9
  v_perm_b32 v205, v238, v234, s13
  v_perm_b32 v206, v239, v235, s9
  v_perm_b32 v207, v239, v235, s13
  s_nop 1
  v_mfma_f32_32x32x16_bf16 v[64:79], v[184:187], v[200:203], v[64:79]
  v_mfma_f32_32x32x16_bf16 v[80:95], v[184:187], v[204:207], v[80:95]
  v_mfma_f32_32x32x16_bf16 v[96:111], v[188:191], v[200:203], v[96:111]
  v_mfma_f32_32x32x16_bf16 v[112:127], v[188:191], v[204:207], v[112:127]
  s_add_u32 s6, s14, 4096
  s_add_u32 s7, s14, 69632
  buffer_load_dwordx4 v[184:187], v240, s[64:67], s6 offen
  buffer_load_dwordx4 v[188:191], v240, s[64:67], s7 offen
  ds_read_b64_tr_b16 v[216:217], v242 offset:8704
  ds_read_b64_tr_b16 v[218:219], v242 offset:9728
  ds_read_b64_tr_b16 v[220:221], v242 offset:10752
  ds_read_b64_tr_b16 v[222:223], v242 offset:11776
  v_mfma_f32_32x32x16_bf16 v[0:15], v[160:163], v[208:211], v[0:15]
  v_mfma_f32_32x32x16_bf16 v[16:31], v[160:163], v[212:215], v[16:31]
  v_mfma_f32_32x32x16_bf16 v[32:47], v[164:167], v[208:211], v[32:47]
  v_mfma_f32_32x32x16_bf16 v[48:63], v[164:167], v[212:215], v[48:63]
  s_waitcnt vmcnt(12)
  ds_read_b64_tr_b16 v[208:209], v242 offset:0
  ds_read_b64_tr_b16 v[210:211], v242 offset:1024
  ds_read_b64_tr_b16 v[212:213], v242 offset:2048
  ds_read_b64_tr_b16 v[214:215], v242 offset:3072
  s_waitcnt lgkmcnt(4)
  v_mfma_f32_32x32x16_bf16 v[0:15], v[168:171], v[216:219], v[0:15]
  v_mfma_f32_32x32x16_bf16 v[16:31], v[168:171], v[220:223], v[16:31]
  v_mfma_f32_32x32x16_bf16 v[32:47], v[172:175], v[216:219], v[32:47]
  v_mfma_f32_32x32x16_bf16 v[48:63], v[172:175], v[220:223], v[48:63]
  s_add_u32 s6, s11, 10240
  s_add_u32 s7, s11, 272384
  buffer_load_dwordx4 v[160:163], v240, s[64:67], s6 offen
  buffer_load_dwordx4 v[164:167], v240, s[64:67], s7 offen
  s_add_u32 m0, s10, 8192
  s_add_u32 s8, s12, 163840
  buffer_load_dwordx4 v241, s[52:55], s8 offen lds
  s_add_u32 m0, s10, 10240
  s_add_u32 s8, s8, 64
  buffer_load_dwordx4 v241, s[52:55], s8 offen lds
  s_add_u32 s6, s11, 11264
  s_add_u32 s7, s11, 273408
  buffer_load_dwordx4 v[168:171], v240, s[64:67], s6 offen
  buffer_load_dwordx4 v[172:175], v240, s[64:67], s7 offen
  s_add_u32 m0, s10, 9216
  s_add_u32 s8, s12, 180224
  buffer_load_dwordx4 v241, s[52:55], s8 offen lds
  s_add_u32 m0, s10, 11264
  s_add_u32 s8, s8, 64
  buffer_load_dwordx4 v241, s[52:55], s8 offen lds
  v_xor_b32 v250, 32, v244
  ds_read_b128 v[224:227], v250 offset:0
  ds_read_b128 v[228:231], v250 offset:4096
  ds_read_b128 v[232:235], v250 offset:2048
  ds_read_b128 v[236:239], v250 offset:6144
  s_waitcnt lgkmcnt(0)
  v_perm_b32 v200, v228, v224, s9
  v_perm_b32 v201, v228, v224, s13
  v_perm_b32 v202, v229, v225, s9
  v_perm_b32 v203, v229, v225, s13
  v_perm_b32 v204, v236, v232, s9
  v_perm_b32 v205, v236, v232, s13
  v_perm_b32 v206, v237, v233, s9
  v_perm_b32 v207, v237, v233, s13
  s_nop 1
  v_mfma_f32_32x32x16_bf16 v[64:79], v[192:195], v[200:203], v[64:79]
  v_mfma_f32_32x32x16_bf16 v[80:95], v[192:195], v[204:207], v[80:95]
  v_mfma_f32_32x32x16_bf16 v[96:111], v[196:199], v[200:203], v[96:111]
  v_mfma_f32_32x32x16_bf16 v[112:127], v[196:199], v[204:207], v[112:127]
  s_add_u32 s6, s14, 5120
  s_add_u32 s7, s14, 70656
  buffer_load_dwordx4 v[192:195], v240, s[64:67], s6 offen
  buffer_load_dwordx4 v[196:199], v240, s[64:67], s7 offen
  v_perm_b32 v200, v230, v226, s9
  v_perm_b32 v201, v230, v226, s13
  v_perm_b32 v202, v231, v227, s9
  v_perm_b32 v203, v231, v227, s13
  v_perm_b32 v204, v238, v234, s9
  v_perm_b32 v205, v238, v234, s13
  v_perm_b32 v206, v239, v235, s9
  v_perm_b32 v207, v239, v235, s13
  s_nop 1
  s_waitcnt vmcnt(12)
  v_mfma_f32_32x32x16_bf16 v[64:79], v[176:179], v[200:203], v[64:79]
  v_mfma_f32_32x32x16_bf16 v[80:95], v[176:179], v[204:207], v[80:95]
  v_mfma_f32_32x32x16_bf16 v[96:111], v[180:183], v[200:203], v[96:111]
  v_mfma_f32_32x32x16_bf16 v[112:127], v[180:183], v[204:207], v[112:127]
  s_add_u32 s6, s14, 6144
  s_add_u32 s7, s14, 71680
  buffer_load_dwordx4 v[176:179], v240, s[64:67], s6 offen
  buffer_load_dwordx4 v[180:183], v240, s[64:67], s7 offen
  s_add_u32 m0, s10, 12288
  s_add_u32 s6, s15, 64
  buffer_load_dwordx4 v243, s[56:59], s6 offen lds
  s_add_u32 m0, s10, 13312
  s_add_u32 s6, s15, 16448
  buffer_load_dwordx4 v243, s[56:59], s6 offen lds
  s_add_u32 m0, s10, 14336
  s_add_u32 s6, s15, 32832
  buffer_load_dwordx4 v243, s[56:59], s6 offen lds
  s_add_u32 m0, s10, 15360
  s_add_u32 s6, s15, 49216
  buffer_load_dwordx4 v243, s[56:59], s6 offen lds
  s_add_u32 m0, s10, 16384
  s_add_u32 s6, s15, 64
  buffer_load_dwordx4 v243, s[60:63], s6 offen lds
  s_add_u32 m0, s10, 17408
  s_add_u32 s6, s15, 16448
  buffer_load_dwordx4 v243, s[60:63], s6 offen lds
  s_add_u32 m0, s10, 18432
  s_add_u32 s6, s15, 32832
  buffer_load_dwordx4 v243, s[60:63], s6 offen lds
  s_add_u32 m0, s10, 19456
  s_add_u32 s6, s15, 49216
  buffer_load_dwordx4 v243, s[60:63], s6 offen lds
  ds_read_b64_tr_b16 v[216:217], v242 offset:512
  ds_read_b64_tr_b16 v[218:219], v242 offset:1536
  ds_read_b64_tr_b16 v[220:221], v242 offset:2560
  ds_read_b64_tr_b16 v[222:223], v242 offset:3584
  v_mfma_f32_32x32x16_bf16 v[0:15], v[128:131], v[208:211], v[0:15]
  v_mfma_f32_32x32x16_bf16 v[16:31], v[128:131], v[212:215], v[16:31]
  v_mfma_f32_32x32x16_bf16 v[32:47], v[132:135], v[208:211], v[32:47]
  v_mfma_f32_32x32x16_bf16 v[48:63], v[132:135], v[212:215], v[48:63]
  ds_read_b64_tr_b16 v[208:209], v242 offset:4096
  ds_read_b64_tr_b16 v[210:211], v242 offset:5120
  ds_read_b64_tr_b16 v[212:213], v242 offset:6144
  ds_read_b64_tr_b16 v[214:215], v242 offset:7168
  s_waitcnt lgkmcnt(4)
  v_mfma_f32_32x32x16_bf16 v[0:15], v[136:139], v[216:219], v[0:15]
  v_mfma_f32_32x32x16_bf16 v[16:31], v[136:139], v[220:223], v[16:31]
  v_mfma_f32_32x32x16_bf16 v[32:47], v[140:143], v[216:219], v[32:47]
  v_mfma_f32_32x32x16_bf16 v[48:63], v[140:143], v[220:223], v[48:63]
  s_add_u32 s6, s11, 12288
  s_add_u32 s7, s11, 274432
  buffer_load_dwordx4 v[128:131], v240, s[64:67], s6 offen
  buffer_load_dwordx4 v[132:135], v240, s[64:67], s7 offen
  s_add_u32 m0, s10, 0
  s_add_u32 s8, s12, 196608
  buffer_load_dwordx4 v241, s[52:55], s8 offen lds
  s_add_u32 m0, s10, 2048
  s_add_u32 s8, s8, 64
  buffer_load_dwordx4 v241, s[52:55], s8 offen lds
  s_add_u32 s6, s11, 13312
  s_add_u32 s7, s11, 275456
  buffer_load_dwordx4 v[136:139], v240, s[64:67], s6 offen
  buffer_load_dwordx4 v[140:143], v240, s[64:67], s7 offen
  s_add_u32 m0, s10, 1024
  s_add_u32 s8, s12, 212992
  buffer_load_dwordx4 v241, s[52:55], s8 offen lds
  s_add_u32 m0, s10, 3072
  s_add_u32 s8, s8, 64
  buffer_load_dwordx4 v241, s[52:55], s8 offen lds
  ds_read_b64_tr_b16 v[216:217], v242 offset:4608
  ds_read_b64_tr_b16 v[218:219], v242 offset:5632
  ds_read_b64_tr_b16 v[220:221], v242 offset:6656
  ds_read_b64_tr_b16 v[222:223], v242 offset:7680
  s_waitcnt lgkmcnt(4)
  v_mfma_f32_32x32x16_bf16 v[0:15], v[144:147], v[208:211], v[0:15]
  v_mfma_f32_32x32x16_bf16 v[16:31], v[144:147], v[212:215], v[16:31]
  v_mfma_f32_32x32x16_bf16 v[32:47], v[148:151], v[208:211], v[32:47]
  v_mfma_f32_32x32x16_bf16 v[48:63], v[148:151], v[212:215], v[48:63]
  s_waitcnt vmcnt(20)
  ds_read_b64_tr_b16 v[208:209], v242 offset:8192
  ds_read_b64_tr_b16 v[210:211], v242 offset:9216
  ds_read_b64_tr_b16 v[212:213], v242 offset:10240
  ds_read_b64_tr_b16 v[214:215], v242 offset:11264
  s_waitcnt lgkmcnt(4)
  v_mfma_f32_32x32x16_bf16 v[0:15], v[152:155], v[216:219], v[0:15]
  v_mfma_f32_32x32x16_bf16 v[16:31], v[152:155], v[220:223], v[16:31]
  v_mfma_f32_32x32x16_bf16 v[32:47], v[156:159], v[216:219], v[32:47]
  v_mfma_f32_32x32x16_bf16 v[48:63], v[156:159], v[220:223], v[48:63]
  s_add_u32 s6, s11, 14336
  s_add_u32 s7, s11, 276480
  buffer_load_dwordx4 v[144:147], v240, s[64:67], s6 offen
  buffer_load_dwordx4 v[148:151], v240, s[64:67], s7 offen
  s_add_u32 m0, s10, 4096
  s_add_u32 s8, s12, 229376
  buffer_load_dwordx4 v241, s[52:55], s8 offen lds
  s_add_u32 m0, s10, 6144
  s_add_u32 s8, s8, 64
  buffer_load_dwordx4 v241, s[52:55], s8 offen lds
  s_add_u32 s6, s11, 15360
  s_add_u32 s7, s11, 277504
  buffer_load_dwordx4 v[152:155], v240, s[64:67], s6 offen
  buffer_load_dwordx4 v[156:159], v240, s[64:67], s7 offen
  s_add_u32 m0, s10, 5120
  s_add_u32 s8, s12, 245760
  buffer_load_dwordx4 v241, s[52:55], s8 offen lds
  s_add_u32 m0, s10, 7168
  s_add_u32 s8, s8, 64
  buffer_load_dwordx4 v241, s[52:55], s8 offen lds
  ds_read_b64_tr_b16 v[216:217], v242 offset:8704
  ds_read_b64_tr_b16 v[218:219], v242 offset:9728
  ds_read_b64_tr_b16 v[220:221], v242 offset:10752
  ds_read_b64_tr_b16 v[222:223], v242 offset:11776
  s_waitcnt lgkmcnt(4)
  v_mfma_f32_32x32x16_bf16 v[0:15], v[160:163], v[208:211], v[0:15]
  v_mfma_f32_32x32x16_bf16 v[16:31], v[160:163], v[212:215], v[16:31]
  v_mfma_f32_32x32x16_bf16 v[32:47], v[164:167], v[208:211], v[32:47]
  v_mfma_f32_32x32x16_bf16 v[48:63], v[164:167], v[212:215], v[48:63]
  s_waitcnt vmcnt(8)
  ds_read_b64_tr_b16 v[208:209], v242 offset:0
  ds_read_b64_tr_b16 v[210:211], v242 offset:1024
  ds_read_b64_tr_b16 v[212:213], v242 offset:2048
  ds_read_b64_tr_b16 v[214:215], v242 offset:3072
  s_waitcnt lgkmcnt(4)
  v_mfma_f32_32x32x16_bf16 v[0:15], v[168:171], v[216:219], v[0:15]
  v_mfma_f32_32x32x16_bf16 v[16:31], v[168:171], v[220:223], v[16:31]
  v_mfma_f32_32x32x16_bf16 v[32:47], v[172:175], v[216:219], v[32:47]
  v_mfma_f32_32x32x16_bf16 v[48:63], v[172:175], v[220:223], v[48:63]
  s_add_u32 s6, s11, 16384
  s_add_u32 s7, s11, 278528
  buffer_load_dwordx4 v[160:163], v240, s[64:67], s6 offen
  buffer_load_dwordx4 v[164:167], v240, s[64:67], s7 offen
  s_add_u32 m0, s10, 8192
  s_add_u32 s8, s12, 262144
  buffer_load_dwordx4 v241, s[52:55], s8 offen lds
  s_add_u32 m0, s10, 10240
  s_add_u32 s8, s8, 64
  buffer_load_dwordx4 v241, s[52:55], s8 offen lds
  s_add_u32 s6, s11, 17408
  s_add_u32 s7, s11, 279552
  buffer_load_dwordx4 v[168:171], v240, s[64:67], s6 offen
  buffer_load_dwordx4 v[172:175], v240, s[64:67], s7 offen
  s_add_u32 m0, s10, 9216
  s_add_u32 s8, s12, 278528
  buffer_load_dwordx4 v241, s[52:55], s8 offen lds
  s_add_u32 m0, s10, 11264
  s_add_u32 s8, s8, 64
  buffer_load_dwordx4 v241, s[52:55], s8 offen lds
  ds_read_b64_tr_b16 v[216:217], v242 offset:512
  ds_read_b64_tr_b16 v[218:219], v242 offset:1536
  ds_read_b64_tr_b16 v[220:221], v242 offset:2560
  ds_read_b64_tr_b16 v[222:223], v242 offset:3584
  s_waitcnt lgkmcnt(4)
  v_mfma_f32_32x32x16_bf16 v[0:15], v[128:131], v[208:211], v[0:15]
  v_mfma_f32_32x32x16_bf16 v[16:31], v[128:131], v[212:215], v[16:31]
  v_mfma_f32_32x32x16_bf16 v[32:47], v[132:135], v[208:211], v[32:47]
  v_mfma_f32_32x32x16_bf16 v[48:63], v[132:135], v[212:215], v[48:63]
  ds_read_b128 v[224:227], v244 offset:0
  ds_read_b128 v[228:231], v244 offset:4096
  ds_read_b128 v[232:235], v244 offset:2048
  ds_read_b128 v[236:239], v244 offset:6144
  s_waitcnt lgkmcnt(0)
  v_perm_b32 v200, v228, v224, s9
  v_perm_b32 v201, v228, v224, s13
  v_perm_b32 v202, v229, v225, s9
  v_perm_b32 v203, v229, v225, s13
  v_perm_b32 v204, v236, v232, s9
  v_perm_b32 v205, v236, v232, s13
  v_perm_b32 v206, v237, v233, s9
  v_perm_b32 v207, v237, v233, s13
  s_nop 1
  v_mfma_f32_32x32x16_bf16 v[64:79], v[184:187], v[200:203], v[64:79]
  v_mfma_f32_32x32x16_bf16 v[80:95], v[184:187], v[204:207], v[80:95]
  v_mfma_f32_32x32x16_bf16 v[96:111], v[188:191], v[200:203], v[96:111]
  v_mfma_f32_32x32x16_bf16 v[112:127], v[188:191], v[204:207], v[112:127]
  s_add_u32 s6, s14, 7168
  s_add_u32 s7, s14, 72704
  buffer_load_dwordx4 v[184:187], v240, s[64:67], s6 offen
  buffer_load_dwordx4 v[188:191], v240, s[64:67], s7 offen
  v_perm_b32 v200, v230, v226, s9
  v_perm_b32 v201, v230, v226, s13
  v_perm_b32 v202, v231, v227, s9
  v_perm_b32 v203, v231, v227, s13
  v_perm_b32 v204, v238, v234, s9
  v_perm_b32 v205, v238, v234, s13
  v_perm_b32 v206, v239, v235, s9
  v_perm_b32 v207, v239, v235, s13
  s_nop 1
  v_mfma_f32_32x32x16_bf16 v[64:79], v[192:195], v[200:203], v[64:79]
  v_mfma_f32_32x32x16_bf16 v[80:95], v[192:195], v[204:207], v[80:95]
  v_mfma_f32_32x32x16_bf16 v[96:111], v[196:199], v[200:203], v[96:111]
  v_mfma_f32_32x32x16_bf16 v[112:127], v[196:199], v[204:207], v[112:127]
  s_waitcnt vmcnt(10)
  ds_read_b64_tr_b16 v[208:209], v242 offset:4096
  ds_read_b64_tr_b16 v[210:211], v242 offset:5120
  ds_read_b64_tr_b16 v[212:213], v242 offset:6144
  ds_read_b64_tr_b16 v[214:215], v242 offset:7168
  v_mfma_f32_32x32x16_bf16 v[0:15], v[136:139], v[216:219], v[0:15]
  v_mfma_f32_32x32x16_bf16 v[16:31], v[136:139], v[220:223], v[16:31]
  v_mfma_f32_32x32x16_bf16 v[32:47], v[140:143], v[216:219], v[32:47]
  v_mfma_f32_32x32x16_bf16 v[48:63], v[140:143], v[220:223], v[48:63]
  s_add_u32 s6, s11, 18432
  s_add_u32 s7, s11, 280576
  buffer_load_dwordx4 v[128:131], v240, s[64:67], s6 offen
  buffer_load_dwordx4 v[132:135], v240, s[64:67], s7 offen
  s_add_u32 m0, s10, 0
  s_add_u32 s8, s12, 294912
  buffer_load_dwordx4 v241, s[52:55], s8 offen lds
  s_add_u32 m0, s10, 2048
  s_add_u32 s8, s8, 64
  buffer_load_dwordx4 v241, s[52:55], s8 offen lds
  s_add_u32 s6, s11, 19456
  s_add_u32 s7, s11, 281600
  buffer_load_dwordx4 v[136:139], v240, s[64:67], s6 offen
  buffer_load_dwordx4 v[140:143], v240, s[64:67], s7 offen
  s_add_u32 m0, s10, 1024
  s_add_u32 s8, s12, 311296
  buffer_load_dwordx4 v241, s[52:55], s8 offen lds
  s_add_u32 m0, s10, 3072
  s_add_u32 s8, s8, 64
  buffer_load_dwordx4 v241, s[52:55], s8 offen lds
  ds_read_b64_tr_b16 v[216:217], v242 offset:4608
  ds_read_b64_tr_b16 v[218:219], v242 offset:5632
  ds_read_b64_tr_b16 v[220:221], v242 offset:6656
  ds_read_b64_tr_b16 v[222:223], v242 offset:7680
  s_waitcnt lgkmcnt(4)
  v_mfma_f32_32x32x16_bf16 v[0:15], v[144:147], v[208:211], v[0:15]
  v_mfma_f32_32x32x16_bf16 v[16:31], v[144:147], v[212:215], v[16:31]
  v_mfma_f32_32x32x16_bf16 v[32:47], v[148:151], v[208:211], v[32:47]
  v_mfma_f32_32x32x16_bf16 v[48:63], v[148:151], v[212:215], v[48:63]
  v_xor_b32 v250, 32, v244
  ds_read_b128 v[224:227], v250 offset:0
  ds_read_b128 v[228:231], v250 offset:4096
  ds_read_b128 v[232:235], v250 offset:2048
  ds_read_b128 v[236:239], v250 offset:6144
  s_waitcnt lgkmcnt(0)
  v_perm_b32 v200, v228, v224, s9
  v_perm_b32 v201, v228, v224, s13
  v_perm_b32 v202, v229, v225, s9
  v_perm_b32 v203, v229, v225, s13
  v_perm_b32 v204, v236, v232, s9
  v_perm_b32 v205, v236, v232, s13
  v_perm_b32 v206, v237, v233, s9
  v_perm_b32 v207, v237, v233, s13
  s_nop 1
  v_mfma_f32_32x32x16_bf16 v[64:79], v[176:179], v[200:203], v[64:79]
  v_mfma_f32_32x32x16_bf16 v[80:95], v[176:179], v[204:207], v[80:95]
  v_mfma_f32_32x32x16_bf16 v[96:111], v[180:183], v[200:203], v[96:111]
  v_mfma_f32_32x32x16_bf16 v[112:127], v[180:183], v[204:207], v[112:127]
  v_perm_b32 v200, v230, v226, s9
  v_perm_b32 v201, v230, v226, s13
  v_perm_b32 v202, v231, v227, s9
  v_perm_b32 v203, v231, v227, s13
  v_perm_b32 v204, v238, v234, s9
  v_perm_b32 v205, v238, v234, s13
  v_perm_b32 v206, v239, v235, s9
  v_perm_b32 v207, v239, v235, s13
  s_nop 1
  s_waitcnt vmcnt(8)
  v_mfma_f32_32x32x16_bf16 v[64:79], v[184:187], v[200:203], v[64:79]
  v_mfma_f32_32x32x16_bf16 v[80:95], v[184:187], v[204:207], v[80:95]
  v_mfma_f32_32x32x16_bf16 v[96:111], v[188:191], v[200:203], v[96:111]
  v_mfma_f32_32x32x16_bf16 v[112:127], v[188:191], v[204:207], v[112:127]
  buffer_load_ushort v184, v247, s[80:83], 0 offen
  s_add_u32 s75, s74, 0
  buffer_load_ushort v176, v246, s[76:79], s75 offen offset:0
  buffer_load_ushort v177, v246, s[76:79], s75 offen offset:1024
  buffer_load_ushort v178, v246, s[76:79], s75 offen offset:2048
  buffer_load_ushort v179, v246, s[76:79], s75 offen offset:3072
  s_add_u32 s75, s74, 32768
  buffer_load_ushort v180, v246, s[76:79], s75 offen offset:0
  buffer_load_ushort v181, v246, s[76:79], s75 offen offset:1024
  buffer_load_ushort v182, v246, s[76:79], s75 offen offset:2048
  buffer_load_ushort v183, v246, s[76:79], s75 offen offset:3072
  ds_read_b64_tr_b16 v[208:209], v242 offset:8192
  ds_read_b64_tr_b16 v[210:211], v242 offset:9216
  ds_read_b64_tr_b16 v[212:213], v242 offset:10240
  ds_read_b64_tr_b16 v[214:215], v242 offset:11264
  v_mfma_f32_32x32x16_bf16 v[0:15], v[152:155], v[216:219], v[0:15]
  v_mfma_f32_32x32x16_bf16 v[16:31], v[152:155], v[220:223], v[16:31]
  v_mfma_f32_32x32x16_bf16 v[32:47], v[156:159], v[216:219], v[32:47]
  v_mfma_f32_32x32x16_bf16 v[48:63], v[156:159], v[220:223], v[48:63]
  s_add_u32 s6, s11, 20480
  s_add_u32 s7, s11, 282624
  buffer_load_dwordx4 v[144:147], v240, s[64:67], s6 offen
  buffer_load_dwordx4 v[148:151], v240, s[64:67], s7 offen
  s_add_u32 m0, s10, 4096
  s_add_u32 s8, s12, 327680
  buffer_load_dwordx4 v241, s[52:55], s8 offen lds
  s_add_u32 m0, s10, 6144
  s_add_u32 s8, s8, 64
  buffer_load_dwordx4 v241, s[52:55], s8 offen lds
  s_add_u32 s6, s11, 21504
  s_add_u32 s7, s11, 283648
  buffer_load_dwordx4 v[152:155], v240, s[64:67], s6 offen
  buffer_load_dwordx4 v[156:159], v240, s[64:67], s7 offen
  s_add_u32 m0, s10, 5120
  s_add_u32 s8, s12, 344064
  buffer_load_dwordx4 v241, s[52:55], s8 offen lds
  s_add_u32 m0, s10, 7168
  s_add_u32 s8, s8, 64
  buffer_load_dwordx4 v241, s[52:55], s8 offen lds
  ds_read_b64_tr_b16 v[216:217], v242 offset:8704
  ds_read_b64_tr_b16 v[218:219], v242 offset:9728
  ds_read_b64_tr_b16 v[220:221], v242 offset:10752
  ds_read_b64_tr_b16 v[222:223], v242 offset:11776
  s_waitcnt lgkmcnt(4)
  v_mfma_f32_32x32x16_bf16 v[0:15], v[160:163], v[208:211], v[0:15]
  v_mfma_f32_32x32x16_bf16 v[16:31], v[160:163], v[212:215], v[16:31]
  v_mfma_f32_32x32x16_bf16 v[32:47], v[164:167], v[208:211], v[32:47]
  v_mfma_f32_32x32x16_bf16 v[48:63], v[164:167], v[212:215], v[48:63]
  s_waitcnt vmcnt(17)
  ds_read_b64_tr_b16 v[208:209], v242 offset:0
  ds_read_b64_tr_b16 v[210:211], v242 offset:1024
  ds_read_b64_tr_b16 v[212:213], v242 offset:2048
  ds_read_b64_tr_b16 v[214:215], v242 offset:3072
  s_waitcnt lgkmcnt(4)
  v_mfma_f32_32x32x16_bf16 v[0:15], v[168:171], v[216:219], v[0:15]
  v_mfma_f32_32x32x16_bf16 v[16:31], v[168:171], v[220:223], v[16:31]
  v_mfma_f32_32x32x16_bf16 v[32:47], v[172:175], v[216:219], v[32:47]
  v_mfma_f32_32x32x16_bf16 v[48:63], v[172:175], v[220:223], v[48:63]
  s_add_u32 s6, s11, 22528
  s_add_u32 s7, s11, 284672
  buffer_load_dwordx4 v[160:163], v240, s[64:67], s6 offen
  buffer_load_dwordx4 v[164:167], v240, s[64:67], s7 offen
  s_add_u32 m0, s10, 8192
  s_add_u32 s8, s12, 360448
  buffer_load_dwordx4 v241, s[52:55], s8 offen lds
  s_add_u32 m0, s10, 10240
  s_add_u32 s8, s8, 64
  buffer_load_dwordx4 v241, s[52:55], s8 offen lds
  s_add_u32 s6, s11, 23552
  s_add_u32 s7, s11, 285696
  buffer_load_dwordx4 v[168:171], v240, s[64:67], s6 offen
  buffer_load_dwordx4 v[172:175], v240, s[64:67], s7 offen
  s_add_u32 m0, s10, 9216
  s_add_u32 s8, s12, 376832
  buffer_load_dwordx4 v241, s[52:55], s8 offen lds
  s_add_u32 m0, s10, 11264
  s_add_u32 s8, s8, 64
  buffer_load_dwordx4 v241, s[52:55], s8 offen lds
  ds_write_b128 v253, v[64:67] offset:0
  ds_write_b128 v253, v[68:71] offset:1024
  ds_write_b128 v253, v[72:75] offset:2048
  ds_write_b128 v253, v[76:79] offset:3072
  ds_write_b128 v253, v[80:83] offset:4096
  ds_write_b128 v253, v[84:87] offset:5120
  ds_write_b128 v253, v[88:91] offset:6144
  ds_write_b128 v253, v[92:95] offset:7168
  s_waitcnt lgkmcnt(0)
  s_barrier
  ds_read_b64_tr_b16 v[216:217], v242 offset:512
  ds_read_b64_tr_b16 v[218:219], v242 offset:1536
  ds_read_b64_tr_b16 v[220:221], v242 offset:2560
  ds_read_b64_tr_b16 v[222:223], v242 offset:3584
  v_mfma_f32_32x32x16_bf16 v[0:15], v[128:131], v[208:211], v[0:15]
  v_mfma_f32_32x32x16_bf16 v[16:31], v[128:131], v[212:215], v[16:31]
  v_mfma_f32_32x32x16_bf16 v[32:47], v[132:135], v[208:211], v[32:47]
  v_mfma_f32_32x32x16_bf16 v[48:63], v[132:135], v[212:215], v[48:63]
  s_waitcnt vmcnt(8)
  ds_read_b64_tr_b16 v[208:209], v242 offset:4096
  ds_read_b64_tr_b16 v[210:211], v242 offset:5120
  ds_read_b64_tr_b16 v[212:213], v242 offset:6144
  ds_read_b64_tr_b16 v[214:215], v242 offset:7168
  s_waitcnt lgkmcnt(4)
  v_mfma_f32_32x32x16_bf16 v[0:15], v[136:139], v[216:219], v[0:15]
  v_mfma_f32_32x32x16_bf16 v[16:31], v[136:139], v[220:223], v[16:31]
  v_mfma_f32_32x32x16_bf16 v[32:47], v[140:143], v[216:219], v[32:47]
  v_mfma_f32_32x32x16_bf16 v[48:63], v[140:143], v[220:223], v[48:63]
  s_add_u32 s6, s11, 24576
  s_add_u32 s7, s11, 286720
  buffer_load_dwordx4 v[128:131], v240, s[64:67], s6 offen
  buffer_load_dwordx4 v[132:135], v240, s[64:67], s7 offen
  s_add_u32 m0, s10, 0
  s_add_u32 s8, s12, 393216
  buffer_load_dwordx4 v241, s[52:55], s8 offen lds
  s_add_u32 m0, s10, 2048
  s_add_u32 s8, s8, 64
  buffer_load_dwordx4 v241, s[52:55], s8 offen lds
  s_add_u32 s6, s11, 25600
  s_add_u32 s7, s11, 287744
  buffer_load_dwordx4 v[136:139], v240, s[64:67], s6 offen
  buffer_load_dwordx4 v[140:143], v240, s[64:67], s7 offen
  s_add_u32 m0, s10, 1024
  s_add_u32 s8, s12, 409600
  buffer_load_dwordx4 v241, s[52:55], s8 offen lds
  s_add_u32 m0, s10, 3072
  s_add_u32 s8, s8, 64
  buffer_load_dwordx4 v241, s[52:55], s8 offen lds
  ds_read_b128 v[64:67], v254
  v_add_u32 v250, 20480, v254
  ds_read_b128 v[68:71], v250
  v_add_u32 v250, 40960, v254
  ds_read_b128 v[72:75], v250
  v_add_u32 v250, 61440, v254
  ds_read_b128 v[76:79], v250
  v_add_u32 v250, 81920, v254
  ds_read_b128 v[80:83], v250
  v_add_u32 v250, 102400, v254
  ds_read_b128 v[84:87], v250
  v_add_u32 v250, 122880, v254
  ds_read_b128 v[88:91], v250
  v_add_u32 v250, 143360, v254
  ds_read_b128 v[92:95], v250
  s_waitcnt lgkmcnt(0)
  s_barrier
  v_add_f32 v64, v64, v80
  v_add_f32 v65, v65, v81
  v_add_f32 v66, v66, v82
  v_add_f32 v67, v67, v83
  v_add_f32 v68, v68, v84
  v_add_f32 v69, v69, v85
  v_add_f32 v70, v70, v86
  v_add_f32 v71, v71, v87
  v_add_f32 v72, v72, v88
  v_add_f32 v73, v73, v89
  v_add_f32 v74, v74, v90
  v_add_f32 v75, v75, v91
  v_add_f32 v76, v76, v92
  v_add_f32 v77, v77, v93
  v_add_f32 v78, v78, v94
  v_add_f32 v79, v79, v95
  v_add_f32 v64, v64, v72
  v_add_f32 v65, v65, v73
  v_add_f32 v66, v66, v74
  v_add_f32 v67, v67, v75
  v_add_f32 v68, v68, v76
  v_add_f32 v69, v69, v77
  v_add_f32 v70, v70, v78
  v_add_f32 v71, v71, v79
  v_add_f32 v64, v64, v68
  v_add_f32 v65, v65, v69
  v_add_f32 v66, v66, v70
  v_add_f32 v67, v67, v71
  v_lshlrev_b32 v184, 16, v184
  v_lshlrev_b32 v176, 16, v176
  v_mul_f32 v176, v176, v184
  v_lshlrev_b32 v177, 16, v177
  v_mul_f32 v177, v177, v184
  v_lshlrev_b32 v178, 16, v178
  v_mul_f32 v178, v178, v184
  v_lshlrev_b32 v179, 16, v179
  v_mul_f32 v179, v179, v184
  v_cvt_pk_bf16_f32 v176, v176, v177
  v_and_b32 v177, 0xffff0000, v176
  v_lshlrev_b32 v176, 16, v176
  v_add_f32 v64, v64, v176
  v_add_f32 v65, v65, v177
  v_cvt_pk_bf16_f32 v178, v178, v179
  v_and_b32 v179, 0xffff0000, v178
  v_lshlrev_b32 v178, 16, v178
  v_add_f32 v66, v66, v178
  v_add_f32 v67, v67, v179
  s_add_u32 s75, s84, 0
  buffer_store_dword v64, v252, s[68:71], s75 offen offset:2048
  s_add_u32 s75, s75, 4096
  buffer_store_dword v65, v252, s[68:71], s75 offen offset:2048
  s_add_u32 s75, s75, 4096
  buffer_store_dword v66, v252, s[68:71], s75 offen offset:2048
  s_add_u32 s75, s75, 4096
  buffer_store_dword v67, v252, s[68:71], s75 offen offset:2048
  ds_read_b64_tr_b16 v[216:217], v242 offset:4608
  ds_read_b64_tr_b16 v[218:219], v242 offset:5632
  ds_read_b64_tr_b16 v[220:221], v242 offset:6656
  ds_read_b64_tr_b16 v[222:223], v242 offset:7680
  v_mfma_f32_32x32x16_bf16 v[0:15], v[144:147], v[208:211], v[0:15]
  v_mfma_f32_32x32x16_bf16 v[16:31], v[144:147], v[212:215], v[16:31]
  v_mfma_f32_32x32x16_bf16 v[32:47], v[148:151], v[208:211], v[32:47]
  v_mfma_f32_32x32x16_bf16 v[48:63], v[148:151], v[212:215], v[48:63]
  s_waitcnt vmcnt(12)
  ds_read_b64_tr_b16 v[208:209], v242 offset:8192
  ds_read_b64_tr_b16 v[210:211], v242 offset:9216
  ds_read_b64_tr_b16 v[212:213], v242 offset:10240
  ds_read_b64_tr_b16 v[214:215], v242 offset:11264
  s_waitcnt lgkmcnt(4)
  v_mfma_f32_32x32x16_bf16 v[0:15], v[152:155], v[216:219], v[0:15]
  v_mfma_f32_32x32x16_bf16 v[16:31], v[152:155], v[220:223], v[16:31]
  v_mfma_f32_32x32x16_bf16 v[32:47], v[156:159], v[216:219], v[32:47]
  v_mfma_f32_32x32x16_bf16 v[48:63], v[156:159], v[220:223], v[48:63]
  s_add_u32 s6, s11, 26624
  s_add_u32 s7, s11, 288768
  buffer_load_dwordx4 v[144:147], v240, s[64:67], s6 offen
  buffer_load_dwordx4 v[148:151], v240, s[64:67], s7 offen
  s_add_u32 m0, s10, 4096
  s_add_u32 s8, s12, 425984
  buffer_load_dwordx4 v241, s[52:55], s8 offen lds
  s_add_u32 m0, s10, 6144
  s_add_u32 s8, s8, 64
  buffer_load_dwordx4 v241, s[52:55], s8 offen lds
  s_add_u32 s6, s11, 27648
  s_add_u32 s7, s11, 289792
  buffer_load_dwordx4 v[152:155], v240, s[64:67], s6 offen
  buffer_load_dwordx4 v[156:159], v240, s[64:67], s7 offen
  s_add_u32 m0, s10, 5120
  s_add_u32 s8, s12, 442368
  buffer_load_dwordx4 v241, s[52:55], s8 offen lds
  s_add_u32 m0, s10, 7168
  s_add_u32 s8, s8, 64
  buffer_load_dwordx4 v241, s[52:55], s8 offen lds
  ds_write_b128 v253, v[96:99] offset:0
  ds_write_b128 v253, v[100:103] offset:1024
  ds_write_b128 v253, v[104:107] offset:2048
  ds_write_b128 v253, v[108:111] offset:3072
  ds_write_b128 v253, v[112:115] offset:4096
  ds_write_b128 v253, v[116:119] offset:5120
  ds_write_b128 v253, v[120:123] offset:6144
  ds_write_b128 v253, v[124:127] offset:7168
  s_waitcnt lgkmcnt(0)
  s_barrier
  ds_read_b64_tr_b16 v[216:217], v242 offset:8704
  ds_read_b64_tr_b16 v[218:219], v242 offset:9728
  ds_read_b64_tr_b16 v[220:221], v242 offset:10752
  ds_read_b64_tr_b16 v[222:223], v242 offset:11776
  v_mfma_f32_32x32x16_bf16 v[0:15], v[160:163], v[208:211], v[0:15]
  v_mfma_f32_32x32x16_bf16 v[16:31], v[160:163], v[212:215], v[16:31]
  v_mfma_f32_32x32x16_bf16 v[32:47], v[164:167], v[208:211], v[32:47]
  v_mfma_f32_32x32x16_bf16 v[48:63], v[164:167], v[212:215], v[48:63]
  s_waitcnt vmcnt(12)
  ds_read_b64_tr_b16 v[208:209], v242 offset:0
  ds_read_b64_tr_b16 v[210:211], v242 offset:1024
  ds_read_b64_tr_b16 v[212:213], v242 offset:2048
  ds_read_b64_tr_b16 v[214:215], v242 offset:3072
  s_waitcnt lgkmcnt(4)
  v_mfma_f32_32x32x16_bf16 v[0:15], v[168:171], v[216:219], v[0:15]
  v_mfma_f32_32x32x16_bf16 v[16:31], v[168:171], v[220:223], v[16:31]
  v_mfma_f32_32x32x16_bf16 v[32:47], v[172:175], v[216:219], v[32:47]
  v_mfma_f32_32x32x16_bf16 v[48:63], v[172:175], v[220:223], v[48:63]
  s_add_u32 s6, s11, 28672
  s_add_u32 s7, s11, 290816
  buffer_load_dwordx4 v[160:163], v240, s[64:67], s6 offen
  buffer_load_dwordx4 v[164:167], v240, s[64:67], s7 offen
  s_add_u32 m0, s10, 8192
  s_add_u32 s8, s12, 458752
  buffer_load_dwordx4 v241, s[52:55], s8 offen lds
  s_add_u32 m0, s10, 10240
  s_add_u32 s8, s8, 64
  buffer_load_dwordx4 v241, s[52:55], s8 offen lds
  s_add_u32 s6, s11, 29696
  s_add_u32 s7, s11, 291840
  buffer_load_dwordx4 v[168:171], v240, s[64:67], s6 offen
  buffer_load_dwordx4 v[172:175], v240, s[64:67], s7 offen
  s_add_u32 m0, s10, 9216
  s_add_u32 s8, s12, 475136
  buffer_load_dwordx4 v241, s[52:55], s8 offen lds
  s_add_u32 m0, s10, 11264
  s_add_u32 s8, s8, 64
  buffer_load_dwordx4 v241, s[52:55], s8 offen lds
  ds_read_b128 v[96:99], v254
  v_add_u32 v250, 20480, v254
  ds_read_b128 v[100:103], v250
  v_add_u32 v250, 40960, v254
  ds_read_b128 v[104:107], v250
  v_add_u32 v250, 61440, v254
  ds_read_b128 v[108:111], v250
  v_add_u32 v250, 81920, v254
  ds_read_b128 v[112:115], v250
  v_add_u32 v250, 102400, v254
  ds_read_b128 v[116:119], v250
  v_add_u32 v250, 122880, v254
  ds_read_b128 v[120:123], v250
  v_add_u32 v250, 143360, v254
  ds_read_b128 v[124:127], v250
  s_waitcnt lgkmcnt(0)
  s_barrier
  v_add_f32 v96, v96, v112
  v_add_f32 v97, v97, v113
  v_add_f32 v98, v98, v114
  v_add_f32 v99, v99, v115
  v_add_f32 v100, v100, v116
  v_add_f32 v101, v101, v117
  v_add_f32 v102, v102, v118
  v_add_f32 v103, v103, v119
  v_add_f32 v104, v104, v120
  v_add_f32 v105, v105, v121
  v_add_f32 v106, v106, v122
  v_add_f32 v107, v107, v123
  v_add_f32 v108, v108, v124
  v_add_f32 v109, v109, v125
  v_add_f32 v110, v110, v126
  v_add_f32 v111, v111, v127
  v_add_f32 v96, v96, v104
  v_add_f32 v97, v97, v105
  v_add_f32 v98, v98, v106
  v_add_f32 v99, v99, v107
  v_add_f32 v100, v100, v108
  v_add_f32 v101, v101, v109
  v_add_f32 v102, v102, v110
  v_add_f32 v103, v103, v111
  v_add_f32 v96, v96, v100
  v_add_f32 v97, v97, v101
  v_add_f32 v98, v98, v102
  v_add_f32 v99, v99, v103
  v_lshlrev_b32 v180, 16, v180
  v_mul_f32 v180, v180, v184
  v_lshlrev_b32 v181, 16, v181
  v_mul_f32 v181, v181, v184
  v_lshlrev_b32 v182, 16, v182
  v_mul_f32 v182, v182, v184
  v_lshlrev_b32 v183, 16, v183
  v_mul_f32 v183, v183, v184
  v_cvt_pk_bf16_f32 v180, v180, v181
  v_and_b32 v181, 0xffff0000, v180
  v_lshlrev_b32 v180, 16, v180
  v_add_f32 v96, v96, v180
  v_add_f32 v97, v97, v181
  v_cvt_pk_bf16_f32 v182, v182, v183
  v_and_b32 v183, 0xffff0000, v182
  v_lshlrev_b32 v182, 16, v182
  v_add_f32 v98, v98, v182
  v_add_f32 v99, v99, v183
  s_add_u32 s75, s84, 131072
  buffer_store_dword v96, v252, s[68:71], s75 offen offset:2048
  s_add_u32 s75, s75, 4096
  buffer_store_dword v97, v252, s[68:71], s75 offen offset:2048
  s_add_u32 s75, s75, 4096
  buffer_store_dword v98, v252, s[68:71], s75 offen offset:2048
  s_add_u32 s75, s75, 4096
  buffer_store_dword v99, v252, s[68:71], s75 offen offset:2048
  ds_read_b64_tr_b16 v[216:217], v242 offset:512
  ds_read_b64_tr_b16 v[218:219], v242 offset:1536
  ds_read_b64_tr_b16 v[220:221], v242 offset:2560
  ds_read_b64_tr_b16 v[222:223], v242 offset:3584
  v_mfma_f32_32x32x16_bf16 v[0:15], v[128:131], v[208:211], v[0:15]
  v_mfma_f32_32x32x16_bf16 v[16:31], v[128:131], v[212:215], v[16:31]
  v_mfma_f32_32x32x16_bf16 v[32:47], v[132:135], v[208:211], v[32:47]
  v_mfma_f32_32x32x16_bf16 v[48:63], v[132:135], v[212:215], v[48:63]
  s_waitcnt vmcnt(12)
  ds_read_b64_tr_b16 v[208:209], v242 offset:4096
  ds_read_b64_tr_b16 v[210:211], v242 offset:5120
  ds_read_b64_tr_b16 v[212:213], v242 offset:6144
  ds_read_b64_tr_b16 v[214:215], v242 offset:7168
  s_waitcnt lgkmcnt(4)
  v_mfma_f32_32x32x16_bf16 v[0:15], v[136:139], v[216:219], v[0:15]
  v_mfma_f32_32x32x16_bf16 v[16:31], v[136:139], v[220:223], v[16:31]
  v_mfma_f32_32x32x16_bf16 v[32:47], v[140:143], v[216:219], v[32:47]
  v_mfma_f32_32x32x16_bf16 v[48:63], v[140:143], v[220:223], v[48:63]
  s_add_u32 s6, s11, 30720
  s_add_u32 s7, s11, 292864
  buffer_load_dwordx4 v[128:131], v240, s[64:67], s6 offen
  buffer_load_dwordx4 v[132:135], v240, s[64:67], s7 offen
  s_add_u32 m0, s10, 0
  s_add_u32 s8, s12, 491520
  buffer_load_dwordx4 v241, s[52:55], s8 offen lds
  s_add_u32 m0, s10, 2048
  s_add_u32 s8, s8, 64
  buffer_load_dwordx4 v241, s[52:55], s8 offen lds
  s_add_u32 s6, s11, 31744
  s_add_u32 s7, s11, 293888
  buffer_load_dwordx4 v[136:139], v240, s[64:67], s6 offen
  buffer_load_dwordx4 v[140:143], v240, s[64:67], s7 offen
  s_add_u32 m0, s10, 1024
  s_add_u32 s8, s12, 507904
  buffer_load_dwordx4 v241, s[52:55], s8 offen lds
  s_add_u32 m0, s10, 3072
  s_add_u32 s8, s8, 64
  buffer_load_dwordx4 v241, s[52:55], s8 offen lds
  ds_read_b64_tr_b16 v[216:217], v242 offset:4608
  ds_read_b64_tr_b16 v[218:219], v242 offset:5632
  ds_read_b64_tr_b16 v[220:221], v242 offset:6656
  ds_read_b64_tr_b16 v[222:223], v242 offset:7680
  s_waitcnt lgkmcnt(4)
  v_mfma_f32_32x32x16_bf16 v[0:15], v[144:147], v[208:211], v[0:15]
  v_mfma_f32_32x32x16_bf16 v[16:31], v[144:147], v[212:215], v[16:31]
  v_mfma_f32_32x32x16_bf16 v[32:47], v[148:151], v[208:211], v[32:47]
  v_mfma_f32_32x32x16_bf16 v[48:63], v[148:151], v[212:215], v[48:63]
  s_waitcnt vmcnt(12)
  ds_read_b64_tr_b16 v[208:209], v242 offset:8192
  ds_read_b64_tr_b16 v[210:211], v242 offset:9216
  ds_read_b64_tr_b16 v[212:213], v242 offset:10240
  ds_read_b64_tr_b16 v[214:215], v242 offset:11264
  s_waitcnt lgkmcnt(4)
  v_mfma_f32_32x32x16_bf16 v[0:15], v[152:155], v[216:219], v[0:15]
  v_mfma_f32_32x32x16_bf16 v[16:31], v[152:155], v[220:223], v[16:31]
  v_mfma_f32_32x32x16_bf16 v[32:47], v[156:159], v[216:219], v[32:47]
  v_mfma_f32_32x32x16_bf16 v[48:63], v[156:159], v[220:223], v[48:63]
  ds_read_b64_tr_b16 v[216:217], v242 offset:8704
  ds_read_b64_tr_b16 v[218:219], v242 offset:9728
  ds_read_b64_tr_b16 v[220:221], v242 offset:10752
  ds_read_b64_tr_b16 v[222:223], v242 offset:11776
  s_waitcnt lgkmcnt(4)
  v_mfma_f32_32x32x16_bf16 v[0:15], v[160:163], v[208:211], v[0:15]
  v_mfma_f32_32x32x16_bf16 v[16:31], v[160:163], v[212:215], v[16:31]
  v_mfma_f32_32x32x16_bf16 v[32:47], v[164:167], v[208:211], v[32:47]
  v_mfma_f32_32x32x16_bf16 v[48:63], v[164:167], v[212:215], v[48:63]
  s_waitcnt vmcnt(0)
  ds_read_b64_tr_b16 v[208:209], v242 offset:0
  ds_read_b64_tr_b16 v[210:211], v242 offset:1024
  ds_read_b64_tr_b16 v[212:213], v242 offset:2048
  ds_read_b64_tr_b16 v[214:215], v242 offset:3072
  s_waitcnt lgkmcnt(4)
  v_mfma_f32_32x32x16_bf16 v[0:15], v[168:171], v[216:219], v[0:15]
  v_mfma_f32_32x32x16_bf16 v[16:31], v[168:171], v[220:223], v[16:31]
  v_mfma_f32_32x32x16_bf16 v[32:47], v[172:175], v[216:219], v[32:47]
  v_mfma_f32_32x32x16_bf16 v[48:63], v[172:175], v[220:223], v[48:63]
  ds_read_b64_tr_b16 v[216:217], v242 offset:512
  ds_read_b64_tr_b16 v[218:219], v242 offset:1536
  ds_read_b64_tr_b16 v[220:221], v242 offset:2560
  ds_read_b64_tr_b16 v[222:223], v242 offset:3584
  s_waitcnt lgkmcnt(4)
  v_mfma_f32_32x32x16_bf16 v[0:15], v[128:131], v[208:211], v[0:15]
  v_mfma_f32_32x32x16_bf16 v[16:31], v[128:131], v[212:215], v[16:31]
  v_mfma_f32_32x32x16_bf16 v[32:47], v[132:135], v[208:211], v[32:47]
  v_mfma_f32_32x32x16_bf16 v[48:63], v[132:135], v[212:215], v[48:63]
  s_waitcnt lgkmcnt(0)
  v_mfma_f32_32x32x16_bf16 v[0:15], v[136:139], v[216:219], v[0:15]
  v_mfma_f32_32x32x16_bf16 v[16:31], v[136:139], v[220:223], v[16:31]
  v_mfma_f32_32x32x16_bf16 v[32:47], v[140:143], v[216:219], v[32:47]
  v_mfma_f32_32x32x16_bf16 v[48:63], v[140:143], v[220:223], v[48:63]
  v_add_u32 v250, s10, v240
  s_nop 7
  s_nop 3
  ds_write_b128 v250, v[0:3] offset:0
  ds_write_b128 v250, v[4:7] offset:1024
  ds_write_b128 v250, v[8:11] offset:2048
  ds_write_b128 v250, v[12:15] offset:3072
  ds_write_b128 v250, v[16:19] offset:4096
  ds_write_b128 v250, v[20:23] offset:5120
  ds_write_b128 v250, v[24:27] offset:6144
  ds_write_b128 v250, v[28:31] offset:7168
  ds_write_b128 v250, v[32:35] offset:8192
  ds_write_b128 v250, v[36:39] offset:9216
  ds_write_b128 v250, v[40:43] offset:10240
  ds_write_b128 v250, v[44:47] offset:11264
  ds_write_b128 v250, v[48:51] offset:12288
  ds_write_b128 v250, v[52:55] offset:13312
  ds_write_b128 v250, v[56:59] offset:14336
  ds_write_b128 v250, v[60:63] offset:15360
  v_add_u32 v129, 61440, v249
  v_add_u32 v130, 122880, v249
  s_waitcnt lgkmcnt(0)
  s_barrier
  ds_read_b128 v[0:3], v249 offset:0
  ds_read_b128 v[4:7], v249 offset:1024
  ds_read_b128 v[8:11], v249 offset:20480
  ds_read_b128 v[12:15], v249 offset:21504
  ds_read_b128 v[16:19], v249 offset:40960
  ds_read_b128 v[20:23], v249 offset:41984
  ds_read_b128 v[24:27], v129 offset:0
  ds_read_b128 v[28:31], v129 offset:1024
  ds_read_b128 v[32:35], v129 offset:20480
  ds_read_b128 v[36:39], v129 offset:21504
  ds_read_b128 v[40:43], v129 offset:40960
  ds_read_b128 v[44:47], v129 offset:41984
  ds_read_b128 v[48:51], v130 offset:0
  ds_read_b128 v[52:55], v130 offset:1024
  ds_read_b128 v[56:59], v130 offset:20480
  ds_read_b128 v[60:63], v130 offset:21504
  s_waitcnt lgkmcnt(0)
  v_add_f32 v0, v0, v32
  v_add_f32 v1, v1, v33
  v_add_f32 v2, v2, v34
  v_add_f32 v3, v3, v35
  v_add_f32 v4, v4, v36
  v_add_f32 v5, v5, v37
  v_add_f32 v6, v6, v38
  v_add_f32 v7, v7, v39
  v_add_f32 v8, v8, v40
  v_add_f32 v9, v9, v41
  v_add_f32 v10, v10, v42
  v_add_f32 v11, v11, v43
  v_add_f32 v12, v12, v44
  v_add_f32 v13, v13, v45
  v_add_f32 v14, v14, v46
  v_add_f32 v15, v15, v47
  v_add_f32 v16, v16, v48
  v_add_f32 v17, v17, v49
  v_add_f32 v18, v18, v50
  v_add_f32 v19, v19, v51
  v_add_f32 v20, v20, v52
  v_add_f32 v21, v21, v53
  v_add_f32 v22, v22, v54
  v_add_f32 v23, v23, v55
  v_add_f32 v24, v24, v56
  v_add_f32 v25, v25, v57
  v_add_f32 v26, v26, v58
  v_add_f32 v27, v27, v59
  v_add_f32 v28, v28, v60
  v_add_f32 v29, v29, v61
  v_add_f32 v30, v30, v62
  v_add_f32 v31, v31, v63
  v_add_f32 v0, v0, v16
  v_add_f32 v1, v1, v17
  v_add_f32 v2, v2, v18
  v_add_f32 v3, v3, v19
  v_add_f32 v4, v4, v20
  v_add_f32 v5, v5, v21
  v_add_f32 v6, v6, v22
  v_add_f32 v7, v7, v23
  v_add_f32 v8, v8, v24
  v_add_f32 v9, v9, v25
  v_add_f32 v10, v10, v26
  v_add_f32 v11, v11, v27
  v_add_f32 v12, v12, v28
  v_add_f32 v13, v13, v29
  v_add_f32 v14, v14, v30
  v_add_f32 v15, v15, v31
  v_add_f32 v0, v0, v8
  v_add_f32 v1, v1, v9
  v_add_f32 v2, v2, v10
  v_add_f32 v3, v3, v11
  v_add_f32 v4, v4, v12
  v_add_f32 v5, v5, v13
  v_add_f32 v6, v6, v14
  v_add_f32 v7, v7, v15
  v_cvt_pk_bf16_f32 v128, v0, v1
  v_and_b32 v129, 0xffff0000, v128
  v_lshlrev_b32 v128, 16, v128
  v_cvt_pk_bf16_f32 v130, v2, v3
  v_and_b32 v131, 0xffff0000, v130
  v_lshlrev_b32 v130, 16, v130
  v_cvt_pk_bf16_f32 v132, v4, v5
  v_and_b32 v133, 0xffff0000, v132
  v_lshlrev_b32 v132, 16, v132
  v_cvt_pk_bf16_f32 v134, v6, v7
  v_and_b32 v135, 0xffff0000, v134
  v_lshlrev_b32 v134, 16, v134
  s_add_u32 s75, s73, 0
  buffer_store_dword v128, v245, s[68:71], s75 offen
  s_add_u32 s75, s75, 4096
  buffer_store_dword v129, v245, s[68:71], s75 offen
  s_add_u32 s75, s75, 4096
  buffer_store_dword v130, v245, s[68:71], s75 offen
  s_add_u32 s75, s75, 4096
  buffer_store_dword v131, v245, s[68:71], s75 offen
  s_add_u32 s75, s73, 32768
  buffer_store_dword v132, v245, s[68:71], s75 offen
  s_add_u32 s75, s75, 4096
  buffer_store_dword v133, v245, s[68:71], s75 offen
  s_add_u32 s75, s75, 4096
  buffer_store_dword v134, v245, s[68:71], s75 offen
  s_add_u32 s75, s75, 4096
  buffer_store_dword v135, v245, s[68:71], s75 offen
K3_exit:
  s_endpgm
K3e:

.section .rodata,"a"
.p2align 6
.amdhsa_kernel k3_kernel
  .amdhsa_next_free_vgpr 256
  .amdhsa_next_free_sgpr 102
  .amdhsa_accum_offset 256
  .amdhsa_group_segment_fixed_size 0
  .amdhsa_kernarg_size 144
  .amdhsa_user_sgpr_count 2
  .amdhsa_user_sgpr_kernarg_segment_ptr 1
  .amdhsa_system_sgpr_workgroup_id_x 1
.end_amdhsa_kernel
```
